```python
import torch

def _softmax(x, axis=-1):
    return torch.softmax(x, dim=axis)
def _gelu(x):
    return torch.nn.functional.gelu(x, approximate="tanh")
def _silu(x):
    return torch.nn.functional.silu(x)
def _sigmoid(x):
    return torch.sigmoid(x)
def _layernorm(x, axis=-1, eps=1e-5):
    m = x.mean(dim=axis, keepdim=True)
    v = x.var(dim=axis, keepdim=True, unbiased=False)
    return (x - m) / torch.sqrt(v + eps)
def _scatter_add(tgt, idx, src, axis=0):
    return tgt.clone().index_add_(axis, idx, src)
def _segment_sum(src, seg, n):
    out = torch.zeros((n,) + src.shape[1:], dtype=src.dtype)
    return out.index_add_(0, seg, src)
def _pad(x, pw):
    flat = tuple(v for pair in reversed(pw) for v in pair)
    return torch.nn.functional.pad(x, flat)

kernel_name = 'recurrent_scan__mha_block_cached__geglu_ffn__prompt'

def setup_inputs():

    _w = (lambda a: (lambda t: t.to(torch.bfloat16) if t.is_floating_point() else t)(torch.as_tensor(a)))
    def _A_setup():
        B, Sq, D = 1, 2048, 576
        H, Sk, Dh = 32, 2048, 128
        return {
            "x": _w((lambda *s: torch.randn(*s, dtype=torch.bfloat16) * 0.05)(B, Sq, D)),
            "k_cache": _w((lambda *s: torch.randn(*s, dtype=torch.bfloat16) * 0.8)(B, H, Sk, Dh)),
            "v_cache": _w((lambda *s: torch.randn(*s, dtype=torch.bfloat16) * 0.2)(B, H, Sk, Dh)),
            "wq": _w((lambda *s: torch.randn(*s, dtype=torch.bfloat16) * 0.8)(D, H * Dh) * (D ** -0.5)),
            "wo": _w((lambda *s: torch.randn(*s, dtype=torch.bfloat16) * 0.2)(H * Dh, D) * ((H * Dh) ** -0.5)),
        }
    _A_in = _A_setup()

    def _B_setup():
        B, S, D, F = 1, 2048, 576, 4608
        return {
            "x": _w((lambda *s: torch.randn(*s, dtype=torch.bfloat16) * 0.05)(B, S, D)),
            "w_gate": _w((lambda *s: torch.randn(*s, dtype=torch.bfloat16) * 0.1)(D, F)),
            "w_up": _w((lambda *s: torch.randn(*s, dtype=torch.bfloat16) * 0.1)(D, F)),
            "w_down": _w((lambda *s: torch.randn(*s, dtype=torch.bfloat16) * 0.1)(F, D)),
        }
    _B_in = _B_setup()

    return {
        "A_x": _A_in["x"],
        "A_k_cache": _A_in["k_cache"],
        "A_v_cache": _A_in["v_cache"],
        "A_wq": _A_in["wq"],
        "A_wo": _A_in["wo"],
        "B_x": _B_in["x"],
        "B_w_gate": _B_in["w_gate"],
        "B_w_up": _B_in["w_up"],
        "B_w_down": _B_in["w_down"],
    }

def reference(A_x, A_k_cache, A_v_cache, A_wq, A_wo, B_x, B_w_gate, B_w_up, B_w_down):
    def _A_ref(x, k_cache, v_cache, wq, wo):
        B, Sq, D = x.shape
        H, Dh = 32, 128
        q = (lambda x, *d: x.permute(*d))((x @ wq).reshape(B, Sq, H, Dh), 0, 2, 1, 3)
        scores = torch.einsum("bhqd,bhkd->bhqk", q, k_cache) * (Dh ** -0.5)
        p = _softmax(scores, axis=-1)
        o = torch.einsum("bhqk,bhkd->bhqd", p, v_cache)
        return (lambda x, *d: x.permute(*d))(o, 0, 2, 1, 3).reshape(B, Sq, H * Dh) @ wo

    def _B_ref(x, w_gate, w_up, w_down):
        return (_gelu(x @ w_gate) * (x @ w_up)) @ w_down

    x = A_x
    xn = _layernorm(x, axis=-1)
    s = _A_ref(xn, A_k_cache, A_v_cache, A_wq, A_wo)
    g = _silu(_B_ref(xn, B_w_gate, B_w_up, B_w_down))
    return x + s * g
```

```asm
; @launch grid=(256,1,1) block=(256,1,1) lds=159744
.amdgcn_target "amdgcn-amd-amdhsa--gfx950"
.text
.globl recurrent_scan__mha_block_cached__geglu_ffn__prompt_kernel
.p2align 8
.type recurrent_scan__mha_block_cached__geglu_ffn__prompt_kernel,@function
recurrent_scan__mha_block_cached__geglu_ffn__prompt_kernel:
    s_cmp_ge_u32 s2, 256
    s_cbranch_scc1 L_k2_done
    s_load_dwordx2 s[6:7], s[0:1], 0
    s_load_dwordx4 s[68:71], s[0:1], 8
    s_load_dwordx4 s[72:75], s[0:1], 24
    s_load_dwordx4 s[76:79], s[0:1], 48
    s_load_dwordx2 s[64:65], s[0:1], 64
    s_load_dwordx2 s[66:67], s[0:1], 88
    s_load_dwordx2 s[62:63], s[0:1], 80
    s_getpc_b64 s[24:25]
L_k2_cp:
    s_lshr_b32 s3, s2, 5
    s_mul_i32 s4, s3, 33
    s_andn2_b32 s3, 1, s3
    s_lshl_b32 s3, s3, 3
    s_add_u32 s54, s3, s4
    s_mov_b32 s26, L_k2_loopB_end-L_k2_cp
    s_cmp_eq_u32 s54, s2
    s_cselect_b32 s26, 0, s26
    s_mov_b32 s27, 0x00020000
    v_lshlrev_b32 v90, 7, v0
    buffer_load_dword v91, v90, s[24:27], 0 offen
    v_lshrrev_b32 v1, 6, v0
    v_and_b32 v18, 63, v0
    v_readfirstlane_b32 s40, v1
    v_lshlrev_b32 v98, 2, v0
    s_and_b32 s3, s2, 7
    s_lshl_b32 s3, s3, 2
    s_bfe_u32 s4, s2, 0x20003
    s_add_u32 s41, s3, s4
    s_lshr_b32 s42, s2, 5
    s_and_b32 s52, s41, 1
    v_lshrrev_b32 v100, 4, v18
    v_and_b32 v101, 15, v18
    s_add_u32 s53, s42, s41
    s_and_b32 s53, s53, 1
    s_lshl_b32 s3, s40, 2
    v_add_u32 v110, s3, v100
    v_mul_u32_u24 v111, 1152, v110
    v_lshrrev_b32 v112, 2, v101
    v_and_b32 v113, 3, v101
    v_lshl_add_u32 v114, v101, 3, v111
    v_lshl_add_u32 v111, v112, 6, v111
    v_lshl_add_u32 v111, v113, 3, v111
    s_lshl_b32 s3, s42, 4
    s_lshr_b32 s4, s41, 1
    s_add_u32 s5, s3, s4
    s_mul_i32 s3, s5, 18432
    s_waitcnt lgkmcnt(0)
    s_add_u32 s28, s6, s3
    s_addc_u32 s29, s7, 0
    s_mov_b32 s30, 18432
    s_mov_b32 s31, 0x00020000
    s_cmp_lg_u32 s53, 0
    s_cbranch_scc1 L_k2_nox
    buffer_load_dwordx2 v[120:121], v111, s[28:31], 0 offen offset:0
    buffer_load_dwordx2 v[122:123], v111, s[28:31], 0 offen offset:32
    buffer_load_dwordx2 v[124:125], v111, s[28:31], 0 offen offset:256
    buffer_load_dwordx2 v[126:127], v111, s[28:31], 0 offen offset:288
    buffer_load_dwordx2 v[128:129], v111, s[28:31], 0 offen offset:512
    buffer_load_dwordx2 v[130:131], v111, s[28:31], 0 offen offset:544
    buffer_load_dwordx2 v[132:133], v111, s[28:31], 0 offen offset:768
    buffer_load_dwordx2 v[134:135], v111, s[28:31], 0 offen offset:800
    buffer_load_dwordx2 v[136:137], v114, s[28:31], 0 offen offset:1024
L_k2_nox:
    s_lshl_b32 s3, s42, 2
    s_add_u32 s36, s62, s3
    s_addc_u32 s37, s63, 0
    s_mov_b32 s38, 4
    s_mov_b32 s39, 0x00020000
    s_lshl_b32 s7, s42, 12
    s_add_u32 s7, s7, 3145728
    v_mov_b32 v99, 1
    s_add_u32 s3, s54, s40
    s_cmp_lg_u32 s3, s2
    s_cbranch_scc1 L_k2_noz
    s_cmp_lg_u32 s40, 0
    s_cbranch_scc1 L_k2_noz
    s_add_u32 s28, s66, s7
    s_addc_u32 s29, s67, 0
    s_mov_b32 s30, 4096
    s_mov_b32 s31, 0x00020000
    v_lshlrev_b32 v92, 4, v18
    v_mov_b32 v192, 0
    v_mov_b32 v193, 0
    v_mov_b32 v194, 0
    v_mov_b32 v195, 0
    buffer_store_dwordx4 v[192:195], v92, s[28:31], 0 offen offset:2048 sc1
    buffer_store_dwordx4 v[192:195], v92, s[28:31], 0 offen offset:3072 sc1
    buffer_store_dwordx4 v[192:195], v92, s[28:31], 0 offen offset:0 sc1
    buffer_store_dwordx4 v[192:195], v92, s[28:31], 0 offen offset:1024 sc1
    s_waitcnt vmcnt(0)
    buffer_store_dword v99, v98, s[36:39], 0 offen sc1
L_k2_noz:
    v_add_u32 v90, 0x8000, v90
    buffer_load_dword v91, v90, s[24:27], 0 offen
    s_lshr_b32 s3, s5, 2
    s_mul_i32 s3, s3, 73728
    s_and_b32 s4, s5, 3
    s_lshl_b32 s4, s4, 10
    s_add_u32 s3, s3, s4
    s_add_u32 s32, s66, s3
    s_addc_u32 s33, s67, 0
    s_mov_b32 s34, 70656
    s_mov_b32 s35, 0x00020000
    v_lshlrev_b32 v115, 4, v110
    v_lshl_add_u32 v115, v113, 8, v115
    v_lshrrev_b32 v116, 1, v112
    v_lshl_add_u32 v116, v116, 12, v115
    v_and_b32 v117, 1, v112
    v_lshl_add_u32 v116, v117, 3, v116
    v_lshl_add_u32 v115, v112, 12, v115
    v_lshlrev_b32 v102, 2, v100
    v_xor_b32 v102, v101, v102
    s_lshl_b32 s3, s40, 2
    v_add_u32 v103, s3, v100
    v_lshlrev_b32 v3, 13, v103
    v_lshl_add_u32 v3, v102, 4, v3
    s_lshl_b32 s3, s40, 7
    v_add_u32 v104, s3, v18
    v_mul_u32_u24 v105, 3641, v104
    v_lshrrev_b32 v105, 16, v105
    v_mul_u32_u24 v106, 18, v105
    v_sub_u32 v104, v104, v106
    v_mul_u32_u24 v4, 9216, v105
    v_lshl_add_u32 v4, v104, 4, v4
    s_add_u32 s3, s3, 64
    v_add_u32 v104, s3, v18
    v_mul_u32_u24 v105, 3641, v104
    v_lshrrev_b32 v105, 16, v105
    v_mul_u32_u24 v106, 18, v105
    v_sub_u32 v104, v104, v106
    v_mul_u32_u24 v5, 9216, v105
    v_lshl_add_u32 v5, v104, 4, v5
    v_add_u32 v104, 512, v18
    v_mul_u32_u24 v105, 3641, v104
    v_lshrrev_b32 v105, 16, v105
    v_mul_u32_u24 v106, 18, v105
    v_sub_u32 v104, v104, v106
    v_mul_u32_u24 v6, 9216, v105
    v_lshl_add_u32 v6, v104, 4, v6
    s_lshr_b32 s3, s40, 1
    s_mul_i32 s3, s3, 294912
    v_add_u32 v6, s3, v6
    v_lshlrev_b32 v7, 4, v18
    s_lshl_b32 s55, s40, 12
    s_lshl_b32 s58, s40, 10
    s_lshl_b32 s3, s40, 11
    s_add_u32 s59, s3, 16384
    s_and_b32 s3, s40, 1
    s_mul_i32 s3, s3, 18432
    s_lshr_b32 s4, s40, 1
    s_mul_i32 s4, s4, 9216
    s_add_u32 s3, s3, s4
    s_add_u32 s60, s3, 24576
    s_mov_b32 s43, 0
    s_mov_b32 s44, s58
    s_mov_b32 s45, s59
    s_mov_b32 s46, s60
    s_mov_b32 s47, 0
    s_mov_b32 s48, 0
    s_mov_b32 s49, 294912
    s_mov_b32 s51, 0
    s_mov_b32 s56, 0
    s_mov_b32 s57, 0
    s_mov_b32 s61, 0
    s_lshl_b32 s3, s41, 8
    s_sub_u32 s4, 4718592, s3
    s_add_u32 s12, s72, s3
    s_addc_u32 s13, s73, 0
    s_mov_b32 s14, s4
    s_mov_b32 s15, 0x00020000
    s_mul_i32 s3, s41, 288
    s_sub_u32 s4, 5308416, s3
    s_add_u32 s16, s76, s3
    s_addc_u32 s17, s77, 0
    s_mov_b32 s18, s4
    s_mov_b32 s19, 0x00020000
    s_add_u32 s20, s78, s3
    s_addc_u32 s21, s79, 0
    s_mov_b32 s22, s4
    s_mov_b32 s23, 0x00020000
    s_bitcmp1_b32 s40, 0
    s_cselect_b32 s24, s20, s16
    s_cselect_b32 s25, s21, s17
    s_mov_b32 s26, s4
    s_mov_b32 s27, 0x00020000
    s_lshl_b32 s5, s42, 2
    s_add_u32 s5, s5, s40
    s_mul_i32 s3, s5, 73728
    s_add_u32 s8, s66, s3
    s_addc_u32 s9, s67, 0
    s_mov_b32 s10, 73728
    s_mov_b32 s11, 0x00020000
    s_cmp_lg_u32 s53, 0
    s_cbranch_scc1 L_k2_noln
    s_lshr_b32 s3, s41, 1
    s_lshl_b32 s3, s3, 7
    s_add_u32 s3, s3, s7
    s_add_u32 s3, s3, 2048
    s_add_u32 s28, s66, s3
    s_addc_u32 s29, s67, 0
    s_mov_b32 s30, 4
    s_mov_b32 s31, 0x00020000
    v_mov_b32 v97, 0
    s_waitcnt vmcnt(9)
    v_lshlrev_b32 v140, 16, v120
    v_and_b32 v141, 0xffff0000, v120
    v_lshlrev_b32 v142, 16, v121
    v_and_b32 v143, 0xffff0000, v121
    s_waitcnt vmcnt(8)
    v_lshlrev_b32 v144, 16, v122
    v_and_b32 v145, 0xffff0000, v122
    v_lshlrev_b32 v146, 16, v123
    v_and_b32 v147, 0xffff0000, v123
    s_waitcnt vmcnt(7)
    v_lshlrev_b32 v148, 16, v124
    v_and_b32 v149, 0xffff0000, v124
    v_lshlrev_b32 v150, 16, v125
    v_and_b32 v151, 0xffff0000, v125
    s_waitcnt vmcnt(6)
    v_lshlrev_b32 v152, 16, v126
    v_and_b32 v153, 0xffff0000, v126
    v_lshlrev_b32 v154, 16, v127
    v_and_b32 v155, 0xffff0000, v127
    s_waitcnt vmcnt(5)
    v_lshlrev_b32 v156, 16, v128
    v_and_b32 v157, 0xffff0000, v128
    v_lshlrev_b32 v158, 16, v129
    v_and_b32 v159, 0xffff0000, v129
    s_waitcnt vmcnt(4)
    v_lshlrev_b32 v160, 16, v130
    v_and_b32 v161, 0xffff0000, v130
    v_lshlrev_b32 v162, 16, v131
    v_and_b32 v163, 0xffff0000, v131
    s_waitcnt vmcnt(3)
    v_lshlrev_b32 v164, 16, v132
    v_and_b32 v165, 0xffff0000, v132
    v_lshlrev_b32 v166, 16, v133
    v_and_b32 v167, 0xffff0000, v133
    s_waitcnt vmcnt(2)
    v_lshlrev_b32 v168, 16, v134
    v_and_b32 v169, 0xffff0000, v134
    v_lshlrev_b32 v170, 16, v135
    v_and_b32 v171, 0xffff0000, v135
    s_waitcnt vmcnt(1)
    v_lshlrev_b32 v172, 16, v136
    v_and_b32 v173, 0xffff0000, v136
    v_lshlrev_b32 v174, 16, v137
    v_and_b32 v175, 0xffff0000, v137
    v_pk_add_f32 v[180:181], v[140:141], v[144:145]
    v_pk_add_f32 v[182:183], v[142:143], v[146:147]
    v_pk_add_f32 v[180:181], v[180:181], v[148:149]
    v_pk_add_f32 v[182:183], v[182:183], v[150:151]
    v_pk_add_f32 v[180:181], v[180:181], v[152:153]
    v_pk_add_f32 v[182:183], v[182:183], v[154:155]
    v_pk_add_f32 v[180:181], v[180:181], v[156:157]
    v_pk_add_f32 v[182:183], v[182:183], v[158:159]
    v_pk_add_f32 v[180:181], v[180:181], v[160:161]
    v_pk_add_f32 v[182:183], v[182:183], v[162:163]
    v_pk_add_f32 v[180:181], v[180:181], v[164:165]
    v_pk_add_f32 v[182:183], v[182:183], v[166:167]
    v_pk_add_f32 v[180:181], v[180:181], v[168:169]
    v_pk_add_f32 v[182:183], v[182:183], v[170:171]
    v_pk_add_f32 v[180:181], v[180:181], v[172:173]
    v_pk_add_f32 v[182:183], v[182:183], v[174:175]
    v_pk_add_f32 v[180:181], v[180:181], v[182:183]
    v_add_f32 v180, v180, v181
    s_nop 1
    v_add_f32_dpp v180, v180, v180 row_ror:8 row_mask:0xf bank_mask:0xf
    s_nop 1
    v_add_f32_dpp v180, v180, v180 row_ror:4 row_mask:0xf bank_mask:0xf
    s_nop 1
    v_add_f32_dpp v180, v180, v180 row_ror:2 row_mask:0xf bank_mask:0xf
    s_nop 1
    v_add_f32_dpp v180, v180, v180 row_ror:1 row_mask:0xf bank_mask:0xf
    v_mul_f32 v180, 0xbae38e39, v180
    v_mov_b32 v181, v180
    v_pk_add_f32 v[186:187], v[140:141], v[180:181]
    v_pk_add_f32 v[188:189], v[142:143], v[180:181]
    v_pk_mul_f32 v[182:183], v[186:187], v[186:187]
    v_pk_mul_f32 v[184:185], v[188:189], v[188:189]
    v_pk_add_f32 v[186:187], v[144:145], v[180:181]
    v_pk_add_f32 v[188:189], v[146:147], v[180:181]
    v_pk_fma_f32 v[182:183], v[186:187], v[186:187], v[182:183]
    v_pk_fma_f32 v[184:185], v[188:189], v[188:189], v[184:185]
    v_pk_add_f32 v[186:187], v[148:149], v[180:181]
    v_pk_add_f32 v[188:189], v[150:151], v[180:181]
    v_pk_fma_f32 v[182:183], v[186:187], v[186:187], v[182:183]
    v_pk_fma_f32 v[184:185], v[188:189], v[188:189], v[184:185]
    v_pk_add_f32 v[186:187], v[152:153], v[180:181]
    v_pk_add_f32 v[188:189], v[154:155], v[180:181]
    v_pk_fma_f32 v[182:183], v[186:187], v[186:187], v[182:183]
    v_pk_fma_f32 v[184:185], v[188:189], v[188:189], v[184:185]
    v_pk_add_f32 v[186:187], v[156:157], v[180:181]
    v_pk_add_f32 v[188:189], v[158:159], v[180:181]
    v_pk_fma_f32 v[182:183], v[186:187], v[186:187], v[182:183]
    v_pk_fma_f32 v[184:185], v[188:189], v[188:189], v[184:185]
    v_pk_add_f32 v[186:187], v[160:161], v[180:181]
    v_pk_add_f32 v[188:189], v[162:163], v[180:181]
    v_pk_fma_f32 v[182:183], v[186:187], v[186:187], v[182:183]
    v_pk_fma_f32 v[184:185], v[188:189], v[188:189], v[184:185]
    v_pk_add_f32 v[186:187], v[164:165], v[180:181]
    v_pk_add_f32 v[188:189], v[166:167], v[180:181]
    v_pk_fma_f32 v[182:183], v[186:187], v[186:187], v[182:183]
    v_pk_fma_f32 v[184:185], v[188:189], v[188:189], v[184:185]
    v_pk_add_f32 v[186:187], v[168:169], v[180:181]
    v_pk_add_f32 v[188:189], v[170:171], v[180:181]
    v_pk_fma_f32 v[182:183], v[186:187], v[186:187], v[182:183]
    v_pk_fma_f32 v[184:185], v[188:189], v[188:189], v[184:185]
    v_pk_add_f32 v[186:187], v[172:173], v[180:181]
    v_pk_add_f32 v[188:189], v[174:175], v[180:181]
    v_pk_fma_f32 v[182:183], v[186:187], v[186:187], v[182:183]
    v_pk_fma_f32 v[184:185], v[188:189], v[188:189], v[184:185]
    v_pk_add_f32 v[182:183], v[182:183], v[184:185]
    v_add_f32 v182, v182, v183
    s_nop 1
    v_add_f32_dpp v182, v182, v182 row_ror:8 row_mask:0xf bank_mask:0xf
    s_nop 1
    v_add_f32_dpp v182, v182, v182 row_ror:4 row_mask:0xf bank_mask:0xf
    s_nop 1
    v_add_f32_dpp v182, v182, v182 row_ror:2 row_mask:0xf bank_mask:0xf
    s_nop 1
    v_add_f32_dpp v182, v182, v182 row_ror:1 row_mask:0xf bank_mask:0xf
    buffer_load_dword v96, v97, s[36:39], 0 offen sc1
    v_mul_f32 v182, 0x3ae38e39, v182
    v_cvt_pk_bf16_f32 v181, v180, v182
    v_lshlrev_b32 v180, 16, v181
    v_and_b32 v182, 0xffff0000, v181
    v_mov_b32 v181, v180
    v_add_f32 v182, 0x3727c5ac, v182
    v_cvt_pk_bf16_f32 v182, v182, v182
    v_lshlrev_b32 v182, 16, v182
    v_sqrt_f32 v182, v182
    s_nop 0
    v_cvt_pk_bf16_f32 v182, v182, v182
    v_lshlrev_b32 v182, 16, v182
    v_rcp_f32 v182, v182
    s_nop 0
    v_mov_b32 v183, v182
    v_pk_add_f32 v[140:141], v[140:141], v[180:181]
    v_pk_add_f32 v[142:143], v[142:143], v[180:181]
    v_cvt_pk_bf16_f32 v140, v140, v141
    v_cvt_pk_bf16_f32 v142, v142, v143
    v_and_b32 v141, 0xffff0000, v140
    v_and_b32 v143, 0xffff0000, v142
    v_lshlrev_b32 v140, 16, v140
    v_lshlrev_b32 v142, 16, v142
    v_pk_mul_f32 v[140:141], v[140:141], v[182:183]
    v_pk_mul_f32 v[142:143], v[142:143], v[182:183]
    v_cvt_pk_bf16_f32 v120, v140, v141
    v_cvt_pk_bf16_f32 v121, v142, v143
    v_pk_add_f32 v[144:145], v[144:145], v[180:181]
    v_pk_add_f32 v[146:147], v[146:147], v[180:181]
    v_cvt_pk_bf16_f32 v144, v144, v145
    v_cvt_pk_bf16_f32 v146, v146, v147
    v_and_b32 v145, 0xffff0000, v144
    v_and_b32 v147, 0xffff0000, v146
    v_lshlrev_b32 v144, 16, v144
    v_lshlrev_b32 v146, 16, v146
    v_pk_mul_f32 v[144:145], v[144:145], v[182:183]
    v_pk_mul_f32 v[146:147], v[146:147], v[182:183]
    v_cvt_pk_bf16_f32 v122, v144, v145
    v_cvt_pk_bf16_f32 v123, v146, v147
    s_mov_b32 s3, 0
    buffer_store_dwordx4 v[120:123], v115, s[32:35], s3 offen sc1
    v_pk_add_f32 v[148:149], v[148:149], v[180:181]
    v_pk_add_f32 v[150:151], v[150:151], v[180:181]
    v_cvt_pk_bf16_f32 v148, v148, v149
    v_cvt_pk_bf16_f32 v150, v150, v151
    v_and_b32 v149, 0xffff0000, v148
    v_and_b32 v151, 0xffff0000, v150
    v_lshlrev_b32 v148, 16, v148
    v_lshlrev_b32 v150, 16, v150
    v_pk_mul_f32 v[148:149], v[148:149], v[182:183]
    v_pk_mul_f32 v[150:151], v[150:151], v[182:183]
    v_cvt_pk_bf16_f32 v124, v148, v149
    v_cvt_pk_bf16_f32 v125, v150, v151
    v_pk_add_f32 v[152:153], v[152:153], v[180:181]
    v_pk_add_f32 v[154:155], v[154:155], v[180:181]
    v_cvt_pk_bf16_f32 v152, v152, v153
    v_cvt_pk_bf16_f32 v154, v154, v155
    v_and_b32 v153, 0xffff0000, v152
    v_and_b32 v155, 0xffff0000, v154
    v_lshlrev_b32 v152, 16, v152
    v_lshlrev_b32 v154, 16, v154
    v_pk_mul_f32 v[152:153], v[152:153], v[182:183]
    v_pk_mul_f32 v[154:155], v[154:155], v[182:183]
    v_cvt_pk_bf16_f32 v126, v152, v153
    v_cvt_pk_bf16_f32 v127, v154, v155
    s_mov_b32 s3, 16384
    buffer_store_dwordx4 v[124:127], v115, s[32:35], s3 offen sc1
    v_pk_add_f32 v[156:157], v[156:157], v[180:181]
    v_pk_add_f32 v[158:159], v[158:159], v[180:181]
    v_cvt_pk_bf16_f32 v156, v156, v157
    v_cvt_pk_bf16_f32 v158, v158, v159
    v_and_b32 v157, 0xffff0000, v156
    v_and_b32 v159, 0xffff0000, v158
    v_lshlrev_b32 v156, 16, v156
    v_lshlrev_b32 v158, 16, v158
    v_pk_mul_f32 v[156:157], v[156:157], v[182:183]
    v_pk_mul_f32 v[158:159], v[158:159], v[182:183]
    v_cvt_pk_bf16_f32 v128, v156, v157
    v_cvt_pk_bf16_f32 v129, v158, v159
    v_pk_add_f32 v[160:161], v[160:161], v[180:181]
    v_pk_add_f32 v[162:163], v[162:163], v[180:181]
    v_cvt_pk_bf16_f32 v160, v160, v161
    v_cvt_pk_bf16_f32 v162, v162, v163
    v_and_b32 v161, 0xffff0000, v160
    v_and_b32 v163, 0xffff0000, v162
    v_lshlrev_b32 v160, 16, v160
    v_lshlrev_b32 v162, 16, v162
    v_pk_mul_f32 v[160:161], v[160:161], v[182:183]
    v_pk_mul_f32 v[162:163], v[162:163], v[182:183]
    v_cvt_pk_bf16_f32 v130, v160, v161
    v_cvt_pk_bf16_f32 v131, v162, v163
    s_mov_b32 s3, 32768
    buffer_store_dwordx4 v[128:131], v115, s[32:35], s3 offen sc1
    v_pk_add_f32 v[164:165], v[164:165], v[180:181]
    v_pk_add_f32 v[166:167], v[166:167], v[180:181]
    v_cvt_pk_bf16_f32 v164, v164, v165
    v_cvt_pk_bf16_f32 v166, v166, v167
    v_and_b32 v165, 0xffff0000, v164
    v_and_b32 v167, 0xffff0000, v166
    v_lshlrev_b32 v164, 16, v164
    v_lshlrev_b32 v166, 16, v166
    v_pk_mul_f32 v[164:165], v[164:165], v[182:183]
    v_pk_mul_f32 v[166:167], v[166:167], v[182:183]
    v_cvt_pk_bf16_f32 v132, v164, v165
    v_cvt_pk_bf16_f32 v133, v166, v167
    v_pk_add_f32 v[168:169], v[168:169], v[180:181]
    v_pk_add_f32 v[170:171], v[170:171], v[180:181]
    v_cvt_pk_bf16_f32 v168, v168, v169
    v_cvt_pk_bf16_f32 v170, v170, v171
    v_and_b32 v169, 0xffff0000, v168
    v_and_b32 v171, 0xffff0000, v170
    v_lshlrev_b32 v168, 16, v168
    v_lshlrev_b32 v170, 16, v170
    v_pk_mul_f32 v[168:169], v[168:169], v[182:183]
    v_pk_mul_f32 v[170:171], v[170:171], v[182:183]
    v_cvt_pk_bf16_f32 v134, v168, v169
    v_cvt_pk_bf16_f32 v135, v170, v171
    s_mov_b32 s3, 49152
    buffer_store_dwordx4 v[132:135], v115, s[32:35], s3 offen sc1
    v_pk_add_f32 v[172:173], v[172:173], v[180:181]
    v_pk_add_f32 v[174:175], v[174:175], v[180:181]
    v_cvt_pk_bf16_f32 v172, v172, v173
    v_cvt_pk_bf16_f32 v174, v174, v175
    v_and_b32 v173, 0xffff0000, v172
    v_and_b32 v175, 0xffff0000, v174
    v_lshlrev_b32 v172, 16, v172
    v_lshlrev_b32 v174, 16, v174
    v_pk_mul_f32 v[172:173], v[172:173], v[182:183]
    v_pk_mul_f32 v[174:175], v[174:175], v[182:183]
    v_cvt_pk_bf16_f32 v136, v172, v173
    v_cvt_pk_bf16_f32 v137, v174, v175
    s_mov_b32 s3, 65536
    buffer_store_dwordx2 v[136:137], v116, s[32:35], s3 offen sc1
    s_waitcnt vmcnt(0)
    s_mov_b32 s3, 0
L_k2_zw1:
    v_cmp_eq_u32 vcc, 0, v96
    s_cbranch_vccz L_k2_zw1_ok
    s_sleep 4
    buffer_load_dword v96, v97, s[36:39], 0 offen sc1
    s_add_u32 s3, s3, 1
    s_waitcnt vmcnt(0)
    s_cmp_lt_u32 s3, 0x40000
    s_cbranch_scc1 L_k2_zw1
L_k2_zw1_ok:
    s_barrier
    buffer_store_dword v99, v98, s[28:31], 0 offen sc1
L_k2_noln:
    s_add_u32 m0, s44, 0
    s_add_u32 s50, s47, 0
    buffer_load_dwordx4 v3, s[12:15], s50 offen lds
    s_add_u32 m0, s44, 4096
    s_add_u32 s50, s47, 131072
    buffer_load_dwordx4 v3, s[12:15], s50 offen lds
    s_add_u32 m0, s45, 0
    s_nop 0
    buffer_load_dwordx4 v4, s[16:19], s48 offen lds
    s_add_u32 m0, s45, 1024
    s_nop 0
    buffer_load_dwordx4 v5, s[16:19], s48 offen lds
    s_add_u32 m0, s45, 18432
    s_nop 0
    buffer_load_dwordx4 v4, s[20:23], s48 offen lds
    s_add_u32 m0, s45, 19456
    s_nop 0
    buffer_load_dwordx4 v5, s[20:23], s48 offen lds
    s_mov_b32 m0, s46
    s_nop 0
    buffer_load_dwordx4 v6, s[24:27], s48 offen lds
    s_add_u32 m0, s44, 8192
    s_add_u32 s50, s47, 262144
    buffer_load_dwordx4 v3, s[12:15], s50 offen lds
    s_add_u32 m0, s44, 12288
    s_add_u32 s50, s47, 393216
    buffer_load_dwordx4 v3, s[12:15], s50 offen lds
    s_add_u32 m0, s45, 9216
    s_nop 0
    buffer_load_dwordx4 v4, s[16:19], s49 offen lds
    s_add_u32 m0, s45, 10240
    s_nop 0
    buffer_load_dwordx4 v5, s[16:19], s49 offen lds
    s_add_u32 m0, s45, 27648
    s_nop 0
    buffer_load_dwordx4 v4, s[20:23], s49 offen lds
    s_add_u32 m0, s45, 28672
    s_nop 0
    buffer_load_dwordx4 v5, s[20:23], s49 offen lds
    s_add_u32 s43, s43, 53248
    s_cmp_ge_u32 s43, 159744
    s_cselect_b32 s43, 0, s43
    s_add_u32 s44, s43, s58
    s_add_u32 s45, s43, s59
    s_add_u32 s46, s43, s60
    s_add_u32 s47, s47, 524288
    s_add_u32 s48, s48, 589824
    s_add_u32 s49, s49, 589824
    s_cmp_eq_u32 s53, 0
    s_cbranch_scc1 L_k2_nopf
    s_lshr_b32 s3, s42, 1
    s_lshl_b32 s3, s3, 5
    s_add_u32 s3, s3, 64
    v_lshrrev_b32 v92, 2, v18
    v_add_u32 v92, s3, v92
    v_and_b32 v93, 3, v18
    s_cmp_eq_u32 s40, 1
    s_cbranch_scc1 L_k2_pfq
    v_mul_u32_u24 v92, 9216, v92
    v_mul_u32_u24 v93, 92, v93
    v_add_u32 v92, v92, v93
    s_mov_b32 s3, 147456
    s_cmp_lt_u32 s40, 2
    s_cbranch_scc1 L_k2_nopf
    buffer_load_dword v91, v92, s[24:27], 0 offen
    buffer_load_dword v91, v92, s[24:27], s3 offen
    s_branch L_k2_nopf
L_k2_pfq:
    v_lshlrev_b32 v92, 13, v92
    v_lshl_add_u32 v92, v93, 6, v92
    s_mov_b32 s3, 131072
    buffer_load_dword v91, v92, s[12:15], 0 offen
    buffer_load_dword v91, v92, s[12:15], s3 offen
L_k2_nopf:
    v_lshrrev_b32 v104, 2, v18
    v_and_b32 v105, 3, v104
    v_and_b32 v106, 3, v18
    v_lshlrev_b32 v107, 8, v104
    v_lshl_add_u32 v107, v106, 4, v107
    v_lshl_add_u32 v0, v105, 6, v107
    v_mul_u32_u24 v107, 288, v104
    v_lshl_add_u32 v107, v106, 3, v107
    s_lshl_b32 s3, s52, 5
    s_add_u32 s3, s3, 16384
    v_add_u32 v1, s3, v107
    s_lshl_b32 s3, s52, 8
    s_sub_u32 s3, 16640, s3
    v_add_u32 v2, s3, v107
    s_lshl_b32 s3, s41, 19
    s_add_u32 s32, s70, s3
    s_addc_u32 s33, s71, 0
    s_mov_b32 s34, 524288
    s_mov_b32 s35, 0x00020000
    s_mov_b32 s62, 4294860800
    s_mov_b32 s63, 53248
    s_lshl_b32 s3, s40, 9
    s_add_u32 s3, s3, s7
    s_add_u32 s3, s3, 2048
    s_add_u32 s28, s66, s3
    s_addc_u32 s29, s67, 0
    s_mov_b32 s30, 512
    s_mov_b32 s31, 0x00020000
    v_lshlrev_b32 v95, 7, v113
    s_cmp_eq_u32 s53, 0
    s_cbranch_scc1 L_k2_zw2_ok
    v_mov_b32 v97, 0
    buffer_load_dword v96, v97, s[36:39], 0 offen sc1
    s_waitcnt vmcnt(0)
    s_mov_b32 s3, 0
L_k2_zw2:
    v_cmp_eq_u32 vcc, 0, v96
    s_cbranch_vccz L_k2_zw2_ok
    s_sleep 4
    buffer_load_dword v96, v97, s[36:39], 0 offen sc1
    s_add_u32 s3, s3, 1
    s_waitcnt vmcnt(0)
    s_cmp_lt_u32 s3, 0x40000
    s_cbranch_scc1 L_k2_zw2
L_k2_zw2_ok:
    buffer_load_dword v96, v95, s[28:31], 0 offen sc1
    s_waitcnt vmcnt(0)
    s_mov_b32 s3, 0
L_k2_lnw:
    v_cmp_eq_u32 vcc, 0, v96
    s_cbranch_vccz L_k2_lnw_ok
    s_sleep 4
    buffer_load_dword v96, v95, s[28:31], 0 offen sc1
    s_add_u32 s3, s3, 1
    s_waitcnt vmcnt(0)
    s_cmp_lt_u32 s3, 0x40000
    s_cbranch_scc1 L_k2_lnw
L_k2_lnw_ok:
    buffer_load_dwordx4 a[192:195], v7, s[8:11], s51 offen offset:0 sc1
    buffer_load_dwordx4 a[196:199], v7, s[8:11], s51 offen offset:1024 sc1
    buffer_load_dwordx4 a[200:203], v7, s[8:11], s51 offen offset:2048 sc1
    buffer_load_dwordx4 a[204:207], v7, s[8:11], s51 offen offset:3072 sc1
    s_add_u32 s51, s51, 4096
    buffer_load_dwordx4 a[208:211], v7, s[8:11], s51 offen offset:0 sc1
    buffer_load_dwordx4 a[212:215], v7, s[8:11], s51 offen offset:1024 sc1
    buffer_load_dwordx4 a[216:219], v7, s[8:11], s51 offen offset:2048 sc1
    buffer_load_dwordx4 a[220:223], v7, s[8:11], s51 offen offset:3072 sc1
    s_add_u32 s51, s51, 4096
    s_lshl_b32 s3, s41, 19
    s_add_u32 s28, s68, s3
    s_addc_u32 s29, s69, 0
    s_mov_b32 s30, 524288
    s_mov_b32 s31, 0x00020000
    s_mul_i32 s3, s5, 1114112
    s_add_u32 s3, s3, 4194304
    s_add_u32 s36, s66, s3
    s_addc_u32 s37, s67, 0
    s_mov_b32 s38, 1114112
    s_mov_b32 s39, 0x00020000
    s_barrier
    ds_read_b64_tr_b16 v[8:9], v0 offset:0
    ds_read_b64_tr_b16 v[10:11], v0 offset:4096
    ds_read_b64_tr_b16 v[12:13], v0 offset:8192
    ds_read_b64_tr_b16 v[14:15], v0 offset:12288
    s_mov_b32 s53, 0
    s_waitcnt vmcnt(0) lgkmcnt(0)
    v_mfma_f32_16x16x32_bf16 a[0:3], v[8:11], a[192:195], 0
    ds_read_b64_tr_b16 v[16:17], v0 offset:8
    ds_read_b64_tr_b16 v[18:19], v0 offset:4104
    v_mfma_f32_16x16x32_bf16 a[0:3], v[12:15], a[208:211], a[0:3]
    ds_read_b64_tr_b16 v[20:21], v0 offset:8200
    ds_read_b64_tr_b16 v[22:23], v0 offset:12296
    v_mfma_f32_16x16x32_bf16 a[4:7], v[12:15], a[212:215], 0
    v_mfma_f32_16x16x32_bf16 a[4:7], v[8:11], a[196:199], a[4:7]
    v_xor_b32 v0, 0x40, v0
    v_mfma_f32_16x16x32_bf16 a[8:11], v[8:11], a[200:203], 0
    ds_read_b64_tr_b16 v[24:25], v0 offset:0
    ds_read_b64_tr_b16 v[26:27], v0 offset:4096
    v_mfma_f32_16x16x32_bf16 a[8:11], v[12:15], a[216:219], a[8:11]
    ds_read_b64_tr_b16 v[28:29], v0 offset:8192
    ds_read_b64_tr_b16 v[30:31], v0 offset:12288
    v_mfma_f32_16x16x32_bf16 a[12:15], v[12:15], a[220:223], 0
    v_mfma_f32_16x16x32_bf16 a[12:15], v[8:11], a[204:207], a[12:15]
    s_add_u32 m0, s44, 0
    s_add_u32 s50, s47, 0
    s_waitcnt lgkmcnt(4)
    v_mfma_f32_16x16x32_bf16 a[16:19], v[16:19], a[192:195], 0
    ds_read_b64_tr_b16 v[8:9], v0 offset:8
    v_mfma_f32_16x16x32_bf16 a[16:19], v[20:23], a[208:211], a[16:19]
    ds_read_b64_tr_b16 v[10:11], v0 offset:4104
    v_mfma_f32_16x16x32_bf16 a[20:23], v[20:23], a[212:215], 0
    buffer_load_dwordx4 v3, s[12:15], s50 offen lds
    v_mfma_f32_16x16x32_bf16 a[20:23], v[16:19], a[196:199], a[20:23]
    s_add_u32 m0, s44, 4096
    s_add_u32 s50, s47, 131072
    v_mfma_f32_16x16x32_bf16 a[24:27], v[16:19], a[200:203], 0
    ds_read_b64_tr_b16 v[12:13], v0 offset:8200
    v_mfma_f32_16x16x32_bf16 a[24:27], v[20:23], a[216:219], a[24:27]
    ds_read_b64_tr_b16 v[14:15], v0 offset:12296
    v_mfma_f32_16x16x32_bf16 a[28:31], v[20:23], a[220:223], 0
    buffer_load_dwordx4 v3, s[12:15], s50 offen lds
    v_mfma_f32_16x16x32_bf16 a[28:31], v[16:19], a[204:207], a[28:31]
    s_add_u32 m0, s45, 0
    v_xor_b32 v0, 0xc0, v0
    s_waitcnt lgkmcnt(4)
    v_mfma_f32_16x16x32_bf16 a[32:35], v[24:27], a[192:195], 0
    ds_read_b64_tr_b16 v[16:17], v0 offset:0
    v_mfma_f32_16x16x32_bf16 a[32:35], v[28:31], a[208:211], a[32:35]
    ds_read_b64_tr_b16 v[18:19], v0 offset:4096
    v_mfma_f32_16x16x32_bf16 a[36:39], v[28:31], a[212:215], 0
    buffer_load_dwordx4 v4, s[16:19], s48 offen lds
    v_mfma_f32_16x16x32_bf16 a[36:39], v[24:27], a[196:199], a[36:39]
    s_add_u32 m0, s45, 1024
    v_mfma_f32_16x16x32_bf16 a[40:43], v[24:27], a[200:203], 0
    ds_read_b64_tr_b16 v[20:21], v0 offset:8192
    v_mfma_f32_16x16x32_bf16 a[40:43], v[28:31], a[216:219], a[40:43]
    ds_read_b64_tr_b16 v[22:23], v0 offset:12288
    v_mfma_f32_16x16x32_bf16 a[44:47], v[28:31], a[220:223], 0
    buffer_load_dwordx4 v5, s[16:19], s48 offen lds
    v_mfma_f32_16x16x32_bf16 a[44:47], v[24:27], a[204:207], a[44:47]
    s_add_u32 m0, s45, 18432
    s_waitcnt lgkmcnt(4)
    v_mfma_f32_16x16x32_bf16 a[48:51], v[8:11], a[192:195], 0
    ds_read_b64_tr_b16 v[24:25], v0 offset:8
    v_mfma_f32_16x16x32_bf16 a[48:51], v[12:15], a[208:211], a[48:51]
    ds_read_b64_tr_b16 v[26:27], v0 offset:4104
    v_mfma_f32_16x16x32_bf16 a[52:55], v[12:15], a[212:215], 0
    buffer_load_dwordx4 v4, s[20:23], s48 offen lds
    v_mfma_f32_16x16x32_bf16 a[52:55], v[8:11], a[196:199], a[52:55]
    s_add_u32 m0, s45, 19456
    v_mfma_f32_16x16x32_bf16 a[56:59], v[8:11], a[200:203], 0
    ds_read_b64_tr_b16 v[28:29], v0 offset:8200
    v_mfma_f32_16x16x32_bf16 a[56:59], v[12:15], a[216:219], a[56:59]
    ds_read_b64_tr_b16 v[30:31], v0 offset:12296
    v_mfma_f32_16x16x32_bf16 a[60:63], v[12:15], a[220:223], 0
    buffer_load_dwordx4 v5, s[20:23], s48 offen lds
    v_mfma_f32_16x16x32_bf16 a[60:63], v[8:11], a[204:207], a[60:63]
    s_mov_b32 m0, s46
    v_xor_b32 v0, 0x40, v0
    s_waitcnt lgkmcnt(4)
    v_mfma_f32_16x16x32_bf16 a[64:67], v[16:19], a[192:195], 0
    ds_read_b64_tr_b16 v[8:9], v0 offset:0
    v_mfma_f32_16x16x32_bf16 a[64:67], v[20:23], a[208:211], a[64:67]
    ds_read_b64_tr_b16 v[10:11], v0 offset:4096
    v_mfma_f32_16x16x32_bf16 a[68:71], v[20:23], a[212:215], 0
    buffer_load_dwordx4 v6, s[24:27], s48 offen lds
    v_mfma_f32_16x16x32_bf16 a[68:71], v[16:19], a[196:199], a[68:71]
    s_add_u32 m0, s44, 8192
    s_add_u32 s50, s47, 262144
    v_mfma_f32_16x16x32_bf16 a[72:75], v[16:19], a[200:203], 0
    ds_read_b64_tr_b16 v[12:13], v0 offset:8192
    v_mfma_f32_16x16x32_bf16 a[72:75], v[20:23], a[216:219], a[72:75]
    ds_read_b64_tr_b16 v[14:15], v0 offset:12288
    v_mfma_f32_16x16x32_bf16 a[76:79], v[20:23], a[220:223], 0
    buffer_load_dwordx4 v3, s[12:15], s50 offen lds
    v_mfma_f32_16x16x32_bf16 a[76:79], v[16:19], a[204:207], a[76:79]
    s_add_u32 m0, s44, 12288
    s_add_u32 s50, s47, 393216
    s_waitcnt lgkmcnt(4)
    v_mfma_f32_16x16x32_bf16 a[80:83], v[24:27], a[192:195], 0
    ds_read_b64_tr_b16 v[16:17], v0 offset:8
    v_mfma_f32_16x16x32_bf16 a[80:83], v[28:31], a[208:211], a[80:83]
    ds_read_b64_tr_b16 v[18:19], v0 offset:4104
    v_mfma_f32_16x16x32_bf16 a[84:87], v[28:31], a[212:215], 0
    buffer_load_dwordx4 v3, s[12:15], s50 offen lds
    v_mfma_f32_16x16x32_bf16 a[84:87], v[24:27], a[196:199], a[84:87]
    s_add_u32 m0, s45, 9216
    v_mfma_f32_16x16x32_bf16 a[88:91], v[24:27], a[200:203], 0
    ds_read_b64_tr_b16 v[20:21], v0 offset:8200
    v_mfma_f32_16x16x32_bf16 a[88:91], v[28:31], a[216:219], a[88:91]
    ds_read_b64_tr_b16 v[22:23], v0 offset:12296
    v_mfma_f32_16x16x32_bf16 a[92:95], v[28:31], a[220:223], 0
    buffer_load_dwordx4 v4, s[16:19], s49 offen lds
    v_mfma_f32_16x16x32_bf16 a[92:95], v[24:27], a[204:207], a[92:95]
    s_add_u32 m0, s45, 10240
    v_xor_b32 v0, 0xc0, v0
    s_waitcnt lgkmcnt(4)
    v_mfma_f32_16x16x32_bf16 a[96:99], v[8:11], a[192:195], 0
    ds_read_b64_tr_b16 v[24:25], v1 offset:0
    v_mfma_f32_16x16x32_bf16 a[96:99], v[12:15], a[208:211], a[96:99]
    ds_read_b64_tr_b16 v[26:27], v1 offset:4608
    v_mfma_f32_16x16x32_bf16 a[100:103], v[12:15], a[212:215], 0
    buffer_load_dwordx4 v5, s[16:19], s49 offen lds
    v_mfma_f32_16x16x32_bf16 a[100:103], v[8:11], a[196:199], a[100:103]
    s_add_u32 m0, s45, 27648
    v_mfma_f32_16x16x32_bf16 a[104:107], v[8:11], a[200:203], 0
    ds_read_b64_tr_b16 v[28:29], v1 offset:9216
    v_mfma_f32_16x16x32_bf16 a[104:107], v[12:15], a[216:219], a[104:107]
    ds_read_b64_tr_b16 v[30:31], v1 offset:13824
    v_mfma_f32_16x16x32_bf16 a[108:111], v[12:15], a[220:223], 0
    buffer_load_dwordx4 v4, s[20:23], s49 offen lds
    v_mfma_f32_16x16x32_bf16 a[108:111], v[8:11], a[204:207], a[108:111]
    s_add_u32 m0, s45, 28672
    s_waitcnt lgkmcnt(4)
    v_mfma_f32_16x16x32_bf16 a[112:115], v[16:19], a[192:195], 0
    ds_read_b64_tr_b16 v[8:9], v1 offset:18432
    v_mfma_f32_16x16x32_bf16 a[112:115], v[20:23], a[208:211], a[112:115]
    ds_read_b64_tr_b16 v[10:11], v1 offset:23040
    v_mfma_f32_16x16x32_bf16 a[116:119], v[20:23], a[212:215], 0
    buffer_load_dwordx4 v5, s[20:23], s49 offen lds
    v_mfma_f32_16x16x32_bf16 a[116:119], v[16:19], a[196:199], a[116:119]
    v_mfma_f32_16x16x32_bf16 a[120:123], v[16:19], a[200:203], 0
    ds_read_b64_tr_b16 v[12:13], v1 offset:27648
    v_mfma_f32_16x16x32_bf16 a[120:123], v[20:23], a[216:219], a[120:123]
    ds_read_b64_tr_b16 v[14:15], v1 offset:32256
    v_mfma_f32_16x16x32_bf16 a[124:127], v[20:23], a[220:223], 0
    s_add_u32 s43, s43, 53248
    s_cmp_ge_u32 s43, 159744
    s_cselect_b32 s43, 0, s43
    v_mfma_f32_16x16x32_bf16 a[124:127], v[16:19], a[204:207], a[124:127]
    s_waitcnt lgkmcnt(4)
    v_mfma_f32_16x16x32_bf16 a[128:131], v[24:27], a[192:195], 0
    ds_read_b64_tr_b16 v[16:17], v1 offset:32
    v_mfma_f32_16x16x32_bf16 a[128:131], v[28:31], a[208:211], a[128:131]
    ds_read_b64_tr_b16 v[18:19], v1 offset:4640
    v_mfma_f32_16x16x32_bf16 a[132:135], v[28:31], a[212:215], 0
    s_add_u32 s44, s43, s58
    s_add_u32 s45, s43, s59
    s_add_u32 s46, s43, s60
    v_mfma_f32_16x16x32_bf16 a[132:135], v[24:27], a[196:199], a[132:135]
    v_mfma_f32_16x16x32_bf16 a[136:139], v[24:27], a[200:203], 0
    ds_read_b64_tr_b16 v[20:21], v1 offset:9248
    v_mfma_f32_16x16x32_bf16 a[136:139], v[28:31], a[216:219], a[136:139]
    ds_read_b64_tr_b16 v[22:23], v1 offset:13856
    v_mfma_f32_16x16x32_bf16 a[140:143], v[28:31], a[220:223], 0
    s_add_u32 s47, s47, 524288
    s_add_u32 s48, s48, 589824
    s_add_u32 s49, s49, 589824
    v_mfma_f32_16x16x32_bf16 a[140:143], v[24:27], a[204:207], a[140:143]
    s_waitcnt lgkmcnt(4)
    v_mfma_f32_16x16x32_bf16 a[144:147], v[8:11], a[192:195], 0
    ds_read_b64_tr_b16 v[24:25], v1 offset:18464
    v_mfma_f32_16x16x32_bf16 a[144:147], v[12:15], a[208:211], a[144:147]
    ds_read_b64_tr_b16 v[26:27], v1 offset:23072
    v_mfma_f32_16x16x32_bf16 a[148:151], v[12:15], a[212:215], 0
    buffer_load_dwordx4 a[224:227], v7, s[8:11], s51 offen offset:0 sc1
    v_mfma_f32_16x16x32_bf16 a[148:151], v[8:11], a[196:199], a[148:151]
    v_mfma_f32_16x16x32_bf16 a[152:155], v[8:11], a[200:203], 0
    ds_read_b64_tr_b16 v[28:29], v1 offset:27680
    v_mfma_f32_16x16x32_bf16 a[152:155], v[12:15], a[216:219], a[152:155]
    ds_read_b64_tr_b16 v[30:31], v1 offset:32288
    v_mfma_f32_16x16x32_bf16 a[156:159], v[12:15], a[220:223], 0
    buffer_load_dwordx4 a[228:231], v7, s[8:11], s51 offen offset:1024 sc1
    v_mfma_f32_16x16x32_bf16 a[156:159], v[8:11], a[204:207], a[156:159]
    s_waitcnt lgkmcnt(4)
    v_mfma_f32_16x16x32_bf16 a[160:163], v[16:19], a[192:195], 0
    ds_read_b64_tr_b16 v[8:9], v1 offset:64
    v_mfma_f32_16x16x32_bf16 a[160:163], v[20:23], a[208:211], a[160:163]
    ds_read_b64_tr_b16 v[10:11], v1 offset:4672
    v_mfma_f32_16x16x32_bf16 a[164:167], v[20:23], a[212:215], 0
    buffer_load_dwordx4 a[232:235], v7, s[8:11], s51 offen offset:2048 sc1
    v_mfma_f32_16x16x32_bf16 a[164:167], v[16:19], a[196:199], a[164:167]
    v_mfma_f32_16x16x32_bf16 a[168:171], v[16:19], a[200:203], 0
    ds_read_b64_tr_b16 v[12:13], v1 offset:9280
    v_mfma_f32_16x16x32_bf16 a[168:171], v[20:23], a[216:219], a[168:171]
    ds_read_b64_tr_b16 v[14:15], v1 offset:13888
    v_mfma_f32_16x16x32_bf16 a[172:175], v[20:23], a[220:223], 0
    buffer_load_dwordx4 a[236:239], v7, s[8:11], s51 offen offset:3072 sc1
    v_mfma_f32_16x16x32_bf16 a[172:175], v[16:19], a[204:207], a[172:175]
    s_add_u32 s51, s51, 4096
    s_waitcnt lgkmcnt(4)
    v_mfma_f32_16x16x32_bf16 a[176:179], v[24:27], a[192:195], 0
    ds_read_b64_tr_b16 v[16:17], v1 offset:18496
    v_mfma_f32_16x16x32_bf16 a[176:179], v[28:31], a[208:211], a[176:179]
    ds_read_b64_tr_b16 v[18:19], v1 offset:23104
    v_mfma_f32_16x16x32_bf16 a[180:183], v[28:31], a[212:215], 0
    buffer_load_dwordx4 a[240:243], v7, s[8:11], s51 offen offset:0 sc1
    v_mfma_f32_16x16x32_bf16 a[180:183], v[24:27], a[196:199], a[180:183]
    v_mfma_f32_16x16x32_bf16 a[184:187], v[24:27], a[200:203], 0
    ds_read_b64_tr_b16 v[20:21], v1 offset:27712
    v_mfma_f32_16x16x32_bf16 a[184:187], v[28:31], a[216:219], a[184:187]
    ds_read_b64_tr_b16 v[22:23], v1 offset:32320
    v_mfma_f32_16x16x32_bf16 a[188:191], v[28:31], a[220:223], 0
    buffer_load_dwordx4 a[244:247], v7, s[8:11], s51 offen offset:1024 sc1
    v_mfma_f32_16x16x32_bf16 a[188:191], v[24:27], a[204:207], a[188:191]
    s_waitcnt lgkmcnt(4)
    v_mfma_f32_16x16x32_bf16 v[32:35], v[8:11], a[192:195], 0
    ds_read_b64_tr_b16 v[24:25], v1 offset:96
    v_mfma_f32_16x16x32_bf16 v[32:35], v[12:15], a[208:211], v[32:35]
    ds_read_b64_tr_b16 v[26:27], v1 offset:4704
    v_mfma_f32_16x16x32_bf16 v[36:39], v[12:15], a[212:215], 0
    buffer_load_dwordx4 a[248:251], v7, s[8:11], s51 offen offset:2048 sc1
    v_mfma_f32_16x16x32_bf16 v[36:39], v[8:11], a[196:199], v[36:39]
    v_mfma_f32_16x16x32_bf16 v[40:43], v[8:11], a[200:203], 0
    ds_read_b64_tr_b16 v[28:29], v1 offset:9312
    v_mfma_f32_16x16x32_bf16 v[40:43], v[12:15], a[216:219], v[40:43]
    ds_read_b64_tr_b16 v[30:31], v1 offset:13920
    v_mfma_f32_16x16x32_bf16 v[44:47], v[12:15], a[220:223], 0
    buffer_load_dwordx4 a[252:255], v7, s[8:11], s51 offen offset:3072 sc1
    v_mfma_f32_16x16x32_bf16 v[44:47], v[8:11], a[204:207], v[44:47]
    s_add_u32 m0, s44, 0
    s_add_u32 s50, s47, 0
    s_add_u32 s51, s51, 4096
    s_waitcnt lgkmcnt(4)
    v_mfma_f32_16x16x32_bf16 v[48:51], v[16:19], a[192:195], 0
    ds_read_b64_tr_b16 v[8:9], v1 offset:18528
    v_mfma_f32_16x16x32_bf16 v[48:51], v[20:23], a[208:211], v[48:51]
    ds_read_b64_tr_b16 v[10:11], v1 offset:23136
    v_mfma_f32_16x16x32_bf16 v[52:55], v[20:23], a[212:215], 0
    buffer_load_dwordx4 v3, s[12:15], s50 offen lds
    v_mfma_f32_16x16x32_bf16 v[52:55], v[16:19], a[196:199], v[52:55]
    s_add_u32 m0, s44, 4096
    s_add_u32 s50, s47, 131072
    v_mfma_f32_16x16x32_bf16 v[56:59], v[16:19], a[200:203], 0
    ds_read_b64_tr_b16 v[12:13], v1 offset:27744
    v_mfma_f32_16x16x32_bf16 v[56:59], v[20:23], a[216:219], v[56:59]
    ds_read_b64_tr_b16 v[14:15], v1 offset:32352
    v_mfma_f32_16x16x32_bf16 v[60:63], v[20:23], a[220:223], 0
    buffer_load_dwordx4 v3, s[12:15], s50 offen lds
    v_mfma_f32_16x16x32_bf16 v[60:63], v[16:19], a[204:207], v[60:63]
    s_add_u32 m0, s45, 0
    s_waitcnt lgkmcnt(4)
    v_mfma_f32_16x16x32_bf16 v[64:67], v[24:27], a[192:195], 0
    ds_read_b64_tr_b16 v[16:17], v1 offset:128
    v_mfma_f32_16x16x32_bf16 v[64:67], v[28:31], a[208:211], v[64:67]
    ds_read_b64_tr_b16 v[18:19], v1 offset:4736
    v_mfma_f32_16x16x32_bf16 v[68:71], v[28:31], a[212:215], 0
    buffer_load_dwordx4 v4, s[16:19], s48 offen lds
    v_mfma_f32_16x16x32_bf16 v[68:71], v[24:27], a[196:199], v[68:71]
    s_add_u32 m0, s45, 1024
    v_mfma_f32_16x16x32_bf16 v[72:75], v[24:27], a[200:203], 0
    ds_read_b64_tr_b16 v[20:21], v1 offset:9344
    v_mfma_f32_16x16x32_bf16 v[72:75], v[28:31], a[216:219], v[72:75]
    ds_read_b64_tr_b16 v[22:23], v1 offset:13952
    v_mfma_f32_16x16x32_bf16 v[76:79], v[28:31], a[220:223], 0
    buffer_load_dwordx4 v5, s[16:19], s48 offen lds
    v_mfma_f32_16x16x32_bf16 v[76:79], v[24:27], a[204:207], v[76:79]
    s_add_u32 m0, s45, 18432
    s_waitcnt lgkmcnt(4)
    v_mfma_f32_16x16x32_bf16 v[80:83], v[8:11], a[192:195], 0
    ds_read_b64_tr_b16 v[24:25], v1 offset:18560
    v_mfma_f32_16x16x32_bf16 v[80:83], v[12:15], a[208:211], v[80:83]
    ds_read_b64_tr_b16 v[26:27], v1 offset:23168
    v_mfma_f32_16x16x32_bf16 v[84:87], v[12:15], a[212:215], 0
    buffer_load_dwordx4 v4, s[20:23], s48 offen lds
    v_mfma_f32_16x16x32_bf16 v[84:87], v[8:11], a[196:199], v[84:87]
    s_add_u32 m0, s45, 19456
    v_mfma_f32_16x16x32_bf16 v[88:91], v[8:11], a[200:203], 0
    ds_read_b64_tr_b16 v[28:29], v1 offset:27776
    v_mfma_f32_16x16x32_bf16 v[88:91], v[12:15], a[216:219], v[88:91]
    ds_read_b64_tr_b16 v[30:31], v1 offset:32384
    v_mfma_f32_16x16x32_bf16 v[92:95], v[12:15], a[220:223], 0
    buffer_load_dwordx4 v5, s[20:23], s48 offen lds
    v_mfma_f32_16x16x32_bf16 v[92:95], v[8:11], a[204:207], v[92:95]
    s_mov_b32 m0, s46
    s_waitcnt lgkmcnt(4)
    v_mfma_f32_16x16x32_bf16 v[96:99], v[16:19], a[192:195], 0
    ds_read_b64_tr_b16 v[8:9], v1 offset:160
    v_mfma_f32_16x16x32_bf16 v[96:99], v[20:23], a[208:211], v[96:99]
    ds_read_b64_tr_b16 v[10:11], v1 offset:4768
    v_mfma_f32_16x16x32_bf16 v[100:103], v[20:23], a[212:215], 0
    buffer_load_dwordx4 v6, s[24:27], s48 offen lds
    v_mfma_f32_16x16x32_bf16 v[100:103], v[16:19], a[196:199], v[100:103]
    s_add_u32 m0, s44, 8192
    s_add_u32 s50, s47, 262144
    v_mfma_f32_16x16x32_bf16 v[104:107], v[16:19], a[200:203], 0
    ds_read_b64_tr_b16 v[12:13], v1 offset:9376
    v_mfma_f32_16x16x32_bf16 v[104:107], v[20:23], a[216:219], v[104:107]
    ds_read_b64_tr_b16 v[14:15], v1 offset:13984
    v_mfma_f32_16x16x32_bf16 v[108:111], v[20:23], a[220:223], 0
    buffer_load_dwordx4 v3, s[12:15], s50 offen lds
    v_mfma_f32_16x16x32_bf16 v[108:111], v[16:19], a[204:207], v[108:111]
    s_add_u32 m0, s44, 12288
    s_add_u32 s50, s47, 393216
    s_waitcnt lgkmcnt(4)
    v_mfma_f32_16x16x32_bf16 v[112:115], v[24:27], a[192:195], 0
    ds_read_b64_tr_b16 v[16:17], v1 offset:18592
    v_mfma_f32_16x16x32_bf16 v[112:115], v[28:31], a[208:211], v[112:115]
    ds_read_b64_tr_b16 v[18:19], v1 offset:23200
    v_mfma_f32_16x16x32_bf16 v[116:119], v[28:31], a[212:215], 0
    buffer_load_dwordx4 v3, s[12:15], s50 offen lds
    v_mfma_f32_16x16x32_bf16 v[116:119], v[24:27], a[196:199], v[116:119]
    s_add_u32 m0, s45, 9216
    v_mfma_f32_16x16x32_bf16 v[120:123], v[24:27], a[200:203], 0
    ds_read_b64_tr_b16 v[20:21], v1 offset:27808
    v_mfma_f32_16x16x32_bf16 v[120:123], v[28:31], a[216:219], v[120:123]
    ds_read_b64_tr_b16 v[22:23], v1 offset:32416
    v_mfma_f32_16x16x32_bf16 v[124:127], v[28:31], a[220:223], 0
    buffer_load_dwordx4 v4, s[16:19], s49 offen lds
    v_mfma_f32_16x16x32_bf16 v[124:127], v[24:27], a[204:207], v[124:127]
    s_add_u32 m0, s45, 10240
    s_waitcnt lgkmcnt(4)
    v_mfma_f32_16x16x32_bf16 v[128:131], v[8:11], a[192:195], 0
    ds_read_b64_tr_b16 v[24:25], v1 offset:192
    v_mfma_f32_16x16x32_bf16 v[128:131], v[12:15], a[208:211], v[128:131]
    ds_read_b64_tr_b16 v[26:27], v1 offset:4800
    v_mfma_f32_16x16x32_bf16 v[132:135], v[12:15], a[212:215], 0
    buffer_load_dwordx4 v5, s[16:19], s49 offen lds
    v_mfma_f32_16x16x32_bf16 v[132:135], v[8:11], a[196:199], v[132:135]
    s_add_u32 m0, s45, 27648
    v_mfma_f32_16x16x32_bf16 v[136:139], v[8:11], a[200:203], 0
    ds_read_b64_tr_b16 v[28:29], v1 offset:9408
    v_mfma_f32_16x16x32_bf16 v[136:139], v[12:15], a[216:219], v[136:139]
    ds_read_b64_tr_b16 v[30:31], v1 offset:14016
    v_mfma_f32_16x16x32_bf16 v[140:143], v[12:15], a[220:223], 0
    buffer_load_dwordx4 v4, s[20:23], s49 offen lds
    v_mfma_f32_16x16x32_bf16 v[140:143], v[8:11], a[204:207], v[140:143]
    s_add_u32 m0, s45, 28672
    s_waitcnt lgkmcnt(4)
    v_mfma_f32_16x16x32_bf16 v[144:147], v[16:19], a[192:195], 0
    ds_read_b64_tr_b16 v[8:9], v1 offset:18624
    v_mfma_f32_16x16x32_bf16 v[144:147], v[20:23], a[208:211], v[144:147]
    ds_read_b64_tr_b16 v[10:11], v1 offset:23232
    v_mfma_f32_16x16x32_bf16 v[148:151], v[20:23], a[212:215], 0
    buffer_load_dwordx4 v5, s[20:23], s49 offen lds
    v_mfma_f32_16x16x32_bf16 v[148:151], v[16:19], a[196:199], v[148:151]
    v_mfma_f32_16x16x32_bf16 v[152:155], v[16:19], a[200:203], 0
    ds_read_b64_tr_b16 v[12:13], v1 offset:27840
    v_mfma_f32_16x16x32_bf16 v[152:155], v[20:23], a[216:219], v[152:155]
    ds_read_b64_tr_b16 v[14:15], v1 offset:32448
    v_mfma_f32_16x16x32_bf16 v[156:159], v[20:23], a[220:223], 0
    s_add_u32 s43, s43, 53248
    s_cmp_ge_u32 s43, 159744
    s_cselect_b32 s43, 0, s43
    v_mfma_f32_16x16x32_bf16 v[156:159], v[16:19], a[204:207], v[156:159]
    s_waitcnt lgkmcnt(4)
    v_mfma_f32_16x16x32_bf16 v[160:163], v[24:27], a[192:195], 0
    ds_read_b64_tr_b16 v[16:17], v1 offset:224
    v_mfma_f32_16x16x32_bf16 v[160:163], v[28:31], a[208:211], v[160:163]
    ds_read_b64_tr_b16 v[18:19], v1 offset:4832
    v_mfma_f32_16x16x32_bf16 v[164:167], v[28:31], a[212:215], 0
    s_add_u32 s44, s43, s58
    s_add_u32 s45, s43, s59
    s_add_u32 s46, s43, s60
    v_mfma_f32_16x16x32_bf16 v[164:167], v[24:27], a[196:199], v[164:167]
    v_mfma_f32_16x16x32_bf16 v[168:171], v[24:27], a[200:203], 0
    ds_read_b64_tr_b16 v[20:21], v1 offset:9440
    v_mfma_f32_16x16x32_bf16 v[168:171], v[28:31], a[216:219], v[168:171]
    ds_read_b64_tr_b16 v[22:23], v1 offset:14048
    v_mfma_f32_16x16x32_bf16 v[172:175], v[28:31], a[220:223], 0
    s_add_u32 s47, s47, 524288
    s_add_u32 s48, s48, 589824
    s_add_u32 s49, s49, 589824
    v_mfma_f32_16x16x32_bf16 v[172:175], v[24:27], a[204:207], v[172:175]
    s_waitcnt lgkmcnt(4)
    v_mfma_f32_16x16x32_bf16 v[176:179], v[8:11], a[192:195], 0
    ds_read_b64_tr_b16 v[24:25], v1 offset:18656
    v_mfma_f32_16x16x32_bf16 v[176:179], v[12:15], a[208:211], v[176:179]
    ds_read_b64_tr_b16 v[26:27], v1 offset:23264
    v_mfma_f32_16x16x32_bf16 v[180:183], v[12:15], a[212:215], 0
    v_mfma_f32_16x16x32_bf16 v[180:183], v[8:11], a[196:199], v[180:183]
    v_mfma_f32_16x16x32_bf16 v[184:187], v[8:11], a[200:203], 0
    ds_read_b64_tr_b16 v[28:29], v1 offset:27872
    v_mfma_f32_16x16x32_bf16 v[184:187], v[12:15], a[216:219], v[184:187]
    ds_read_b64_tr_b16 v[30:31], v1 offset:32480
    v_mfma_f32_16x16x32_bf16 v[188:191], v[12:15], a[220:223], 0
    v_mfma_f32_16x16x32_bf16 v[188:191], v[8:11], a[204:207], v[188:191]
    s_waitcnt lgkmcnt(4)
    v_mfma_f32_16x16x32_bf16 v[192:195], v[16:19], a[192:195], 0
    ds_read_b64_tr_b16 v[8:9], v2 offset:0
    v_mfma_f32_16x16x32_bf16 v[192:195], v[20:23], a[208:211], v[192:195]
    ds_read_b64_tr_b16 v[10:11], v2 offset:4608
    v_mfma_f32_16x16x32_bf16 v[196:199], v[20:23], a[212:215], 0
    v_mfma_f32_16x16x32_bf16 v[196:199], v[16:19], a[196:199], v[196:199]
    v_mfma_f32_16x16x32_bf16 v[200:203], v[16:19], a[200:203], 0
    ds_read_b64_tr_b16 v[12:13], v2 offset:9216
    v_mfma_f32_16x16x32_bf16 v[200:203], v[20:23], a[216:219], v[200:203]
    ds_read_b64_tr_b16 v[14:15], v2 offset:13824
    v_mfma_f32_16x16x32_bf16 v[204:207], v[20:23], a[220:223], 0
    v_mfma_f32_16x16x32_bf16 v[204:207], v[16:19], a[204:207], v[204:207]
    s_waitcnt lgkmcnt(4)
    v_mfma_f32_16x16x32_bf16 v[208:211], v[24:27], a[192:195], 0
    ds_read_b64_tr_b16 v[16:17], v2 offset:18432
    v_mfma_f32_16x16x32_bf16 v[208:211], v[28:31], a[208:211], v[208:211]
    ds_read_b64_tr_b16 v[18:19], v2 offset:23040
    v_mfma_f32_16x16x32_bf16 v[212:215], v[28:31], a[212:215], 0
    v_mfma_f32_16x16x32_bf16 v[212:215], v[24:27], a[196:199], v[212:215]
    v_mfma_f32_16x16x32_bf16 v[216:219], v[24:27], a[200:203], 0
    ds_read_b64_tr_b16 v[20:21], v2 offset:27648
    v_mfma_f32_16x16x32_bf16 v[216:219], v[28:31], a[216:219], v[216:219]
    ds_read_b64_tr_b16 v[22:23], v2 offset:32256
    v_mfma_f32_16x16x32_bf16 v[220:223], v[28:31], a[220:223], 0
    v_mfma_f32_16x16x32_bf16 v[220:223], v[24:27], a[204:207], v[220:223]
    s_waitcnt lgkmcnt(4)
    v_mfma_f32_16x16x32_bf16 v[224:227], v[8:11], a[192:195], 0
    s_add_u32 s61, s61, 1
    s_cmp_eq_u32 s61, 3
    v_mfma_f32_16x16x32_bf16 v[224:227], v[12:15], a[208:211], v[224:227]
    s_cselect_b32 s61, 0, s61
    s_cselect_b32 s54, s62, s63
    v_mfma_f32_16x16x32_bf16 v[228:231], v[12:15], a[212:215], 0
    v_mfma_f32_16x16x32_bf16 v[228:231], v[8:11], a[196:199], v[228:231]
    v_add_u32 v0, s54, v0
    v_mfma_f32_16x16x32_bf16 v[232:235], v[8:11], a[200:203], 0
    v_add_u32 v1, s54, v1
    v_mfma_f32_16x16x32_bf16 v[232:235], v[12:15], a[216:219], v[232:235]
    v_add_u32 v2, s54, v2
    v_mfma_f32_16x16x32_bf16 v[236:239], v[12:15], a[220:223], 0
    v_mfma_f32_16x16x32_bf16 v[236:239], v[8:11], a[204:207], v[236:239]
    s_waitcnt vmcnt(21) lgkmcnt(0)
    s_barrier
    v_mfma_f32_16x16x32_bf16 v[240:243], v[16:19], a[192:195], 0
    ds_read_b64_tr_b16 v[8:9], v0 offset:0
    ds_read_b64_tr_b16 v[10:11], v0 offset:4096
    v_mfma_f32_16x16x32_bf16 v[240:243], v[20:23], a[208:211], v[240:243]
    ds_read_b64_tr_b16 v[12:13], v0 offset:8192
    ds_read_b64_tr_b16 v[14:15], v0 offset:12288
    v_mfma_f32_16x16x32_bf16 v[244:247], v[20:23], a[212:215], 0
    v_mfma_f32_16x16x32_bf16 v[244:247], v[16:19], a[196:199], v[244:247]
    v_mfma_f32_16x16x32_bf16 v[248:251], v[16:19], a[200:203], 0
    v_mfma_f32_16x16x32_bf16 v[248:251], v[20:23], a[216:219], v[248:251]
    v_mfma_f32_16x16x32_bf16 v[252:255], v[20:23], a[220:223], 0
    v_mfma_f32_16x16x32_bf16 v[252:255], v[16:19], a[204:207], v[252:255]
L_k2_loopA:
    s_waitcnt vmcnt(13) lgkmcnt(0)
    v_mfma_f32_16x16x32_bf16 a[0:3], v[8:11], a[224:227], a[0:3]
    ds_read_b64_tr_b16 v[16:17], v0 offset:8
    ds_read_b64_tr_b16 v[18:19], v0 offset:4104
    v_mfma_f32_16x16x32_bf16 a[0:3], v[12:15], a[240:243], a[0:3]
    ds_read_b64_tr_b16 v[20:21], v0 offset:8200
    ds_read_b64_tr_b16 v[22:23], v0 offset:12296
    v_mfma_f32_16x16x32_bf16 a[4:7], v[12:15], a[244:247], a[4:7]
    v_mfma_f32_16x16x32_bf16 a[4:7], v[8:11], a[228:231], a[4:7]
    v_xor_b32 v0, 0x40, v0
    v_mfma_f32_16x16x32_bf16 a[8:11], v[8:11], a[232:235], a[8:11]
    ds_read_b64_tr_b16 v[24:25], v0 offset:0
    ds_read_b64_tr_b16 v[26:27], v0 offset:4096
    v_mfma_f32_16x16x32_bf16 a[8:11], v[12:15], a[248:251], a[8:11]
    ds_read_b64_tr_b16 v[28:29], v0 offset:8192
    ds_read_b64_tr_b16 v[30:31], v0 offset:12288
    v_mfma_f32_16x16x32_bf16 a[12:15], v[12:15], a[252:255], a[12:15]
    v_mfma_f32_16x16x32_bf16 a[12:15], v[8:11], a[236:239], a[12:15]
    s_waitcnt lgkmcnt(4)
    v_mfma_f32_16x16x32_bf16 a[16:19], v[16:19], a[224:227], a[16:19]
    ds_read_b64_tr_b16 v[8:9], v0 offset:8
    v_mfma_f32_16x16x32_bf16 a[16:19], v[20:23], a[240:243], a[16:19]
    ds_read_b64_tr_b16 v[10:11], v0 offset:4104
    v_mfma_f32_16x16x32_bf16 a[20:23], v[20:23], a[244:247], a[20:23]
    buffer_load_dwordx4 a[192:195], v7, s[8:11], s51 offen offset:0 sc1
    v_mfma_f32_16x16x32_bf16 a[20:23], v[16:19], a[228:231], a[20:23]
    v_mfma_f32_16x16x32_bf16 a[24:27], v[16:19], a[232:235], a[24:27]
    ds_read_b64_tr_b16 v[12:13], v0 offset:8200
    v_mfma_f32_16x16x32_bf16 a[24:27], v[20:23], a[248:251], a[24:27]
    ds_read_b64_tr_b16 v[14:15], v0 offset:12296
    v_mfma_f32_16x16x32_bf16 a[28:31], v[20:23], a[252:255], a[28:31]
    v_mfma_f32_16x16x32_bf16 a[28:31], v[16:19], a[236:239], a[28:31]
    v_xor_b32 v0, 0xc0, v0
    s_waitcnt lgkmcnt(4)
    v_mfma_f32_16x16x32_bf16 a[32:35], v[24:27], a[224:227], a[32:35]
    ds_read_b64_tr_b16 v[16:17], v0 offset:0
    v_mfma_f32_16x16x32_bf16 a[32:35], v[28:31], a[240:243], a[32:35]
    ds_read_b64_tr_b16 v[18:19], v0 offset:4096
    v_mfma_f32_16x16x32_bf16 a[36:39], v[28:31], a[244:247], a[36:39]
    buffer_load_dwordx4 a[196:199], v7, s[8:11], s51 offen offset:1024 sc1
    v_mfma_f32_16x16x32_bf16 a[36:39], v[24:27], a[228:231], a[36:39]
    v_mfma_f32_16x16x32_bf16 a[40:43], v[24:27], a[232:235], a[40:43]
    ds_read_b64_tr_b16 v[20:21], v0 offset:8192
    v_mfma_f32_16x16x32_bf16 a[40:43], v[28:31], a[248:251], a[40:43]
    ds_read_b64_tr_b16 v[22:23], v0 offset:12288
    v_mfma_f32_16x16x32_bf16 a[44:47], v[28:31], a[252:255], a[44:47]
    v_mfma_f32_16x16x32_bf16 a[44:47], v[24:27], a[236:239], a[44:47]
    s_waitcnt lgkmcnt(4)
    v_mfma_f32_16x16x32_bf16 a[48:51], v[8:11], a[224:227], a[48:51]
    ds_read_b64_tr_b16 v[24:25], v0 offset:8
    v_mfma_f32_16x16x32_bf16 a[48:51], v[12:15], a[240:243], a[48:51]
    ds_read_b64_tr_b16 v[26:27], v0 offset:4104
    v_mfma_f32_16x16x32_bf16 a[52:55], v[12:15], a[244:247], a[52:55]
    buffer_load_dwordx4 a[200:203], v7, s[8:11], s51 offen offset:2048 sc1
    v_mfma_f32_16x16x32_bf16 a[52:55], v[8:11], a[228:231], a[52:55]
    v_mfma_f32_16x16x32_bf16 a[56:59], v[8:11], a[232:235], a[56:59]
    ds_read_b64_tr_b16 v[28:29], v0 offset:8200
    v_mfma_f32_16x16x32_bf16 a[56:59], v[12:15], a[248:251], a[56:59]
    ds_read_b64_tr_b16 v[30:31], v0 offset:12296
    v_mfma_f32_16x16x32_bf16 a[60:63], v[12:15], a[252:255], a[60:63]
    v_mfma_f32_16x16x32_bf16 a[60:63], v[8:11], a[236:239], a[60:63]
    v_xor_b32 v0, 0x40, v0
    s_waitcnt lgkmcnt(4)
    v_mfma_f32_16x16x32_bf16 a[64:67], v[16:19], a[224:227], a[64:67]
    ds_read_b64_tr_b16 v[8:9], v0 offset:0
    v_mfma_f32_16x16x32_bf16 a[64:67], v[20:23], a[240:243], a[64:67]
    ds_read_b64_tr_b16 v[10:11], v0 offset:4096
    v_mfma_f32_16x16x32_bf16 a[68:71], v[20:23], a[244:247], a[68:71]
    buffer_load_dwordx4 a[204:207], v7, s[8:11], s51 offen offset:3072 sc1
    v_mfma_f32_16x16x32_bf16 a[68:71], v[16:19], a[228:231], a[68:71]
    s_add_u32 s51, s51, 4096
    v_mfma_f32_16x16x32_bf16 a[72:75], v[16:19], a[232:235], a[72:75]
    ds_read_b64_tr_b16 v[12:13], v0 offset:8192
    v_mfma_f32_16x16x32_bf16 a[72:75], v[20:23], a[248:251], a[72:75]
    ds_read_b64_tr_b16 v[14:15], v0 offset:12288
    v_mfma_f32_16x16x32_bf16 a[76:79], v[20:23], a[252:255], a[76:79]
    v_mfma_f32_16x16x32_bf16 a[76:79], v[16:19], a[236:239], a[76:79]
    s_waitcnt lgkmcnt(4)
    v_mfma_f32_16x16x32_bf16 a[80:83], v[24:27], a[224:227], a[80:83]
    ds_read_b64_tr_b16 v[16:17], v0 offset:8
    v_mfma_f32_16x16x32_bf16 a[80:83], v[28:31], a[240:243], a[80:83]
    ds_read_b64_tr_b16 v[18:19], v0 offset:4104
    v_mfma_f32_16x16x32_bf16 a[84:87], v[28:31], a[244:247], a[84:87]
    buffer_load_dwordx4 a[208:211], v7, s[8:11], s51 offen offset:0 sc1
    v_mfma_f32_16x16x32_bf16 a[84:87], v[24:27], a[228:231], a[84:87]
    v_mfma_f32_16x16x32_bf16 a[88:91], v[24:27], a[232:235], a[88:91]
    ds_read_b64_tr_b16 v[20:21], v0 offset:8200
    v_mfma_f32_16x16x32_bf16 a[88:91], v[28:31], a[248:251], a[88:91]
    ds_read_b64_tr_b16 v[22:23], v0 offset:12296
    v_mfma_f32_16x16x32_bf16 a[92:95], v[28:31], a[252:255], a[92:95]
    v_mfma_f32_16x16x32_bf16 a[92:95], v[24:27], a[236:239], a[92:95]
    v_xor_b32 v0, 0xc0, v0
    s_waitcnt lgkmcnt(4)
    v_mfma_f32_16x16x32_bf16 a[96:99], v[8:11], a[224:227], a[96:99]
    ds_read_b64_tr_b16 v[24:25], v1 offset:0
    v_mfma_f32_16x16x32_bf16 a[96:99], v[12:15], a[240:243], a[96:99]
    ds_read_b64_tr_b16 v[26:27], v1 offset:4608
    v_mfma_f32_16x16x32_bf16 a[100:103], v[12:15], a[244:247], a[100:103]
    buffer_load_dwordx4 a[212:215], v7, s[8:11], s51 offen offset:1024 sc1
    v_mfma_f32_16x16x32_bf16 a[100:103], v[8:11], a[228:231], a[100:103]
    v_mfma_f32_16x16x32_bf16 a[104:107], v[8:11], a[232:235], a[104:107]
    ds_read_b64_tr_b16 v[28:29], v1 offset:9216
    v_mfma_f32_16x16x32_bf16 a[104:107], v[12:15], a[248:251], a[104:107]
    ds_read_b64_tr_b16 v[30:31], v1 offset:13824
    v_mfma_f32_16x16x32_bf16 a[108:111], v[12:15], a[252:255], a[108:111]
    v_mfma_f32_16x16x32_bf16 a[108:111], v[8:11], a[236:239], a[108:111]
    s_waitcnt lgkmcnt(4)
    v_mfma_f32_16x16x32_bf16 a[112:115], v[16:19], a[224:227], a[112:115]
    ds_read_b64_tr_b16 v[8:9], v1 offset:18432
    v_mfma_f32_16x16x32_bf16 a[112:115], v[20:23], a[240:243], a[112:115]
    ds_read_b64_tr_b16 v[10:11], v1 offset:23040
    v_mfma_f32_16x16x32_bf16 a[116:119], v[20:23], a[244:247], a[116:119]
    buffer_load_dwordx4 a[216:219], v7, s[8:11], s51 offen offset:2048 sc1
    v_mfma_f32_16x16x32_bf16 a[116:119], v[16:19], a[228:231], a[116:119]
    v_mfma_f32_16x16x32_bf16 a[120:123], v[16:19], a[232:235], a[120:123]
    ds_read_b64_tr_b16 v[12:13], v1 offset:27648
    v_mfma_f32_16x16x32_bf16 a[120:123], v[20:23], a[248:251], a[120:123]
    ds_read_b64_tr_b16 v[14:15], v1 offset:32256
    v_mfma_f32_16x16x32_bf16 a[124:127], v[20:23], a[252:255], a[124:127]
    v_mfma_f32_16x16x32_bf16 a[124:127], v[16:19], a[236:239], a[124:127]
    s_waitcnt lgkmcnt(4)
    v_mfma_f32_16x16x32_bf16 a[128:131], v[24:27], a[224:227], a[128:131]
    ds_read_b64_tr_b16 v[16:17], v1 offset:32
    v_mfma_f32_16x16x32_bf16 a[128:131], v[28:31], a[240:243], a[128:131]
    ds_read_b64_tr_b16 v[18:19], v1 offset:4640
    v_mfma_f32_16x16x32_bf16 a[132:135], v[28:31], a[244:247], a[132:135]
    buffer_load_dwordx4 a[220:223], v7, s[8:11], s51 offen offset:3072 sc1
    v_mfma_f32_16x16x32_bf16 a[132:135], v[24:27], a[228:231], a[132:135]
    s_add_u32 s51, s51, 4096
    v_mfma_f32_16x16x32_bf16 a[136:139], v[24:27], a[232:235], a[136:139]
    ds_read_b64_tr_b16 v[20:21], v1 offset:9248
    v_mfma_f32_16x16x32_bf16 a[136:139], v[28:31], a[248:251], a[136:139]
    ds_read_b64_tr_b16 v[22:23], v1 offset:13856
    v_mfma_f32_16x16x32_bf16 a[140:143], v[28:31], a[252:255], a[140:143]
    v_mfma_f32_16x16x32_bf16 a[140:143], v[24:27], a[236:239], a[140:143]
    s_add_u32 m0, s44, 0
    s_add_u32 s50, s47, 0
    s_waitcnt lgkmcnt(4)
    v_mfma_f32_16x16x32_bf16 a[144:147], v[8:11], a[224:227], a[144:147]
    ds_read_b64_tr_b16 v[24:25], v1 offset:18464
    v_mfma_f32_16x16x32_bf16 a[144:147], v[12:15], a[240:243], a[144:147]
    ds_read_b64_tr_b16 v[26:27], v1 offset:23072
    v_mfma_f32_16x16x32_bf16 a[148:151], v[12:15], a[244:247], a[148:151]
    buffer_load_dwordx4 v3, s[12:15], s50 offen lds
    v_mfma_f32_16x16x32_bf16 a[148:151], v[8:11], a[228:231], a[148:151]
    v_mfma_f32_16x16x32_bf16 a[152:155], v[8:11], a[232:235], a[152:155]
    ds_read_b64_tr_b16 v[28:29], v1 offset:27680
    v_mfma_f32_16x16x32_bf16 a[152:155], v[12:15], a[248:251], a[152:155]
    ds_read_b64_tr_b16 v[30:31], v1 offset:32288
    v_mfma_f32_16x16x32_bf16 a[156:159], v[12:15], a[252:255], a[156:159]
    v_mfma_f32_16x16x32_bf16 a[156:159], v[8:11], a[236:239], a[156:159]
    s_add_u32 m0, s44, 4096
    s_add_u32 s50, s47, 131072
    s_waitcnt lgkmcnt(4)
    v_mfma_f32_16x16x32_bf16 a[160:163], v[16:19], a[224:227], a[160:163]
    ds_read_b64_tr_b16 v[8:9], v1 offset:64
    v_mfma_f32_16x16x32_bf16 a[160:163], v[20:23], a[240:243], a[160:163]
    ds_read_b64_tr_b16 v[10:11], v1 offset:4672
    v_mfma_f32_16x16x32_bf16 a[164:167], v[20:23], a[244:247], a[164:167]
    buffer_load_dwordx4 v3, s[12:15], s50 offen lds
    v_mfma_f32_16x16x32_bf16 a[164:167], v[16:19], a[228:231], a[164:167]
    v_mfma_f32_16x16x32_bf16 a[168:171], v[16:19], a[232:235], a[168:171]
    ds_read_b64_tr_b16 v[12:13], v1 offset:9280
    v_mfma_f32_16x16x32_bf16 a[168:171], v[20:23], a[248:251], a[168:171]
    ds_read_b64_tr_b16 v[14:15], v1 offset:13888
    v_mfma_f32_16x16x32_bf16 a[172:175], v[20:23], a[252:255], a[172:175]
    v_mfma_f32_16x16x32_bf16 a[172:175], v[16:19], a[236:239], a[172:175]
    s_add_u32 m0, s45, 0
    s_waitcnt lgkmcnt(4)
    v_mfma_f32_16x16x32_bf16 a[176:179], v[24:27], a[224:227], a[176:179]
    ds_read_b64_tr_b16 v[16:17], v1 offset:18496
    v_mfma_f32_16x16x32_bf16 a[176:179], v[28:31], a[240:243], a[176:179]
    ds_read_b64_tr_b16 v[18:19], v1 offset:23104
    v_mfma_f32_16x16x32_bf16 a[180:183], v[28:31], a[244:247], a[180:183]
    buffer_load_dwordx4 v4, s[16:19], s48 offen lds
    v_mfma_f32_16x16x32_bf16 a[180:183], v[24:27], a[228:231], a[180:183]
    v_mfma_f32_16x16x32_bf16 a[184:187], v[24:27], a[232:235], a[184:187]
    ds_read_b64_tr_b16 v[20:21], v1 offset:27712
    v_mfma_f32_16x16x32_bf16 a[184:187], v[28:31], a[248:251], a[184:187]
    ds_read_b64_tr_b16 v[22:23], v1 offset:32320
    v_mfma_f32_16x16x32_bf16 a[188:191], v[28:31], a[252:255], a[188:191]
    v_mfma_f32_16x16x32_bf16 a[188:191], v[24:27], a[236:239], a[188:191]
    s_add_u32 m0, s45, 1024
    s_waitcnt lgkmcnt(4)
    v_mfma_f32_16x16x32_bf16 v[32:35], v[8:11], a[224:227], v[32:35]
    ds_read_b64_tr_b16 v[24:25], v1 offset:96
    v_mfma_f32_16x16x32_bf16 v[32:35], v[12:15], a[240:243], v[32:35]
    ds_read_b64_tr_b16 v[26:27], v1 offset:4704
    v_mfma_f32_16x16x32_bf16 v[36:39], v[12:15], a[244:247], v[36:39]
    buffer_load_dwordx4 v5, s[16:19], s48 offen lds
    v_mfma_f32_16x16x32_bf16 v[36:39], v[8:11], a[228:231], v[36:39]
    v_mfma_f32_16x16x32_bf16 v[40:43], v[8:11], a[232:235], v[40:43]
    ds_read_b64_tr_b16 v[28:29], v1 offset:9312
    v_mfma_f32_16x16x32_bf16 v[40:43], v[12:15], a[248:251], v[40:43]
    ds_read_b64_tr_b16 v[30:31], v1 offset:13920
    v_mfma_f32_16x16x32_bf16 v[44:47], v[12:15], a[252:255], v[44:47]
    v_mfma_f32_16x16x32_bf16 v[44:47], v[8:11], a[236:239], v[44:47]
    s_add_u32 m0, s45, 18432
    s_waitcnt lgkmcnt(4)
    v_mfma_f32_16x16x32_bf16 v[48:51], v[16:19], a[224:227], v[48:51]
    ds_read_b64_tr_b16 v[8:9], v1 offset:18528
    v_mfma_f32_16x16x32_bf16 v[48:51], v[20:23], a[240:243], v[48:51]
    ds_read_b64_tr_b16 v[10:11], v1 offset:23136
    v_mfma_f32_16x16x32_bf16 v[52:55], v[20:23], a[244:247], v[52:55]
    buffer_load_dwordx4 v4, s[20:23], s48 offen lds
    v_mfma_f32_16x16x32_bf16 v[52:55], v[16:19], a[228:231], v[52:55]
    v_mfma_f32_16x16x32_bf16 v[56:59], v[16:19], a[232:235], v[56:59]
    ds_read_b64_tr_b16 v[12:13], v1 offset:27744
    v_mfma_f32_16x16x32_bf16 v[56:59], v[20:23], a[248:251], v[56:59]
    ds_read_b64_tr_b16 v[14:15], v1 offset:32352
    v_mfma_f32_16x16x32_bf16 v[60:63], v[20:23], a[252:255], v[60:63]
    v_mfma_f32_16x16x32_bf16 v[60:63], v[16:19], a[236:239], v[60:63]
    s_add_u32 m0, s45, 19456
    s_waitcnt lgkmcnt(4)
    v_mfma_f32_16x16x32_bf16 v[64:67], v[24:27], a[224:227], v[64:67]
    ds_read_b64_tr_b16 v[16:17], v1 offset:128
    v_mfma_f32_16x16x32_bf16 v[64:67], v[28:31], a[240:243], v[64:67]
    ds_read_b64_tr_b16 v[18:19], v1 offset:4736
    v_mfma_f32_16x16x32_bf16 v[68:71], v[28:31], a[244:247], v[68:71]
    buffer_load_dwordx4 v5, s[20:23], s48 offen lds
    v_mfma_f32_16x16x32_bf16 v[68:71], v[24:27], a[228:231], v[68:71]
    v_mfma_f32_16x16x32_bf16 v[72:75], v[24:27], a[232:235], v[72:75]
    ds_read_b64_tr_b16 v[20:21], v1 offset:9344
    v_mfma_f32_16x16x32_bf16 v[72:75], v[28:31], a[248:251], v[72:75]
    ds_read_b64_tr_b16 v[22:23], v1 offset:13952
    v_mfma_f32_16x16x32_bf16 v[76:79], v[28:31], a[252:255], v[76:79]
    v_mfma_f32_16x16x32_bf16 v[76:79], v[24:27], a[236:239], v[76:79]
    s_mov_b32 m0, s46
    s_waitcnt lgkmcnt(4)
    v_mfma_f32_16x16x32_bf16 v[80:83], v[8:11], a[224:227], v[80:83]
    ds_read_b64_tr_b16 v[24:25], v1 offset:18560
    v_mfma_f32_16x16x32_bf16 v[80:83], v[12:15], a[240:243], v[80:83]
    ds_read_b64_tr_b16 v[26:27], v1 offset:23168
    v_mfma_f32_16x16x32_bf16 v[84:87], v[12:15], a[244:247], v[84:87]
    buffer_load_dwordx4 v6, s[24:27], s48 offen lds
    v_mfma_f32_16x16x32_bf16 v[84:87], v[8:11], a[228:231], v[84:87]
    v_mfma_f32_16x16x32_bf16 v[88:91], v[8:11], a[232:235], v[88:91]
    ds_read_b64_tr_b16 v[28:29], v1 offset:27776
    v_mfma_f32_16x16x32_bf16 v[88:91], v[12:15], a[248:251], v[88:91]
    ds_read_b64_tr_b16 v[30:31], v1 offset:32384
    v_mfma_f32_16x16x32_bf16 v[92:95], v[12:15], a[252:255], v[92:95]
    v_mfma_f32_16x16x32_bf16 v[92:95], v[8:11], a[236:239], v[92:95]
    s_add_u32 m0, s44, 8192
    s_add_u32 s50, s47, 262144
    s_waitcnt lgkmcnt(4)
    v_mfma_f32_16x16x32_bf16 v[96:99], v[16:19], a[224:227], v[96:99]
    ds_read_b64_tr_b16 v[8:9], v1 offset:160
    v_mfma_f32_16x16x32_bf16 v[96:99], v[20:23], a[240:243], v[96:99]
    ds_read_b64_tr_b16 v[10:11], v1 offset:4768
    v_mfma_f32_16x16x32_bf16 v[100:103], v[20:23], a[244:247], v[100:103]
    buffer_load_dwordx4 v3, s[12:15], s50 offen lds
    v_mfma_f32_16x16x32_bf16 v[100:103], v[16:19], a[228:231], v[100:103]
    v_mfma_f32_16x16x32_bf16 v[104:107], v[16:19], a[232:235], v[104:107]
    ds_read_b64_tr_b16 v[12:13], v1 offset:9376
    v_mfma_f32_16x16x32_bf16 v[104:107], v[20:23], a[248:251], v[104:107]
    ds_read_b64_tr_b16 v[14:15], v1 offset:13984
    v_mfma_f32_16x16x32_bf16 v[108:111], v[20:23], a[252:255], v[108:111]
    v_mfma_f32_16x16x32_bf16 v[108:111], v[16:19], a[236:239], v[108:111]
    s_add_u32 m0, s44, 12288
    s_add_u32 s50, s47, 393216
    s_waitcnt lgkmcnt(4)
    v_mfma_f32_16x16x32_bf16 v[112:115], v[24:27], a[224:227], v[112:115]
    ds_read_b64_tr_b16 v[16:17], v1 offset:18592
    v_mfma_f32_16x16x32_bf16 v[112:115], v[28:31], a[240:243], v[112:115]
    ds_read_b64_tr_b16 v[18:19], v1 offset:23200
    v_mfma_f32_16x16x32_bf16 v[116:119], v[28:31], a[244:247], v[116:119]
    buffer_load_dwordx4 v3, s[12:15], s50 offen lds
    v_mfma_f32_16x16x32_bf16 v[116:119], v[24:27], a[228:231], v[116:119]
    v_mfma_f32_16x16x32_bf16 v[120:123], v[24:27], a[232:235], v[120:123]
    ds_read_b64_tr_b16 v[20:21], v1 offset:27808
    v_mfma_f32_16x16x32_bf16 v[120:123], v[28:31], a[248:251], v[120:123]
    ds_read_b64_tr_b16 v[22:23], v1 offset:32416
    v_mfma_f32_16x16x32_bf16 v[124:127], v[28:31], a[252:255], v[124:127]
    v_mfma_f32_16x16x32_bf16 v[124:127], v[24:27], a[236:239], v[124:127]
    s_add_u32 m0, s45, 9216
    s_waitcnt lgkmcnt(4)
    v_mfma_f32_16x16x32_bf16 v[128:131], v[8:11], a[224:227], v[128:131]
    ds_read_b64_tr_b16 v[24:25], v1 offset:192
    v_mfma_f32_16x16x32_bf16 v[128:131], v[12:15], a[240:243], v[128:131]
    ds_read_b64_tr_b16 v[26:27], v1 offset:4800
    v_mfma_f32_16x16x32_bf16 v[132:135], v[12:15], a[244:247], v[132:135]
    buffer_load_dwordx4 v4, s[16:19], s49 offen lds
    v_mfma_f32_16x16x32_bf16 v[132:135], v[8:11], a[228:231], v[132:135]
    v_mfma_f32_16x16x32_bf16 v[136:139], v[8:11], a[232:235], v[136:139]
    ds_read_b64_tr_b16 v[28:29], v1 offset:9408
    v_mfma_f32_16x16x32_bf16 v[136:139], v[12:15], a[248:251], v[136:139]
    ds_read_b64_tr_b16 v[30:31], v1 offset:14016
    v_mfma_f32_16x16x32_bf16 v[140:143], v[12:15], a[252:255], v[140:143]
    v_mfma_f32_16x16x32_bf16 v[140:143], v[8:11], a[236:239], v[140:143]
    s_add_u32 m0, s45, 10240
    s_waitcnt lgkmcnt(4)
    v_mfma_f32_16x16x32_bf16 v[144:147], v[16:19], a[224:227], v[144:147]
    ds_read_b64_tr_b16 v[8:9], v1 offset:18624
    v_mfma_f32_16x16x32_bf16 v[144:147], v[20:23], a[240:243], v[144:147]
    ds_read_b64_tr_b16 v[10:11], v1 offset:23232
    v_mfma_f32_16x16x32_bf16 v[148:151], v[20:23], a[244:247], v[148:151]
    buffer_load_dwordx4 v5, s[16:19], s49 offen lds
    v_mfma_f32_16x16x32_bf16 v[148:151], v[16:19], a[228:231], v[148:151]
    v_mfma_f32_16x16x32_bf16 v[152:155], v[16:19], a[232:235], v[152:155]
    ds_read_b64_tr_b16 v[12:13], v1 offset:27840
    v_mfma_f32_16x16x32_bf16 v[152:155], v[20:23], a[248:251], v[152:155]
    ds_read_b64_tr_b16 v[14:15], v1 offset:32448
    v_mfma_f32_16x16x32_bf16 v[156:159], v[20:23], a[252:255], v[156:159]
    v_mfma_f32_16x16x32_bf16 v[156:159], v[16:19], a[236:239], v[156:159]
    s_add_u32 m0, s45, 27648
    s_waitcnt lgkmcnt(4)
    v_mfma_f32_16x16x32_bf16 v[160:163], v[24:27], a[224:227], v[160:163]
    ds_read_b64_tr_b16 v[16:17], v1 offset:224
    v_mfma_f32_16x16x32_bf16 v[160:163], v[28:31], a[240:243], v[160:163]
    ds_read_b64_tr_b16 v[18:19], v1 offset:4832
    v_mfma_f32_16x16x32_bf16 v[164:167], v[28:31], a[244:247], v[164:167]
    buffer_load_dwordx4 v4, s[20:23], s49 offen lds
    v_mfma_f32_16x16x32_bf16 v[164:167], v[24:27], a[228:231], v[164:167]
    v_mfma_f32_16x16x32_bf16 v[168:171], v[24:27], a[232:235], v[168:171]
    ds_read_b64_tr_b16 v[20:21], v1 offset:9440
    v_mfma_f32_16x16x32_bf16 v[168:171], v[28:31], a[248:251], v[168:171]
    ds_read_b64_tr_b16 v[22:23], v1 offset:14048
    v_mfma_f32_16x16x32_bf16 v[172:175], v[28:31], a[252:255], v[172:175]
    v_mfma_f32_16x16x32_bf16 v[172:175], v[24:27], a[236:239], v[172:175]
    s_add_u32 m0, s45, 28672
    s_waitcnt lgkmcnt(4)
    v_mfma_f32_16x16x32_bf16 v[176:179], v[8:11], a[224:227], v[176:179]
    ds_read_b64_tr_b16 v[24:25], v1 offset:18656
    v_mfma_f32_16x16x32_bf16 v[176:179], v[12:15], a[240:243], v[176:179]
    ds_read_b64_tr_b16 v[26:27], v1 offset:23264
    v_mfma_f32_16x16x32_bf16 v[180:183], v[12:15], a[244:247], v[180:183]
    buffer_load_dwordx4 v5, s[20:23], s49 offen lds
    v_mfma_f32_16x16x32_bf16 v[180:183], v[8:11], a[228:231], v[180:183]
    v_mfma_f32_16x16x32_bf16 v[184:187], v[8:11], a[232:235], v[184:187]
    ds_read_b64_tr_b16 v[28:29], v1 offset:27872
    v_mfma_f32_16x16x32_bf16 v[184:187], v[12:15], a[248:251], v[184:187]
    ds_read_b64_tr_b16 v[30:31], v1 offset:32480
    v_mfma_f32_16x16x32_bf16 v[188:191], v[12:15], a[252:255], v[188:191]
    v_mfma_f32_16x16x32_bf16 v[188:191], v[8:11], a[236:239], v[188:191]
    s_waitcnt lgkmcnt(4)
    v_mfma_f32_16x16x32_bf16 v[192:195], v[16:19], a[224:227], v[192:195]
    ds_read_b64_tr_b16 v[8:9], v2 offset:0
    v_mfma_f32_16x16x32_bf16 v[192:195], v[20:23], a[240:243], v[192:195]
    ds_read_b64_tr_b16 v[10:11], v2 offset:4608
    v_mfma_f32_16x16x32_bf16 v[196:199], v[20:23], a[244:247], v[196:199]
    s_add_u32 s43, s43, 53248
    s_cmp_ge_u32 s43, 159744
    s_cselect_b32 s43, 0, s43
    v_mfma_f32_16x16x32_bf16 v[196:199], v[16:19], a[228:231], v[196:199]
    v_mfma_f32_16x16x32_bf16 v[200:203], v[16:19], a[232:235], v[200:203]
    ds_read_b64_tr_b16 v[12:13], v2 offset:9216
    v_mfma_f32_16x16x32_bf16 v[200:203], v[20:23], a[248:251], v[200:203]
    ds_read_b64_tr_b16 v[14:15], v2 offset:13824
    v_mfma_f32_16x16x32_bf16 v[204:207], v[20:23], a[252:255], v[204:207]
    s_add_u32 s44, s43, s58
    s_add_u32 s45, s43, s59
    s_add_u32 s46, s43, s60
    v_mfma_f32_16x16x32_bf16 v[204:207], v[16:19], a[236:239], v[204:207]
    s_waitcnt lgkmcnt(4)
    v_mfma_f32_16x16x32_bf16 v[208:211], v[24:27], a[224:227], v[208:211]
    ds_read_b64_tr_b16 v[16:17], v2 offset:18432
    v_mfma_f32_16x16x32_bf16 v[208:211], v[28:31], a[240:243], v[208:211]
    ds_read_b64_tr_b16 v[18:19], v2 offset:23040
    v_mfma_f32_16x16x32_bf16 v[212:215], v[28:31], a[244:247], v[212:215]
    s_add_u32 s47, s47, 524288
    s_add_u32 s48, s48, 589824
    s_add_u32 s49, s49, 589824
    v_mfma_f32_16x16x32_bf16 v[212:215], v[24:27], a[228:231], v[212:215]
    v_mfma_f32_16x16x32_bf16 v[216:219], v[24:27], a[232:235], v[216:219]
    ds_read_b64_tr_b16 v[20:21], v2 offset:27648
    v_mfma_f32_16x16x32_bf16 v[216:219], v[28:31], a[248:251], v[216:219]
    ds_read_b64_tr_b16 v[22:23], v2 offset:32256
    v_mfma_f32_16x16x32_bf16 v[220:223], v[28:31], a[252:255], v[220:223]
    v_mfma_f32_16x16x32_bf16 v[220:223], v[24:27], a[236:239], v[220:223]
    s_waitcnt lgkmcnt(4)
    v_mfma_f32_16x16x32_bf16 v[224:227], v[8:11], a[224:227], v[224:227]
    s_add_u32 s61, s61, 1
    s_cmp_eq_u32 s61, 3
    v_mfma_f32_16x16x32_bf16 v[224:227], v[12:15], a[240:243], v[224:227]
    s_cselect_b32 s61, 0, s61
    s_cselect_b32 s54, s62, s63
    v_mfma_f32_16x16x32_bf16 v[228:231], v[12:15], a[244:247], v[228:231]
    v_mfma_f32_16x16x32_bf16 v[228:231], v[8:11], a[228:231], v[228:231]
    v_add_u32 v0, s54, v0
    v_mfma_f32_16x16x32_bf16 v[232:235], v[8:11], a[232:235], v[232:235]
    v_add_u32 v1, s54, v1
    v_mfma_f32_16x16x32_bf16 v[232:235], v[12:15], a[248:251], v[232:235]
    v_add_u32 v2, s54, v2
    v_mfma_f32_16x16x32_bf16 v[236:239], v[12:15], a[252:255], v[236:239]
    v_mfma_f32_16x16x32_bf16 v[236:239], v[8:11], a[236:239], v[236:239]
    s_waitcnt vmcnt(21) lgkmcnt(0)
    s_barrier
    v_mfma_f32_16x16x32_bf16 v[240:243], v[16:19], a[224:227], v[240:243]
    ds_read_b64_tr_b16 v[8:9], v0 offset:0
    ds_read_b64_tr_b16 v[10:11], v0 offset:4096
    v_mfma_f32_16x16x32_bf16 v[240:243], v[20:23], a[240:243], v[240:243]
    ds_read_b64_tr_b16 v[12:13], v0 offset:8192
    ds_read_b64_tr_b16 v[14:15], v0 offset:12288
    v_mfma_f32_16x16x32_bf16 v[244:247], v[20:23], a[244:247], v[244:247]
    v_mfma_f32_16x16x32_bf16 v[244:247], v[16:19], a[228:231], v[244:247]
    v_mfma_f32_16x16x32_bf16 v[248:251], v[16:19], a[232:235], v[248:251]
    v_mfma_f32_16x16x32_bf16 v[248:251], v[20:23], a[248:251], v[248:251]
    v_mfma_f32_16x16x32_bf16 v[252:255], v[20:23], a[252:255], v[252:255]
    v_mfma_f32_16x16x32_bf16 v[252:255], v[16:19], a[236:239], v[252:255]
    s_waitcnt vmcnt(13) lgkmcnt(0)
    v_mfma_f32_16x16x32_bf16 a[0:3], v[8:11], a[192:195], a[0:3]
    ds_read_b64_tr_b16 v[16:17], v0 offset:8
    ds_read_b64_tr_b16 v[18:19], v0 offset:4104
    v_mfma_f32_16x16x32_bf16 a[0:3], v[12:15], a[208:211], a[0:3]
    ds_read_b64_tr_b16 v[20:21], v0 offset:8200
    ds_read_b64_tr_b16 v[22:23], v0 offset:12296
    v_mfma_f32_16x16x32_bf16 a[4:7], v[12:15], a[212:215], a[4:7]
    v_mfma_f32_16x16x32_bf16 a[4:7], v[8:11], a[196:199], a[4:7]
    v_xor_b32 v0, 0x40, v0
    v_mfma_f32_16x16x32_bf16 a[8:11], v[8:11], a[200:203], a[8:11]
    ds_read_b64_tr_b16 v[24:25], v0 offset:0
    ds_read_b64_tr_b16 v[26:27], v0 offset:4096
    v_mfma_f32_16x16x32_bf16 a[8:11], v[12:15], a[216:219], a[8:11]
    ds_read_b64_tr_b16 v[28:29], v0 offset:8192
    ds_read_b64_tr_b16 v[30:31], v0 offset:12288
    v_mfma_f32_16x16x32_bf16 a[12:15], v[12:15], a[220:223], a[12:15]
    v_mfma_f32_16x16x32_bf16 a[12:15], v[8:11], a[204:207], a[12:15]
    s_waitcnt lgkmcnt(4)
    v_mfma_f32_16x16x32_bf16 a[16:19], v[16:19], a[192:195], a[16:19]
    ds_read_b64_tr_b16 v[8:9], v0 offset:8
    v_mfma_f32_16x16x32_bf16 a[16:19], v[20:23], a[208:211], a[16:19]
    ds_read_b64_tr_b16 v[10:11], v0 offset:4104
    v_mfma_f32_16x16x32_bf16 a[20:23], v[20:23], a[212:215], a[20:23]
    buffer_load_dwordx4 a[224:227], v7, s[8:11], s51 offen offset:0 sc1
    v_mfma_f32_16x16x32_bf16 a[20:23], v[16:19], a[196:199], a[20:23]
    v_mfma_f32_16x16x32_bf16 a[24:27], v[16:19], a[200:203], a[24:27]
    ds_read_b64_tr_b16 v[12:13], v0 offset:8200
    v_mfma_f32_16x16x32_bf16 a[24:27], v[20:23], a[216:219], a[24:27]
    ds_read_b64_tr_b16 v[14:15], v0 offset:12296
    v_mfma_f32_16x16x32_bf16 a[28:31], v[20:23], a[220:223], a[28:31]
    v_mfma_f32_16x16x32_bf16 a[28:31], v[16:19], a[204:207], a[28:31]
    v_xor_b32 v0, 0xc0, v0
    s_waitcnt lgkmcnt(4)
    v_mfma_f32_16x16x32_bf16 a[32:35], v[24:27], a[192:195], a[32:35]
    ds_read_b64_tr_b16 v[16:17], v0 offset:0
    v_mfma_f32_16x16x32_bf16 a[32:35], v[28:31], a[208:211], a[32:35]
    ds_read_b64_tr_b16 v[18:19], v0 offset:4096
    v_mfma_f32_16x16x32_bf16 a[36:39], v[28:31], a[212:215], a[36:39]
    buffer_load_dwordx4 a[228:231], v7, s[8:11], s51 offen offset:1024 sc1
    v_mfma_f32_16x16x32_bf16 a[36:39], v[24:27], a[196:199], a[36:39]
    v_mfma_f32_16x16x32_bf16 a[40:43], v[24:27], a[200:203], a[40:43]
    ds_read_b64_tr_b16 v[20:21], v0 offset:8192
    v_mfma_f32_16x16x32_bf16 a[40:43], v[28:31], a[216:219], a[40:43]
    ds_read_b64_tr_b16 v[22:23], v0 offset:12288
    v_mfma_f32_16x16x32_bf16 a[44:47], v[28:31], a[220:223], a[44:47]
    v_mfma_f32_16x16x32_bf16 a[44:47], v[24:27], a[204:207], a[44:47]
    s_waitcnt lgkmcnt(4)
    v_mfma_f32_16x16x32_bf16 a[48:51], v[8:11], a[192:195], a[48:51]
    ds_read_b64_tr_b16 v[24:25], v0 offset:8
    v_mfma_f32_16x16x32_bf16 a[48:51], v[12:15], a[208:211], a[48:51]
    ds_read_b64_tr_b16 v[26:27], v0 offset:4104
    v_mfma_f32_16x16x32_bf16 a[52:55], v[12:15], a[212:215], a[52:55]
    buffer_load_dwordx4 a[232:235], v7, s[8:11], s51 offen offset:2048 sc1
    v_mfma_f32_16x16x32_bf16 a[52:55], v[8:11], a[196:199], a[52:55]
    v_mfma_f32_16x16x32_bf16 a[56:59], v[8:11], a[200:203], a[56:59]
    ds_read_b64_tr_b16 v[28:29], v0 offset:8200
    v_mfma_f32_16x16x32_bf16 a[56:59], v[12:15], a[216:219], a[56:59]
    ds_read_b64_tr_b16 v[30:31], v0 offset:12296
    v_mfma_f32_16x16x32_bf16 a[60:63], v[12:15], a[220:223], a[60:63]
    v_mfma_f32_16x16x32_bf16 a[60:63], v[8:11], a[204:207], a[60:63]
    v_xor_b32 v0, 0x40, v0
    s_waitcnt lgkmcnt(4)
    v_mfma_f32_16x16x32_bf16 a[64:67], v[16:19], a[192:195], a[64:67]
    ds_read_b64_tr_b16 v[8:9], v0 offset:0
    v_mfma_f32_16x16x32_bf16 a[64:67], v[20:23], a[208:211], a[64:67]
    ds_read_b64_tr_b16 v[10:11], v0 offset:4096
    v_mfma_f32_16x16x32_bf16 a[68:71], v[20:23], a[212:215], a[68:71]
    buffer_load_dwordx4 a[236:239], v7, s[8:11], s51 offen offset:3072 sc1
    v_mfma_f32_16x16x32_bf16 a[68:71], v[16:19], a[196:199], a[68:71]
    s_add_u32 s51, s51, 4096
    v_mfma_f32_16x16x32_bf16 a[72:75], v[16:19], a[200:203], a[72:75]
    ds_read_b64_tr_b16 v[12:13], v0 offset:8192
    v_mfma_f32_16x16x32_bf16 a[72:75], v[20:23], a[216:219], a[72:75]
    ds_read_b64_tr_b16 v[14:15], v0 offset:12288
    v_mfma_f32_16x16x32_bf16 a[76:79], v[20:23], a[220:223], a[76:79]
    v_mfma_f32_16x16x32_bf16 a[76:79], v[16:19], a[204:207], a[76:79]
    s_waitcnt lgkmcnt(4)
    v_mfma_f32_16x16x32_bf16 a[80:83], v[24:27], a[192:195], a[80:83]
    ds_read_b64_tr_b16 v[16:17], v0 offset:8
    v_mfma_f32_16x16x32_bf16 a[80:83], v[28:31], a[208:211], a[80:83]
    ds_read_b64_tr_b16 v[18:19], v0 offset:4104
    v_mfma_f32_16x16x32_bf16 a[84:87], v[28:31], a[212:215], a[84:87]
    buffer_load_dwordx4 a[240:243], v7, s[8:11], s51 offen offset:0 sc1
    v_mfma_f32_16x16x32_bf16 a[84:87], v[24:27], a[196:199], a[84:87]
    v_mfma_f32_16x16x32_bf16 a[88:91], v[24:27], a[200:203], a[88:91]
    ds_read_b64_tr_b16 v[20:21], v0 offset:8200
    v_mfma_f32_16x16x32_bf16 a[88:91], v[28:31], a[216:219], a[88:91]
    ds_read_b64_tr_b16 v[22:23], v0 offset:12296
    v_mfma_f32_16x16x32_bf16 a[92:95], v[28:31], a[220:223], a[92:95]
    v_mfma_f32_16x16x32_bf16 a[92:95], v[24:27], a[204:207], a[92:95]
    v_xor_b32 v0, 0xc0, v0
    s_waitcnt lgkmcnt(4)
    v_mfma_f32_16x16x32_bf16 a[96:99], v[8:11], a[192:195], a[96:99]
    ds_read_b64_tr_b16 v[24:25], v1 offset:0
    v_mfma_f32_16x16x32_bf16 a[96:99], v[12:15], a[208:211], a[96:99]
    ds_read_b64_tr_b16 v[26:27], v1 offset:4608
    v_mfma_f32_16x16x32_bf16 a[100:103], v[12:15], a[212:215], a[100:103]
    buffer_load_dwordx4 a[244:247], v7, s[8:11], s51 offen offset:1024 sc1
    v_mfma_f32_16x16x32_bf16 a[100:103], v[8:11], a[196:199], a[100:103]
    v_mfma_f32_16x16x32_bf16 a[104:107], v[8:11], a[200:203], a[104:107]
    ds_read_b64_tr_b16 v[28:29], v1 offset:9216
    v_mfma_f32_16x16x32_bf16 a[104:107], v[12:15], a[216:219], a[104:107]
    ds_read_b64_tr_b16 v[30:31], v1 offset:13824
    v_mfma_f32_16x16x32_bf16 a[108:111], v[12:15], a[220:223], a[108:111]
    v_mfma_f32_16x16x32_bf16 a[108:111], v[8:11], a[204:207], a[108:111]
    s_waitcnt lgkmcnt(4)
    v_mfma_f32_16x16x32_bf16 a[112:115], v[16:19], a[192:195], a[112:115]
    ds_read_b64_tr_b16 v[8:9], v1 offset:18432
    v_mfma_f32_16x16x32_bf16 a[112:115], v[20:23], a[208:211], a[112:115]
    ds_read_b64_tr_b16 v[10:11], v1 offset:23040
    v_mfma_f32_16x16x32_bf16 a[116:119], v[20:23], a[212:215], a[116:119]
    buffer_load_dwordx4 a[248:251], v7, s[8:11], s51 offen offset:2048 sc1
    v_mfma_f32_16x16x32_bf16 a[116:119], v[16:19], a[196:199], a[116:119]
    v_mfma_f32_16x16x32_bf16 a[120:123], v[16:19], a[200:203], a[120:123]
    ds_read_b64_tr_b16 v[12:13], v1 offset:27648
    v_mfma_f32_16x16x32_bf16 a[120:123], v[20:23], a[216:219], a[120:123]
    ds_read_b64_tr_b16 v[14:15], v1 offset:32256
    v_mfma_f32_16x16x32_bf16 a[124:127], v[20:23], a[220:223], a[124:127]
    v_mfma_f32_16x16x32_bf16 a[124:127], v[16:19], a[204:207], a[124:127]
    s_waitcnt lgkmcnt(4)
    v_mfma_f32_16x16x32_bf16 a[128:131], v[24:27], a[192:195], a[128:131]
    ds_read_b64_tr_b16 v[16:17], v1 offset:32
    v_mfma_f32_16x16x32_bf16 a[128:131], v[28:31], a[208:211], a[128:131]
    ds_read_b64_tr_b16 v[18:19], v1 offset:4640
    v_mfma_f32_16x16x32_bf16 a[132:135], v[28:31], a[212:215], a[132:135]
    buffer_load_dwordx4 a[252:255], v7, s[8:11], s51 offen offset:3072 sc1
    v_mfma_f32_16x16x32_bf16 a[132:135], v[24:27], a[196:199], a[132:135]
    s_add_u32 s51, s51, 4096
    v_mfma_f32_16x16x32_bf16 a[136:139], v[24:27], a[200:203], a[136:139]
    ds_read_b64_tr_b16 v[20:21], v1 offset:9248
    v_mfma_f32_16x16x32_bf16 a[136:139], v[28:31], a[216:219], a[136:139]
    ds_read_b64_tr_b16 v[22:23], v1 offset:13856
    v_mfma_f32_16x16x32_bf16 a[140:143], v[28:31], a[220:223], a[140:143]
    v_mfma_f32_16x16x32_bf16 a[140:143], v[24:27], a[204:207], a[140:143]
    s_add_u32 m0, s44, 0
    s_add_u32 s50, s47, 0
    s_waitcnt lgkmcnt(4)
    v_mfma_f32_16x16x32_bf16 a[144:147], v[8:11], a[192:195], a[144:147]
    ds_read_b64_tr_b16 v[24:25], v1 offset:18464
    v_mfma_f32_16x16x32_bf16 a[144:147], v[12:15], a[208:211], a[144:147]
    ds_read_b64_tr_b16 v[26:27], v1 offset:23072
    v_mfma_f32_16x16x32_bf16 a[148:151], v[12:15], a[212:215], a[148:151]
    buffer_load_dwordx4 v3, s[12:15], s50 offen lds
    v_mfma_f32_16x16x32_bf16 a[148:151], v[8:11], a[196:199], a[148:151]
    v_mfma_f32_16x16x32_bf16 a[152:155], v[8:11], a[200:203], a[152:155]
    ds_read_b64_tr_b16 v[28:29], v1 offset:27680
    v_mfma_f32_16x16x32_bf16 a[152:155], v[12:15], a[216:219], a[152:155]
    ds_read_b64_tr_b16 v[30:31], v1 offset:32288
    v_mfma_f32_16x16x32_bf16 a[156:159], v[12:15], a[220:223], a[156:159]
    v_mfma_f32_16x16x32_bf16 a[156:159], v[8:11], a[204:207], a[156:159]
    s_add_u32 m0, s44, 4096
    s_add_u32 s50, s47, 131072
    s_waitcnt lgkmcnt(4)
    v_mfma_f32_16x16x32_bf16 a[160:163], v[16:19], a[192:195], a[160:163]
    ds_read_b64_tr_b16 v[8:9], v1 offset:64
    v_mfma_f32_16x16x32_bf16 a[160:163], v[20:23], a[208:211], a[160:163]
    ds_read_b64_tr_b16 v[10:11], v1 offset:4672
    v_mfma_f32_16x16x32_bf16 a[164:167], v[20:23], a[212:215], a[164:167]
    buffer_load_dwordx4 v3, s[12:15], s50 offen lds
    v_mfma_f32_16x16x32_bf16 a[164:167], v[16:19], a[196:199], a[164:167]
    v_mfma_f32_16x16x32_bf16 a[168:171], v[16:19], a[200:203], a[168:171]
    ds_read_b64_tr_b16 v[12:13], v1 offset:9280
    v_mfma_f32_16x16x32_bf16 a[168:171], v[20:23], a[216:219], a[168:171]
    ds_read_b64_tr_b16 v[14:15], v1 offset:13888
    v_mfma_f32_16x16x32_bf16 a[172:175], v[20:23], a[220:223], a[172:175]
    v_mfma_f32_16x16x32_bf16 a[172:175], v[16:19], a[204:207], a[172:175]
    s_add_u32 m0, s45, 0
    s_waitcnt lgkmcnt(4)
    v_mfma_f32_16x16x32_bf16 a[176:179], v[24:27], a[192:195], a[176:179]
    ds_read_b64_tr_b16 v[16:17], v1 offset:18496
    v_mfma_f32_16x16x32_bf16 a[176:179], v[28:31], a[208:211], a[176:179]
    ds_read_b64_tr_b16 v[18:19], v1 offset:23104
    v_mfma_f32_16x16x32_bf16 a[180:183], v[28:31], a[212:215], a[180:183]
    buffer_load_dwordx4 v4, s[16:19], s48 offen lds
    v_mfma_f32_16x16x32_bf16 a[180:183], v[24:27], a[196:199], a[180:183]
    v_mfma_f32_16x16x32_bf16 a[184:187], v[24:27], a[200:203], a[184:187]
    ds_read_b64_tr_b16 v[20:21], v1 offset:27712
    v_mfma_f32_16x16x32_bf16 a[184:187], v[28:31], a[216:219], a[184:187]
    ds_read_b64_tr_b16 v[22:23], v1 offset:32320
    v_mfma_f32_16x16x32_bf16 a[188:191], v[28:31], a[220:223], a[188:191]
    v_mfma_f32_16x16x32_bf16 a[188:191], v[24:27], a[204:207], a[188:191]
    s_add_u32 m0, s45, 1024
    s_waitcnt lgkmcnt(4)
    v_mfma_f32_16x16x32_bf16 v[32:35], v[8:11], a[192:195], v[32:35]
    ds_read_b64_tr_b16 v[24:25], v1 offset:96
    v_mfma_f32_16x16x32_bf16 v[32:35], v[12:15], a[208:211], v[32:35]
    ds_read_b64_tr_b16 v[26:27], v1 offset:4704
    v_mfma_f32_16x16x32_bf16 v[36:39], v[12:15], a[212:215], v[36:39]
    buffer_load_dwordx4 v5, s[16:19], s48 offen lds
    v_mfma_f32_16x16x32_bf16 v[36:39], v[8:11], a[196:199], v[36:39]
    v_mfma_f32_16x16x32_bf16 v[40:43], v[8:11], a[200:203], v[40:43]
    ds_read_b64_tr_b16 v[28:29], v1 offset:9312
    v_mfma_f32_16x16x32_bf16 v[40:43], v[12:15], a[216:219], v[40:43]
    ds_read_b64_tr_b16 v[30:31], v1 offset:13920
    v_mfma_f32_16x16x32_bf16 v[44:47], v[12:15], a[220:223], v[44:47]
    v_mfma_f32_16x16x32_bf16 v[44:47], v[8:11], a[204:207], v[44:47]
    s_add_u32 m0, s45, 18432
    s_waitcnt lgkmcnt(4)
    v_mfma_f32_16x16x32_bf16 v[48:51], v[16:19], a[192:195], v[48:51]
    ds_read_b64_tr_b16 v[8:9], v1 offset:18528
    v_mfma_f32_16x16x32_bf16 v[48:51], v[20:23], a[208:211], v[48:51]
    ds_read_b64_tr_b16 v[10:11], v1 offset:23136
    v_mfma_f32_16x16x32_bf16 v[52:55], v[20:23], a[212:215], v[52:55]
    buffer_load_dwordx4 v4, s[20:23], s48 offen lds
    v_mfma_f32_16x16x32_bf16 v[52:55], v[16:19], a[196:199], v[52:55]
    v_mfma_f32_16x16x32_bf16 v[56:59], v[16:19], a[200:203], v[56:59]
    ds_read_b64_tr_b16 v[12:13], v1 offset:27744
    v_mfma_f32_16x16x32_bf16 v[56:59], v[20:23], a[216:219], v[56:59]
    ds_read_b64_tr_b16 v[14:15], v1 offset:32352
    v_mfma_f32_16x16x32_bf16 v[60:63], v[20:23], a[220:223], v[60:63]
    v_mfma_f32_16x16x32_bf16 v[60:63], v[16:19], a[204:207], v[60:63]
    s_add_u32 m0, s45, 19456
    s_waitcnt lgkmcnt(4)
    v_mfma_f32_16x16x32_bf16 v[64:67], v[24:27], a[192:195], v[64:67]
    ds_read_b64_tr_b16 v[16:17], v1 offset:128
    v_mfma_f32_16x16x32_bf16 v[64:67], v[28:31], a[208:211], v[64:67]
    ds_read_b64_tr_b16 v[18:19], v1 offset:4736
    v_mfma_f32_16x16x32_bf16 v[68:71], v[28:31], a[212:215], v[68:71]
    buffer_load_dwordx4 v5, s[20:23], s48 offen lds
    v_mfma_f32_16x16x32_bf16 v[68:71], v[24:27], a[196:199], v[68:71]
    v_mfma_f32_16x16x32_bf16 v[72:75], v[24:27], a[200:203], v[72:75]
    ds_read_b64_tr_b16 v[20:21], v1 offset:9344
    v_mfma_f32_16x16x32_bf16 v[72:75], v[28:31], a[216:219], v[72:75]
    ds_read_b64_tr_b16 v[22:23], v1 offset:13952
    v_mfma_f32_16x16x32_bf16 v[76:79], v[28:31], a[220:223], v[76:79]
    v_mfma_f32_16x16x32_bf16 v[76:79], v[24:27], a[204:207], v[76:79]
    s_mov_b32 m0, s46
    s_waitcnt lgkmcnt(4)
    v_mfma_f32_16x16x32_bf16 v[80:83], v[8:11], a[192:195], v[80:83]
    ds_read_b64_tr_b16 v[24:25], v1 offset:18560
    v_mfma_f32_16x16x32_bf16 v[80:83], v[12:15], a[208:211], v[80:83]
    ds_read_b64_tr_b16 v[26:27], v1 offset:23168
    v_mfma_f32_16x16x32_bf16 v[84:87], v[12:15], a[212:215], v[84:87]
    buffer_load_dwordx4 v6, s[24:27], s48 offen lds
    v_mfma_f32_16x16x32_bf16 v[84:87], v[8:11], a[196:199], v[84:87]
    v_mfma_f32_16x16x32_bf16 v[88:91], v[8:11], a[200:203], v[88:91]
    ds_read_b64_tr_b16 v[28:29], v1 offset:27776
    v_mfma_f32_16x16x32_bf16 v[88:91], v[12:15], a[216:219], v[88:91]
    ds_read_b64_tr_b16 v[30:31], v1 offset:32384
    v_mfma_f32_16x16x32_bf16 v[92:95], v[12:15], a[220:223], v[92:95]
    v_mfma_f32_16x16x32_bf16 v[92:95], v[8:11], a[204:207], v[92:95]
    s_add_u32 m0, s44, 8192
    s_add_u32 s50, s47, 262144
    s_waitcnt lgkmcnt(4)
    v_mfma_f32_16x16x32_bf16 v[96:99], v[16:19], a[192:195], v[96:99]
    ds_read_b64_tr_b16 v[8:9], v1 offset:160
    v_mfma_f32_16x16x32_bf16 v[96:99], v[20:23], a[208:211], v[96:99]
    ds_read_b64_tr_b16 v[10:11], v1 offset:4768
    v_mfma_f32_16x16x32_bf16 v[100:103], v[20:23], a[212:215], v[100:103]
    buffer_load_dwordx4 v3, s[12:15], s50 offen lds
    v_mfma_f32_16x16x32_bf16 v[100:103], v[16:19], a[196:199], v[100:103]
    v_mfma_f32_16x16x32_bf16 v[104:107], v[16:19], a[200:203], v[104:107]
    ds_read_b64_tr_b16 v[12:13], v1 offset:9376
    v_mfma_f32_16x16x32_bf16 v[104:107], v[20:23], a[216:219], v[104:107]
    ds_read_b64_tr_b16 v[14:15], v1 offset:13984
    v_mfma_f32_16x16x32_bf16 v[108:111], v[20:23], a[220:223], v[108:111]
    v_mfma_f32_16x16x32_bf16 v[108:111], v[16:19], a[204:207], v[108:111]
    s_add_u32 m0, s44, 12288
    s_add_u32 s50, s47, 393216
    s_waitcnt lgkmcnt(4)
    v_mfma_f32_16x16x32_bf16 v[112:115], v[24:27], a[192:195], v[112:115]
    ds_read_b64_tr_b16 v[16:17], v1 offset:18592
    v_mfma_f32_16x16x32_bf16 v[112:115], v[28:31], a[208:211], v[112:115]
    ds_read_b64_tr_b16 v[18:19], v1 offset:23200
    v_mfma_f32_16x16x32_bf16 v[116:119], v[28:31], a[212:215], v[116:119]
    buffer_load_dwordx4 v3, s[12:15], s50 offen lds
    v_mfma_f32_16x16x32_bf16 v[116:119], v[24:27], a[196:199], v[116:119]
    v_mfma_f32_16x16x32_bf16 v[120:123], v[24:27], a[200:203], v[120:123]
    ds_read_b64_tr_b16 v[20:21], v1 offset:27808
    v_mfma_f32_16x16x32_bf16 v[120:123], v[28:31], a[216:219], v[120:123]
    ds_read_b64_tr_b16 v[22:23], v1 offset:32416
    v_mfma_f32_16x16x32_bf16 v[124:127], v[28:31], a[220:223], v[124:127]
    v_mfma_f32_16x16x32_bf16 v[124:127], v[24:27], a[204:207], v[124:127]
    s_add_u32 m0, s45, 9216
    s_waitcnt lgkmcnt(4)
    v_mfma_f32_16x16x32_bf16 v[128:131], v[8:11], a[192:195], v[128:131]
    ds_read_b64_tr_b16 v[24:25], v1 offset:192
    v_mfma_f32_16x16x32_bf16 v[128:131], v[12:15], a[208:211], v[128:131]
    ds_read_b64_tr_b16 v[26:27], v1 offset:4800
    v_mfma_f32_16x16x32_bf16 v[132:135], v[12:15], a[212:215], v[132:135]
    buffer_load_dwordx4 v4, s[16:19], s49 offen lds
    v_mfma_f32_16x16x32_bf16 v[132:135], v[8:11], a[196:199], v[132:135]
    v_mfma_f32_16x16x32_bf16 v[136:139], v[8:11], a[200:203], v[136:139]
    ds_read_b64_tr_b16 v[28:29], v1 offset:9408
    v_mfma_f32_16x16x32_bf16 v[136:139], v[12:15], a[216:219], v[136:139]
    ds_read_b64_tr_b16 v[30:31], v1 offset:14016
    v_mfma_f32_16x16x32_bf16 v[140:143], v[12:15], a[220:223], v[140:143]
    v_mfma_f32_16x16x32_bf16 v[140:143], v[8:11], a[204:207], v[140:143]
    s_add_u32 m0, s45, 10240
    s_waitcnt lgkmcnt(4)
    v_mfma_f32_16x16x32_bf16 v[144:147], v[16:19], a[192:195], v[144:147]
    ds_read_b64_tr_b16 v[8:9], v1 offset:18624
    v_mfma_f32_16x16x32_bf16 v[144:147], v[20:23], a[208:211], v[144:147]
    ds_read_b64_tr_b16 v[10:11], v1 offset:23232
    v_mfma_f32_16x16x32_bf16 v[148:151], v[20:23], a[212:215], v[148:151]
    buffer_load_dwordx4 v5, s[16:19], s49 offen lds
    v_mfma_f32_16x16x32_bf16 v[148:151], v[16:19], a[196:199], v[148:151]
    v_mfma_f32_16x16x32_bf16 v[152:155], v[16:19], a[200:203], v[152:155]
    ds_read_b64_tr_b16 v[12:13], v1 offset:27840
    v_mfma_f32_16x16x32_bf16 v[152:155], v[20:23], a[216:219], v[152:155]
    ds_read_b64_tr_b16 v[14:15], v1 offset:32448
    v_mfma_f32_16x16x32_bf16 v[156:159], v[20:23], a[220:223], v[156:159]
    v_mfma_f32_16x16x32_bf16 v[156:159], v[16:19], a[204:207], v[156:159]
    s_add_u32 m0, s45, 27648
    s_waitcnt lgkmcnt(4)
    v_mfma_f32_16x16x32_bf16 v[160:163], v[24:27], a[192:195], v[160:163]
    ds_read_b64_tr_b16 v[16:17], v1 offset:224
    v_mfma_f32_16x16x32_bf16 v[160:163], v[28:31], a[208:211], v[160:163]
    ds_read_b64_tr_b16 v[18:19], v1 offset:4832
    v_mfma_f32_16x16x32_bf16 v[164:167], v[28:31], a[212:215], v[164:167]
    buffer_load_dwordx4 v4, s[20:23], s49 offen lds
    v_mfma_f32_16x16x32_bf16 v[164:167], v[24:27], a[196:199], v[164:167]
    v_mfma_f32_16x16x32_bf16 v[168:171], v[24:27], a[200:203], v[168:171]
    ds_read_b64_tr_b16 v[20:21], v1 offset:9440
    v_mfma_f32_16x16x32_bf16 v[168:171], v[28:31], a[216:219], v[168:171]
    ds_read_b64_tr_b16 v[22:23], v1 offset:14048
    v_mfma_f32_16x16x32_bf16 v[172:175], v[28:31], a[220:223], v[172:175]
    v_mfma_f32_16x16x32_bf16 v[172:175], v[24:27], a[204:207], v[172:175]
    s_add_u32 m0, s45, 28672
    s_waitcnt lgkmcnt(4)
    v_mfma_f32_16x16x32_bf16 v[176:179], v[8:11], a[192:195], v[176:179]
    ds_read_b64_tr_b16 v[24:25], v1 offset:18656
    v_mfma_f32_16x16x32_bf16 v[176:179], v[12:15], a[208:211], v[176:179]
    ds_read_b64_tr_b16 v[26:27], v1 offset:23264
    v_mfma_f32_16x16x32_bf16 v[180:183], v[12:15], a[212:215], v[180:183]
    buffer_load_dwordx4 v5, s[20:23], s49 offen lds
    v_mfma_f32_16x16x32_bf16 v[180:183], v[8:11], a[196:199], v[180:183]
    v_mfma_f32_16x16x32_bf16 v[184:187], v[8:11], a[200:203], v[184:187]
    ds_read_b64_tr_b16 v[28:29], v1 offset:27872
    v_mfma_f32_16x16x32_bf16 v[184:187], v[12:15], a[216:219], v[184:187]
    ds_read_b64_tr_b16 v[30:31], v1 offset:32480
    v_mfma_f32_16x16x32_bf16 v[188:191], v[12:15], a[220:223], v[188:191]
    v_mfma_f32_16x16x32_bf16 v[188:191], v[8:11], a[204:207], v[188:191]
    s_waitcnt lgkmcnt(4)
    v_mfma_f32_16x16x32_bf16 v[192:195], v[16:19], a[192:195], v[192:195]
    ds_read_b64_tr_b16 v[8:9], v2 offset:0
    v_mfma_f32_16x16x32_bf16 v[192:195], v[20:23], a[208:211], v[192:195]
    ds_read_b64_tr_b16 v[10:11], v2 offset:4608
    v_mfma_f32_16x16x32_bf16 v[196:199], v[20:23], a[212:215], v[196:199]
    s_add_u32 s43, s43, 53248
    s_cmp_ge_u32 s43, 159744
    s_cselect_b32 s43, 0, s43
    v_mfma_f32_16x16x32_bf16 v[196:199], v[16:19], a[196:199], v[196:199]
    v_mfma_f32_16x16x32_bf16 v[200:203], v[16:19], a[200:203], v[200:203]
    ds_read_b64_tr_b16 v[12:13], v2 offset:9216
    v_mfma_f32_16x16x32_bf16 v[200:203], v[20:23], a[216:219], v[200:203]
    ds_read_b64_tr_b16 v[14:15], v2 offset:13824
    v_mfma_f32_16x16x32_bf16 v[204:207], v[20:23], a[220:223], v[204:207]
    s_add_u32 s44, s43, s58
    s_add_u32 s45, s43, s59
    s_add_u32 s46, s43, s60
    v_mfma_f32_16x16x32_bf16 v[204:207], v[16:19], a[204:207], v[204:207]
    s_waitcnt lgkmcnt(4)
    v_mfma_f32_16x16x32_bf16 v[208:211], v[24:27], a[192:195], v[208:211]
    ds_read_b64_tr_b16 v[16:17], v2 offset:18432
    v_mfma_f32_16x16x32_bf16 v[208:211], v[28:31], a[208:211], v[208:211]
    ds_read_b64_tr_b16 v[18:19], v2 offset:23040
    v_mfma_f32_16x16x32_bf16 v[212:215], v[28:31], a[212:215], v[212:215]
    s_add_u32 s47, s47, 524288
    s_add_u32 s48, s48, 589824
    s_add_u32 s49, s49, 589824
    v_mfma_f32_16x16x32_bf16 v[212:215], v[24:27], a[196:199], v[212:215]
    v_mfma_f32_16x16x32_bf16 v[216:219], v[24:27], a[200:203], v[216:219]
    ds_read_b64_tr_b16 v[20:21], v2 offset:27648
    v_mfma_f32_16x16x32_bf16 v[216:219], v[28:31], a[216:219], v[216:219]
    ds_read_b64_tr_b16 v[22:23], v2 offset:32256
    v_mfma_f32_16x16x32_bf16 v[220:223], v[28:31], a[220:223], v[220:223]
    v_mfma_f32_16x16x32_bf16 v[220:223], v[24:27], a[204:207], v[220:223]
    s_waitcnt lgkmcnt(4)
    v_mfma_f32_16x16x32_bf16 v[224:227], v[8:11], a[192:195], v[224:227]
    s_add_u32 s61, s61, 1
    s_cmp_eq_u32 s61, 3
    v_mfma_f32_16x16x32_bf16 v[224:227], v[12:15], a[208:211], v[224:227]
    s_cselect_b32 s61, 0, s61
    s_cselect_b32 s54, s62, s63
    v_mfma_f32_16x16x32_bf16 v[228:231], v[12:15], a[212:215], v[228:231]
    v_mfma_f32_16x16x32_bf16 v[228:231], v[8:11], a[196:199], v[228:231]
    v_add_u32 v0, s54, v0
    v_mfma_f32_16x16x32_bf16 v[232:235], v[8:11], a[200:203], v[232:235]
    v_add_u32 v1, s54, v1
    v_mfma_f32_16x16x32_bf16 v[232:235], v[12:15], a[216:219], v[232:235]
    v_add_u32 v2, s54, v2
    v_mfma_f32_16x16x32_bf16 v[236:239], v[12:15], a[220:223], v[236:239]
    v_mfma_f32_16x16x32_bf16 v[236:239], v[8:11], a[204:207], v[236:239]
    s_waitcnt vmcnt(21) lgkmcnt(0)
    s_barrier
    v_mfma_f32_16x16x32_bf16 v[240:243], v[16:19], a[192:195], v[240:243]
    ds_read_b64_tr_b16 v[8:9], v0 offset:0
    ds_read_b64_tr_b16 v[10:11], v0 offset:4096
    v_mfma_f32_16x16x32_bf16 v[240:243], v[20:23], a[208:211], v[240:243]
    ds_read_b64_tr_b16 v[12:13], v0 offset:8192
    ds_read_b64_tr_b16 v[14:15], v0 offset:12288
    v_mfma_f32_16x16x32_bf16 v[244:247], v[20:23], a[212:215], v[244:247]
    v_mfma_f32_16x16x32_bf16 v[244:247], v[16:19], a[196:199], v[244:247]
    v_mfma_f32_16x16x32_bf16 v[248:251], v[16:19], a[200:203], v[248:251]
    v_mfma_f32_16x16x32_bf16 v[248:251], v[20:23], a[216:219], v[248:251]
    v_mfma_f32_16x16x32_bf16 v[252:255], v[20:23], a[220:223], v[252:255]
    v_mfma_f32_16x16x32_bf16 v[252:255], v[16:19], a[204:207], v[252:255]
    s_add_u32 s53, s53, 1
    s_cmp_lt_u32 s53, 3
    s_cbranch_scc1 L_k2_loopA
    s_waitcnt vmcnt(13) lgkmcnt(0)
    v_mfma_f32_16x16x32_bf16 a[0:3], v[8:11], a[224:227], a[0:3]
    ds_read_b64_tr_b16 v[16:17], v0 offset:8
    ds_read_b64_tr_b16 v[18:19], v0 offset:4104
    v_mfma_f32_16x16x32_bf16 a[0:3], v[12:15], a[240:243], a[0:3]
    ds_read_b64_tr_b16 v[20:21], v0 offset:8200
    ds_read_b64_tr_b16 v[22:23], v0 offset:12296
    v_mfma_f32_16x16x32_bf16 a[4:7], v[12:15], a[244:247], a[4:7]
    v_mfma_f32_16x16x32_bf16 a[4:7], v[8:11], a[228:231], a[4:7]
    v_xor_b32 v0, 0x40, v0
    v_mfma_f32_16x16x32_bf16 a[8:11], v[8:11], a[232:235], a[8:11]
    ds_read_b64_tr_b16 v[24:25], v0 offset:0
    ds_read_b64_tr_b16 v[26:27], v0 offset:4096
    v_mfma_f32_16x16x32_bf16 a[8:11], v[12:15], a[248:251], a[8:11]
    ds_read_b64_tr_b16 v[28:29], v0 offset:8192
    ds_read_b64_tr_b16 v[30:31], v0 offset:12288
    v_mfma_f32_16x16x32_bf16 a[12:15], v[12:15], a[252:255], a[12:15]
    v_mfma_f32_16x16x32_bf16 a[12:15], v[8:11], a[236:239], a[12:15]
    s_waitcnt lgkmcnt(4)
    v_mfma_f32_16x16x32_bf16 a[16:19], v[16:19], a[224:227], a[16:19]
    ds_read_b64_tr_b16 v[8:9], v0 offset:8
    v_mfma_f32_16x16x32_bf16 a[16:19], v[20:23], a[240:243], a[16:19]
    ds_read_b64_tr_b16 v[10:11], v0 offset:4104
    v_lshrrev_b32 v3, 4, v7
    v_mfma_f32_16x16x32_bf16 a[20:23], v[20:23], a[244:247], a[20:23]
    buffer_load_dwordx4 a[192:195], v7, s[8:11], s51 offen offset:0 sc1
    v_mfma_f32_16x16x32_bf16 a[20:23], v[16:19], a[228:231], a[20:23]
    v_mfma_f32_16x16x32_bf16 a[24:27], v[16:19], a[232:235], a[24:27]
    ds_read_b64_tr_b16 v[12:13], v0 offset:8200
    v_mfma_f32_16x16x32_bf16 a[24:27], v[20:23], a[248:251], a[24:27]
    ds_read_b64_tr_b16 v[14:15], v0 offset:12296
    v_and_b32 v3, 0x30, v3
    v_mfma_f32_16x16x32_bf16 a[28:31], v[20:23], a[252:255], a[28:31]
    v_mfma_f32_16x16x32_bf16 a[28:31], v[16:19], a[236:239], a[28:31]
    v_xor_b32 v0, 0xc0, v0
    s_waitcnt lgkmcnt(4)
    v_mfma_f32_16x16x32_bf16 a[32:35], v[24:27], a[224:227], a[32:35]
    ds_read_b64_tr_b16 v[16:17], v0 offset:0
    v_mfma_f32_16x16x32_bf16 a[32:35], v[28:31], a[240:243], a[32:35]
    ds_read_b64_tr_b16 v[18:19], v0 offset:4096
    v_xor_b32 v3, v3, v7
    v_mfma_f32_16x16x32_bf16 a[36:39], v[28:31], a[244:247], a[36:39]
    buffer_load_dwordx4 a[196:199], v7, s[8:11], s51 offen offset:1024 sc1
    v_mfma_f32_16x16x32_bf16 a[36:39], v[24:27], a[228:231], a[36:39]
    v_mfma_f32_16x16x32_bf16 a[40:43], v[24:27], a[232:235], a[40:43]
    ds_read_b64_tr_b16 v[20:21], v0 offset:8192
    v_mfma_f32_16x16x32_bf16 a[40:43], v[28:31], a[248:251], a[40:43]
    ds_read_b64_tr_b16 v[22:23], v0 offset:12288
    v_add_u32 v3, s55, v3
    v_mfma_f32_16x16x32_bf16 a[44:47], v[28:31], a[252:255], a[44:47]
    v_mfma_f32_16x16x32_bf16 a[44:47], v[24:27], a[236:239], a[44:47]
    s_waitcnt lgkmcnt(4)
    v_mfma_f32_16x16x32_bf16 a[48:51], v[8:11], a[224:227], a[48:51]
    ds_read_b64_tr_b16 v[24:25], v0 offset:8
    v_mfma_f32_16x16x32_bf16 a[48:51], v[12:15], a[240:243], a[48:51]
    ds_read_b64_tr_b16 v[26:27], v0 offset:4104
    v_xor_b32 v4, 0x40, v3
    v_mfma_f32_16x16x32_bf16 a[52:55], v[12:15], a[244:247], a[52:55]
    buffer_load_dwordx4 a[200:203], v7, s[8:11], s51 offen offset:2048 sc1
    v_mfma_f32_16x16x32_bf16 a[52:55], v[8:11], a[228:231], a[52:55]
    v_mfma_f32_16x16x32_bf16 a[56:59], v[8:11], a[232:235], a[56:59]
    ds_read_b64_tr_b16 v[28:29], v0 offset:8200
    v_mfma_f32_16x16x32_bf16 a[56:59], v[12:15], a[248:251], a[56:59]
    ds_read_b64_tr_b16 v[30:31], v0 offset:12296
    v_xor_b32 v5, 0x80, v3
    v_mfma_f32_16x16x32_bf16 a[60:63], v[12:15], a[252:255], a[60:63]
    v_mfma_f32_16x16x32_bf16 a[60:63], v[8:11], a[236:239], a[60:63]
    v_xor_b32 v0, 0x40, v0
    s_waitcnt lgkmcnt(4)
    v_mfma_f32_16x16x32_bf16 a[64:67], v[16:19], a[224:227], a[64:67]
    ds_read_b64_tr_b16 v[8:9], v0 offset:0
    v_mfma_f32_16x16x32_bf16 a[64:67], v[20:23], a[240:243], a[64:67]
    ds_read_b64_tr_b16 v[10:11], v0 offset:4096
    v_xor_b32 v6, 0xc0, v3
    v_mfma_f32_16x16x32_bf16 a[68:71], v[20:23], a[244:247], a[68:71]
    buffer_load_dwordx4 a[204:207], v7, s[8:11], s51 offen offset:3072 sc1
    v_mfma_f32_16x16x32_bf16 a[68:71], v[16:19], a[228:231], a[68:71]
    s_add_u32 s51, s51, 4096
    v_mfma_f32_16x16x32_bf16 a[72:75], v[16:19], a[232:235], a[72:75]
    ds_read_b64_tr_b16 v[12:13], v0 offset:8192
    v_mfma_f32_16x16x32_bf16 a[72:75], v[20:23], a[248:251], a[72:75]
    ds_read_b64_tr_b16 v[14:15], v0 offset:12288
    v_mfma_f32_16x16x32_bf16 a[76:79], v[20:23], a[252:255], a[76:79]
    v_mfma_f32_16x16x32_bf16 a[76:79], v[16:19], a[236:239], a[76:79]
    s_waitcnt lgkmcnt(4)
    v_mfma_f32_16x16x32_bf16 a[80:83], v[24:27], a[224:227], a[80:83]
    ds_read_b64_tr_b16 v[16:17], v0 offset:8
    v_mfma_f32_16x16x32_bf16 a[80:83], v[28:31], a[240:243], a[80:83]
    ds_read_b64_tr_b16 v[18:19], v0 offset:4104
    v_mfma_f32_16x16x32_bf16 a[84:87], v[28:31], a[244:247], a[84:87]
    buffer_load_dwordx4 a[208:211], v7, s[8:11], s51 offen offset:0 sc1
    v_mfma_f32_16x16x32_bf16 a[84:87], v[24:27], a[228:231], a[84:87]
    v_mfma_f32_16x16x32_bf16 a[88:91], v[24:27], a[232:235], a[88:91]
    ds_read_b64_tr_b16 v[20:21], v0 offset:8200
    v_mfma_f32_16x16x32_bf16 a[88:91], v[28:31], a[248:251], a[88:91]
    ds_read_b64_tr_b16 v[22:23], v0 offset:12296
    v_mfma_f32_16x16x32_bf16 a[92:95], v[28:31], a[252:255], a[92:95]
    v_mfma_f32_16x16x32_bf16 a[92:95], v[24:27], a[236:239], a[92:95]
    v_xor_b32 v0, 0xc0, v0
    s_waitcnt lgkmcnt(4)
    v_mfma_f32_16x16x32_bf16 a[96:99], v[8:11], a[224:227], a[96:99]
    ds_read_b64_tr_b16 v[24:25], v1 offset:0
    v_mfma_f32_16x16x32_bf16 a[96:99], v[12:15], a[240:243], a[96:99]
    ds_read_b64_tr_b16 v[26:27], v1 offset:4608
    v_mfma_f32_16x16x32_bf16 a[100:103], v[12:15], a[244:247], a[100:103]
    buffer_load_dwordx4 a[212:215], v7, s[8:11], s51 offen offset:1024 sc1
    v_mfma_f32_16x16x32_bf16 a[100:103], v[8:11], a[228:231], a[100:103]
    v_mfma_f32_16x16x32_bf16 a[104:107], v[8:11], a[232:235], a[104:107]
    ds_read_b64_tr_b16 v[28:29], v1 offset:9216
    v_mfma_f32_16x16x32_bf16 a[104:107], v[12:15], a[248:251], a[104:107]
    ds_read_b64_tr_b16 v[30:31], v1 offset:13824
    v_mfma_f32_16x16x32_bf16 a[108:111], v[12:15], a[252:255], a[108:111]
    v_mfma_f32_16x16x32_bf16 a[108:111], v[8:11], a[236:239], a[108:111]
    s_waitcnt lgkmcnt(4)
    v_mfma_f32_16x16x32_bf16 a[112:115], v[16:19], a[224:227], a[112:115]
    ds_read_b64_tr_b16 v[8:9], v1 offset:18432
    v_mfma_f32_16x16x32_bf16 a[112:115], v[20:23], a[240:243], a[112:115]
    ds_read_b64_tr_b16 v[10:11], v1 offset:23040
    v_mfma_f32_16x16x32_bf16 a[116:119], v[20:23], a[244:247], a[116:119]
    buffer_load_dwordx4 a[216:219], v7, s[8:11], s51 offen offset:2048 sc1
    v_mfma_f32_16x16x32_bf16 a[116:119], v[16:19], a[228:231], a[116:119]
    v_mfma_f32_16x16x32_bf16 a[120:123], v[16:19], a[232:235], a[120:123]
    ds_read_b64_tr_b16 v[12:13], v1 offset:27648
    v_mfma_f32_16x16x32_bf16 a[120:123], v[20:23], a[248:251], a[120:123]
    ds_read_b64_tr_b16 v[14:15], v1 offset:32256
    v_mfma_f32_16x16x32_bf16 a[124:127], v[20:23], a[252:255], a[124:127]
    v_mfma_f32_16x16x32_bf16 a[124:127], v[16:19], a[236:239], a[124:127]
    s_waitcnt lgkmcnt(4)
    v_mfma_f32_16x16x32_bf16 a[128:131], v[24:27], a[224:227], a[128:131]
    ds_read_b64_tr_b16 v[16:17], v1 offset:32
    v_mfma_f32_16x16x32_bf16 a[128:131], v[28:31], a[240:243], a[128:131]
    ds_read_b64_tr_b16 v[18:19], v1 offset:4640
    v_mfma_f32_16x16x32_bf16 a[132:135], v[28:31], a[244:247], a[132:135]
    buffer_load_dwordx4 a[220:223], v7, s[8:11], s51 offen offset:3072 sc1
    v_mfma_f32_16x16x32_bf16 a[132:135], v[24:27], a[228:231], a[132:135]
    s_add_u32 s51, s51, 4096
    v_mfma_f32_16x16x32_bf16 a[136:139], v[24:27], a[232:235], a[136:139]
    ds_read_b64_tr_b16 v[20:21], v1 offset:9248
    v_mfma_f32_16x16x32_bf16 a[136:139], v[28:31], a[248:251], a[136:139]
    ds_read_b64_tr_b16 v[22:23], v1 offset:13856
    v_mfma_f32_16x16x32_bf16 a[140:143], v[28:31], a[252:255], a[140:143]
    v_mfma_f32_16x16x32_bf16 a[140:143], v[24:27], a[236:239], a[140:143]
    s_add_u32 m0, s55, 0
    s_waitcnt lgkmcnt(4)
    v_mfma_f32_16x16x32_bf16 a[144:147], v[8:11], a[224:227], a[144:147]
    ds_read_b64_tr_b16 v[24:25], v1 offset:18464
    v_mfma_f32_16x16x32_bf16 a[144:147], v[12:15], a[240:243], a[144:147]
    ds_read_b64_tr_b16 v[26:27], v1 offset:23072
    v_mfma_f32_16x16x32_bf16 a[148:151], v[12:15], a[244:247], a[148:151]
    buffer_load_dwordx4 v3, s[28:31], s56 offen offset:0 lds
    v_mfma_f32_16x16x32_bf16 a[148:151], v[8:11], a[228:231], a[148:151]
    v_mfma_f32_16x16x32_bf16 a[152:155], v[8:11], a[232:235], a[152:155]
    ds_read_b64_tr_b16 v[28:29], v1 offset:27680
    v_mfma_f32_16x16x32_bf16 a[152:155], v[12:15], a[248:251], a[152:155]
    ds_read_b64_tr_b16 v[30:31], v1 offset:32288
    v_mfma_f32_16x16x32_bf16 a[156:159], v[12:15], a[252:255], a[156:159]
    v_mfma_f32_16x16x32_bf16 a[156:159], v[8:11], a[236:239], a[156:159]
    s_waitcnt lgkmcnt(4)
    v_mfma_f32_16x16x32_bf16 a[160:163], v[16:19], a[224:227], a[160:163]
    ds_read_b64_tr_b16 v[8:9], v1 offset:64
    v_mfma_f32_16x16x32_bf16 a[160:163], v[20:23], a[240:243], a[160:163]
    ds_read_b64_tr_b16 v[10:11], v1 offset:4672
    v_mfma_f32_16x16x32_bf16 a[164:167], v[20:23], a[244:247], a[164:167]
    buffer_load_dwordx4 v4, s[28:31], s56 offen offset:1024 lds
    v_mfma_f32_16x16x32_bf16 a[164:167], v[16:19], a[228:231], a[164:167]
    v_mfma_f32_16x16x32_bf16 a[168:171], v[16:19], a[232:235], a[168:171]
    ds_read_b64_tr_b16 v[12:13], v1 offset:9280
    v_mfma_f32_16x16x32_bf16 a[168:171], v[20:23], a[248:251], a[168:171]
    ds_read_b64_tr_b16 v[14:15], v1 offset:13888
    v_mfma_f32_16x16x32_bf16 a[172:175], v[20:23], a[252:255], a[172:175]
    v_mfma_f32_16x16x32_bf16 a[172:175], v[16:19], a[236:239], a[172:175]
    s_waitcnt lgkmcnt(4)
    v_mfma_f32_16x16x32_bf16 a[176:179], v[24:27], a[224:227], a[176:179]
    ds_read_b64_tr_b16 v[16:17], v1 offset:18496
    v_mfma_f32_16x16x32_bf16 a[176:179], v[28:31], a[240:243], a[176:179]
    ds_read_b64_tr_b16 v[18:19], v1 offset:23104
    v_mfma_f32_16x16x32_bf16 a[180:183], v[28:31], a[244:247], a[180:183]
    buffer_load_dwordx4 v5, s[28:31], s56 offen offset:2048 lds
    v_mfma_f32_16x16x32_bf16 a[180:183], v[24:27], a[228:231], a[180:183]
    v_mfma_f32_16x16x32_bf16 a[184:187], v[24:27], a[232:235], a[184:187]
    ds_read_b64_tr_b16 v[20:21], v1 offset:27712
    v_mfma_f32_16x16x32_bf16 a[184:187], v[28:31], a[248:251], a[184:187]
    ds_read_b64_tr_b16 v[22:23], v1 offset:32320
    v_mfma_f32_16x16x32_bf16 a[188:191], v[28:31], a[252:255], a[188:191]
    v_mfma_f32_16x16x32_bf16 a[188:191], v[24:27], a[236:239], a[188:191]
    s_waitcnt lgkmcnt(4)
    v_mfma_f32_16x16x32_bf16 v[32:35], v[8:11], a[224:227], v[32:35]
    ds_read_b64_tr_b16 v[24:25], v1 offset:96
    v_mfma_f32_16x16x32_bf16 v[32:35], v[12:15], a[240:243], v[32:35]
    ds_read_b64_tr_b16 v[26:27], v1 offset:4704
    v_mfma_f32_16x16x32_bf16 v[36:39], v[12:15], a[244:247], v[36:39]
    buffer_load_dwordx4 v6, s[28:31], s56 offen offset:3072 lds
    v_mfma_f32_16x16x32_bf16 v[36:39], v[8:11], a[228:231], v[36:39]
    s_add_u32 s56, s56, 16384
    v_mfma_f32_16x16x32_bf16 v[40:43], v[8:11], a[232:235], v[40:43]
    ds_read_b64_tr_b16 v[28:29], v1 offset:9312
    v_mfma_f32_16x16x32_bf16 v[40:43], v[12:15], a[248:251], v[40:43]
    ds_read_b64_tr_b16 v[30:31], v1 offset:13920
    v_mfma_f32_16x16x32_bf16 v[44:47], v[12:15], a[252:255], v[44:47]
    v_mfma_f32_16x16x32_bf16 v[44:47], v[8:11], a[236:239], v[44:47]
    s_add_u32 m0, s55, 16384
    s_waitcnt lgkmcnt(4)
    v_mfma_f32_16x16x32_bf16 v[48:51], v[16:19], a[224:227], v[48:51]
    ds_read_b64_tr_b16 v[8:9], v1 offset:18528
    v_mfma_f32_16x16x32_bf16 v[48:51], v[20:23], a[240:243], v[48:51]
    ds_read_b64_tr_b16 v[10:11], v1 offset:23136
    v_mfma_f32_16x16x32_bf16 v[52:55], v[20:23], a[244:247], v[52:55]
    buffer_load_dwordx4 v3, s[28:31], s56 offen offset:0 lds
    v_mfma_f32_16x16x32_bf16 v[52:55], v[16:19], a[228:231], v[52:55]
    v_mfma_f32_16x16x32_bf16 v[56:59], v[16:19], a[232:235], v[56:59]
    ds_read_b64_tr_b16 v[12:13], v1 offset:27744
    v_mfma_f32_16x16x32_bf16 v[56:59], v[20:23], a[248:251], v[56:59]
    ds_read_b64_tr_b16 v[14:15], v1 offset:32352
    v_mfma_f32_16x16x32_bf16 v[60:63], v[20:23], a[252:255], v[60:63]
    v_mfma_f32_16x16x32_bf16 v[60:63], v[16:19], a[236:239], v[60:63]
    s_waitcnt lgkmcnt(4)
    v_mfma_f32_16x16x32_bf16 v[64:67], v[24:27], a[224:227], v[64:67]
    ds_read_b64_tr_b16 v[16:17], v1 offset:128
    v_mfma_f32_16x16x32_bf16 v[64:67], v[28:31], a[240:243], v[64:67]
    ds_read_b64_tr_b16 v[18:19], v1 offset:4736
    v_mfma_f32_16x16x32_bf16 v[68:71], v[28:31], a[244:247], v[68:71]
    buffer_load_dwordx4 v4, s[28:31], s56 offen offset:1024 lds
    v_mfma_f32_16x16x32_bf16 v[68:71], v[24:27], a[228:231], v[68:71]
    v_mfma_f32_16x16x32_bf16 v[72:75], v[24:27], a[232:235], v[72:75]
    ds_read_b64_tr_b16 v[20:21], v1 offset:9344
    v_mfma_f32_16x16x32_bf16 v[72:75], v[28:31], a[248:251], v[72:75]
    ds_read_b64_tr_b16 v[22:23], v1 offset:13952
    v_mfma_f32_16x16x32_bf16 v[76:79], v[28:31], a[252:255], v[76:79]
    v_mfma_f32_16x16x32_bf16 v[76:79], v[24:27], a[236:239], v[76:79]
    s_waitcnt lgkmcnt(4)
    v_mfma_f32_16x16x32_bf16 v[80:83], v[8:11], a[224:227], v[80:83]
    ds_read_b64_tr_b16 v[24:25], v1 offset:18560
    v_mfma_f32_16x16x32_bf16 v[80:83], v[12:15], a[240:243], v[80:83]
    ds_read_b64_tr_b16 v[26:27], v1 offset:23168
    v_mfma_f32_16x16x32_bf16 v[84:87], v[12:15], a[244:247], v[84:87]
    buffer_load_dwordx4 v5, s[28:31], s56 offen offset:2048 lds
    v_mfma_f32_16x16x32_bf16 v[84:87], v[8:11], a[228:231], v[84:87]
    v_mfma_f32_16x16x32_bf16 v[88:91], v[8:11], a[232:235], v[88:91]
    ds_read_b64_tr_b16 v[28:29], v1 offset:27776
    v_mfma_f32_16x16x32_bf16 v[88:91], v[12:15], a[248:251], v[88:91]
    ds_read_b64_tr_b16 v[30:31], v1 offset:32384
    v_mfma_f32_16x16x32_bf16 v[92:95], v[12:15], a[252:255], v[92:95]
    v_mfma_f32_16x16x32_bf16 v[92:95], v[8:11], a[236:239], v[92:95]
    s_waitcnt lgkmcnt(4)
    v_mfma_f32_16x16x32_bf16 v[96:99], v[16:19], a[224:227], v[96:99]
    ds_read_b64_tr_b16 v[8:9], v1 offset:160
    v_mfma_f32_16x16x32_bf16 v[96:99], v[20:23], a[240:243], v[96:99]
    ds_read_b64_tr_b16 v[10:11], v1 offset:4768
    v_mfma_f32_16x16x32_bf16 v[100:103], v[20:23], a[244:247], v[100:103]
    buffer_load_dwordx4 v6, s[28:31], s56 offen offset:3072 lds
    v_mfma_f32_16x16x32_bf16 v[100:103], v[16:19], a[228:231], v[100:103]
    s_add_u32 s56, s56, 16384
    v_mfma_f32_16x16x32_bf16 v[104:107], v[16:19], a[232:235], v[104:107]
    ds_read_b64_tr_b16 v[12:13], v1 offset:9376
    v_mfma_f32_16x16x32_bf16 v[104:107], v[20:23], a[248:251], v[104:107]
    ds_read_b64_tr_b16 v[14:15], v1 offset:13984
    v_mfma_f32_16x16x32_bf16 v[108:111], v[20:23], a[252:255], v[108:111]
    v_mfma_f32_16x16x32_bf16 v[108:111], v[16:19], a[236:239], v[108:111]
    s_add_u32 m0, s55, 32768
    s_waitcnt lgkmcnt(4)
    v_mfma_f32_16x16x32_bf16 v[112:115], v[24:27], a[224:227], v[112:115]
    ds_read_b64_tr_b16 v[16:17], v1 offset:18592
    v_mfma_f32_16x16x32_bf16 v[112:115], v[28:31], a[240:243], v[112:115]
    ds_read_b64_tr_b16 v[18:19], v1 offset:23200
    v_mfma_f32_16x16x32_bf16 v[116:119], v[28:31], a[244:247], v[116:119]
    buffer_load_dwordx4 v3, s[28:31], s56 offen offset:0 lds
    v_mfma_f32_16x16x32_bf16 v[116:119], v[24:27], a[228:231], v[116:119]
    v_mfma_f32_16x16x32_bf16 v[120:123], v[24:27], a[232:235], v[120:123]
    ds_read_b64_tr_b16 v[20:21], v1 offset:27808
    v_mfma_f32_16x16x32_bf16 v[120:123], v[28:31], a[248:251], v[120:123]
    ds_read_b64_tr_b16 v[22:23], v1 offset:32416
    v_mfma_f32_16x16x32_bf16 v[124:127], v[28:31], a[252:255], v[124:127]
    v_mfma_f32_16x16x32_bf16 v[124:127], v[24:27], a[236:239], v[124:127]
    s_waitcnt lgkmcnt(4)
    v_mfma_f32_16x16x32_bf16 v[128:131], v[8:11], a[224:227], v[128:131]
    ds_read_b64_tr_b16 v[24:25], v1 offset:192
    v_mfma_f32_16x16x32_bf16 v[128:131], v[12:15], a[240:243], v[128:131]
    ds_read_b64_tr_b16 v[26:27], v1 offset:4800
    v_mfma_f32_16x16x32_bf16 v[132:135], v[12:15], a[244:247], v[132:135]
    buffer_load_dwordx4 v4, s[28:31], s56 offen offset:1024 lds
    v_mfma_f32_16x16x32_bf16 v[132:135], v[8:11], a[228:231], v[132:135]
    v_mfma_f32_16x16x32_bf16 v[136:139], v[8:11], a[232:235], v[136:139]
    ds_read_b64_tr_b16 v[28:29], v1 offset:9408
    v_mfma_f32_16x16x32_bf16 v[136:139], v[12:15], a[248:251], v[136:139]
    ds_read_b64_tr_b16 v[30:31], v1 offset:14016
    v_mfma_f32_16x16x32_bf16 v[140:143], v[12:15], a[252:255], v[140:143]
    v_mfma_f32_16x16x32_bf16 v[140:143], v[8:11], a[236:239], v[140:143]
    s_waitcnt lgkmcnt(4)
    v_mfma_f32_16x16x32_bf16 v[144:147], v[16:19], a[224:227], v[144:147]
    ds_read_b64_tr_b16 v[8:9], v1 offset:18624
    v_mfma_f32_16x16x32_bf16 v[144:147], v[20:23], a[240:243], v[144:147]
    ds_read_b64_tr_b16 v[10:11], v1 offset:23232
    v_mfma_f32_16x16x32_bf16 v[148:151], v[20:23], a[244:247], v[148:151]
    buffer_load_dwordx4 v5, s[28:31], s56 offen offset:2048 lds
    v_mfma_f32_16x16x32_bf16 v[148:151], v[16:19], a[228:231], v[148:151]
    v_mfma_f32_16x16x32_bf16 v[152:155], v[16:19], a[232:235], v[152:155]
    ds_read_b64_tr_b16 v[12:13], v1 offset:27840
    v_mfma_f32_16x16x32_bf16 v[152:155], v[20:23], a[248:251], v[152:155]
    ds_read_b64_tr_b16 v[14:15], v1 offset:32448
    v_mfma_f32_16x16x32_bf16 v[156:159], v[20:23], a[252:255], v[156:159]
    v_mfma_f32_16x16x32_bf16 v[156:159], v[16:19], a[236:239], v[156:159]
    s_waitcnt lgkmcnt(4)
    v_mfma_f32_16x16x32_bf16 v[160:163], v[24:27], a[224:227], v[160:163]
    ds_read_b64_tr_b16 v[16:17], v1 offset:224
    v_mfma_f32_16x16x32_bf16 v[160:163], v[28:31], a[240:243], v[160:163]
    ds_read_b64_tr_b16 v[18:19], v1 offset:4832
    v_mfma_f32_16x16x32_bf16 v[164:167], v[28:31], a[244:247], v[164:167]
    buffer_load_dwordx4 v6, s[28:31], s56 offen offset:3072 lds
    v_mfma_f32_16x16x32_bf16 v[164:167], v[24:27], a[228:231], v[164:167]
    s_add_u32 s56, s56, 16384
    v_mfma_f32_16x16x32_bf16 v[168:171], v[24:27], a[232:235], v[168:171]
    ds_read_b64_tr_b16 v[20:21], v1 offset:9440
    v_mfma_f32_16x16x32_bf16 v[168:171], v[28:31], a[248:251], v[168:171]
    ds_read_b64_tr_b16 v[22:23], v1 offset:14048
    v_mfma_f32_16x16x32_bf16 v[172:175], v[28:31], a[252:255], v[172:175]
    v_mfma_f32_16x16x32_bf16 v[172:175], v[24:27], a[236:239], v[172:175]
    s_waitcnt lgkmcnt(4)
    v_mfma_f32_16x16x32_bf16 v[176:179], v[8:11], a[224:227], v[176:179]
    ds_read_b64_tr_b16 v[24:25], v1 offset:18656
    v_mfma_f32_16x16x32_bf16 v[176:179], v[12:15], a[240:243], v[176:179]
    ds_read_b64_tr_b16 v[26:27], v1 offset:23264
    v_mfma_f32_16x16x32_bf16 v[180:183], v[12:15], a[244:247], v[180:183]
    v_mfma_f32_16x16x32_bf16 v[180:183], v[8:11], a[228:231], v[180:183]
    v_mfma_f32_16x16x32_bf16 v[184:187], v[8:11], a[232:235], v[184:187]
    ds_read_b64_tr_b16 v[28:29], v1 offset:27872
    v_mfma_f32_16x16x32_bf16 v[184:187], v[12:15], a[248:251], v[184:187]
    ds_read_b64_tr_b16 v[30:31], v1 offset:32480
    v_mfma_f32_16x16x32_bf16 v[188:191], v[12:15], a[252:255], v[188:191]
    v_mfma_f32_16x16x32_bf16 v[188:191], v[8:11], a[236:239], v[188:191]
    s_waitcnt lgkmcnt(4)
    v_mfma_f32_16x16x32_bf16 v[192:195], v[16:19], a[224:227], v[192:195]
    ds_read_b64_tr_b16 v[8:9], v2 offset:0
    v_mfma_f32_16x16x32_bf16 v[192:195], v[20:23], a[240:243], v[192:195]
    ds_read_b64_tr_b16 v[10:11], v2 offset:4608
    v_mfma_f32_16x16x32_bf16 v[196:199], v[20:23], a[244:247], v[196:199]
    v_mfma_f32_16x16x32_bf16 v[196:199], v[16:19], a[228:231], v[196:199]
    v_mfma_f32_16x16x32_bf16 v[200:203], v[16:19], a[232:235], v[200:203]
    ds_read_b64_tr_b16 v[12:13], v2 offset:9216
    v_mfma_f32_16x16x32_bf16 v[200:203], v[20:23], a[248:251], v[200:203]
    ds_read_b64_tr_b16 v[14:15], v2 offset:13824
    v_mfma_f32_16x16x32_bf16 v[204:207], v[20:23], a[252:255], v[204:207]
    v_mfma_f32_16x16x32_bf16 v[204:207], v[16:19], a[236:239], v[204:207]
    s_waitcnt lgkmcnt(4)
    v_mfma_f32_16x16x32_bf16 v[208:211], v[24:27], a[224:227], v[208:211]
    ds_read_b64_tr_b16 v[16:17], v2 offset:18432
    v_mfma_f32_16x16x32_bf16 v[208:211], v[28:31], a[240:243], v[208:211]
    ds_read_b64_tr_b16 v[18:19], v2 offset:23040
    v_mfma_f32_16x16x32_bf16 v[212:215], v[28:31], a[244:247], v[212:215]
    v_mfma_f32_16x16x32_bf16 v[212:215], v[24:27], a[228:231], v[212:215]
    v_mfma_f32_16x16x32_bf16 v[216:219], v[24:27], a[232:235], v[216:219]
    ds_read_b64_tr_b16 v[20:21], v2 offset:27648
    v_mfma_f32_16x16x32_bf16 v[216:219], v[28:31], a[248:251], v[216:219]
    ds_read_b64_tr_b16 v[22:23], v2 offset:32256
    v_mfma_f32_16x16x32_bf16 v[220:223], v[28:31], a[252:255], v[220:223]
    v_mfma_f32_16x16x32_bf16 v[220:223], v[24:27], a[236:239], v[220:223]
    s_waitcnt lgkmcnt(4)
    v_mfma_f32_16x16x32_bf16 v[224:227], v[8:11], a[224:227], v[224:227]
    s_add_u32 s61, s61, 1
    s_cmp_eq_u32 s61, 3
    v_mfma_f32_16x16x32_bf16 v[224:227], v[12:15], a[240:243], v[224:227]
    s_cselect_b32 s61, 0, s61
    s_cselect_b32 s54, s62, s63
    v_mfma_f32_16x16x32_bf16 v[228:231], v[12:15], a[244:247], v[228:231]
    v_mfma_f32_16x16x32_bf16 v[228:231], v[8:11], a[228:231], v[228:231]
    v_add_u32 v0, s54, v0
    v_mfma_f32_16x16x32_bf16 v[232:235], v[8:11], a[232:235], v[232:235]
    v_add_u32 v1, s54, v1
    v_mfma_f32_16x16x32_bf16 v[232:235], v[12:15], a[248:251], v[232:235]
    v_add_u32 v2, s54, v2
    v_mfma_f32_16x16x32_bf16 v[236:239], v[12:15], a[252:255], v[236:239]
    v_mfma_f32_16x16x32_bf16 v[236:239], v[8:11], a[236:239], v[236:239]
    s_waitcnt vmcnt(20) lgkmcnt(0)
    s_barrier
    v_mfma_f32_16x16x32_bf16 v[240:243], v[16:19], a[224:227], v[240:243]
    ds_read_b64_tr_b16 v[8:9], v0 offset:0
    ds_read_b64_tr_b16 v[10:11], v0 offset:4096
    v_mfma_f32_16x16x32_bf16 v[240:243], v[20:23], a[240:243], v[240:243]
    ds_read_b64_tr_b16 v[12:13], v0 offset:8192
    ds_read_b64_tr_b16 v[14:15], v0 offset:12288
    v_mfma_f32_16x16x32_bf16 v[244:247], v[20:23], a[244:247], v[244:247]
    v_mfma_f32_16x16x32_bf16 v[244:247], v[16:19], a[228:231], v[244:247]
    v_mfma_f32_16x16x32_bf16 v[248:251], v[16:19], a[232:235], v[248:251]
    v_mfma_f32_16x16x32_bf16 v[248:251], v[20:23], a[248:251], v[248:251]
    v_mfma_f32_16x16x32_bf16 v[252:255], v[20:23], a[252:255], v[252:255]
    v_mfma_f32_16x16x32_bf16 v[252:255], v[16:19], a[236:239], v[252:255]
    s_waitcnt vmcnt(12) lgkmcnt(0)
    v_mfma_f32_16x16x32_bf16 a[0:3], v[8:11], a[192:195], a[0:3]
    ds_read_b64_tr_b16 v[16:17], v0 offset:8
    ds_read_b64_tr_b16 v[18:19], v0 offset:4104
    v_mfma_f32_16x16x32_bf16 a[0:3], v[12:15], a[208:211], a[0:3]
    ds_read_b64_tr_b16 v[20:21], v0 offset:8200
    ds_read_b64_tr_b16 v[22:23], v0 offset:12296
    v_mfma_f32_16x16x32_bf16 a[4:7], v[12:15], a[212:215], a[4:7]
    v_mfma_f32_16x16x32_bf16 a[4:7], v[8:11], a[196:199], a[4:7]
    v_xor_b32 v0, 0x40, v0
    v_mfma_f32_16x16x32_bf16 a[8:11], v[8:11], a[200:203], a[8:11]
    ds_read_b64_tr_b16 v[24:25], v0 offset:0
    ds_read_b64_tr_b16 v[26:27], v0 offset:4096
    v_mfma_f32_16x16x32_bf16 a[8:11], v[12:15], a[216:219], a[8:11]
    ds_read_b64_tr_b16 v[28:29], v0 offset:8192
    ds_read_b64_tr_b16 v[30:31], v0 offset:12288
    v_mfma_f32_16x16x32_bf16 a[12:15], v[12:15], a[220:223], a[12:15]
    v_mfma_f32_16x16x32_bf16 a[12:15], v[8:11], a[204:207], a[12:15]
    s_lshl_b32 s3, s5, 10
    s_add_u32 s4, s3, 0
    s_waitcnt lgkmcnt(4)
    v_mfma_f32_16x16x32_bf16 a[16:19], v[16:19], a[192:195], a[16:19]
    ds_read_b64_tr_b16 v[8:9], v0 offset:8
    v_mfma_f32_16x16x32_bf16 a[16:19], v[20:23], a[208:211], a[16:19]
    ds_read_b64_tr_b16 v[10:11], v0 offset:4104
    v_mfma_f32_16x16x32_bf16 a[20:23], v[20:23], a[212:215], a[20:23]
    buffer_load_dword a255, v7, s[32:35], s4 offen
    v_mfma_f32_16x16x32_bf16 a[20:23], v[16:19], a[196:199], a[20:23]
    v_mfma_f32_16x16x32_bf16 a[24:27], v[16:19], a[200:203], a[24:27]
    ds_read_b64_tr_b16 v[12:13], v0 offset:8200
    v_mfma_f32_16x16x32_bf16 a[24:27], v[20:23], a[216:219], a[24:27]
    ds_read_b64_tr_b16 v[14:15], v0 offset:12296
    v_mfma_f32_16x16x32_bf16 a[28:31], v[20:23], a[220:223], a[28:31]
    v_mfma_f32_16x16x32_bf16 a[28:31], v[16:19], a[204:207], a[28:31]
    s_add_u32 s4, s3, 32768
    v_xor_b32 v0, 0xc0, v0
    s_waitcnt lgkmcnt(4)
    v_mfma_f32_16x16x32_bf16 a[32:35], v[24:27], a[192:195], a[32:35]
    ds_read_b64_tr_b16 v[16:17], v0 offset:0
    v_mfma_f32_16x16x32_bf16 a[32:35], v[28:31], a[208:211], a[32:35]
    ds_read_b64_tr_b16 v[18:19], v0 offset:4096
    v_mfma_f32_16x16x32_bf16 a[36:39], v[28:31], a[212:215], a[36:39]
    buffer_load_dword a255, v7, s[32:35], s4 offen
    v_mfma_f32_16x16x32_bf16 a[36:39], v[24:27], a[196:199], a[36:39]
    v_mfma_f32_16x16x32_bf16 a[40:43], v[24:27], a[200:203], a[40:43]
    ds_read_b64_tr_b16 v[20:21], v0 offset:8192
    v_mfma_f32_16x16x32_bf16 a[40:43], v[28:31], a[216:219], a[40:43]
    ds_read_b64_tr_b16 v[22:23], v0 offset:12288
    v_mfma_f32_16x16x32_bf16 a[44:47], v[28:31], a[220:223], a[44:47]
    v_mfma_f32_16x16x32_bf16 a[44:47], v[24:27], a[204:207], a[44:47]
    s_add_u32 m0, s55, 49152
    s_waitcnt lgkmcnt(4)
    v_mfma_f32_16x16x32_bf16 a[48:51], v[8:11], a[192:195], a[48:51]
    ds_read_b64_tr_b16 v[24:25], v0 offset:8
    v_mfma_f32_16x16x32_bf16 a[48:51], v[12:15], a[208:211], a[48:51]
    ds_read_b64_tr_b16 v[26:27], v0 offset:4104
    v_mfma_f32_16x16x32_bf16 a[52:55], v[12:15], a[212:215], a[52:55]
    buffer_load_dwordx4 v3, s[28:31], s56 offen offset:0 lds
    v_mfma_f32_16x16x32_bf16 a[52:55], v[8:11], a[196:199], a[52:55]
    v_mfma_f32_16x16x32_bf16 a[56:59], v[8:11], a[200:203], a[56:59]
    ds_read_b64_tr_b16 v[28:29], v0 offset:8200
    v_mfma_f32_16x16x32_bf16 a[56:59], v[12:15], a[216:219], a[56:59]
    ds_read_b64_tr_b16 v[30:31], v0 offset:12296
    v_mfma_f32_16x16x32_bf16 a[60:63], v[12:15], a[220:223], a[60:63]
    v_mfma_f32_16x16x32_bf16 a[60:63], v[8:11], a[204:207], a[60:63]
    v_xor_b32 v0, 0x40, v0
    s_waitcnt lgkmcnt(4)
    v_mfma_f32_16x16x32_bf16 a[64:67], v[16:19], a[192:195], a[64:67]
    ds_read_b64_tr_b16 v[8:9], v0 offset:0
    v_mfma_f32_16x16x32_bf16 a[64:67], v[20:23], a[208:211], a[64:67]
    ds_read_b64_tr_b16 v[10:11], v0 offset:4096
    v_mfma_f32_16x16x32_bf16 a[68:71], v[20:23], a[212:215], a[68:71]
    buffer_load_dwordx4 v4, s[28:31], s56 offen offset:1024 lds
    v_mfma_f32_16x16x32_bf16 a[68:71], v[16:19], a[196:199], a[68:71]
    v_mfma_f32_16x16x32_bf16 a[72:75], v[16:19], a[200:203], a[72:75]
    ds_read_b64_tr_b16 v[12:13], v0 offset:8192
    v_mfma_f32_16x16x32_bf16 a[72:75], v[20:23], a[216:219], a[72:75]
    ds_read_b64_tr_b16 v[14:15], v0 offset:12288
    v_mfma_f32_16x16x32_bf16 a[76:79], v[20:23], a[220:223], a[76:79]
    v_mfma_f32_16x16x32_bf16 a[76:79], v[16:19], a[204:207], a[76:79]
    s_waitcnt lgkmcnt(4)
    v_mfma_f32_16x16x32_bf16 a[80:83], v[24:27], a[192:195], a[80:83]
    ds_read_b64_tr_b16 v[16:17], v0 offset:8
    v_mfma_f32_16x16x32_bf16 a[80:83], v[28:31], a[208:211], a[80:83]
    ds_read_b64_tr_b16 v[18:19], v0 offset:4104
    v_mfma_f32_16x16x32_bf16 a[84:87], v[28:31], a[212:215], a[84:87]
    buffer_load_dwordx4 v5, s[28:31], s56 offen offset:2048 lds
    v_mfma_f32_16x16x32_bf16 a[84:87], v[24:27], a[196:199], a[84:87]
    v_mfma_f32_16x16x32_bf16 a[88:91], v[24:27], a[200:203], a[88:91]
    ds_read_b64_tr_b16 v[20:21], v0 offset:8200
    v_mfma_f32_16x16x32_bf16 a[88:91], v[28:31], a[216:219], a[88:91]
    ds_read_b64_tr_b16 v[22:23], v0 offset:12296
    v_mfma_f32_16x16x32_bf16 a[92:95], v[28:31], a[220:223], a[92:95]
    v_mfma_f32_16x16x32_bf16 a[92:95], v[24:27], a[204:207], a[92:95]
    v_xor_b32 v0, 0xc0, v0
    s_waitcnt lgkmcnt(4)
    v_mfma_f32_16x16x32_bf16 a[96:99], v[8:11], a[192:195], a[96:99]
    ds_read_b64_tr_b16 v[24:25], v1 offset:0
    v_lshrrev_b32 v0, 3, v7
    v_mfma_f32_16x16x32_bf16 a[96:99], v[12:15], a[208:211], a[96:99]
    ds_read_b64_tr_b16 v[26:27], v1 offset:4608
    v_and_b32 v0, 0x60, v0
    v_mfma_f32_16x16x32_bf16 a[100:103], v[12:15], a[212:215], a[100:103]
    buffer_load_dwordx4 v6, s[28:31], s56 offen offset:3072 lds
    v_mfma_f32_16x16x32_bf16 a[100:103], v[8:11], a[196:199], a[100:103]
    s_add_u32 s56, s56, 16384
    v_mfma_f32_16x16x32_bf16 a[104:107], v[8:11], a[200:203], a[104:107]
    ds_read_b64_tr_b16 v[28:29], v1 offset:9216
    v_xor_b32 v0, v0, v7
    v_mfma_f32_16x16x32_bf16 a[104:107], v[12:15], a[216:219], a[104:107]
    ds_read_b64_tr_b16 v[30:31], v1 offset:13824
    v_add_u32 v0, s55, v0
    v_mfma_f32_16x16x32_bf16 a[108:111], v[12:15], a[220:223], a[108:111]
    v_mfma_f32_16x16x32_bf16 a[108:111], v[8:11], a[204:207], a[108:111]
    s_add_u32 s4, s3, 65536
    s_waitcnt lgkmcnt(4)
    v_mfma_f32_16x16x32_bf16 a[112:115], v[16:19], a[192:195], a[112:115]
    ds_read_b64_tr_b16 v[8:9], v1 offset:18432
    v_mfma_f32_16x16x32_bf16 a[112:115], v[20:23], a[208:211], a[112:115]
    ds_read_b64_tr_b16 v[10:11], v1 offset:23040
    v_mfma_f32_16x16x32_bf16 a[116:119], v[20:23], a[212:215], a[116:119]
    buffer_load_dword a255, v7, s[28:31], s4 offen
    v_mfma_f32_16x16x32_bf16 a[116:119], v[16:19], a[196:199], a[116:119]
    v_mfma_f32_16x16x32_bf16 a[120:123], v[16:19], a[200:203], a[120:123]
    ds_read_b64_tr_b16 v[12:13], v1 offset:27648
    v_mfma_f32_16x16x32_bf16 a[120:123], v[20:23], a[216:219], a[120:123]
    ds_read_b64_tr_b16 v[14:15], v1 offset:32256
    v_mfma_f32_16x16x32_bf16 a[124:127], v[20:23], a[220:223], a[124:127]
    v_mfma_f32_16x16x32_bf16 a[124:127], v[16:19], a[204:207], a[124:127]
    s_add_u32 m0, s55, 65536
    s_waitcnt lgkmcnt(4)
    v_mfma_f32_16x16x32_bf16 a[128:131], v[24:27], a[192:195], a[128:131]
    ds_read_b64_tr_b16 v[16:17], v1 offset:32
    v_mfma_f32_16x16x32_bf16 a[128:131], v[28:31], a[208:211], a[128:131]
    ds_read_b64_tr_b16 v[18:19], v1 offset:4640
    v_mfma_f32_16x16x32_bf16 a[132:135], v[28:31], a[212:215], a[132:135]
    buffer_load_dwordx4 v0, s[32:35], s57 offen offset:0 lds
    v_mfma_f32_16x16x32_bf16 a[132:135], v[24:27], a[196:199], a[132:135]
    v_xor_b32 v0, 0x80, v0
    v_mfma_f32_16x16x32_bf16 a[136:139], v[24:27], a[200:203], a[136:139]
    ds_read_b64_tr_b16 v[20:21], v1 offset:9248
    v_mfma_f32_16x16x32_bf16 a[136:139], v[28:31], a[216:219], a[136:139]
    ds_read_b64_tr_b16 v[22:23], v1 offset:13856
    v_mfma_f32_16x16x32_bf16 a[140:143], v[28:31], a[220:223], a[140:143]
    buffer_load_dwordx4 v0, s[32:35], s57 offen offset:1024 lds
    v_mfma_f32_16x16x32_bf16 a[140:143], v[24:27], a[204:207], a[140:143]
    v_xor_b32 v0, 0x80, v0
    s_waitcnt lgkmcnt(4)
    v_mfma_f32_16x16x32_bf16 a[144:147], v[8:11], a[192:195], a[144:147]
    ds_read_b64_tr_b16 v[24:25], v1 offset:18464
    v_mfma_f32_16x16x32_bf16 a[144:147], v[12:15], a[208:211], a[144:147]
    ds_read_b64_tr_b16 v[26:27], v1 offset:23072
    v_mfma_f32_16x16x32_bf16 a[148:151], v[12:15], a[212:215], a[148:151]
    buffer_load_dwordx4 v0, s[32:35], s57 offen offset:2048 lds
    v_mfma_f32_16x16x32_bf16 a[148:151], v[8:11], a[196:199], a[148:151]
    v_xor_b32 v0, 0x80, v0
    v_mfma_f32_16x16x32_bf16 a[152:155], v[8:11], a[200:203], a[152:155]
    ds_read_b64_tr_b16 v[28:29], v1 offset:27680
    v_mfma_f32_16x16x32_bf16 a[152:155], v[12:15], a[216:219], a[152:155]
    ds_read_b64_tr_b16 v[30:31], v1 offset:32288
    v_mfma_f32_16x16x32_bf16 a[156:159], v[12:15], a[220:223], a[156:159]
    buffer_load_dwordx4 v0, s[32:35], s57 offen offset:3072 lds
    v_mfma_f32_16x16x32_bf16 a[156:159], v[8:11], a[204:207], a[156:159]
    s_add_u32 m0, s55, 81920
    s_add_u32 s57, s57, 16384
    v_xor_b32 v0, 0x80, v0
    s_waitcnt lgkmcnt(4)
    v_mfma_f32_16x16x32_bf16 a[160:163], v[16:19], a[192:195], a[160:163]
    ds_read_b64_tr_b16 v[8:9], v1 offset:64
    v_mfma_f32_16x16x32_bf16 a[160:163], v[20:23], a[208:211], a[160:163]
    ds_read_b64_tr_b16 v[10:11], v1 offset:4672
    v_mfma_f32_16x16x32_bf16 a[164:167], v[20:23], a[212:215], a[164:167]
    buffer_load_dwordx4 v0, s[32:35], s57 offen offset:0 lds
    v_mfma_f32_16x16x32_bf16 a[164:167], v[16:19], a[196:199], a[164:167]
    v_xor_b32 v0, 0x80, v0
    v_mfma_f32_16x16x32_bf16 a[168:171], v[16:19], a[200:203], a[168:171]
    ds_read_b64_tr_b16 v[12:13], v1 offset:9280
    v_mfma_f32_16x16x32_bf16 a[168:171], v[20:23], a[216:219], a[168:171]
    ds_read_b64_tr_b16 v[14:15], v1 offset:13888
    v_mfma_f32_16x16x32_bf16 a[172:175], v[20:23], a[220:223], a[172:175]
    buffer_load_dwordx4 v0, s[32:35], s57 offen offset:1024 lds
    v_mfma_f32_16x16x32_bf16 a[172:175], v[16:19], a[204:207], a[172:175]
    v_xor_b32 v0, 0x80, v0
    s_waitcnt lgkmcnt(4)
    v_mfma_f32_16x16x32_bf16 a[176:179], v[24:27], a[192:195], a[176:179]
    ds_read_b64_tr_b16 v[16:17], v1 offset:18496
    v_mfma_f32_16x16x32_bf16 a[176:179], v[28:31], a[208:211], a[176:179]
    ds_read_b64_tr_b16 v[18:19], v1 offset:23104
    v_mfma_f32_16x16x32_bf16 a[180:183], v[28:31], a[212:215], a[180:183]
    buffer_load_dwordx4 v0, s[32:35], s57 offen offset:2048 lds
    v_mfma_f32_16x16x32_bf16 a[180:183], v[24:27], a[196:199], a[180:183]
    v_xor_b32 v0, 0x80, v0
    v_mfma_f32_16x16x32_bf16 a[184:187], v[24:27], a[200:203], a[184:187]
    ds_read_b64_tr_b16 v[20:21], v1 offset:27712
    v_mfma_f32_16x16x32_bf16 a[184:187], v[28:31], a[216:219], a[184:187]
    ds_read_b64_tr_b16 v[22:23], v1 offset:32320
    v_mfma_f32_16x16x32_bf16 a[188:191], v[28:31], a[220:223], a[188:191]
    buffer_load_dwordx4 v0, s[32:35], s57 offen offset:3072 lds
    v_mfma_f32_16x16x32_bf16 a[188:191], v[24:27], a[204:207], a[188:191]
    s_add_u32 s57, s57, 16384
    v_xor_b32 v0, 0x80, v0
    s_waitcnt lgkmcnt(4)
    v_mfma_f32_16x16x32_bf16 v[32:35], v[8:11], a[192:195], v[32:35]
    ds_read_b64_tr_b16 v[24:25], v1 offset:96
    v_mfma_f32_16x16x32_bf16 v[32:35], v[12:15], a[208:211], v[32:35]
    ds_read_b64_tr_b16 v[26:27], v1 offset:4704
    v_mfma_f32_16x16x32_bf16 v[36:39], v[12:15], a[212:215], v[36:39]
    v_mfma_f32_16x16x32_bf16 v[36:39], v[8:11], a[196:199], v[36:39]
    v_mfma_f32_16x16x32_bf16 v[40:43], v[8:11], a[200:203], v[40:43]
    ds_read_b64_tr_b16 v[28:29], v1 offset:9312
    v_mfma_f32_16x16x32_bf16 v[40:43], v[12:15], a[216:219], v[40:43]
    ds_read_b64_tr_b16 v[30:31], v1 offset:13920
    v_mfma_f32_16x16x32_bf16 v[44:47], v[12:15], a[220:223], v[44:47]
    s_and_b32 s43, s2, 7
    s_bfe_u32 s44, s2, 0x20003
    s_mul_i32 s5, s40, 36864
    v_mfma_f32_16x16x32_bf16 v[44:47], v[8:11], a[204:207], v[44:47]
    s_mul_i32 s3, s44, 288
    s_add_u32 s5, s5, s3
    s_and_b32 s6, s43, 3
    s_waitcnt lgkmcnt(4)
    v_mfma_f32_16x16x32_bf16 v[48:51], v[16:19], a[192:195], v[48:51]
    ds_read_b64_tr_b16 v[8:9], v1 offset:18528
    v_mfma_f32_16x16x32_bf16 v[48:51], v[20:23], a[208:211], v[48:51]
    ds_read_b64_tr_b16 v[10:11], v1 offset:23136
    v_mfma_f32_16x16x32_bf16 v[52:55], v[20:23], a[212:215], v[52:55]
    s_mul_i32 s7, s6, 9
    s_lshl_b32 s6, s6, 2
    s_add_u32 s3, s44, 0
    v_mfma_f32_16x16x32_bf16 v[52:55], v[16:19], a[196:199], v[52:55]
    s_and_b32 s3, s3, 3
    s_add_u32 s3, s3, s6
    s_add_u32 s4, s7, 0
    v_mfma_f32_16x16x32_bf16 v[56:59], v[16:19], a[200:203], v[56:59]
    ds_read_b64_tr_b16 v[12:13], v1 offset:27744
    v_mfma_f32_16x16x32_bf16 v[56:59], v[20:23], a[216:219], v[56:59]
    ds_read_b64_tr_b16 v[14:15], v1 offset:32352
    v_mfma_f32_16x16x32_bf16 v[60:63], v[20:23], a[220:223], v[60:63]
    s_cmp_ge_u32 s43, 4
    s_cselect_b32 s3, s4, s3
    s_cselect_b32 s4, 524288, 0
    v_mfma_f32_16x16x32_bf16 v[60:63], v[16:19], a[204:207], v[60:63]
    s_mul_i32 s45, s3, 147456
    s_add_u32 s45, s45, s5
    s_lshl_b32 s3, s3, 14
    s_waitcnt lgkmcnt(4)
    v_mfma_f32_16x16x32_bf16 v[64:67], v[24:27], a[192:195], v[64:67]
    ds_read_b64_tr_b16 v[16:17], v1 offset:128
    v_mfma_f32_16x16x32_bf16 v[64:67], v[28:31], a[208:211], v[64:67]
    ds_read_b64_tr_b16 v[18:19], v1 offset:4736
    v_mfma_f32_16x16x32_bf16 v[68:71], v[28:31], a[212:215], v[68:71]
    s_add_u32 s58, s3, s4
    s_add_u32 s3, s44, 1
    s_and_b32 s3, s3, 3
    v_mfma_f32_16x16x32_bf16 v[68:71], v[24:27], a[196:199], v[68:71]
    s_add_u32 s3, s3, s6
    s_add_u32 s4, s7, 1
    s_cmp_ge_u32 s43, 4
    v_mfma_f32_16x16x32_bf16 v[72:75], v[24:27], a[200:203], v[72:75]
    ds_read_b64_tr_b16 v[20:21], v1 offset:9344
    v_mfma_f32_16x16x32_bf16 v[72:75], v[28:31], a[216:219], v[72:75]
    ds_read_b64_tr_b16 v[22:23], v1 offset:13952
    v_mfma_f32_16x16x32_bf16 v[76:79], v[28:31], a[220:223], v[76:79]
    s_cselect_b32 s3, s4, s3
    s_cselect_b32 s4, 524288, 0
    s_mul_i32 s46, s3, 147456
    v_mfma_f32_16x16x32_bf16 v[76:79], v[24:27], a[204:207], v[76:79]
    s_add_u32 s46, s46, s5
    s_lshl_b32 s3, s3, 14
    s_add_u32 s59, s3, s4
    s_waitcnt lgkmcnt(4)
    v_mfma_f32_16x16x32_bf16 v[80:83], v[8:11], a[192:195], v[80:83]
    ds_read_b64_tr_b16 v[24:25], v1 offset:18560
    v_mfma_f32_16x16x32_bf16 v[80:83], v[12:15], a[208:211], v[80:83]
    ds_read_b64_tr_b16 v[26:27], v1 offset:23168
    v_mfma_f32_16x16x32_bf16 v[84:87], v[12:15], a[212:215], v[84:87]
    s_add_u32 s3, s44, 2
    s_and_b32 s3, s3, 3
    s_add_u32 s3, s3, s6
    v_mfma_f32_16x16x32_bf16 v[84:87], v[8:11], a[196:199], v[84:87]
    s_add_u32 s4, s7, 2
    s_cmp_ge_u32 s43, 4
    s_cselect_b32 s3, s4, s3
    v_mfma_f32_16x16x32_bf16 v[88:91], v[8:11], a[200:203], v[88:91]
    ds_read_b64_tr_b16 v[28:29], v1 offset:27776
    v_mfma_f32_16x16x32_bf16 v[88:91], v[12:15], a[216:219], v[88:91]
    ds_read_b64_tr_b16 v[30:31], v1 offset:32384
    v_mfma_f32_16x16x32_bf16 v[92:95], v[12:15], a[220:223], v[92:95]
    s_cselect_b32 s4, 524288, 0
    s_mul_i32 s47, s3, 147456
    s_add_u32 s47, s47, s5
    v_mfma_f32_16x16x32_bf16 v[92:95], v[8:11], a[204:207], v[92:95]
    s_lshl_b32 s3, s3, 14
    s_add_u32 s60, s3, s4
    s_add_u32 s3, s44, 3
    s_waitcnt lgkmcnt(4)
    v_mfma_f32_16x16x32_bf16 v[96:99], v[16:19], a[192:195], v[96:99]
    ds_read_b64_tr_b16 v[8:9], v1 offset:160
    v_mfma_f32_16x16x32_bf16 v[96:99], v[20:23], a[208:211], v[96:99]
    ds_read_b64_tr_b16 v[10:11], v1 offset:4768
    v_mfma_f32_16x16x32_bf16 v[100:103], v[20:23], a[212:215], v[100:103]
    s_and_b32 s3, s3, 3
    s_add_u32 s3, s3, s6
    s_add_u32 s4, s7, 3
    v_mfma_f32_16x16x32_bf16 v[100:103], v[16:19], a[196:199], v[100:103]
    s_cmp_ge_u32 s43, 4
    s_cselect_b32 s3, s4, s3
    s_cselect_b32 s4, 524288, 0
    v_mfma_f32_16x16x32_bf16 v[104:107], v[16:19], a[200:203], v[104:107]
    ds_read_b64_tr_b16 v[12:13], v1 offset:9376
    v_mfma_f32_16x16x32_bf16 v[104:107], v[20:23], a[216:219], v[104:107]
    ds_read_b64_tr_b16 v[14:15], v1 offset:13984
    v_mfma_f32_16x16x32_bf16 v[108:111], v[20:23], a[220:223], v[108:111]
    s_mul_i32 s48, s3, 147456
    s_add_u32 s48, s48, s5
    s_lshl_b32 s3, s3, 14
    v_mfma_f32_16x16x32_bf16 v[108:111], v[16:19], a[204:207], v[108:111]
    s_add_u32 s61, s3, s4
    s_add_u32 s3, s6, 16
    s_add_u32 s4, s7, 4
    s_waitcnt lgkmcnt(4)
    v_mfma_f32_16x16x32_bf16 v[112:115], v[24:27], a[192:195], v[112:115]
    ds_read_b64_tr_b16 v[16:17], v1 offset:18592
    v_mfma_f32_16x16x32_bf16 v[112:115], v[28:31], a[208:211], v[112:115]
    ds_read_b64_tr_b16 v[18:19], v1 offset:23200
    v_mfma_f32_16x16x32_bf16 v[116:119], v[28:31], a[212:215], v[116:119]
    s_cmp_ge_u32 s43, 4
    s_cselect_b32 s3, s4, s3
    s_cselect_b32 s4, 524288, 0
    v_mfma_f32_16x16x32_bf16 v[116:119], v[24:27], a[196:199], v[116:119]
    s_mul_i32 s52, s3, 147456
    s_add_u32 s52, s52, s5
    s_lshl_b32 s3, s3, 14
    v_mfma_f32_16x16x32_bf16 v[120:123], v[24:27], a[200:203], v[120:123]
    ds_read_b64_tr_b16 v[20:21], v1 offset:27808
    v_mfma_f32_16x16x32_bf16 v[120:123], v[28:31], a[216:219], v[120:123]
    ds_read_b64_tr_b16 v[22:23], v1 offset:32416
    v_mfma_f32_16x16x32_bf16 v[124:127], v[28:31], a[220:223], v[124:127]
    s_add_u32 s62, s3, s4
    s_mul_i32 s7, s7, 147456
    s_mul_i32 s6, s6, 147456
    v_mfma_f32_16x16x32_bf16 v[124:127], v[24:27], a[204:207], v[124:127]
    s_add_u32 s3, s7, 663552
    s_add_u32 s4, s6, 2359296
    s_cmp_ge_u32 s43, 4
    s_waitcnt lgkmcnt(4)
    v_mfma_f32_16x16x32_bf16 v[128:131], v[8:11], a[192:195], v[128:131]
    ds_read_b64_tr_b16 v[24:25], v1 offset:192
    v_mfma_f32_16x16x32_bf16 v[128:131], v[12:15], a[208:211], v[128:131]
    ds_read_b64_tr_b16 v[26:27], v1 offset:4800
    v_mfma_f32_16x16x32_bf16 v[132:135], v[12:15], a[212:215], v[132:135]
    s_cselect_b32 s5, s7, s6
    s_cselect_b32 s7, s3, s4
    s_cselect_b32 s8, s64, s74
    v_mfma_f32_16x16x32_bf16 v[132:135], v[8:11], a[196:199], v[132:135]
    s_cselect_b32 s9, s65, s75
    s_mov_b32 s3, 4718592
    s_cselect_b32 s10, 5308416, s3
    v_mfma_f32_16x16x32_bf16 v[136:139], v[8:11], a[200:203], v[136:139]
    ds_read_b64_tr_b16 v[28:29], v1 offset:9408
    v_mfma_f32_16x16x32_bf16 v[136:139], v[12:15], a[216:219], v[136:139]
    ds_read_b64_tr_b16 v[30:31], v1 offset:14016
    v_mfma_f32_16x16x32_bf16 v[140:143], v[12:15], a[220:223], v[140:143]
    s_mov_b32 s11, 0x00020000
    s_mov_b32 s12, s36
    s_mov_b32 s13, s37
    v_mfma_f32_16x16x32_bf16 v[140:143], v[8:11], a[204:207], v[140:143]
    s_cselect_b32 s14, 1114112, 0
    s_mov_b32 s15, 0x00020000
    s_mul_i32 s49, s40, 9216
    s_waitcnt lgkmcnt(4)
    v_mfma_f32_16x16x32_bf16 v[144:147], v[16:19], a[192:195], v[144:147]
    ds_read_b64_tr_b16 v[8:9], v1 offset:18624
    v_mfma_f32_16x16x32_bf16 v[144:147], v[20:23], a[208:211], v[144:147]
    ds_read_b64_tr_b16 v[10:11], v1 offset:23232
    v_mfma_f32_16x16x32_bf16 v[148:151], v[20:23], a[212:215], v[148:151]
    s_lshl_b32 s3, s42, 12
    s_add_u32 s19, s3, 3145728
    s_and_b32 s4, s43, 3
    v_mfma_f32_16x16x32_bf16 v[148:151], v[16:19], a[196:199], v[148:151]
    s_lshl_b32 s4, s4, 7
    s_add_u32 s4, s4, s19
    s_add_u32 s68, s66, s4
    v_mfma_f32_16x16x32_bf16 v[152:155], v[16:19], a[200:203], v[152:155]
    ds_read_b64_tr_b16 v[12:13], v1 offset:27840
    v_mfma_f32_16x16x32_bf16 v[152:155], v[20:23], a[216:219], v[152:155]
    ds_read_b64_tr_b16 v[14:15], v1 offset:32448
    v_mfma_f32_16x16x32_bf16 v[156:159], v[20:23], a[220:223], v[156:159]
    s_addc_u32 s69, s67, 0
    s_mov_b32 s70, 32
    s_mov_b32 s71, 0x00020000
    v_mfma_f32_16x16x32_bf16 v[156:159], v[16:19], a[204:207], v[156:159]
    s_lshr_b32 s3, s41, 3
    s_lshl_b32 s3, s3, 7
    s_and_b32 s4, s41, 7
    s_waitcnt lgkmcnt(4)
    v_mfma_f32_16x16x32_bf16 v[160:163], v[24:27], a[192:195], v[160:163]
    ds_read_b64_tr_b16 v[16:17], v1 offset:224
    v_mfma_f32_16x16x32_bf16 v[160:163], v[28:31], a[208:211], v[160:163]
    ds_read_b64_tr_b16 v[18:19], v1 offset:4832
    v_mfma_f32_16x16x32_bf16 v[164:167], v[28:31], a[212:215], v[164:167]
    s_lshl_b32 s4, s4, 2
    s_add_u32 s3, s3, s4
    s_add_u32 s3, s3, s19
    v_mfma_f32_16x16x32_bf16 v[164:167], v[24:27], a[196:199], v[164:167]
    s_add_u32 s20, s66, s3
    s_addc_u32 s21, s67, 0
    s_mov_b32 s22, 4
    v_mfma_f32_16x16x32_bf16 v[168:171], v[24:27], a[200:203], v[168:171]
    ds_read_b64_tr_b16 v[20:21], v1 offset:9440
    v_mfma_f32_16x16x32_bf16 v[168:171], v[28:31], a[216:219], v[168:171]
    ds_read_b64_tr_b16 v[22:23], v1 offset:14048
    v_mfma_f32_16x16x32_bf16 v[172:175], v[28:31], a[220:223], v[172:175]
    s_mov_b32 s23, 0x00020000
    s_getpc_b64 s[24:25]
L_k2_cp2:
    s_add_u32 s24, s24, L_k2_loopB_end-L_k2_cp2
    v_mfma_f32_16x16x32_bf16 v[172:175], v[24:27], a[204:207], v[172:175]
    s_addc_u32 s25, s25, 0
    s_mov_b32 s26, L_k2_fallback-L_k2_loopB_end
    s_mov_b32 s27, 0x00020000
    s_waitcnt lgkmcnt(4)
    v_mfma_f32_16x16x32_bf16 v[176:179], v[8:11], a[192:195], v[176:179]
    ds_read_b64_tr_b16 v[24:25], v1 offset:18656
    v_mfma_f32_16x16x32_bf16 v[176:179], v[12:15], a[208:211], v[176:179]
    ds_read_b64_tr_b16 v[26:27], v1 offset:23264
    v_mfma_f32_16x16x32_bf16 v[180:183], v[12:15], a[212:215], v[180:183]
    s_lshr_b32 s3, s2, 3
    s_lshl_b32 s3, s3, 2
    s_add_u32 s3, s3, s40
    v_mfma_f32_16x16x32_bf16 v[180:183], v[8:11], a[196:199], v[180:183]
    s_mul_i32 s16, s3, 1408
    s_sub_u32 s16, s16, 540672
    s_lshl_b32 s17, s3, 9
    v_mfma_f32_16x16x32_bf16 v[184:187], v[8:11], a[200:203], v[184:187]
    ds_read_b64_tr_b16 v[28:29], v1 offset:27872
    v_mfma_f32_16x16x32_bf16 v[184:187], v[12:15], a[216:219], v[184:187]
    ds_read_b64_tr_b16 v[30:31], v1 offset:32480
    v_mfma_f32_16x16x32_bf16 v[188:191], v[12:15], a[220:223], v[188:191]
    s_lshl_b32 s18, s40, 8
    s_and_b32 s3, s41, 1
    s_mul_i32 s50, s41, 9
    v_mfma_f32_16x16x32_bf16 v[188:191], v[8:11], a[204:207], v[188:191]
    s_add_u32 s50, s50, s3
    s_lshr_b32 s50, s50, 1
    s_add_u32 s50, s50, 128
    s_waitcnt lgkmcnt(4)
    v_mfma_f32_16x16x32_bf16 v[192:195], v[16:19], a[192:195], v[192:195]
    ds_read_b64_tr_b16 v[8:9], v2 offset:0
    v_mfma_f32_16x16x32_bf16 v[192:195], v[20:23], a[208:211], v[192:195]
    ds_read_b64_tr_b16 v[10:11], v2 offset:4608
    v_mfma_f32_16x16x32_bf16 v[196:199], v[20:23], a[212:215], v[196:199]
    s_lshl_b32 s50, s50, 12
    s_mul_i32 s4, s3, 18432
    s_add_u32 s6, s50, 16384
    v_mfma_f32_16x16x32_bf16 v[196:199], v[16:19], a[196:199], v[196:199]
    s_sub_u32 s6, s6, s4
    v_mfma_f32_16x16x32_bf16 v[200:203], v[16:19], a[200:203], v[200:203]
    ds_read_b64_tr_b16 v[12:13], v2 offset:9216
    v_mfma_f32_16x16x32_bf16 v[200:203], v[20:23], a[216:219], v[200:203]
    ds_read_b64_tr_b16 v[14:15], v2 offset:13824
    v_mfma_f32_16x16x32_bf16 v[204:207], v[20:23], a[220:223], v[204:207]
    v_mfma_f32_16x16x32_bf16 v[204:207], v[16:19], a[204:207], v[204:207]
    s_waitcnt lgkmcnt(4)
    v_mfma_f32_16x16x32_bf16 v[208:211], v[24:27], a[192:195], v[208:211]
    ds_read_b64_tr_b16 v[16:17], v2 offset:18432
    v_mfma_f32_16x16x32_bf16 v[208:211], v[28:31], a[208:211], v[208:211]
    ds_read_b64_tr_b16 v[18:19], v2 offset:23040
    v_mfma_f32_16x16x32_bf16 v[212:215], v[28:31], a[212:215], v[212:215]
    v_mfma_f32_16x16x32_bf16 v[212:215], v[24:27], a[196:199], v[212:215]
    v_mfma_f32_16x16x32_bf16 v[216:219], v[24:27], a[200:203], v[216:219]
    ds_read_b64_tr_b16 v[20:21], v2 offset:27648
    v_mfma_f32_16x16x32_bf16 v[216:219], v[28:31], a[216:219], v[216:219]
    ds_read_b64_tr_b16 v[22:23], v2 offset:32256
    v_mfma_f32_16x16x32_bf16 v[220:223], v[28:31], a[220:223], v[220:223]
    v_mfma_f32_16x16x32_bf16 v[220:223], v[24:27], a[204:207], v[220:223]
    s_waitcnt lgkmcnt(4)
    v_mfma_f32_16x16x32_bf16 v[224:227], v[8:11], a[192:195], v[224:227]
    v_mfma_f32_16x16x32_bf16 v[224:227], v[12:15], a[208:211], v[224:227]
    v_mfma_f32_16x16x32_bf16 v[228:231], v[12:15], a[212:215], v[228:231]
    v_mfma_f32_16x16x32_bf16 v[228:231], v[8:11], a[196:199], v[228:231]
    v_mfma_f32_16x16x32_bf16 v[232:235], v[8:11], a[200:203], v[232:235]
    v_mfma_f32_16x16x32_bf16 v[232:235], v[12:15], a[216:219], v[232:235]
    v_mfma_f32_16x16x32_bf16 v[236:239], v[12:15], a[220:223], v[236:239]
    v_mfma_f32_16x16x32_bf16 v[236:239], v[8:11], a[204:207], v[236:239]
    s_waitcnt lgkmcnt(0)
    v_mfma_f32_16x16x32_bf16 v[240:243], v[16:19], a[192:195], v[240:243]
    v_mfma_f32_16x16x32_bf16 v[240:243], v[20:23], a[208:211], v[240:243]
    v_mfma_f32_16x16x32_bf16 v[244:247], v[20:23], a[212:215], v[244:247]
    v_mfma_f32_16x16x32_bf16 v[244:247], v[16:19], a[196:199], v[244:247]
    v_mfma_f32_16x16x32_bf16 v[248:251], v[16:19], a[200:203], v[248:251]
    v_mfma_f32_16x16x32_bf16 v[248:251], v[20:23], a[216:219], v[248:251]
    v_mfma_f32_16x16x32_bf16 v[252:255], v[20:23], a[220:223], v[252:255]
    v_mfma_f32_16x16x32_bf16 v[252:255], v[16:19], a[204:207], v[252:255]
    v_lshrrev_b32 v18, 4, v7
    v_lshl_add_u32 v0, v18, 2, s18
    v_lshrrev_b32 v16, 3, v7
    v_and_b32 v16, 0x60, v16
    v_xor_b32 v16, v16, v7
    v_add_u32 v16, s55, v16
    v_xor_b32 v17, 0x80, v16
    v_mov_b32 v8, 0xbdd2d3e8
    v_mov_b32 v9, 0xbdd2d3e8
    v_mov_b32 v10, 0xc0135761
    v_mov_b32 v11, 0xc0135761
    v_mov_b32 v12, 0x3f800000
    v_mov_b32 v13, 0x3f800000
    v_mov_b32 v14, 0x3e0293ee
    v_mov_b32 v15, 0x3e0293ee
    v_pk_mul_f32 v[20:21], v[32:33], v[32:33]
    v_pk_mul_f32 v[22:23], v[34:35], v[34:35]
    v_pk_mul_f32 v[24:25], v[64:65], v[64:65]
    v_pk_mul_f32 v[26:27], v[66:67], v[66:67]
    v_pk_fma_f32 v[20:21], v[20:21], v[8:9], v[10:11]
    v_pk_fma_f32 v[22:23], v[22:23], v[8:9], v[10:11]
    v_pk_fma_f32 v[24:25], v[24:25], v[8:9], v[10:11]
    v_pk_fma_f32 v[26:27], v[26:27], v[8:9], v[10:11]
    v_pk_mul_f32 v[20:21], v[20:21], v[32:33]
    v_pk_mul_f32 v[22:23], v[22:23], v[34:35]
    v_pk_mul_f32 v[24:25], v[24:25], v[64:65]
    v_pk_mul_f32 v[26:27], v[26:27], v[66:67]
    v_exp_f32 v20, v20
    v_exp_f32 v21, v21
    v_exp_f32 v22, v22
    v_exp_f32 v23, v23
    v_exp_f32 v24, v24
    v_exp_f32 v25, v25
    v_exp_f32 v26, v26
    v_exp_f32 v27, v27
    v_pk_add_f32 v[20:21], v[20:21], v[12:13]
    v_pk_add_f32 v[22:23], v[22:23], v[12:13]
    v_pk_add_f32 v[24:25], v[24:25], v[12:13]
    v_pk_add_f32 v[26:27], v[26:27], v[12:13]
    v_rcp_f32 v20, v20
    v_rcp_f32 v21, v21
    v_rcp_f32 v22, v22
    v_rcp_f32 v23, v23
    v_rcp_f32 v24, v24
    v_rcp_f32 v25, v25
    v_rcp_f32 v26, v26
    v_rcp_f32 v27, v27
    v_pk_mul_f32 v[20:21], v[20:21], v[32:33]
    v_pk_mul_f32 v[22:23], v[22:23], v[34:35]
    v_pk_mul_f32 v[24:25], v[24:25], v[64:65]
    v_pk_mul_f32 v[26:27], v[26:27], v[66:67]
    v_pk_mul_f32 v[20:21], v[20:21], v[48:49]
    v_pk_mul_f32 v[22:23], v[22:23], v[50:51]
    v_pk_mul_f32 v[24:25], v[24:25], v[80:81]
    v_pk_mul_f32 v[26:27], v[26:27], v[82:83]
    v_cvt_pk_bf16_f32 v28, v20, v21
    v_cvt_pk_bf16_f32 v29, v22, v23
    v_cvt_pk_bf16_f32 v30, v24, v25
    v_cvt_pk_bf16_f32 v31, v26, v27
    s_add_u32 s3, s50, 4096
    buffer_store_dwordx4 v[28:31], v7, s[36:39], s3 offen offset:0 sc1
    v_pk_mul_f32 v[20:21], v[36:37], v[36:37]
    v_pk_mul_f32 v[22:23], v[38:39], v[38:39]
    v_pk_mul_f32 v[24:25], v[68:69], v[68:69]
    v_pk_mul_f32 v[26:27], v[70:71], v[70:71]
    v_pk_fma_f32 v[20:21], v[20:21], v[8:9], v[10:11]
    v_pk_fma_f32 v[22:23], v[22:23], v[8:9], v[10:11]
    v_pk_fma_f32 v[24:25], v[24:25], v[8:9], v[10:11]
    v_pk_fma_f32 v[26:27], v[26:27], v[8:9], v[10:11]
    v_pk_mul_f32 v[20:21], v[20:21], v[36:37]
    v_pk_mul_f32 v[22:23], v[22:23], v[38:39]
    v_pk_mul_f32 v[24:25], v[24:25], v[68:69]
    v_pk_mul_f32 v[26:27], v[26:27], v[70:71]
    v_exp_f32 v20, v20
    v_exp_f32 v21, v21
    v_exp_f32 v22, v22
    v_exp_f32 v23, v23
    v_exp_f32 v24, v24
    v_exp_f32 v25, v25
    v_exp_f32 v26, v26
    v_exp_f32 v27, v27
    v_pk_add_f32 v[20:21], v[20:21], v[12:13]
    v_pk_add_f32 v[22:23], v[22:23], v[12:13]
    v_pk_add_f32 v[24:25], v[24:25], v[12:13]
    v_pk_add_f32 v[26:27], v[26:27], v[12:13]
    v_rcp_f32 v20, v20
    v_rcp_f32 v21, v21
    v_rcp_f32 v22, v22
    v_rcp_f32 v23, v23
    v_rcp_f32 v24, v24
    v_rcp_f32 v25, v25
    v_rcp_f32 v26, v26
    v_rcp_f32 v27, v27
    v_pk_mul_f32 v[20:21], v[20:21], v[36:37]
    v_pk_mul_f32 v[22:23], v[22:23], v[38:39]
    v_pk_mul_f32 v[24:25], v[24:25], v[68:69]
    v_pk_mul_f32 v[26:27], v[26:27], v[70:71]
    v_pk_mul_f32 v[20:21], v[20:21], v[52:53]
    v_pk_mul_f32 v[22:23], v[22:23], v[54:55]
    v_pk_mul_f32 v[24:25], v[24:25], v[84:85]
    v_pk_mul_f32 v[26:27], v[26:27], v[86:87]
    v_cvt_pk_bf16_f32 v28, v20, v21
    v_cvt_pk_bf16_f32 v29, v22, v23
    v_cvt_pk_bf16_f32 v30, v24, v25
    v_cvt_pk_bf16_f32 v31, v26, v27
    s_add_u32 s3, s50, 4096
    buffer_store_dwordx4 v[28:31], v7, s[36:39], s3 offen offset:1024 sc1
    v_pk_mul_f32 v[20:21], v[40:41], v[40:41]
    v_pk_mul_f32 v[22:23], v[42:43], v[42:43]
    v_pk_mul_f32 v[24:25], v[72:73], v[72:73]
    v_pk_mul_f32 v[26:27], v[74:75], v[74:75]
    v_pk_fma_f32 v[20:21], v[20:21], v[8:9], v[10:11]
    v_pk_fma_f32 v[22:23], v[22:23], v[8:9], v[10:11]
    v_pk_fma_f32 v[24:25], v[24:25], v[8:9], v[10:11]
    v_pk_fma_f32 v[26:27], v[26:27], v[8:9], v[10:11]
    v_pk_mul_f32 v[20:21], v[20:21], v[40:41]
    v_pk_mul_f32 v[22:23], v[22:23], v[42:43]
    v_pk_mul_f32 v[24:25], v[24:25], v[72:73]
    v_pk_mul_f32 v[26:27], v[26:27], v[74:75]
    v_exp_f32 v20, v20
    v_exp_f32 v21, v21
    v_exp_f32 v22, v22
    v_exp_f32 v23, v23
    v_exp_f32 v24, v24
    v_exp_f32 v25, v25
    v_exp_f32 v26, v26
    v_exp_f32 v27, v27
    v_pk_add_f32 v[20:21], v[20:21], v[12:13]
    v_pk_add_f32 v[22:23], v[22:23], v[12:13]
    v_pk_add_f32 v[24:25], v[24:25], v[12:13]
    v_pk_add_f32 v[26:27], v[26:27], v[12:13]
    v_rcp_f32 v20, v20
    v_rcp_f32 v21, v21
    v_rcp_f32 v22, v22
    v_rcp_f32 v23, v23
    v_rcp_f32 v24, v24
    v_rcp_f32 v25, v25
    v_rcp_f32 v26, v26
    v_rcp_f32 v27, v27
    v_pk_mul_f32 v[20:21], v[20:21], v[40:41]
    v_pk_mul_f32 v[22:23], v[22:23], v[42:43]
    v_pk_mul_f32 v[24:25], v[24:25], v[72:73]
    v_pk_mul_f32 v[26:27], v[26:27], v[74:75]
    v_pk_mul_f32 v[20:21], v[20:21], v[56:57]
    v_pk_mul_f32 v[22:23], v[22:23], v[58:59]
    v_pk_mul_f32 v[24:25], v[24:25], v[88:89]
    v_pk_mul_f32 v[26:27], v[26:27], v[90:91]
    v_cvt_pk_bf16_f32 v28, v20, v21
    v_cvt_pk_bf16_f32 v29, v22, v23
    v_cvt_pk_bf16_f32 v30, v24, v25
    v_cvt_pk_bf16_f32 v31, v26, v27
    s_add_u32 s3, s50, 4096
    buffer_store_dwordx4 v[28:31], v7, s[36:39], s3 offen offset:2048 sc1
    v_pk_mul_f32 v[20:21], v[44:45], v[44:45]
    v_pk_mul_f32 v[22:23], v[46:47], v[46:47]
    v_pk_mul_f32 v[24:25], v[76:77], v[76:77]
    v_pk_mul_f32 v[26:27], v[78:79], v[78:79]
    v_pk_fma_f32 v[20:21], v[20:21], v[8:9], v[10:11]
    v_pk_fma_f32 v[22:23], v[22:23], v[8:9], v[10:11]
    v_pk_fma_f32 v[24:25], v[24:25], v[8:9], v[10:11]
    v_pk_fma_f32 v[26:27], v[26:27], v[8:9], v[10:11]
    v_pk_mul_f32 v[20:21], v[20:21], v[44:45]
    v_pk_mul_f32 v[22:23], v[22:23], v[46:47]
    v_pk_mul_f32 v[24:25], v[24:25], v[76:77]
    v_pk_mul_f32 v[26:27], v[26:27], v[78:79]
    v_exp_f32 v20, v20
    v_exp_f32 v21, v21
    v_exp_f32 v22, v22
    v_exp_f32 v23, v23
    v_exp_f32 v24, v24
    v_exp_f32 v25, v25
    v_exp_f32 v26, v26
    v_exp_f32 v27, v27
    v_pk_add_f32 v[20:21], v[20:21], v[12:13]
    v_pk_add_f32 v[22:23], v[22:23], v[12:13]
    v_pk_add_f32 v[24:25], v[24:25], v[12:13]
    v_pk_add_f32 v[26:27], v[26:27], v[12:13]
    v_rcp_f32 v20, v20
    v_rcp_f32 v21, v21
    v_rcp_f32 v22, v22
    v_rcp_f32 v23, v23
    v_rcp_f32 v24, v24
    v_rcp_f32 v25, v25
    v_rcp_f32 v26, v26
    v_rcp_f32 v27, v27
    v_pk_mul_f32 v[20:21], v[20:21], v[44:45]
    v_pk_mul_f32 v[22:23], v[22:23], v[46:47]
    v_pk_mul_f32 v[24:25], v[24:25], v[76:77]
    v_pk_mul_f32 v[26:27], v[26:27], v[78:79]
    v_pk_mul_f32 v[20:21], v[20:21], v[60:61]
    v_pk_mul_f32 v[22:23], v[22:23], v[62:63]
    v_pk_mul_f32 v[24:25], v[24:25], v[92:93]
    v_pk_mul_f32 v[26:27], v[26:27], v[94:95]
    v_cvt_pk_bf16_f32 v28, v20, v21
    v_cvt_pk_bf16_f32 v29, v22, v23
    v_cvt_pk_bf16_f32 v30, v24, v25
    v_cvt_pk_bf16_f32 v31, v26, v27
    s_add_u32 s3, s50, 4096
    buffer_store_dwordx4 v[28:31], v7, s[36:39], s3 offen offset:3072 sc1
    v_accvgpr_read_b32 v32, a0
    v_accvgpr_read_b32 v33, a1
    v_accvgpr_read_b32 v34, a2
    v_accvgpr_read_b32 v35, a3
    v_accvgpr_read_b32 v36, a16
    v_accvgpr_read_b32 v37, a17
    v_accvgpr_read_b32 v38, a18
    v_accvgpr_read_b32 v39, a19
    v_accvgpr_read_b32 v40, a4
    v_accvgpr_read_b32 v41, a5
    v_accvgpr_read_b32 v42, a6
    v_accvgpr_read_b32 v43, a7
    v_accvgpr_read_b32 v44, a20
    v_accvgpr_read_b32 v45, a21
    v_accvgpr_read_b32 v46, a22
    v_accvgpr_read_b32 v47, a23
    v_pk_mul_f32 v[32:33], v[32:33], v[14:15]
    v_pk_mul_f32 v[34:35], v[34:35], v[14:15]
    v_pk_mul_f32 v[36:37], v[36:37], v[14:15]
    v_pk_mul_f32 v[38:39], v[38:39], v[14:15]
    v_pk_mul_f32 v[40:41], v[40:41], v[14:15]
    v_pk_mul_f32 v[42:43], v[42:43], v[14:15]
    v_pk_mul_f32 v[44:45], v[44:45], v[14:15]
    v_pk_mul_f32 v[46:47], v[46:47], v[14:15]
    v_cvt_pk_bf16_f32 v64, v32, v33
    v_cvt_pk_bf16_f32 v65, v34, v35
    v_cvt_pk_bf16_f32 v66, v36, v37
    v_cvt_pk_bf16_f32 v67, v38, v39
    v_cvt_pk_bf16_f32 v80, v40, v41
    v_cvt_pk_bf16_f32 v81, v42, v43
    v_cvt_pk_bf16_f32 v82, v44, v45
    v_cvt_pk_bf16_f32 v83, v46, v47
    v_pk_mul_f32 v[20:21], v[96:97], v[96:97]
    v_pk_mul_f32 v[22:23], v[98:99], v[98:99]
    v_pk_mul_f32 v[24:25], v[128:129], v[128:129]
    v_pk_mul_f32 v[26:27], v[130:131], v[130:131]
    v_pk_fma_f32 v[20:21], v[20:21], v[8:9], v[10:11]
    v_pk_fma_f32 v[22:23], v[22:23], v[8:9], v[10:11]
    v_pk_fma_f32 v[24:25], v[24:25], v[8:9], v[10:11]
    v_pk_fma_f32 v[26:27], v[26:27], v[8:9], v[10:11]
    v_pk_mul_f32 v[20:21], v[20:21], v[96:97]
    v_pk_mul_f32 v[22:23], v[22:23], v[98:99]
    v_pk_mul_f32 v[24:25], v[24:25], v[128:129]
    v_pk_mul_f32 v[26:27], v[26:27], v[130:131]
    v_exp_f32 v20, v20
    v_exp_f32 v21, v21
    v_exp_f32 v22, v22
    v_exp_f32 v23, v23
    v_exp_f32 v24, v24
    v_exp_f32 v25, v25
    v_exp_f32 v26, v26
    v_exp_f32 v27, v27
    v_pk_add_f32 v[20:21], v[20:21], v[12:13]
    v_pk_add_f32 v[22:23], v[22:23], v[12:13]
    v_pk_add_f32 v[24:25], v[24:25], v[12:13]
    v_pk_add_f32 v[26:27], v[26:27], v[12:13]
    v_rcp_f32 v20, v20
    v_rcp_f32 v21, v21
    v_rcp_f32 v22, v22
    v_rcp_f32 v23, v23
    v_rcp_f32 v24, v24
    v_rcp_f32 v25, v25
    v_rcp_f32 v26, v26
    v_rcp_f32 v27, v27
    v_pk_mul_f32 v[20:21], v[20:21], v[96:97]
    v_pk_mul_f32 v[22:23], v[22:23], v[98:99]
    v_pk_mul_f32 v[24:25], v[24:25], v[128:129]
    v_pk_mul_f32 v[26:27], v[26:27], v[130:131]
    v_pk_mul_f32 v[20:21], v[20:21], v[112:113]
    v_pk_mul_f32 v[22:23], v[22:23], v[114:115]
    v_pk_mul_f32 v[24:25], v[24:25], v[144:145]
    v_pk_mul_f32 v[26:27], v[26:27], v[146:147]
    v_cvt_pk_bf16_f32 v28, v20, v21
    v_cvt_pk_bf16_f32 v29, v22, v23
    v_cvt_pk_bf16_f32 v30, v24, v25
    v_cvt_pk_bf16_f32 v31, v26, v27
    s_add_u32 s3, s50, 8192
    buffer_store_dwordx4 v[28:31], v7, s[36:39], s3 offen offset:0 sc1
    v_accvgpr_read_b32 v32, a32
    v_accvgpr_read_b32 v33, a33
    v_accvgpr_read_b32 v34, a34
    v_accvgpr_read_b32 v35, a35
    v_accvgpr_read_b32 v36, a48
    v_accvgpr_read_b32 v37, a49
    v_accvgpr_read_b32 v38, a50
    v_accvgpr_read_b32 v39, a51
    v_accvgpr_read_b32 v40, a36
    v_accvgpr_read_b32 v41, a37
    v_accvgpr_read_b32 v42, a38
    v_accvgpr_read_b32 v43, a39
    v_accvgpr_read_b32 v44, a52
    v_accvgpr_read_b32 v45, a53
    v_accvgpr_read_b32 v46, a54
    v_accvgpr_read_b32 v47, a55
    v_pk_mul_f32 v[32:33], v[32:33], v[14:15]
    v_pk_mul_f32 v[34:35], v[34:35], v[14:15]
    v_pk_mul_f32 v[36:37], v[36:37], v[14:15]
    v_pk_mul_f32 v[38:39], v[38:39], v[14:15]
    v_pk_mul_f32 v[40:41], v[40:41], v[14:15]
    v_pk_mul_f32 v[42:43], v[42:43], v[14:15]
    v_pk_mul_f32 v[44:45], v[44:45], v[14:15]
    v_pk_mul_f32 v[46:47], v[46:47], v[14:15]
    v_cvt_pk_bf16_f32 v68, v32, v33
    v_cvt_pk_bf16_f32 v69, v34, v35
    v_cvt_pk_bf16_f32 v70, v36, v37
    v_cvt_pk_bf16_f32 v71, v38, v39
    v_cvt_pk_bf16_f32 v84, v40, v41
    v_cvt_pk_bf16_f32 v85, v42, v43
    v_cvt_pk_bf16_f32 v86, v44, v45
    v_cvt_pk_bf16_f32 v87, v46, v47
    v_pk_mul_f32 v[20:21], v[100:101], v[100:101]
    v_pk_mul_f32 v[22:23], v[102:103], v[102:103]
    v_pk_mul_f32 v[24:25], v[132:133], v[132:133]
    v_pk_mul_f32 v[26:27], v[134:135], v[134:135]
    v_pk_fma_f32 v[20:21], v[20:21], v[8:9], v[10:11]
    v_pk_fma_f32 v[22:23], v[22:23], v[8:9], v[10:11]
    v_pk_fma_f32 v[24:25], v[24:25], v[8:9], v[10:11]
    v_pk_fma_f32 v[26:27], v[26:27], v[8:9], v[10:11]
    v_pk_mul_f32 v[20:21], v[20:21], v[100:101]
    v_pk_mul_f32 v[22:23], v[22:23], v[102:103]
    v_pk_mul_f32 v[24:25], v[24:25], v[132:133]
    v_pk_mul_f32 v[26:27], v[26:27], v[134:135]
    v_exp_f32 v20, v20
    v_exp_f32 v21, v21
    v_exp_f32 v22, v22
    v_exp_f32 v23, v23
    v_exp_f32 v24, v24
    v_exp_f32 v25, v25
    v_exp_f32 v26, v26
    v_exp_f32 v27, v27
    v_pk_add_f32 v[20:21], v[20:21], v[12:13]
    v_pk_add_f32 v[22:23], v[22:23], v[12:13]
    v_pk_add_f32 v[24:25], v[24:25], v[12:13]
    v_pk_add_f32 v[26:27], v[26:27], v[12:13]
    v_rcp_f32 v20, v20
    v_rcp_f32 v21, v21
    v_rcp_f32 v22, v22
    v_rcp_f32 v23, v23
    v_rcp_f32 v24, v24
    v_rcp_f32 v25, v25
    v_rcp_f32 v26, v26
    v_rcp_f32 v27, v27
    v_pk_mul_f32 v[20:21], v[20:21], v[100:101]
    v_pk_mul_f32 v[22:23], v[22:23], v[102:103]
    v_pk_mul_f32 v[24:25], v[24:25], v[132:133]
    v_pk_mul_f32 v[26:27], v[26:27], v[134:135]
    v_pk_mul_f32 v[20:21], v[20:21], v[116:117]
    v_pk_mul_f32 v[22:23], v[22:23], v[118:119]
    v_pk_mul_f32 v[24:25], v[24:25], v[148:149]
    v_pk_mul_f32 v[26:27], v[26:27], v[150:151]
    v_cvt_pk_bf16_f32 v28, v20, v21
    v_cvt_pk_bf16_f32 v29, v22, v23
    v_cvt_pk_bf16_f32 v30, v24, v25
    v_cvt_pk_bf16_f32 v31, v26, v27
    s_add_u32 s3, s50, 8192
    buffer_store_dwordx4 v[28:31], v7, s[36:39], s3 offen offset:1024 sc1
    v_accvgpr_read_b32 v32, a64
    v_accvgpr_read_b32 v33, a65
    v_accvgpr_read_b32 v34, a66
    v_accvgpr_read_b32 v35, a67
    v_accvgpr_read_b32 v36, a80
    v_accvgpr_read_b32 v37, a81
    v_accvgpr_read_b32 v38, a82
    v_accvgpr_read_b32 v39, a83
    v_accvgpr_read_b32 v40, a68
    v_accvgpr_read_b32 v41, a69
    v_accvgpr_read_b32 v42, a70
    v_accvgpr_read_b32 v43, a71
    v_accvgpr_read_b32 v44, a84
    v_accvgpr_read_b32 v45, a85
    v_accvgpr_read_b32 v46, a86
    v_accvgpr_read_b32 v47, a87
    v_pk_mul_f32 v[32:33], v[32:33], v[14:15]
    v_pk_mul_f32 v[34:35], v[34:35], v[14:15]
    v_pk_mul_f32 v[36:37], v[36:37], v[14:15]
    v_pk_mul_f32 v[38:39], v[38:39], v[14:15]
    v_pk_mul_f32 v[40:41], v[40:41], v[14:15]
    v_pk_mul_f32 v[42:43], v[42:43], v[14:15]
    v_pk_mul_f32 v[44:45], v[44:45], v[14:15]
    v_pk_mul_f32 v[46:47], v[46:47], v[14:15]
    v_cvt_pk_bf16_f32 v72, v32, v33
    v_cvt_pk_bf16_f32 v73, v34, v35
    v_cvt_pk_bf16_f32 v74, v36, v37
    v_cvt_pk_bf16_f32 v75, v38, v39
    v_cvt_pk_bf16_f32 v88, v40, v41
    v_cvt_pk_bf16_f32 v89, v42, v43
    v_cvt_pk_bf16_f32 v90, v44, v45
    v_cvt_pk_bf16_f32 v91, v46, v47
    v_pk_mul_f32 v[20:21], v[104:105], v[104:105]
    v_pk_mul_f32 v[22:23], v[106:107], v[106:107]
    v_pk_mul_f32 v[24:25], v[136:137], v[136:137]
    v_pk_mul_f32 v[26:27], v[138:139], v[138:139]
    v_pk_fma_f32 v[20:21], v[20:21], v[8:9], v[10:11]
    v_pk_fma_f32 v[22:23], v[22:23], v[8:9], v[10:11]
    v_pk_fma_f32 v[24:25], v[24:25], v[8:9], v[10:11]
    v_pk_fma_f32 v[26:27], v[26:27], v[8:9], v[10:11]
    v_pk_mul_f32 v[20:21], v[20:21], v[104:105]
    v_pk_mul_f32 v[22:23], v[22:23], v[106:107]
    v_pk_mul_f32 v[24:25], v[24:25], v[136:137]
    v_pk_mul_f32 v[26:27], v[26:27], v[138:139]
    v_exp_f32 v20, v20
    v_exp_f32 v21, v21
    v_exp_f32 v22, v22
    v_exp_f32 v23, v23
    v_exp_f32 v24, v24
    v_exp_f32 v25, v25
    v_exp_f32 v26, v26
    v_exp_f32 v27, v27
    v_pk_add_f32 v[20:21], v[20:21], v[12:13]
    v_pk_add_f32 v[22:23], v[22:23], v[12:13]
    v_pk_add_f32 v[24:25], v[24:25], v[12:13]
    v_pk_add_f32 v[26:27], v[26:27], v[12:13]
    v_rcp_f32 v20, v20
    v_rcp_f32 v21, v21
    v_rcp_f32 v22, v22
    v_rcp_f32 v23, v23
    v_rcp_f32 v24, v24
    v_rcp_f32 v25, v25
    v_rcp_f32 v26, v26
    v_rcp_f32 v27, v27
    v_pk_mul_f32 v[20:21], v[20:21], v[104:105]
    v_pk_mul_f32 v[22:23], v[22:23], v[106:107]
    v_pk_mul_f32 v[24:25], v[24:25], v[136:137]
    v_pk_mul_f32 v[26:27], v[26:27], v[138:139]
    v_pk_mul_f32 v[20:21], v[20:21], v[120:121]
    v_pk_mul_f32 v[22:23], v[22:23], v[122:123]
    v_pk_mul_f32 v[24:25], v[24:25], v[152:153]
    v_pk_mul_f32 v[26:27], v[26:27], v[154:155]
    v_cvt_pk_bf16_f32 v28, v20, v21
    v_cvt_pk_bf16_f32 v29, v22, v23
    v_cvt_pk_bf16_f32 v30, v24, v25
    v_cvt_pk_bf16_f32 v31, v26, v27
    s_add_u32 s3, s50, 8192
    buffer_store_dwordx4 v[28:31], v7, s[36:39], s3 offen offset:2048 sc1
    v_accvgpr_read_b32 v32, a96
    v_accvgpr_read_b32 v33, a97
    v_accvgpr_read_b32 v34, a98
    v_accvgpr_read_b32 v35, a99
    v_accvgpr_read_b32 v36, a112
    v_accvgpr_read_b32 v37, a113
    v_accvgpr_read_b32 v38, a114
    v_accvgpr_read_b32 v39, a115
    v_accvgpr_read_b32 v40, a100
    v_accvgpr_read_b32 v41, a101
    v_accvgpr_read_b32 v42, a102
    v_accvgpr_read_b32 v43, a103
    v_accvgpr_read_b32 v44, a116
    v_accvgpr_read_b32 v45, a117
    v_accvgpr_read_b32 v46, a118
    v_accvgpr_read_b32 v47, a119
    v_pk_mul_f32 v[32:33], v[32:33], v[14:15]
    v_pk_mul_f32 v[34:35], v[34:35], v[14:15]
    v_pk_mul_f32 v[36:37], v[36:37], v[14:15]
    v_pk_mul_f32 v[38:39], v[38:39], v[14:15]
    v_pk_mul_f32 v[40:41], v[40:41], v[14:15]
    v_pk_mul_f32 v[42:43], v[42:43], v[14:15]
    v_pk_mul_f32 v[44:45], v[44:45], v[14:15]
    v_pk_mul_f32 v[46:47], v[46:47], v[14:15]
    v_cvt_pk_bf16_f32 v76, v32, v33
    v_cvt_pk_bf16_f32 v77, v34, v35
    v_cvt_pk_bf16_f32 v78, v36, v37
    v_cvt_pk_bf16_f32 v79, v38, v39
    v_cvt_pk_bf16_f32 v92, v40, v41
    v_cvt_pk_bf16_f32 v93, v42, v43
    v_cvt_pk_bf16_f32 v94, v44, v45
    v_cvt_pk_bf16_f32 v95, v46, v47
    v_pk_mul_f32 v[20:21], v[108:109], v[108:109]
    v_pk_mul_f32 v[22:23], v[110:111], v[110:111]
    v_pk_mul_f32 v[24:25], v[140:141], v[140:141]
    v_pk_mul_f32 v[26:27], v[142:143], v[142:143]
    v_pk_fma_f32 v[20:21], v[20:21], v[8:9], v[10:11]
    v_pk_fma_f32 v[22:23], v[22:23], v[8:9], v[10:11]
    v_pk_fma_f32 v[24:25], v[24:25], v[8:9], v[10:11]
    v_pk_fma_f32 v[26:27], v[26:27], v[8:9], v[10:11]
    v_pk_mul_f32 v[20:21], v[20:21], v[108:109]
    v_pk_mul_f32 v[22:23], v[22:23], v[110:111]
    v_pk_mul_f32 v[24:25], v[24:25], v[140:141]
    v_pk_mul_f32 v[26:27], v[26:27], v[142:143]
    v_exp_f32 v20, v20
    v_exp_f32 v21, v21
    v_exp_f32 v22, v22
    v_exp_f32 v23, v23
    v_exp_f32 v24, v24
    v_exp_f32 v25, v25
    v_exp_f32 v26, v26
    v_exp_f32 v27, v27
    v_pk_add_f32 v[20:21], v[20:21], v[12:13]
    v_pk_add_f32 v[22:23], v[22:23], v[12:13]
    v_pk_add_f32 v[24:25], v[24:25], v[12:13]
    v_pk_add_f32 v[26:27], v[26:27], v[12:13]
    v_rcp_f32 v20, v20
    v_rcp_f32 v21, v21
    v_rcp_f32 v22, v22
    v_rcp_f32 v23, v23
    v_rcp_f32 v24, v24
    v_rcp_f32 v25, v25
    v_rcp_f32 v26, v26
    v_rcp_f32 v27, v27
    v_pk_mul_f32 v[20:21], v[20:21], v[108:109]
    v_pk_mul_f32 v[22:23], v[22:23], v[110:111]
    v_pk_mul_f32 v[24:25], v[24:25], v[140:141]
    v_pk_mul_f32 v[26:27], v[26:27], v[142:143]
    v_pk_mul_f32 v[20:21], v[20:21], v[124:125]
    v_pk_mul_f32 v[22:23], v[22:23], v[126:127]
    v_pk_mul_f32 v[24:25], v[24:25], v[156:157]
    v_pk_mul_f32 v[26:27], v[26:27], v[158:159]
    v_cvt_pk_bf16_f32 v28, v20, v21
    v_cvt_pk_bf16_f32 v29, v22, v23
    v_cvt_pk_bf16_f32 v30, v24, v25
    v_cvt_pk_bf16_f32 v31, v26, v27
    s_add_u32 s3, s50, 8192
    buffer_store_dwordx4 v[28:31], v7, s[36:39], s3 offen offset:3072 sc1
    v_accvgpr_read_b32 v32, a128
    v_accvgpr_read_b32 v33, a129
    v_accvgpr_read_b32 v34, a130
    v_accvgpr_read_b32 v35, a131
    v_accvgpr_read_b32 v36, a160
    v_accvgpr_read_b32 v37, a161
    v_accvgpr_read_b32 v38, a162
    v_accvgpr_read_b32 v39, a163
    v_accvgpr_read_b32 v40, a144
    v_accvgpr_read_b32 v41, a145
    v_accvgpr_read_b32 v42, a146
    v_accvgpr_read_b32 v43, a147
    v_accvgpr_read_b32 v44, a176
    v_accvgpr_read_b32 v45, a177
    v_accvgpr_read_b32 v46, a178
    v_accvgpr_read_b32 v47, a179
    v_pk_mul_f32 v[20:21], v[32:33], v[32:33]
    v_pk_mul_f32 v[22:23], v[34:35], v[34:35]
    v_pk_mul_f32 v[24:25], v[36:37], v[36:37]
    v_pk_mul_f32 v[26:27], v[38:39], v[38:39]
    v_pk_fma_f32 v[20:21], v[20:21], v[8:9], v[10:11]
    v_pk_fma_f32 v[22:23], v[22:23], v[8:9], v[10:11]
    v_pk_fma_f32 v[24:25], v[24:25], v[8:9], v[10:11]
    v_pk_fma_f32 v[26:27], v[26:27], v[8:9], v[10:11]
    v_pk_mul_f32 v[20:21], v[20:21], v[32:33]
    v_pk_mul_f32 v[22:23], v[22:23], v[34:35]
    v_pk_mul_f32 v[24:25], v[24:25], v[36:37]
    v_pk_mul_f32 v[26:27], v[26:27], v[38:39]
    v_exp_f32 v20, v20
    v_exp_f32 v21, v21
    v_exp_f32 v22, v22
    v_exp_f32 v23, v23
    v_exp_f32 v24, v24
    v_exp_f32 v25, v25
    v_exp_f32 v26, v26
    v_exp_f32 v27, v27
    v_pk_add_f32 v[20:21], v[20:21], v[12:13]
    v_pk_add_f32 v[22:23], v[22:23], v[12:13]
    v_pk_add_f32 v[24:25], v[24:25], v[12:13]
    v_pk_add_f32 v[26:27], v[26:27], v[12:13]
    v_rcp_f32 v20, v20
    v_rcp_f32 v21, v21
    v_rcp_f32 v22, v22
    v_rcp_f32 v23, v23
    v_rcp_f32 v24, v24
    v_rcp_f32 v25, v25
    v_rcp_f32 v26, v26
    v_rcp_f32 v27, v27
    v_pk_mul_f32 v[20:21], v[20:21], v[32:33]
    v_pk_mul_f32 v[22:23], v[22:23], v[34:35]
    v_pk_mul_f32 v[24:25], v[24:25], v[36:37]
    v_pk_mul_f32 v[26:27], v[26:27], v[38:39]
    v_pk_mul_f32 v[20:21], v[20:21], v[40:41]
    v_pk_mul_f32 v[22:23], v[22:23], v[42:43]
    v_pk_mul_f32 v[24:25], v[24:25], v[44:45]
    v_pk_mul_f32 v[26:27], v[26:27], v[46:47]
    v_cvt_pk_bf16_f32 v28, v20, v21
    v_cvt_pk_bf16_f32 v29, v22, v23
    v_cvt_pk_bf16_f32 v30, v24, v25
    v_cvt_pk_bf16_f32 v31, v26, v27
    s_add_u32 s3, s50, 0
    buffer_store_dwordx4 v[28:31], v7, s[36:39], s3 offen offset:0 sc1
    v_accvgpr_read_b32 v32, a132
    v_accvgpr_read_b32 v33, a133
    v_accvgpr_read_b32 v34, a134
    v_accvgpr_read_b32 v35, a135
    v_accvgpr_read_b32 v36, a164
    v_accvgpr_read_b32 v37, a165
    v_accvgpr_read_b32 v38, a166
    v_accvgpr_read_b32 v39, a167
    v_accvgpr_read_b32 v40, a148
    v_accvgpr_read_b32 v41, a149
    v_accvgpr_read_b32 v42, a150
    v_accvgpr_read_b32 v43, a151
    v_accvgpr_read_b32 v44, a180
    v_accvgpr_read_b32 v45, a181
    v_accvgpr_read_b32 v46, a182
    v_accvgpr_read_b32 v47, a183
    v_pk_mul_f32 v[20:21], v[32:33], v[32:33]
    v_pk_mul_f32 v[22:23], v[34:35], v[34:35]
    v_pk_mul_f32 v[24:25], v[36:37], v[36:37]
    v_pk_mul_f32 v[26:27], v[38:39], v[38:39]
    v_pk_fma_f32 v[20:21], v[20:21], v[8:9], v[10:11]
    v_pk_fma_f32 v[22:23], v[22:23], v[8:9], v[10:11]
    v_pk_fma_f32 v[24:25], v[24:25], v[8:9], v[10:11]
    v_pk_fma_f32 v[26:27], v[26:27], v[8:9], v[10:11]
    v_pk_mul_f32 v[20:21], v[20:21], v[32:33]
    v_pk_mul_f32 v[22:23], v[22:23], v[34:35]
    v_pk_mul_f32 v[24:25], v[24:25], v[36:37]
    v_pk_mul_f32 v[26:27], v[26:27], v[38:39]
    v_exp_f32 v20, v20
    v_exp_f32 v21, v21
    v_exp_f32 v22, v22
    v_exp_f32 v23, v23
    v_exp_f32 v24, v24
    v_exp_f32 v25, v25
    v_exp_f32 v26, v26
    v_exp_f32 v27, v27
    v_pk_add_f32 v[20:21], v[20:21], v[12:13]
    v_pk_add_f32 v[22:23], v[22:23], v[12:13]
    v_pk_add_f32 v[24:25], v[24:25], v[12:13]
    v_pk_add_f32 v[26:27], v[26:27], v[12:13]
    v_rcp_f32 v20, v20
    v_rcp_f32 v21, v21
    v_rcp_f32 v22, v22
    v_rcp_f32 v23, v23
    v_rcp_f32 v24, v24
    v_rcp_f32 v25, v25
    v_rcp_f32 v26, v26
    v_rcp_f32 v27, v27
    v_pk_mul_f32 v[20:21], v[20:21], v[32:33]
    v_pk_mul_f32 v[22:23], v[22:23], v[34:35]
    v_pk_mul_f32 v[24:25], v[24:25], v[36:37]
    v_pk_mul_f32 v[26:27], v[26:27], v[38:39]
    v_pk_mul_f32 v[20:21], v[20:21], v[40:41]
    v_pk_mul_f32 v[22:23], v[22:23], v[42:43]
    v_pk_mul_f32 v[24:25], v[24:25], v[44:45]
    v_pk_mul_f32 v[26:27], v[26:27], v[46:47]
    v_cvt_pk_bf16_f32 v28, v20, v21
    v_cvt_pk_bf16_f32 v29, v22, v23
    v_cvt_pk_bf16_f32 v30, v24, v25
    v_cvt_pk_bf16_f32 v31, v26, v27
    s_add_u32 s3, s50, 0
    buffer_store_dwordx4 v[28:31], v7, s[36:39], s3 offen offset:1024 sc1
    v_accvgpr_read_b32 v32, a136
    v_accvgpr_read_b32 v33, a137
    v_accvgpr_read_b32 v34, a138
    v_accvgpr_read_b32 v35, a139
    v_accvgpr_read_b32 v36, a168
    v_accvgpr_read_b32 v37, a169
    v_accvgpr_read_b32 v38, a170
    v_accvgpr_read_b32 v39, a171
    v_accvgpr_read_b32 v40, a152
    v_accvgpr_read_b32 v41, a153
    v_accvgpr_read_b32 v42, a154
    v_accvgpr_read_b32 v43, a155
    v_accvgpr_read_b32 v44, a184
    v_accvgpr_read_b32 v45, a185
    v_accvgpr_read_b32 v46, a186
    v_accvgpr_read_b32 v47, a187
    v_pk_mul_f32 v[20:21], v[32:33], v[32:33]
    v_pk_mul_f32 v[22:23], v[34:35], v[34:35]
    v_pk_mul_f32 v[24:25], v[36:37], v[36:37]
    v_pk_mul_f32 v[26:27], v[38:39], v[38:39]
    v_pk_fma_f32 v[20:21], v[20:21], v[8:9], v[10:11]
    v_pk_fma_f32 v[22:23], v[22:23], v[8:9], v[10:11]
    v_pk_fma_f32 v[24:25], v[24:25], v[8:9], v[10:11]
    v_pk_fma_f32 v[26:27], v[26:27], v[8:9], v[10:11]
    v_pk_mul_f32 v[20:21], v[20:21], v[32:33]
    v_pk_mul_f32 v[22:23], v[22:23], v[34:35]
    v_pk_mul_f32 v[24:25], v[24:25], v[36:37]
    v_pk_mul_f32 v[26:27], v[26:27], v[38:39]
    v_exp_f32 v20, v20
    v_exp_f32 v21, v21
    v_exp_f32 v22, v22
    v_exp_f32 v23, v23
    v_exp_f32 v24, v24
    v_exp_f32 v25, v25
    v_exp_f32 v26, v26
    v_exp_f32 v27, v27
    v_pk_add_f32 v[20:21], v[20:21], v[12:13]
    v_pk_add_f32 v[22:23], v[22:23], v[12:13]
    v_pk_add_f32 v[24:25], v[24:25], v[12:13]
    v_pk_add_f32 v[26:27], v[26:27], v[12:13]
    v_rcp_f32 v20, v20
    v_rcp_f32 v21, v21
    v_rcp_f32 v22, v22
    v_rcp_f32 v23, v23
    v_rcp_f32 v24, v24
    v_rcp_f32 v25, v25
    v_rcp_f32 v26, v26
    v_rcp_f32 v27, v27
    v_pk_mul_f32 v[20:21], v[20:21], v[32:33]
    v_pk_mul_f32 v[22:23], v[22:23], v[34:35]
    v_pk_mul_f32 v[24:25], v[24:25], v[36:37]
    v_pk_mul_f32 v[26:27], v[26:27], v[38:39]
    v_pk_mul_f32 v[20:21], v[20:21], v[40:41]
    v_pk_mul_f32 v[22:23], v[22:23], v[42:43]
    v_pk_mul_f32 v[24:25], v[24:25], v[44:45]
    v_pk_mul_f32 v[26:27], v[26:27], v[46:47]
    v_cvt_pk_bf16_f32 v28, v20, v21
    v_cvt_pk_bf16_f32 v29, v22, v23
    v_cvt_pk_bf16_f32 v30, v24, v25
    v_cvt_pk_bf16_f32 v31, v26, v27
    s_add_u32 s3, s50, 0
    buffer_store_dwordx4 v[28:31], v7, s[36:39], s3 offen offset:2048 sc1
    v_accvgpr_read_b32 v32, a140
    v_accvgpr_read_b32 v33, a141
    v_accvgpr_read_b32 v34, a142
    v_accvgpr_read_b32 v35, a143
    v_accvgpr_read_b32 v36, a172
    v_accvgpr_read_b32 v37, a173
    v_accvgpr_read_b32 v38, a174
    v_accvgpr_read_b32 v39, a175
    v_accvgpr_read_b32 v40, a156
    v_accvgpr_read_b32 v41, a157
    v_accvgpr_read_b32 v42, a158
    v_accvgpr_read_b32 v43, a159
    v_accvgpr_read_b32 v44, a188
    v_accvgpr_read_b32 v45, a189
    v_accvgpr_read_b32 v46, a190
    v_accvgpr_read_b32 v47, a191
    v_pk_mul_f32 v[20:21], v[32:33], v[32:33]
    v_pk_mul_f32 v[22:23], v[34:35], v[34:35]
    v_pk_mul_f32 v[24:25], v[36:37], v[36:37]
    v_pk_mul_f32 v[26:27], v[38:39], v[38:39]
    v_pk_fma_f32 v[20:21], v[20:21], v[8:9], v[10:11]
    v_pk_fma_f32 v[22:23], v[22:23], v[8:9], v[10:11]
    v_pk_fma_f32 v[24:25], v[24:25], v[8:9], v[10:11]
    v_pk_fma_f32 v[26:27], v[26:27], v[8:9], v[10:11]
    v_pk_mul_f32 v[20:21], v[20:21], v[32:33]
    v_pk_mul_f32 v[22:23], v[22:23], v[34:35]
    v_pk_mul_f32 v[24:25], v[24:25], v[36:37]
    v_pk_mul_f32 v[26:27], v[26:27], v[38:39]
    v_exp_f32 v20, v20
    v_exp_f32 v21, v21
    v_exp_f32 v22, v22
    v_exp_f32 v23, v23
    v_exp_f32 v24, v24
    v_exp_f32 v25, v25
    v_exp_f32 v26, v26
    v_exp_f32 v27, v27
    v_pk_add_f32 v[20:21], v[20:21], v[12:13]
    v_pk_add_f32 v[22:23], v[22:23], v[12:13]
    v_pk_add_f32 v[24:25], v[24:25], v[12:13]
    v_pk_add_f32 v[26:27], v[26:27], v[12:13]
    v_rcp_f32 v20, v20
    v_rcp_f32 v21, v21
    v_rcp_f32 v22, v22
    v_rcp_f32 v23, v23
    v_rcp_f32 v24, v24
    v_rcp_f32 v25, v25
    v_rcp_f32 v26, v26
    v_rcp_f32 v27, v27
    v_pk_mul_f32 v[20:21], v[20:21], v[32:33]
    v_pk_mul_f32 v[22:23], v[22:23], v[34:35]
    v_pk_mul_f32 v[24:25], v[24:25], v[36:37]
    v_pk_mul_f32 v[26:27], v[26:27], v[38:39]
    v_pk_mul_f32 v[20:21], v[20:21], v[40:41]
    v_pk_mul_f32 v[22:23], v[22:23], v[42:43]
    v_pk_mul_f32 v[24:25], v[24:25], v[44:45]
    v_pk_mul_f32 v[26:27], v[26:27], v[46:47]
    v_cvt_pk_bf16_f32 v28, v20, v21
    v_cvt_pk_bf16_f32 v29, v22, v23
    v_cvt_pk_bf16_f32 v30, v24, v25
    v_cvt_pk_bf16_f32 v31, v26, v27
    s_add_u32 s3, s50, 0
    buffer_store_dwordx4 v[28:31], v7, s[36:39], s3 offen offset:3072 sc1
    v_accvgpr_read_b32 v32, a8
    v_accvgpr_read_b32 v33, a9
    v_accvgpr_read_b32 v34, a10
    v_accvgpr_read_b32 v35, a11
    v_accvgpr_read_b32 v36, a24
    v_accvgpr_read_b32 v37, a25
    v_accvgpr_read_b32 v38, a26
    v_accvgpr_read_b32 v39, a27
    v_accvgpr_read_b32 v40, a12
    v_accvgpr_read_b32 v41, a13
    v_accvgpr_read_b32 v42, a14
    v_accvgpr_read_b32 v43, a15
    v_accvgpr_read_b32 v44, a28
    v_accvgpr_read_b32 v45, a29
    v_accvgpr_read_b32 v46, a30
    v_accvgpr_read_b32 v47, a31
    v_pk_mul_f32 v[32:33], v[32:33], v[14:15]
    v_pk_mul_f32 v[34:35], v[34:35], v[14:15]
    v_pk_mul_f32 v[36:37], v[36:37], v[14:15]
    v_pk_mul_f32 v[38:39], v[38:39], v[14:15]
    v_pk_mul_f32 v[40:41], v[40:41], v[14:15]
    v_pk_mul_f32 v[42:43], v[42:43], v[14:15]
    v_pk_mul_f32 v[44:45], v[44:45], v[14:15]
    v_pk_mul_f32 v[46:47], v[46:47], v[14:15]
    v_cvt_pk_bf16_f32 v96, v32, v33
    v_cvt_pk_bf16_f32 v97, v34, v35
    v_cvt_pk_bf16_f32 v98, v36, v37
    v_cvt_pk_bf16_f32 v99, v38, v39
    v_cvt_pk_bf16_f32 v112, v40, v41
    v_cvt_pk_bf16_f32 v113, v42, v43
    v_cvt_pk_bf16_f32 v114, v44, v45
    v_cvt_pk_bf16_f32 v115, v46, v47
    v_pk_mul_f32 v[20:21], v[160:161], v[160:161]
    v_pk_mul_f32 v[22:23], v[162:163], v[162:163]
    v_pk_mul_f32 v[24:25], v[192:193], v[192:193]
    v_pk_mul_f32 v[26:27], v[194:195], v[194:195]
    v_pk_fma_f32 v[20:21], v[20:21], v[8:9], v[10:11]
    v_pk_fma_f32 v[22:23], v[22:23], v[8:9], v[10:11]
    v_pk_fma_f32 v[24:25], v[24:25], v[8:9], v[10:11]
    v_pk_fma_f32 v[26:27], v[26:27], v[8:9], v[10:11]
    v_pk_mul_f32 v[20:21], v[20:21], v[160:161]
    v_pk_mul_f32 v[22:23], v[22:23], v[162:163]
    v_pk_mul_f32 v[24:25], v[24:25], v[192:193]
    v_pk_mul_f32 v[26:27], v[26:27], v[194:195]
    v_exp_f32 v20, v20
    v_exp_f32 v21, v21
    v_exp_f32 v22, v22
    v_exp_f32 v23, v23
    v_exp_f32 v24, v24
    v_exp_f32 v25, v25
    v_exp_f32 v26, v26
    v_exp_f32 v27, v27
    v_pk_add_f32 v[20:21], v[20:21], v[12:13]
    v_pk_add_f32 v[22:23], v[22:23], v[12:13]
    v_pk_add_f32 v[24:25], v[24:25], v[12:13]
    v_pk_add_f32 v[26:27], v[26:27], v[12:13]
    v_rcp_f32 v20, v20
    v_rcp_f32 v21, v21
    v_rcp_f32 v22, v22
    v_rcp_f32 v23, v23
    v_rcp_f32 v24, v24
    v_rcp_f32 v25, v25
    v_rcp_f32 v26, v26
    v_rcp_f32 v27, v27
    v_pk_mul_f32 v[20:21], v[20:21], v[160:161]
    v_pk_mul_f32 v[22:23], v[22:23], v[162:163]
    v_pk_mul_f32 v[24:25], v[24:25], v[192:193]
    v_pk_mul_f32 v[26:27], v[26:27], v[194:195]
    v_pk_mul_f32 v[20:21], v[20:21], v[176:177]
    v_pk_mul_f32 v[22:23], v[22:23], v[178:179]
    v_pk_mul_f32 v[24:25], v[24:25], v[208:209]
    v_pk_mul_f32 v[26:27], v[26:27], v[210:211]
    v_cvt_pk_bf16_f32 v28, v20, v21
    v_cvt_pk_bf16_f32 v29, v22, v23
    v_cvt_pk_bf16_f32 v30, v24, v25
    v_cvt_pk_bf16_f32 v31, v26, v27
    s_add_u32 s3, s50, 12288
    buffer_store_dwordx4 v[28:31], v7, s[36:39], s3 offen offset:0 sc1
    v_accvgpr_read_b32 v32, a40
    v_accvgpr_read_b32 v33, a41
    v_accvgpr_read_b32 v34, a42
    v_accvgpr_read_b32 v35, a43
    v_accvgpr_read_b32 v36, a56
    v_accvgpr_read_b32 v37, a57
    v_accvgpr_read_b32 v38, a58
    v_accvgpr_read_b32 v39, a59
    v_accvgpr_read_b32 v40, a44
    v_accvgpr_read_b32 v41, a45
    v_accvgpr_read_b32 v42, a46
    v_accvgpr_read_b32 v43, a47
    v_accvgpr_read_b32 v44, a60
    v_accvgpr_read_b32 v45, a61
    v_accvgpr_read_b32 v46, a62
    v_accvgpr_read_b32 v47, a63
    v_pk_mul_f32 v[32:33], v[32:33], v[14:15]
    v_pk_mul_f32 v[34:35], v[34:35], v[14:15]
    v_pk_mul_f32 v[36:37], v[36:37], v[14:15]
    v_pk_mul_f32 v[38:39], v[38:39], v[14:15]
    v_pk_mul_f32 v[40:41], v[40:41], v[14:15]
    v_pk_mul_f32 v[42:43], v[42:43], v[14:15]
    v_pk_mul_f32 v[44:45], v[44:45], v[14:15]
    v_pk_mul_f32 v[46:47], v[46:47], v[14:15]
    v_cvt_pk_bf16_f32 v100, v32, v33
    v_cvt_pk_bf16_f32 v101, v34, v35
    v_cvt_pk_bf16_f32 v102, v36, v37
    v_cvt_pk_bf16_f32 v103, v38, v39
    v_cvt_pk_bf16_f32 v116, v40, v41
    v_cvt_pk_bf16_f32 v117, v42, v43
    v_cvt_pk_bf16_f32 v118, v44, v45
    v_cvt_pk_bf16_f32 v119, v46, v47
    v_pk_mul_f32 v[20:21], v[164:165], v[164:165]
    v_pk_mul_f32 v[22:23], v[166:167], v[166:167]
    v_pk_mul_f32 v[24:25], v[196:197], v[196:197]
    v_pk_mul_f32 v[26:27], v[198:199], v[198:199]
    v_pk_fma_f32 v[20:21], v[20:21], v[8:9], v[10:11]
    v_pk_fma_f32 v[22:23], v[22:23], v[8:9], v[10:11]
    v_pk_fma_f32 v[24:25], v[24:25], v[8:9], v[10:11]
    v_pk_fma_f32 v[26:27], v[26:27], v[8:9], v[10:11]
    v_pk_mul_f32 v[20:21], v[20:21], v[164:165]
    v_pk_mul_f32 v[22:23], v[22:23], v[166:167]
    v_pk_mul_f32 v[24:25], v[24:25], v[196:197]
    v_pk_mul_f32 v[26:27], v[26:27], v[198:199]
    v_exp_f32 v20, v20
    v_exp_f32 v21, v21
    v_exp_f32 v22, v22
    v_exp_f32 v23, v23
    v_exp_f32 v24, v24
    v_exp_f32 v25, v25
    v_exp_f32 v26, v26
    v_exp_f32 v27, v27
    v_pk_add_f32 v[20:21], v[20:21], v[12:13]
    v_pk_add_f32 v[22:23], v[22:23], v[12:13]
    v_pk_add_f32 v[24:25], v[24:25], v[12:13]
    v_pk_add_f32 v[26:27], v[26:27], v[12:13]
    v_rcp_f32 v20, v20
    v_rcp_f32 v21, v21
    v_rcp_f32 v22, v22
    v_rcp_f32 v23, v23
    v_rcp_f32 v24, v24
    v_rcp_f32 v25, v25
    v_rcp_f32 v26, v26
    v_rcp_f32 v27, v27
    v_pk_mul_f32 v[20:21], v[20:21], v[164:165]
    v_pk_mul_f32 v[22:23], v[22:23], v[166:167]
    v_pk_mul_f32 v[24:25], v[24:25], v[196:197]
    v_pk_mul_f32 v[26:27], v[26:27], v[198:199]
    v_pk_mul_f32 v[20:21], v[20:21], v[180:181]
    v_pk_mul_f32 v[22:23], v[22:23], v[182:183]
    v_pk_mul_f32 v[24:25], v[24:25], v[212:213]
    v_pk_mul_f32 v[26:27], v[26:27], v[214:215]
    v_cvt_pk_bf16_f32 v28, v20, v21
    v_cvt_pk_bf16_f32 v29, v22, v23
    v_cvt_pk_bf16_f32 v30, v24, v25
    v_cvt_pk_bf16_f32 v31, v26, v27
    s_add_u32 s3, s50, 12288
    buffer_store_dwordx4 v[28:31], v7, s[36:39], s3 offen offset:1024 sc1
    v_accvgpr_read_b32 v32, a72
    v_accvgpr_read_b32 v33, a73
    v_accvgpr_read_b32 v34, a74
    v_accvgpr_read_b32 v35, a75
    v_accvgpr_read_b32 v36, a88
    v_accvgpr_read_b32 v37, a89
    v_accvgpr_read_b32 v38, a90
    v_accvgpr_read_b32 v39, a91
    v_accvgpr_read_b32 v40, a76
    v_accvgpr_read_b32 v41, a77
    v_accvgpr_read_b32 v42, a78
    v_accvgpr_read_b32 v43, a79
    v_accvgpr_read_b32 v44, a92
    v_accvgpr_read_b32 v45, a93
    v_accvgpr_read_b32 v46, a94
    v_accvgpr_read_b32 v47, a95
    v_pk_mul_f32 v[32:33], v[32:33], v[14:15]
    v_pk_mul_f32 v[34:35], v[34:35], v[14:15]
    v_pk_mul_f32 v[36:37], v[36:37], v[14:15]
    v_pk_mul_f32 v[38:39], v[38:39], v[14:15]
    v_pk_mul_f32 v[40:41], v[40:41], v[14:15]
    v_pk_mul_f32 v[42:43], v[42:43], v[14:15]
    v_pk_mul_f32 v[44:45], v[44:45], v[14:15]
    v_pk_mul_f32 v[46:47], v[46:47], v[14:15]
    v_cvt_pk_bf16_f32 v104, v32, v33
    v_cvt_pk_bf16_f32 v105, v34, v35
    v_cvt_pk_bf16_f32 v106, v36, v37
    v_cvt_pk_bf16_f32 v107, v38, v39
    v_cvt_pk_bf16_f32 v120, v40, v41
    v_cvt_pk_bf16_f32 v121, v42, v43
    v_cvt_pk_bf16_f32 v122, v44, v45
    v_cvt_pk_bf16_f32 v123, v46, v47
    v_pk_mul_f32 v[20:21], v[168:169], v[168:169]
    v_pk_mul_f32 v[22:23], v[170:171], v[170:171]
    v_pk_mul_f32 v[24:25], v[200:201], v[200:201]
    v_pk_mul_f32 v[26:27], v[202:203], v[202:203]
    v_pk_fma_f32 v[20:21], v[20:21], v[8:9], v[10:11]
    v_pk_fma_f32 v[22:23], v[22:23], v[8:9], v[10:11]
    v_pk_fma_f32 v[24:25], v[24:25], v[8:9], v[10:11]
    v_pk_fma_f32 v[26:27], v[26:27], v[8:9], v[10:11]
    v_pk_mul_f32 v[20:21], v[20:21], v[168:169]
    v_pk_mul_f32 v[22:23], v[22:23], v[170:171]
    v_pk_mul_f32 v[24:25], v[24:25], v[200:201]
    v_pk_mul_f32 v[26:27], v[26:27], v[202:203]
    v_exp_f32 v20, v20
    v_exp_f32 v21, v21
    v_exp_f32 v22, v22
    v_exp_f32 v23, v23
    v_exp_f32 v24, v24
    v_exp_f32 v25, v25
    v_exp_f32 v26, v26
    v_exp_f32 v27, v27
    v_pk_add_f32 v[20:21], v[20:21], v[12:13]
    v_pk_add_f32 v[22:23], v[22:23], v[12:13]
    v_pk_add_f32 v[24:25], v[24:25], v[12:13]
    v_pk_add_f32 v[26:27], v[26:27], v[12:13]
    v_rcp_f32 v20, v20
    v_rcp_f32 v21, v21
    v_rcp_f32 v22, v22
    v_rcp_f32 v23, v23
    v_rcp_f32 v24, v24
    v_rcp_f32 v25, v25
    v_rcp_f32 v26, v26
    v_rcp_f32 v27, v27
    v_pk_mul_f32 v[20:21], v[20:21], v[168:169]
    v_pk_mul_f32 v[22:23], v[22:23], v[170:171]
    v_pk_mul_f32 v[24:25], v[24:25], v[200:201]
    v_pk_mul_f32 v[26:27], v[26:27], v[202:203]
    v_pk_mul_f32 v[20:21], v[20:21], v[184:185]
    v_pk_mul_f32 v[22:23], v[22:23], v[186:187]
    v_pk_mul_f32 v[24:25], v[24:25], v[216:217]
    v_pk_mul_f32 v[26:27], v[26:27], v[218:219]
    v_cvt_pk_bf16_f32 v28, v20, v21
    v_cvt_pk_bf16_f32 v29, v22, v23
    v_cvt_pk_bf16_f32 v30, v24, v25
    v_cvt_pk_bf16_f32 v31, v26, v27
    s_add_u32 s3, s50, 12288
    buffer_store_dwordx4 v[28:31], v7, s[36:39], s3 offen offset:2048 sc1
    v_accvgpr_read_b32 v32, a104
    v_accvgpr_read_b32 v33, a105
    v_accvgpr_read_b32 v34, a106
    v_accvgpr_read_b32 v35, a107
    v_accvgpr_read_b32 v36, a120
    v_accvgpr_read_b32 v37, a121
    v_accvgpr_read_b32 v38, a122
    v_accvgpr_read_b32 v39, a123
    v_accvgpr_read_b32 v40, a108
    v_accvgpr_read_b32 v41, a109
    v_accvgpr_read_b32 v42, a110
    v_accvgpr_read_b32 v43, a111
    v_accvgpr_read_b32 v44, a124
    v_accvgpr_read_b32 v45, a125
    v_accvgpr_read_b32 v46, a126
    v_accvgpr_read_b32 v47, a127
    v_pk_mul_f32 v[32:33], v[32:33], v[14:15]
    v_pk_mul_f32 v[34:35], v[34:35], v[14:15]
    v_pk_mul_f32 v[36:37], v[36:37], v[14:15]
    v_pk_mul_f32 v[38:39], v[38:39], v[14:15]
    v_pk_mul_f32 v[40:41], v[40:41], v[14:15]
    v_pk_mul_f32 v[42:43], v[42:43], v[14:15]
    v_pk_mul_f32 v[44:45], v[44:45], v[14:15]
    v_pk_mul_f32 v[46:47], v[46:47], v[14:15]
    v_cvt_pk_bf16_f32 v108, v32, v33
    v_cvt_pk_bf16_f32 v109, v34, v35
    v_cvt_pk_bf16_f32 v110, v36, v37
    v_cvt_pk_bf16_f32 v111, v38, v39
    v_cvt_pk_bf16_f32 v124, v40, v41
    v_cvt_pk_bf16_f32 v125, v42, v43
    v_cvt_pk_bf16_f32 v126, v44, v45
    v_cvt_pk_bf16_f32 v127, v46, v47
    v_pk_mul_f32 v[20:21], v[172:173], v[172:173]
    v_pk_mul_f32 v[22:23], v[174:175], v[174:175]
    v_pk_mul_f32 v[24:25], v[204:205], v[204:205]
    v_pk_mul_f32 v[26:27], v[206:207], v[206:207]
    v_pk_fma_f32 v[20:21], v[20:21], v[8:9], v[10:11]
    v_pk_fma_f32 v[22:23], v[22:23], v[8:9], v[10:11]
    v_pk_fma_f32 v[24:25], v[24:25], v[8:9], v[10:11]
    v_pk_fma_f32 v[26:27], v[26:27], v[8:9], v[10:11]
    v_pk_mul_f32 v[20:21], v[20:21], v[172:173]
    v_pk_mul_f32 v[22:23], v[22:23], v[174:175]
    v_pk_mul_f32 v[24:25], v[24:25], v[204:205]
    v_pk_mul_f32 v[26:27], v[26:27], v[206:207]
    v_exp_f32 v20, v20
    v_exp_f32 v21, v21
    v_exp_f32 v22, v22
    v_exp_f32 v23, v23
    v_exp_f32 v24, v24
    v_exp_f32 v25, v25
    v_exp_f32 v26, v26
    v_exp_f32 v27, v27
    v_pk_add_f32 v[20:21], v[20:21], v[12:13]
    v_pk_add_f32 v[22:23], v[22:23], v[12:13]
    v_pk_add_f32 v[24:25], v[24:25], v[12:13]
    v_pk_add_f32 v[26:27], v[26:27], v[12:13]
    v_rcp_f32 v20, v20
    v_rcp_f32 v21, v21
    v_rcp_f32 v22, v22
    v_rcp_f32 v23, v23
    v_rcp_f32 v24, v24
    v_rcp_f32 v25, v25
    v_rcp_f32 v26, v26
    v_rcp_f32 v27, v27
    v_pk_mul_f32 v[20:21], v[20:21], v[172:173]
    v_pk_mul_f32 v[22:23], v[22:23], v[174:175]
    v_pk_mul_f32 v[24:25], v[24:25], v[204:205]
    v_pk_mul_f32 v[26:27], v[26:27], v[206:207]
    v_pk_mul_f32 v[20:21], v[20:21], v[188:189]
    v_pk_mul_f32 v[22:23], v[22:23], v[190:191]
    v_pk_mul_f32 v[24:25], v[24:25], v[220:221]
    v_pk_mul_f32 v[26:27], v[26:27], v[222:223]
    v_cvt_pk_bf16_f32 v28, v20, v21
    v_cvt_pk_bf16_f32 v29, v22, v23
    v_cvt_pk_bf16_f32 v30, v24, v25
    v_cvt_pk_bf16_f32 v31, v26, v27
    s_add_u32 s3, s50, 12288
    buffer_store_dwordx4 v[28:31], v7, s[36:39], s3 offen offset:3072 sc1
    v_pk_mul_f32 v[20:21], v[224:225], v[224:225]
    v_pk_mul_f32 v[22:23], v[226:227], v[226:227]
    v_pk_mul_f32 v[24:25], v[228:229], v[228:229]
    v_pk_mul_f32 v[26:27], v[230:231], v[230:231]
    v_pk_fma_f32 v[20:21], v[20:21], v[8:9], v[10:11]
    v_pk_fma_f32 v[22:23], v[22:23], v[8:9], v[10:11]
    v_pk_fma_f32 v[24:25], v[24:25], v[8:9], v[10:11]
    v_pk_fma_f32 v[26:27], v[26:27], v[8:9], v[10:11]
    v_pk_mul_f32 v[20:21], v[20:21], v[224:225]
    v_pk_mul_f32 v[22:23], v[22:23], v[226:227]
    v_pk_mul_f32 v[24:25], v[24:25], v[228:229]
    v_pk_mul_f32 v[26:27], v[26:27], v[230:231]
    v_exp_f32 v20, v20
    v_exp_f32 v21, v21
    v_exp_f32 v22, v22
    v_exp_f32 v23, v23
    v_exp_f32 v24, v24
    v_exp_f32 v25, v25
    v_exp_f32 v26, v26
    v_exp_f32 v27, v27
    v_pk_add_f32 v[20:21], v[20:21], v[12:13]
    v_pk_add_f32 v[22:23], v[22:23], v[12:13]
    v_pk_add_f32 v[24:25], v[24:25], v[12:13]
    v_pk_add_f32 v[26:27], v[26:27], v[12:13]
    v_rcp_f32 v20, v20
    v_rcp_f32 v21, v21
    v_rcp_f32 v22, v22
    v_rcp_f32 v23, v23
    v_rcp_f32 v24, v24
    v_rcp_f32 v25, v25
    v_rcp_f32 v26, v26
    v_rcp_f32 v27, v27
    v_pk_mul_f32 v[20:21], v[20:21], v[224:225]
    v_pk_mul_f32 v[22:23], v[22:23], v[226:227]
    v_pk_mul_f32 v[24:25], v[24:25], v[228:229]
    v_pk_mul_f32 v[26:27], v[26:27], v[230:231]
    v_pk_mul_f32 v[20:21], v[20:21], v[240:241]
    v_pk_mul_f32 v[22:23], v[22:23], v[242:243]
    v_pk_mul_f32 v[24:25], v[24:25], v[244:245]
    v_pk_mul_f32 v[26:27], v[26:27], v[246:247]
    v_cvt_pk_bf16_f32 v52, v20, v21
    v_cvt_pk_bf16_f32 v53, v22, v23
    v_cvt_pk_bf16_f32 v54, v24, v25
    v_cvt_pk_bf16_f32 v55, v26, v27
    buffer_store_dwordx4 v[52:55], v7, s[36:39], s6 offen offset:0 sc1
    v_pk_mul_f32 v[20:21], v[232:233], v[232:233]
    v_pk_mul_f32 v[22:23], v[234:235], v[234:235]
    v_pk_mul_f32 v[24:25], v[236:237], v[236:237]
    v_pk_mul_f32 v[26:27], v[238:239], v[238:239]
    v_pk_fma_f32 v[20:21], v[20:21], v[8:9], v[10:11]
    v_pk_fma_f32 v[22:23], v[22:23], v[8:9], v[10:11]
    v_pk_fma_f32 v[24:25], v[24:25], v[8:9], v[10:11]
    v_pk_fma_f32 v[26:27], v[26:27], v[8:9], v[10:11]
    v_pk_mul_f32 v[20:21], v[20:21], v[232:233]
    v_pk_mul_f32 v[22:23], v[22:23], v[234:235]
    v_pk_mul_f32 v[24:25], v[24:25], v[236:237]
    v_pk_mul_f32 v[26:27], v[26:27], v[238:239]
    v_exp_f32 v20, v20
    v_exp_f32 v21, v21
    v_exp_f32 v22, v22
    v_exp_f32 v23, v23
    v_exp_f32 v24, v24
    v_exp_f32 v25, v25
    v_exp_f32 v26, v26
    v_exp_f32 v27, v27
    v_pk_add_f32 v[20:21], v[20:21], v[12:13]
    v_pk_add_f32 v[22:23], v[22:23], v[12:13]
    v_pk_add_f32 v[24:25], v[24:25], v[12:13]
    v_pk_add_f32 v[26:27], v[26:27], v[12:13]
    v_rcp_f32 v20, v20
    v_rcp_f32 v21, v21
    v_rcp_f32 v22, v22
    v_rcp_f32 v23, v23
    v_rcp_f32 v24, v24
    v_rcp_f32 v25, v25
    v_rcp_f32 v26, v26
    v_rcp_f32 v27, v27
    v_pk_mul_f32 v[20:21], v[20:21], v[232:233]
    v_pk_mul_f32 v[22:23], v[22:23], v[234:235]
    v_pk_mul_f32 v[24:25], v[24:25], v[236:237]
    v_pk_mul_f32 v[26:27], v[26:27], v[238:239]
    v_pk_mul_f32 v[20:21], v[20:21], v[248:249]
    v_pk_mul_f32 v[22:23], v[22:23], v[250:251]
    v_pk_mul_f32 v[24:25], v[24:25], v[252:253]
    v_pk_mul_f32 v[26:27], v[26:27], v[254:255]
    v_cvt_pk_bf16_f32 v56, v20, v21
    v_cvt_pk_bf16_f32 v57, v22, v23
    v_cvt_pk_bf16_f32 v58, v24, v25
    v_cvt_pk_bf16_f32 v59, v26, v27
    buffer_store_dwordx4 v[56:59], v7, s[36:39], s6 offen offset:1024 sc1
    s_nop 1
    v_mov_b32 v1, v18
    v_and_b32 v224, 15, v18
    v_lshrrev_b32 v225, 4, v18
    v_xor_b32 v225, v225, v224
    v_lshlrev_b32 v224, 8, v224
    v_lshl_add_u32 v20, v225, 4, v224
    v_xor_b32 v21, 0x40, v20
    v_xor_b32 v22, 0x80, v20
    v_xor_b32 v23, 0xc0, v20
    v_bfe_i32 v13, v18, 1, 1
    v_not_b32 v13, v13
    v_bfe_i32 v61, v18, 0, 1
    v_and_b32 v61, 0xaaaaaaaa, v61
    v_or_b32 v61, 0x44444444, v61
    s_waitcnt vmcnt(41)
    s_barrier
    ds_read_b128 a[128:131], v20 offset:0
    ds_read_b128 a[132:135], v21 offset:0
    ds_read_b128 a[136:139], v22 offset:0
    ds_read_b128 a[140:143], v23 offset:0
    ds_read_b128 a[144:147], v20 offset:4096
    ds_read_b128 a[148:151], v21 offset:4096
    ds_read_b128 a[152:155], v22 offset:4096
    ds_read_b128 a[156:159], v23 offset:4096
    s_waitcnt lgkmcnt(4)
    v_mfma_f32_16x16x32_bf16 v[176:179], a[128:131], v[64:67], 0
    v_lshrrev_b32 v2, 2, v18
    v_and_b32 v14, 7, v2
    v_mfma_f32_16x16x32_bf16 v[176:179], a[132:135], v[68:71], v[176:179]
    ds_read_b128 a[160:163], v20 offset:8192
    v_lshlrev_b32 v14, 5, v14
    v_mfma_f32_16x16x32_bf16 v[176:179], a[136:139], v[72:75], v[176:179]
    ds_read_b128 a[164:167], v21 offset:8192
    v_lshl_add_u32 v14, v2, 8, v14
    v_mfma_f32_16x16x32_bf16 v[176:179], a[140:143], v[76:79], v[176:179]
    ds_read_b128 a[168:171], v22 offset:8192
    v_mul_u32_u24 v2, 288, v2
    v_mfma_f32_16x16x32_bf16 v[180:183], a[140:143], v[92:95], 0
    ds_read_b128 a[172:175], v23 offset:8192
    v_and_b32 v8, 3, v18
    v_mfma_f32_16x16x32_bf16 v[180:183], a[136:139], v[88:91], v[180:183]
    ds_read_b128 a[176:179], v20 offset:12288
    v_lshl_add_u32 v14, v8, 3, v14
    v_mfma_f32_16x16x32_bf16 v[180:183], a[132:135], v[84:87], v[180:183]
    ds_read_b128 a[180:183], v21 offset:12288
    v_add_u32 v24, 0x10000, v14
    v_mfma_f32_16x16x32_bf16 v[180:183], a[128:131], v[80:83], v[180:183]
    ds_read_b128 a[184:187], v22 offset:12288
    v_xor_b32 v25, 0x20, v24
    v_mfma_f32_16x16x32_bf16 v[184:187], a[128:131], v[96:99], 0
    ds_read_b128 a[188:191], v23 offset:12288
    v_xor_b32 v26, 0x40, v24
    v_mfma_f32_16x16x32_bf16 v[184:187], a[132:135], v[100:103], v[184:187]
    s_add_u32 m0, s55, 98304
    v_xor_b32 v27, 0x60, v24
    v_xor_b32 v28, 0x80, v24
    v_mfma_f32_16x16x32_bf16 v[184:187], a[136:139], v[104:107], v[184:187]
    buffer_load_dwordx4 v16, s[32:35], s57 offen offset:0 lds
    v_mfma_f32_16x16x32_bf16 v[184:187], a[140:143], v[108:111], v[184:187]
    v_xor_b32 v29, 0xa0, v24
    v_xor_b32 v30, 0xc0, v24
    v_mfma_f32_16x16x32_bf16 v[188:191], a[140:143], v[124:127], 0
    buffer_load_dwordx4 v17, s[32:35], s57 offen offset:1024 lds
    v_mfma_f32_16x16x32_bf16 v[188:191], a[136:139], v[120:123], v[188:191]
    v_xor_b32 v31, 0xe0, v24
    v_lshl_add_u32 v8, v8, 3, v2
    v_mfma_f32_16x16x32_bf16 v[188:191], a[132:135], v[116:119], v[188:191]
    buffer_load_dwordx4 v16, s[32:35], s57 offen offset:2048 lds
    v_mfma_f32_16x16x32_bf16 v[188:191], a[128:131], v[112:115], v[188:191]
    v_and_b32 v32, 0x3f803f80, v13
    v_and_b32 v33, 0x3f803f80, v13
    s_waitcnt lgkmcnt(8)
    v_mfma_f32_16x16x32_bf16 v[192:195], a[144:147], v[64:67], 0
    buffer_load_dwordx4 v17, s[32:35], s57 offen offset:3072 lds
    v_mfma_f32_16x16x32_bf16 v[192:195], a[148:151], v[68:71], v[192:195]
    s_add_u32 s57, s57, 16384
    v_and_b32 v34, 0x3f803f80, v13
    v_and_b32 v35, 0x3f803f80, v13
    v_mfma_f32_16x16x32_bf16 v[192:195], a[152:155], v[72:75], v[192:195]
    v_max3_f32 v208, v176, v177, v178
    v_max_f32 v208, v208, v179
    v_max3_f32 v210, v180, v181, v182
    v_max_f32 v210, v210, v183
    v_mfma_f32_16x16x32_bf16 v[192:195], a[156:159], v[76:79], v[192:195]
    v_max3_f32 v212, v184, v185, v186
    v_max_f32 v212, v212, v187
    v_max3_f32 v214, v188, v189, v190
    v_max_f32 v214, v214, v191
    v_mfma_f32_16x16x32_bf16 v[196:199], a[156:159], v[92:95], 0
    v_mov_b32 v209, v208
    v_mov_b32 v211, v210
    v_mov_b32 v213, v212
    v_mfma_f32_16x16x32_bf16 v[196:199], a[152:155], v[88:91], v[196:199]
    v_mov_b32 v215, v214
    s_nop 0
    v_permlane16_swap_b32 v208, v209
    v_permlane16_swap_b32 v210, v211
    v_mfma_f32_16x16x32_bf16 v[196:199], a[148:151], v[84:87], v[196:199]
    v_permlane16_swap_b32 v212, v213
    v_permlane16_swap_b32 v214, v215
    v_max_f32 v208, v208, v209
    v_mfma_f32_16x16x32_bf16 v[196:199], a[144:147], v[80:83], v[196:199]
    v_max_f32 v210, v210, v211
    v_max_f32 v212, v212, v213
    v_max_f32 v214, v214, v215
    v_mov_b32 v209, v208
    v_mfma_f32_16x16x32_bf16 v[200:203], a[144:147], v[96:99], 0
    v_mov_b32 v211, v210
    v_mov_b32 v213, v212
    v_mov_b32 v215, v214
    v_mfma_f32_16x16x32_bf16 v[200:203], a[148:151], v[100:103], v[200:203]
    s_nop 0
    v_permlane32_swap_b32 v208, v209
    v_permlane32_swap_b32 v210, v211
    v_permlane32_swap_b32 v212, v213
    v_mfma_f32_16x16x32_bf16 v[200:203], a[152:155], v[104:107], v[200:203]
    v_permlane32_swap_b32 v214, v215
    v_max_f32 v208, v208, v209
    v_max_f32 v210, v210, v211
    v_max_f32 v212, v212, v213
    v_mfma_f32_16x16x32_bf16 v[200:203], a[156:159], v[108:111], v[200:203]
    v_max_f32 v214, v214, v215
    v_sub_f32 v36, 0, v208
    v_sub_f32 v37, 0, v208
    v_mfma_f32_16x16x32_bf16 v[204:207], a[156:159], v[124:127], 0
    v_sub_f32 v38, 0, v208
    v_sub_f32 v39, 0, v208
    v_sub_f32 v40, 0, v210
    v_sub_f32 v41, 0, v210
    v_mfma_f32_16x16x32_bf16 v[204:207], a[152:155], v[120:123], v[204:207]
    v_sub_f32 v42, 0, v210
    v_sub_f32 v43, 0, v210
    v_sub_f32 v44, 0, v212
    v_mfma_f32_16x16x32_bf16 v[204:207], a[148:151], v[116:119], v[204:207]
    v_sub_f32 v45, 0, v212
    v_sub_f32 v46, 0, v212
    v_sub_f32 v47, 0, v212
    v_sub_f32 v48, 0, v214
    v_mfma_f32_16x16x32_bf16 v[204:207], a[144:147], v[112:115], v[204:207]
    v_sub_f32 v49, 0, v214
    v_sub_f32 v50, 0, v214
    v_sub_f32 v51, 0, v214
    s_waitcnt lgkmcnt(4)
    v_mfma_f32_16x16x32_bf16 v[208:211], a[160:163], v[64:67], v[36:39]
    v_add_f32 v176, v176, v36
    v_add_f32 v177, v177, v36
    v_exp_f32 v176, v176
    v_mfma_f32_16x16x32_bf16 v[208:211], a[164:167], v[68:71], v[208:211]
    v_add_f32 v178, v178, v36
    v_exp_f32 v177, v177
    v_mfma_f32_16x16x32_bf16 v[208:211], a[168:171], v[72:75], v[208:211]
    v_cvt_pk_bf16_f32 v128, v176, v177
    v_add_f32 v179, v179, v36
    v_exp_f32 v178, v178
    v_mfma_f32_16x16x32_bf16 v[208:211], a[172:175], v[76:79], v[208:211]
    v_add_f32 v180, v180, v40
    v_exp_f32 v179, v179
    v_mfma_f32_16x16x32_bf16 v[212:215], a[172:175], v[92:95], v[40:43]
    v_cvt_pk_bf16_f32 v129, v178, v179
    v_add_f32 v181, v181, v40
    v_exp_f32 v180, v180
    s_waitcnt vmcnt(26) lgkmcnt(0)
    s_barrier
    v_mfma_f32_16x16x32_bf16 v[212:215], a[168:171], v[88:91], v[212:215]
    ds_read_b128 a[128:131], v20 offset:16384
    v_add_f32 v182, v182, v40
    v_exp_f32 v181, v181
    v_mfma_f32_16x16x32_bf16 v[212:215], a[164:167], v[84:87], v[212:215]
    v_cvt_pk_bf16_f32 v140, v180, v181
    v_add_f32 v183, v183, v40
    v_exp_f32 v182, v182
    v_mfma_f32_16x16x32_bf16 v[212:215], a[160:163], v[80:83], v[212:215]
    ds_read_b128 a[132:135], v21 offset:16384
    v_add_f32 v184, v184, v44
    v_exp_f32 v183, v183
    v_mfma_f32_16x16x32_bf16 v[216:219], a[160:163], v[96:99], v[44:47]
    v_cvt_pk_bf16_f32 v141, v182, v183
    v_add_f32 v185, v185, v44
    v_exp_f32 v184, v184
    v_mfma_f32_16x16x32_bf16 v[216:219], a[164:167], v[100:103], v[216:219]
    ds_read_b128 a[136:139], v22 offset:16384
    v_add_f32 v186, v186, v44
    v_exp_f32 v185, v185
    v_mfma_f32_16x16x32_bf16 v[216:219], a[168:171], v[104:107], v[216:219]
    v_cvt_pk_bf16_f32 v152, v184, v185
    v_add_f32 v187, v187, v44
    v_exp_f32 v186, v186
    v_mfma_f32_16x16x32_bf16 v[216:219], a[172:175], v[108:111], v[216:219]
    ds_read_b128 a[140:143], v23 offset:16384
    v_add_f32 v188, v188, v48
    v_exp_f32 v187, v187
    v_mfma_f32_16x16x32_bf16 v[220:223], a[172:175], v[124:127], v[48:51]
    v_cvt_pk_bf16_f32 v153, v186, v187
    v_add_f32 v189, v189, v48
    v_exp_f32 v188, v188
    v_mfma_f32_16x16x32_bf16 v[220:223], a[168:171], v[120:123], v[220:223]
    ds_read_b128 a[144:147], v20 offset:20480
    v_add_f32 v190, v190, v48
    v_exp_f32 v189, v189
    v_mfma_f32_16x16x32_bf16 v[220:223], a[164:167], v[116:119], v[220:223]
    v_cvt_pk_bf16_f32 v164, v188, v189
    v_add_f32 v191, v191, v48
    v_exp_f32 v190, v190
    v_mfma_f32_16x16x32_bf16 v[220:223], a[160:163], v[112:115], v[220:223]
    ds_read_b128 a[148:151], v21 offset:20480
    v_add_f32 v192, v192, v36
    v_exp_f32 v191, v191
    v_mfma_f32_16x16x32_bf16 v[224:227], a[176:179], v[64:67], v[36:39]
    v_cvt_pk_bf16_f32 v165, v190, v191
    v_add_f32 v193, v193, v36
    v_exp_f32 v192, v192
    v_mfma_f32_16x16x32_bf16 v[224:227], a[180:183], v[68:71], v[224:227]
    ds_read_b128 a[152:155], v22 offset:20480
    v_add_f32 v194, v194, v36
    v_exp_f32 v193, v193
    v_mfma_f32_16x16x32_bf16 v[224:227], a[184:187], v[72:75], v[224:227]
    v_cvt_pk_bf16_f32 v130, v192, v193
    v_add_f32 v195, v195, v36
    v_exp_f32 v194, v194
    v_mfma_f32_16x16x32_bf16 v[224:227], a[188:191], v[76:79], v[224:227]
    ds_read_b128 a[156:159], v23 offset:20480
    v_add_f32 v196, v196, v40
    v_exp_f32 v195, v195
    v_mfma_f32_16x16x32_bf16 v[228:231], a[188:191], v[92:95], v[40:43]
    v_cvt_pk_bf16_f32 v131, v194, v195
    v_add_f32 v197, v197, v40
    v_exp_f32 v196, v196
    v_mfma_f32_16x16x32_bf16 v[228:231], a[184:187], v[88:91], v[228:231]
    ds_read_b128 a[160:163], v20 offset:24576
    v_add_f32 v198, v198, v40
    v_exp_f32 v197, v197
    v_mfma_f32_16x16x32_bf16 v[228:231], a[180:183], v[84:87], v[228:231]
    v_cvt_pk_bf16_f32 v142, v196, v197
    v_add_f32 v199, v199, v40
    v_exp_f32 v198, v198
    v_mfma_f32_16x16x32_bf16 v[228:231], a[176:179], v[80:83], v[228:231]
    ds_read_b128 a[164:167], v21 offset:24576
    v_add_f32 v200, v200, v44
    v_exp_f32 v199, v199
    v_mfma_f32_16x16x32_bf16 v[232:235], a[176:179], v[96:99], v[44:47]
    v_cvt_pk_bf16_f32 v143, v198, v199
    v_add_f32 v201, v201, v44
    v_exp_f32 v200, v200
    v_mfma_f32_16x16x32_bf16 v[232:235], a[180:183], v[100:103], v[232:235]
    ds_read_b128 a[168:171], v22 offset:24576
    v_add_f32 v202, v202, v44
    v_exp_f32 v201, v201
    v_mfma_f32_16x16x32_bf16 v[232:235], a[184:187], v[104:107], v[232:235]
    v_cvt_pk_bf16_f32 v154, v200, v201
    v_add_f32 v203, v203, v44
    v_exp_f32 v202, v202
    v_mfma_f32_16x16x32_bf16 v[232:235], a[188:191], v[108:111], v[232:235]
    ds_read_b128 a[172:175], v23 offset:24576
    v_add_f32 v204, v204, v48
    v_exp_f32 v203, v203
    v_mfma_f32_16x16x32_bf16 v[236:239], a[188:191], v[124:127], v[48:51]
    v_cvt_pk_bf16_f32 v155, v202, v203
    v_add_f32 v205, v205, v48
    v_exp_f32 v204, v204
    v_mfma_f32_16x16x32_bf16 v[236:239], a[184:187], v[120:123], v[236:239]
    v_add_f32 v206, v206, v48
    v_exp_f32 v205, v205
    v_mfma_f32_16x16x32_bf16 v[236:239], a[180:183], v[116:119], v[236:239]
    v_cvt_pk_bf16_f32 v166, v204, v205
    v_add_f32 v207, v207, v48
    v_exp_f32 v206, v206
    v_mfma_f32_16x16x32_bf16 v[236:239], a[176:179], v[112:115], v[236:239]
    v_exp_f32 v207, v207
    v_exp_f32 v208, v208
    v_exp_f32 v209, v209
    v_exp_f32 v210, v210
    v_exp_f32 v211, v211
    v_exp_f32 v212, v212
    v_exp_f32 v213, v213
    v_exp_f32 v214, v214
    v_exp_f32 v215, v215
    v_cvt_pk_bf16_f32 v167, v206, v207
    s_add_u32 m0, s55, 114688
    s_waitcnt lgkmcnt(8)
    v_mfma_f32_16x16x32_bf16 v[176:179], a[128:131], v[64:67], v[36:39]
    v_exp_f32 v216, v216
    v_mfma_f32_16x16x32_bf16 v[176:179], a[132:135], v[68:71], v[176:179]
    v_exp_f32 v217, v217
    v_mfma_f32_16x16x32_bf16 v[176:179], a[136:139], v[72:75], v[176:179]
    ds_read_b128 a[176:179], v20 offset:28672
    v_cvt_pk_bf16_f32 v156, v216, v217
    v_mfma_f32_16x16x32_bf16 v[176:179], a[140:143], v[76:79], v[176:179]
    v_exp_f32 v218, v218
    v_mfma_f32_16x16x32_bf16 v[180:183], a[140:143], v[92:95], v[40:43]
    v_exp_f32 v219, v219
    v_mfma_f32_16x16x32_bf16 v[180:183], a[136:139], v[88:91], v[180:183]
    ds_read_b128 a[180:183], v21 offset:28672
    v_cvt_pk_bf16_f32 v157, v218, v219
    v_mfma_f32_16x16x32_bf16 v[180:183], a[132:135], v[84:87], v[180:183]
    v_exp_f32 v220, v220
    v_mfma_f32_16x16x32_bf16 v[180:183], a[128:131], v[80:83], v[180:183]
    v_exp_f32 v221, v221
    v_mfma_f32_16x16x32_bf16 v[184:187], a[128:131], v[96:99], v[44:47]
    ds_read_b128 a[184:187], v22 offset:28672
    v_cvt_pk_bf16_f32 v168, v220, v221
    v_mfma_f32_16x16x32_bf16 v[184:187], a[132:135], v[100:103], v[184:187]
    v_exp_f32 v222, v222
    v_mfma_f32_16x16x32_bf16 v[184:187], a[136:139], v[104:107], v[184:187]
    v_exp_f32 v223, v223
    v_mfma_f32_16x16x32_bf16 v[184:187], a[140:143], v[108:111], v[184:187]
    ds_read_b128 a[188:191], v23 offset:28672
    v_cvt_pk_bf16_f32 v169, v222, v223
    v_mfma_f32_16x16x32_bf16 v[188:191], a[140:143], v[124:127], v[48:51]
    v_cvt_pk_bf16_f32 v132, v208, v209
    v_mov_b32 v240, 0
    v_mfma_f32_16x16x32_bf16 v[188:191], a[136:139], v[120:123], v[188:191]
    buffer_load_dwordx4 v16, s[32:35], s57 offen offset:0 lds
    v_mfma_f32_16x16x32_bf16 v[188:191], a[132:135], v[116:119], v[188:191]
    v_cvt_pk_bf16_f32 v133, v210, v211
    v_mov_b32 v241, 0
    v_mfma_f32_16x16x32_bf16 v[188:191], a[128:131], v[112:115], v[188:191]
    v_cvt_pk_bf16_f32 v144, v212, v213
    v_cvt_pk_bf16_f32 v145, v214, v215
    s_waitcnt lgkmcnt(8)
    v_mfma_f32_16x16x32_bf16 v[192:195], a[144:147], v[64:67], v[36:39]
    ds_read_b64_tr_b16 a[128:129], v24 offset:0
    v_mov_b32 v244, 0
    v_mfma_f32_16x16x32_bf16 v[192:195], a[148:151], v[68:71], v[192:195]
    v_exp_f32 v224, v224
    v_mfma_f32_16x16x32_bf16 v[192:195], a[152:155], v[72:75], v[192:195]
    v_exp_f32 v225, v225
    v_mfma_f32_16x16x32_bf16 v[192:195], a[156:159], v[76:79], v[192:195]
    ds_read_b64_tr_b16 a[130:131], v24 offset:4096
    v_cvt_pk_bf16_f32 v134, v224, v225
    v_mfma_f32_16x16x32_bf16 v[196:199], a[156:159], v[92:95], v[40:43]
    v_exp_f32 v226, v226
    v_mfma_f32_16x16x32_bf16 v[196:199], a[152:155], v[88:91], v[196:199]
    v_exp_f32 v227, v227
    v_mfma_f32_16x16x32_bf16 v[196:199], a[148:151], v[84:87], v[196:199]
    ds_read_b64_tr_b16 a[132:133], v24 offset:8192
    v_cvt_pk_bf16_f32 v135, v226, v227
    v_mfma_f32_16x16x32_bf16 v[196:199], a[144:147], v[80:83], v[196:199]
    v_exp_f32 v228, v228
    v_mfma_f32_16x16x32_bf16 v[200:203], a[144:147], v[96:99], v[44:47]
    v_exp_f32 v229, v229
    v_mfma_f32_16x16x32_bf16 v[200:203], a[148:151], v[100:103], v[200:203]
    ds_read_b64_tr_b16 a[134:135], v24 offset:12288
    v_cvt_pk_bf16_f32 v146, v228, v229
    v_mfma_f32_16x16x32_bf16 v[200:203], a[152:155], v[104:107], v[200:203]
    v_exp_f32 v230, v230
    v_mfma_f32_16x16x32_bf16 v[200:203], a[156:159], v[108:111], v[200:203]
    v_exp_f32 v231, v231
    v_mfma_f32_16x16x32_bf16 v[204:207], a[156:159], v[124:127], v[48:51]
    ds_read_b64_tr_b16 a[136:137], v25 offset:0
    v_cvt_pk_bf16_f32 v147, v230, v231
    v_mfma_f32_16x16x32_bf16 v[204:207], a[152:155], v[120:123], v[204:207]
    ds_read_b64_tr_b16 a[138:139], v25 offset:4096
    v_mov_b32 v245, 0
    v_mfma_f32_16x16x32_bf16 v[204:207], a[148:151], v[116:119], v[204:207]
    buffer_load_dwordx4 v17, s[32:35], s57 offen offset:1024 lds
    v_mfma_f32_16x16x32_bf16 v[204:207], a[144:147], v[112:115], v[204:207]
    ds_read_b64_tr_b16 a[140:141], v25 offset:8192
    s_waitcnt lgkmcnt(7)
    v_mfma_f32_16x16x32_bf16 v[208:211], a[160:163], v[64:67], v[36:39]
    ds_read_b64_tr_b16 a[142:143], v25 offset:12288
    v_mov_b32 v248, 0
    v_mfma_f32_16x16x32_bf16 v[208:211], a[164:167], v[68:71], v[208:211]
    ds_read_b64_tr_b16 a[144:145], v26 offset:0
    v_mov_b32 v249, 0
    v_mfma_f32_16x16x32_bf16 v[208:211], a[168:171], v[72:75], v[208:211]
    v_exp_f32 v232, v232
    v_mfma_f32_16x16x32_bf16 v[208:211], a[172:175], v[76:79], v[208:211]
    v_exp_f32 v233, v233
    v_mfma_f32_16x16x32_bf16 v[212:215], a[172:175], v[92:95], v[40:43]
    ds_read_b64_tr_b16 a[146:147], v26 offset:4096
    v_cvt_pk_bf16_f32 v158, v232, v233
    v_mfma_f32_16x16x32_bf16 v[212:215], a[168:171], v[88:91], v[212:215]
    v_exp_f32 v234, v234
    v_mfma_f32_16x16x32_bf16 v[212:215], a[164:167], v[84:87], v[212:215]
    v_exp_f32 v235, v235
    v_mfma_f32_16x16x32_bf16 v[212:215], a[160:163], v[80:83], v[212:215]
    ds_read_b64_tr_b16 a[148:149], v26 offset:8192
    v_cvt_pk_bf16_f32 v159, v234, v235
    v_mfma_f32_16x16x32_bf16 v[216:219], a[160:163], v[96:99], v[44:47]
    v_exp_f32 v236, v236
    v_mfma_f32_16x16x32_bf16 v[216:219], a[164:167], v[100:103], v[216:219]
    v_exp_f32 v237, v237
    v_mfma_f32_16x16x32_bf16 v[216:219], a[168:171], v[104:107], v[216:219]
    ds_read_b64_tr_b16 a[150:151], v26 offset:12288
    v_cvt_pk_bf16_f32 v170, v236, v237
    v_mfma_f32_16x16x32_bf16 v[216:219], a[172:175], v[108:111], v[216:219]
    v_exp_f32 v238, v238
    v_mfma_f32_16x16x32_bf16 v[220:223], a[172:175], v[124:127], v[48:51]
    v_exp_f32 v239, v239
    v_mfma_f32_16x16x32_bf16 v[220:223], a[168:171], v[120:123], v[220:223]
    ds_read_b64_tr_b16 a[152:153], v27 offset:0
    v_cvt_pk_bf16_f32 v171, v238, v239
    v_mfma_f32_16x16x32_bf16 v[220:223], a[164:167], v[116:119], v[220:223]
    ds_read_b64_tr_b16 a[154:155], v27 offset:4096
    v_mov_b32 v252, 0
    v_mfma_f32_16x16x32_bf16 v[220:223], a[160:163], v[112:115], v[220:223]
    buffer_load_dwordx4 v16, s[32:35], s57 offen offset:2048 lds
    v_mfma_f32_16x16x32_bf16 v[224:227], a[176:179], v[64:67], v[36:39]
    ds_read_b64_tr_b16 a[156:157], v27 offset:8192
    v_mov_b32 v253, 0
    v_mfma_f32_16x16x32_bf16 v[224:227], a[180:183], v[68:71], v[224:227]
    ds_read_b64_tr_b16 a[158:159], v27 offset:12288
    v_mov_b32 v63, 1
    v_mfma_f32_16x16x32_bf16 v[224:227], a[184:187], v[72:75], v[224:227]
    v_exp_f32 v176, v176
    v_mfma_f32_16x16x32_bf16 v[224:227], a[188:191], v[76:79], v[224:227]
    v_exp_f32 v177, v177
    v_mfma_f32_16x16x32_bf16 v[228:231], a[188:191], v[92:95], v[40:43]
    ds_read_b64_tr_b16 a[160:161], v28 offset:0
    v_cvt_pk_bf16_f32 v136, v176, v177
    v_mfma_f32_16x16x32_bf16 v[228:231], a[184:187], v[88:91], v[228:231]
    v_exp_f32 v178, v178
    v_mfma_f32_16x16x32_bf16 v[228:231], a[180:183], v[84:87], v[228:231]
    v_exp_f32 v179, v179
    v_mfma_f32_16x16x32_bf16 v[228:231], a[176:179], v[80:83], v[228:231]
    ds_read_b64_tr_b16 a[162:163], v28 offset:4096
    v_cvt_pk_bf16_f32 v137, v178, v179
    v_mfma_f32_16x16x32_bf16 v[232:235], a[176:179], v[96:99], v[44:47]
    v_exp_f32 v180, v180
    v_mfma_f32_16x16x32_bf16 v[232:235], a[180:183], v[100:103], v[232:235]
    v_exp_f32 v181, v181
    v_mfma_f32_16x16x32_bf16 v[232:235], a[184:187], v[104:107], v[232:235]
    ds_read_b64_tr_b16 a[164:165], v28 offset:8192
    v_cvt_pk_bf16_f32 v148, v180, v181
    v_mfma_f32_16x16x32_bf16 v[232:235], a[188:191], v[108:111], v[232:235]
    v_exp_f32 v182, v182
    v_mfma_f32_16x16x32_bf16 v[236:239], a[188:191], v[124:127], v[48:51]
    v_exp_f32 v183, v183
    v_mfma_f32_16x16x32_bf16 v[236:239], a[184:187], v[120:123], v[236:239]
    ds_read_b64_tr_b16 a[166:167], v28 offset:12288
    v_cvt_pk_bf16_f32 v149, v182, v183
    v_mfma_f32_16x16x32_bf16 v[236:239], a[180:183], v[116:119], v[236:239]
    ds_read_b64_tr_b16 a[168:169], v29 offset:0
    s_waitcnt lgkmcnt(5)
    v_mfma_f32_16x16x32_bf16 v[236:239], a[176:179], v[112:115], v[236:239]
    buffer_load_dwordx4 v17, s[32:35], s57 offen offset:3072 lds
    v_mfma_f32_16x16x32_bf16 a[0:3], a[128:131], v[128:131], 0
    ds_read_b64_tr_b16 a[170:171], v29 offset:4096
    v_and_b32 v62, 28, v0
    v_mfma_f32_16x16x32_bf16 a[0:3], a[132:135], v[132:135], a[0:3]
    s_add_u32 s57, s57, 16384
    s_add_u32 m0, s55, 0
    ds_read_b64_tr_b16 a[172:173], v29 offset:8192
    v_mfma_f32_16x16x32_bf16 a[4:7], a[132:135], v[144:147], 0
    v_exp_f32 v184, v184
    v_mfma_f32_16x16x32_bf16 a[4:7], a[128:131], v[140:143], a[4:7]
    v_exp_f32 v185, v185
    v_mfma_f32_16x16x32_bf16 a[8:11], a[128:131], v[152:155], 0
    ds_read_b64_tr_b16 a[174:175], v29 offset:12288
    v_cvt_pk_bf16_f32 v160, v184, v185
    v_mfma_f32_16x16x32_bf16 a[8:11], a[132:135], v[156:159], a[8:11]
    v_exp_f32 v186, v186
    v_mfma_f32_16x16x32_bf16 a[12:15], a[132:135], v[168:171], 0
    v_exp_f32 v187, v187
    v_mfma_f32_16x16x32_bf16 a[12:15], a[128:131], v[164:167], a[12:15]
    ds_read_b64_tr_b16 a[176:177], v30 offset:0
    v_cvt_pk_bf16_f32 v161, v186, v187
    v_mfma_f32_16x16x32_bf16 a[16:19], a[136:139], v[128:131], 0
    v_exp_f32 v188, v188
    v_mfma_f32_16x16x32_bf16 a[16:19], a[140:143], v[132:135], a[16:19]
    v_exp_f32 v189, v189
    v_mfma_f32_16x16x32_bf16 a[20:23], a[140:143], v[144:147], 0
    ds_read_b64_tr_b16 a[178:179], v30 offset:4096
    v_cvt_pk_bf16_f32 v172, v188, v189
    v_mfma_f32_16x16x32_bf16 a[20:23], a[136:139], v[140:143], a[20:23]
    v_exp_f32 v190, v190
    v_mfma_f32_16x16x32_bf16 a[24:27], a[136:139], v[152:155], 0
    v_exp_f32 v191, v191
    v_mfma_f32_16x16x32_bf16 a[24:27], a[140:143], v[156:159], a[24:27]
    ds_read_b64_tr_b16 a[180:181], v30 offset:8192
    v_cvt_pk_bf16_f32 v173, v190, v191
    v_mfma_f32_16x16x32_bf16 a[28:31], a[140:143], v[168:171], 0
    ds_read_b64_tr_b16 a[182:183], v30 offset:12288
    v_min_u32 v12, 10, v18
    v_mfma_f32_16x16x32_bf16 a[28:31], a[136:139], v[164:167], a[28:31]
    buffer_load_dwordx4 v3, s[28:31], s56 offen offset:0 lds
    v_mfma_f32_16x16x32_bf16 a[32:35], a[144:147], v[128:131], 0
    ds_read_b64_tr_b16 a[184:185], v31 offset:0
    v_lshl_add_u32 v12, v12, 7, s16
    v_mfma_f32_16x16x32_bf16 a[32:35], a[148:151], v[132:135], a[32:35]
    ds_read_b64_tr_b16 a[186:187], v31 offset:4096
    s_waitcnt lgkmcnt(6)
    v_and_b32 v19, 3, v18
    v_mfma_f32_16x16x32_bf16 a[36:39], a[148:151], v[144:147], 0
    v_exp_f32 v192, v192
    v_mfma_f32_16x16x32_bf16 a[36:39], a[144:147], v[140:143], a[36:39]
    v_exp_f32 v193, v193
    v_mfma_f32_16x16x32_bf16 a[40:43], a[144:147], v[152:155], 0
    ds_read_b64_tr_b16 a[188:189], v31 offset:8192
    v_cvt_pk_bf16_f32 v138, v192, v193
    v_mfma_f32_16x16x32_bf16 a[40:43], a[148:151], v[156:159], a[40:43]
    v_exp_f32 v194, v194
    v_mfma_f32_16x16x32_bf16 a[44:47], a[148:151], v[168:171], 0
    v_exp_f32 v195, v195
    v_mfma_f32_16x16x32_bf16 a[44:47], a[144:147], v[164:167], a[44:47]
    ds_read_b64_tr_b16 a[190:191], v31 offset:12288
    v_cvt_pk_bf16_f32 v139, v194, v195
    v_mfma_f32_16x16x32_bf16 a[48:51], a[152:155], v[128:131], 0
    v_exp_f32 v196, v196
    v_mfma_f32_16x16x32_bf16 a[48:51], a[156:159], v[132:135], a[48:51]
    v_exp_f32 v197, v197
    v_mfma_f32_16x16x32_bf16 a[52:55], a[156:159], v[144:147], 0
    v_cvt_pk_bf16_f32 v150, v196, v197
    v_lshl_add_u32 v19, v19, 7, s17
    v_mfma_f32_16x16x32_bf16 a[52:55], a[152:155], v[140:143], a[52:55]
    v_exp_f32 v198, v198
    v_mfma_f32_16x16x32_bf16 a[56:59], a[152:155], v[152:155], 0
    v_exp_f32 v199, v199
    v_mfma_f32_16x16x32_bf16 a[56:59], a[156:159], v[156:159], a[56:59]
    v_cvt_pk_bf16_f32 v151, v198, v199
    v_add_u32 v9, 36864, v8
    v_mfma_f32_16x16x32_bf16 a[60:63], a[156:159], v[168:171], 0
    v_add_u32 v10, 73728, v8
    v_add_u32 v11, 110592, v8
    v_mfma_f32_16x16x32_bf16 a[60:63], a[152:155], v[164:167], a[60:63]
    buffer_load_dwordx4 v4, s[28:31], s56 offen offset:1024 lds
    v_mfma_f32_16x16x32_bf16 a[64:67], a[160:163], v[128:131], 0
    v_add_u32 v2, 0, v18
    v_mul_u32_u24 v14, 3641, v2
    v_mfma_f32_16x16x32_bf16 a[64:67], a[164:167], v[132:135], a[64:67]
    s_waitcnt vmcnt(28) lgkmcnt(0)
    s_barrier
    v_mfma_f32_16x16x32_bf16 a[68:71], a[164:167], v[144:147], 0
    v_lshrrev_b32 v14, 16, v14
    v_mul_u32_u24 v14, 864, v14
    v_mfma_f32_16x16x32_bf16 a[68:71], a[160:163], v[140:143], a[68:71]
    v_exp_f32 v200, v200
    v_mfma_f32_16x16x32_bf16 a[72:75], a[160:163], v[152:155], 0
    v_exp_f32 v201, v201
    v_mfma_f32_16x16x32_bf16 a[72:75], a[164:167], v[156:159], a[72:75]
    ds_read_b128 a[128:131], v20 offset:32768
    v_cvt_pk_bf16_f32 v162, v200, v201
    v_mfma_f32_16x16x32_bf16 a[76:79], a[164:167], v[168:171], 0
    v_exp_f32 v202, v202
    v_mfma_f32_16x16x32_bf16 a[76:79], a[160:163], v[164:167], a[76:79]
    v_exp_f32 v203, v203
    v_mfma_f32_16x16x32_bf16 a[80:83], a[168:171], v[128:131], 0
    ds_read_b128 a[132:135], v21 offset:32768
    v_cvt_pk_bf16_f32 v163, v202, v203
    v_mfma_f32_16x16x32_bf16 a[80:83], a[172:175], v[132:135], a[80:83]
    v_exp_f32 v204, v204
    v_mfma_f32_16x16x32_bf16 a[84:87], a[172:175], v[144:147], 0
    v_exp_f32 v205, v205
    v_mfma_f32_16x16x32_bf16 a[84:87], a[168:171], v[140:143], a[84:87]
    ds_read_b128 a[136:139], v22 offset:32768
    v_cvt_pk_bf16_f32 v174, v204, v205
    v_mfma_f32_16x16x32_bf16 a[88:91], a[168:171], v[152:155], 0
    v_exp_f32 v206, v206
    v_mfma_f32_16x16x32_bf16 a[88:91], a[172:175], v[156:159], a[88:91]
    v_exp_f32 v207, v207
    v_mfma_f32_16x16x32_bf16 a[92:95], a[172:175], v[168:171], 0
    ds_read_b128 a[140:143], v23 offset:32768
    v_cvt_pk_bf16_f32 v175, v206, v207
    v_mfma_f32_16x16x32_bf16 a[92:95], a[168:171], v[164:167], a[92:95]
    ds_read_b128 a[144:147], v20 offset:36864
    v_lshl_add_u32 v52, v2, 4, v14
    v_mfma_f32_16x16x32_bf16 a[96:99], a[176:179], v[128:131], 0
    buffer_load_dwordx4 v5, s[28:31], s56 offen offset:2048 lds
    v_mfma_f32_16x16x32_bf16 a[96:99], a[180:183], v[132:135], a[96:99]
    ds_read_b128 a[148:151], v21 offset:36864
    v_add_u32 v2, 64, v18
    v_mfma_f32_16x16x32_bf16 a[100:103], a[180:183], v[144:147], 0
    v_mul_u32_u24 v14, 3641, v2
    v_lshrrev_b32 v14, 16, v14
    v_mfma_f32_16x16x32_bf16 a[100:103], a[176:179], v[140:143], a[100:103]
    v_mul_u32_u24 v14, 864, v14
    v_lshl_add_u32 v53, v2, 4, v14
    v_mfma_f32_16x16x32_bf16 a[104:107], a[176:179], v[152:155], 0
    v_exp_f32 v208, v208
    v_mfma_f32_16x16x32_bf16 a[104:107], a[180:183], v[156:159], a[104:107]
    v_exp_f32 v209, v209
    v_smfmac_f32_16x16x64_bf16 v[240:243], v[32:35], v[128:135], v61
    ds_read_b128 a[152:155], v22 offset:36864
    v_mfma_f32_16x16x32_bf16 a[108:111], a[180:183], v[168:171], 0
    v_exp_f32 v210, v210
    v_mfma_f32_16x16x32_bf16 a[108:111], a[176:179], v[164:167], a[108:111]
    v_exp_f32 v211, v211
    v_smfmac_f32_16x16x64_bf16 v[244:247], v[32:35], v[140:147], v61
    ds_read_b128 a[156:159], v23 offset:36864
    v_mfma_f32_16x16x32_bf16 a[112:115], a[184:187], v[128:131], 0
    v_exp_f32 v212, v212
    v_mfma_f32_16x16x32_bf16 a[112:115], a[188:191], v[132:135], a[112:115]
    v_exp_f32 v213, v213
    v_smfmac_f32_16x16x64_bf16 v[248:251], v[32:35], v[152:159], v61
    ds_read_b128 a[160:163], v20 offset:40960
    v_mfma_f32_16x16x32_bf16 a[116:119], a[188:191], v[144:147], 0
    v_exp_f32 v214, v214
    v_mfma_f32_16x16x32_bf16 a[116:119], a[184:187], v[140:143], a[116:119]
    v_exp_f32 v215, v215
    v_smfmac_f32_16x16x64_bf16 v[252:255], v[32:35], v[164:171], v61
    ds_read_b128 a[164:167], v21 offset:40960
    v_mfma_f32_16x16x32_bf16 a[120:123], a[184:187], v[152:155], 0
    ds_read_b128 a[168:171], v22 offset:40960
    v_mfma_f32_16x16x32_bf16 a[120:123], a[188:191], v[156:159], a[120:123]
    buffer_load_dwordx4 v6, s[28:31], s56 offen offset:3072 lds
    v_mfma_f32_16x16x32_bf16 a[124:127], a[188:191], v[168:171], 0
    ds_read_b128 a[172:175], v23 offset:40960
    v_mfma_f32_16x16x32_bf16 a[124:127], a[184:187], v[164:167], a[124:127]
    s_add_u32 s56, s56, 16384
    s_add_u32 m0, s55, 65536
    s_waitcnt lgkmcnt(4)
    s_mov_b32 s53, 0
L_k2_loopB:
    v_mfma_f32_16x16x32_bf16 v[176:179], a[128:131], v[64:67], v[36:39]
    v_exp_f32 v216, v216
    v_mfma_f32_16x16x32_bf16 v[176:179], a[132:135], v[68:71], v[176:179]
    v_exp_f32 v217, v217
    v_mfma_f32_16x16x32_bf16 v[176:179], a[136:139], v[72:75], v[176:179]
    ds_read_b128 a[176:179], v20 offset:45056
    v_cvt_pk_bf16_f32 v156, v216, v217
    v_mfma_f32_16x16x32_bf16 v[176:179], a[140:143], v[76:79], v[176:179]
    v_exp_f32 v218, v218
    v_mfma_f32_16x16x32_bf16 v[180:183], a[140:143], v[92:95], v[40:43]
    v_exp_f32 v219, v219
    v_mfma_f32_16x16x32_bf16 v[180:183], a[136:139], v[88:91], v[180:183]
    ds_read_b128 a[180:183], v21 offset:45056
    v_cvt_pk_bf16_f32 v157, v218, v219
    v_mfma_f32_16x16x32_bf16 v[180:183], a[132:135], v[84:87], v[180:183]
    v_exp_f32 v220, v220
    v_mfma_f32_16x16x32_bf16 v[180:183], a[128:131], v[80:83], v[180:183]
    v_exp_f32 v221, v221
    v_mfma_f32_16x16x32_bf16 v[184:187], a[128:131], v[96:99], v[44:47]
    ds_read_b128 a[184:187], v22 offset:45056
    v_cvt_pk_bf16_f32 v168, v220, v221
    v_mfma_f32_16x16x32_bf16 v[184:187], a[132:135], v[100:103], v[184:187]
    v_exp_f32 v222, v222
    v_mfma_f32_16x16x32_bf16 v[184:187], a[136:139], v[104:107], v[184:187]
    v_exp_f32 v223, v223
    v_mfma_f32_16x16x32_bf16 v[184:187], a[140:143], v[108:111], v[184:187]
    ds_read_b128 a[188:191], v23 offset:45056
    v_cvt_pk_bf16_f32 v169, v222, v223
    v_mfma_f32_16x16x32_bf16 v[188:191], a[140:143], v[124:127], v[48:51]
    v_cvt_pk_bf16_f32 v132, v208, v209
    v_mfma_f32_16x16x32_bf16 v[188:191], a[136:139], v[120:123], v[188:191]
    buffer_load_dwordx4 v16, s[32:35], s57 offen offset:0 lds
    v_mfma_f32_16x16x32_bf16 v[188:191], a[132:135], v[116:119], v[188:191]
    v_cvt_pk_bf16_f32 v133, v210, v211
    v_mfma_f32_16x16x32_bf16 v[188:191], a[128:131], v[112:115], v[188:191]
    v_cvt_pk_bf16_f32 v144, v212, v213
    v_cvt_pk_bf16_f32 v145, v214, v215
    v_mfma_f32_16x16x32_bf16 v[192:195], a[144:147], v[64:67], v[36:39]
    ds_read_b64_tr_b16 a[128:129], v24 offset:16384
    v_mfma_f32_16x16x32_bf16 v[192:195], a[148:151], v[68:71], v[192:195]
    v_exp_f32 v224, v224
    v_mfma_f32_16x16x32_bf16 v[192:195], a[152:155], v[72:75], v[192:195]
    v_exp_f32 v225, v225
    v_mfma_f32_16x16x32_bf16 v[192:195], a[156:159], v[76:79], v[192:195]
    ds_read_b64_tr_b16 a[130:131], v24 offset:20480
    v_cvt_pk_bf16_f32 v134, v224, v225
    v_mfma_f32_16x16x32_bf16 v[196:199], a[156:159], v[92:95], v[40:43]
    v_exp_f32 v226, v226
    v_mfma_f32_16x16x32_bf16 v[196:199], a[152:155], v[88:91], v[196:199]
    v_exp_f32 v227, v227
    v_mfma_f32_16x16x32_bf16 v[196:199], a[148:151], v[84:87], v[196:199]
    ds_read_b64_tr_b16 a[132:133], v24 offset:24576
    v_cvt_pk_bf16_f32 v135, v226, v227
    v_mfma_f32_16x16x32_bf16 v[196:199], a[144:147], v[80:83], v[196:199]
    v_exp_f32 v228, v228
    v_mfma_f32_16x16x32_bf16 v[200:203], a[144:147], v[96:99], v[44:47]
    v_exp_f32 v229, v229
    v_mfma_f32_16x16x32_bf16 v[200:203], a[148:151], v[100:103], v[200:203]
    ds_read_b64_tr_b16 a[134:135], v24 offset:28672
    v_cvt_pk_bf16_f32 v146, v228, v229
    v_mfma_f32_16x16x32_bf16 v[200:203], a[152:155], v[104:107], v[200:203]
    v_exp_f32 v230, v230
    v_mfma_f32_16x16x32_bf16 v[200:203], a[156:159], v[108:111], v[200:203]
    v_exp_f32 v231, v231
    v_mfma_f32_16x16x32_bf16 v[204:207], a[156:159], v[124:127], v[48:51]
    ds_read_b64_tr_b16 a[136:137], v25 offset:16384
    v_cvt_pk_bf16_f32 v147, v230, v231
    v_mfma_f32_16x16x32_bf16 v[204:207], a[152:155], v[120:123], v[204:207]
    ds_read_b64_tr_b16 a[138:139], v25 offset:20480
    v_mfma_f32_16x16x32_bf16 v[204:207], a[148:151], v[116:119], v[204:207]
    buffer_load_dwordx4 v17, s[32:35], s57 offen offset:1024 lds
    v_mfma_f32_16x16x32_bf16 v[204:207], a[144:147], v[112:115], v[204:207]
    ds_read_b64_tr_b16 a[140:141], v25 offset:24576
    s_waitcnt lgkmcnt(7)
    v_mfma_f32_16x16x32_bf16 v[208:211], a[160:163], v[64:67], v[36:39]
    ds_read_b64_tr_b16 a[142:143], v25 offset:28672
    v_mfma_f32_16x16x32_bf16 v[208:211], a[164:167], v[68:71], v[208:211]
    ds_read_b64_tr_b16 a[144:145], v26 offset:16384
    v_mfma_f32_16x16x32_bf16 v[208:211], a[168:171], v[72:75], v[208:211]
    v_exp_f32 v232, v232
    v_mfma_f32_16x16x32_bf16 v[208:211], a[172:175], v[76:79], v[208:211]
    v_exp_f32 v233, v233
    v_mfma_f32_16x16x32_bf16 v[212:215], a[172:175], v[92:95], v[40:43]
    ds_read_b64_tr_b16 a[146:147], v26 offset:20480
    v_cvt_pk_bf16_f32 v158, v232, v233
    v_mfma_f32_16x16x32_bf16 v[212:215], a[168:171], v[88:91], v[212:215]
    v_exp_f32 v234, v234
    v_mfma_f32_16x16x32_bf16 v[212:215], a[164:167], v[84:87], v[212:215]
    v_exp_f32 v235, v235
    v_mfma_f32_16x16x32_bf16 v[212:215], a[160:163], v[80:83], v[212:215]
    ds_read_b64_tr_b16 a[148:149], v26 offset:24576
    v_cvt_pk_bf16_f32 v159, v234, v235
    v_mfma_f32_16x16x32_bf16 v[216:219], a[160:163], v[96:99], v[44:47]
    v_exp_f32 v236, v236
    v_mfma_f32_16x16x32_bf16 v[216:219], a[164:167], v[100:103], v[216:219]
    v_exp_f32 v237, v237
    v_mfma_f32_16x16x32_bf16 v[216:219], a[168:171], v[104:107], v[216:219]
    ds_read_b64_tr_b16 a[150:151], v26 offset:28672
    v_cvt_pk_bf16_f32 v170, v236, v237
    v_mfma_f32_16x16x32_bf16 v[216:219], a[172:175], v[108:111], v[216:219]
    v_exp_f32 v238, v238
    v_mfma_f32_16x16x32_bf16 v[220:223], a[172:175], v[124:127], v[48:51]
    v_exp_f32 v239, v239
    v_mfma_f32_16x16x32_bf16 v[220:223], a[168:171], v[120:123], v[220:223]
    ds_read_b64_tr_b16 a[152:153], v27 offset:16384
    v_cvt_pk_bf16_f32 v171, v238, v239
    v_mfma_f32_16x16x32_bf16 v[220:223], a[164:167], v[116:119], v[220:223]
    ds_read_b64_tr_b16 a[154:155], v27 offset:20480
    v_mfma_f32_16x16x32_bf16 v[220:223], a[160:163], v[112:115], v[220:223]
    buffer_load_dwordx4 v16, s[32:35], s57 offen offset:2048 lds
    v_mfma_f32_16x16x32_bf16 v[224:227], a[176:179], v[64:67], v[36:39]
    ds_read_b64_tr_b16 a[156:157], v27 offset:24576
    v_mfma_f32_16x16x32_bf16 v[224:227], a[180:183], v[68:71], v[224:227]
    ds_read_b64_tr_b16 a[158:159], v27 offset:28672
    v_mfma_f32_16x16x32_bf16 v[224:227], a[184:187], v[72:75], v[224:227]
    v_exp_f32 v176, v176
    v_mfma_f32_16x16x32_bf16 v[224:227], a[188:191], v[76:79], v[224:227]
    v_exp_f32 v177, v177
    v_mfma_f32_16x16x32_bf16 v[228:231], a[188:191], v[92:95], v[40:43]
    ds_read_b64_tr_b16 a[160:161], v28 offset:16384
    v_cvt_pk_bf16_f32 v128, v176, v177
    v_mfma_f32_16x16x32_bf16 v[228:231], a[184:187], v[88:91], v[228:231]
    v_exp_f32 v178, v178
    v_mfma_f32_16x16x32_bf16 v[228:231], a[180:183], v[84:87], v[228:231]
    v_exp_f32 v179, v179
    v_mfma_f32_16x16x32_bf16 v[228:231], a[176:179], v[80:83], v[228:231]
    ds_read_b64_tr_b16 a[162:163], v28 offset:20480
    v_cvt_pk_bf16_f32 v129, v178, v179
    v_mfma_f32_16x16x32_bf16 v[232:235], a[176:179], v[96:99], v[44:47]
    v_exp_f32 v180, v180
    v_mfma_f32_16x16x32_bf16 v[232:235], a[180:183], v[100:103], v[232:235]
    v_exp_f32 v181, v181
    v_mfma_f32_16x16x32_bf16 v[232:235], a[184:187], v[104:107], v[232:235]
    ds_read_b64_tr_b16 a[164:165], v28 offset:24576
    v_cvt_pk_bf16_f32 v140, v180, v181
    v_mfma_f32_16x16x32_bf16 v[232:235], a[188:191], v[108:111], v[232:235]
    v_exp_f32 v182, v182
    v_mfma_f32_16x16x32_bf16 v[236:239], a[188:191], v[124:127], v[48:51]
    v_exp_f32 v183, v183
    v_mfma_f32_16x16x32_bf16 v[236:239], a[184:187], v[120:123], v[236:239]
    ds_read_b64_tr_b16 a[166:167], v28 offset:28672
    v_cvt_pk_bf16_f32 v141, v182, v183
    v_mfma_f32_16x16x32_bf16 v[236:239], a[180:183], v[116:119], v[236:239]
    ds_read_b64_tr_b16 a[168:169], v29 offset:16384
    s_waitcnt lgkmcnt(5)
    v_mfma_f32_16x16x32_bf16 v[236:239], a[176:179], v[112:115], v[236:239]
    buffer_load_dwordx4 v17, s[32:35], s57 offen offset:3072 lds
    v_mfma_f32_16x16x32_bf16 a[0:3], a[128:131], v[136:139], a[0:3]
    ds_read_b64_tr_b16 a[170:171], v29 offset:20480
    v_mfma_f32_16x16x32_bf16 a[0:3], a[132:135], v[132:135], a[0:3]
    s_add_u32 s57, s57, 16384
    s_add_u32 m0, s55, 16384
    ds_read_b64_tr_b16 a[172:173], v29 offset:24576
    v_mfma_f32_16x16x32_bf16 a[4:7], a[132:135], v[144:147], a[4:7]
    v_exp_f32 v184, v184
    v_mfma_f32_16x16x32_bf16 a[4:7], a[128:131], v[148:151], a[4:7]
    v_exp_f32 v185, v185
    v_mfma_f32_16x16x32_bf16 a[8:11], a[128:131], v[160:163], a[8:11]
    ds_read_b64_tr_b16 a[174:175], v29 offset:28672
    v_cvt_pk_bf16_f32 v152, v184, v185
    v_mfma_f32_16x16x32_bf16 a[8:11], a[132:135], v[156:159], a[8:11]
    v_exp_f32 v186, v186
    v_mfma_f32_16x16x32_bf16 a[12:15], a[132:135], v[168:171], a[12:15]
    v_exp_f32 v187, v187
    v_mfma_f32_16x16x32_bf16 a[12:15], a[128:131], v[172:175], a[12:15]
    ds_read_b64_tr_b16 a[176:177], v30 offset:16384
    v_cvt_pk_bf16_f32 v153, v186, v187
    v_mfma_f32_16x16x32_bf16 a[16:19], a[136:139], v[136:139], a[16:19]
    v_exp_f32 v188, v188
    v_mfma_f32_16x16x32_bf16 a[16:19], a[140:143], v[132:135], a[16:19]
    v_exp_f32 v189, v189
    v_mfma_f32_16x16x32_bf16 a[20:23], a[140:143], v[144:147], a[20:23]
    ds_read_b64_tr_b16 a[178:179], v30 offset:20480
    v_cvt_pk_bf16_f32 v164, v188, v189
    v_mfma_f32_16x16x32_bf16 a[20:23], a[136:139], v[148:151], a[20:23]
    v_exp_f32 v190, v190
    v_mfma_f32_16x16x32_bf16 a[24:27], a[136:139], v[160:163], a[24:27]
    v_exp_f32 v191, v191
    v_mfma_f32_16x16x32_bf16 a[24:27], a[140:143], v[156:159], a[24:27]
    ds_read_b64_tr_b16 a[180:181], v30 offset:24576
    v_cvt_pk_bf16_f32 v165, v190, v191
    v_mfma_f32_16x16x32_bf16 a[28:31], a[140:143], v[168:171], a[28:31]
    ds_read_b64_tr_b16 a[182:183], v30 offset:28672
    v_mfma_f32_16x16x32_bf16 a[28:31], a[136:139], v[172:175], a[28:31]
    buffer_load_dwordx4 v3, s[28:31], s56 offen offset:0 lds
    v_mfma_f32_16x16x32_bf16 a[32:35], a[144:147], v[136:139], a[32:35]
    ds_read_b64_tr_b16 a[184:185], v31 offset:16384
    v_mfma_f32_16x16x32_bf16 a[32:35], a[148:151], v[132:135], a[32:35]
    ds_read_b64_tr_b16 a[186:187], v31 offset:20480
    s_waitcnt lgkmcnt(6)
    v_mfma_f32_16x16x32_bf16 a[36:39], a[148:151], v[144:147], a[36:39]
    v_exp_f32 v192, v192
    v_mfma_f32_16x16x32_bf16 a[36:39], a[144:147], v[148:151], a[36:39]
    v_exp_f32 v193, v193
    v_mfma_f32_16x16x32_bf16 a[40:43], a[144:147], v[160:163], a[40:43]
    ds_read_b64_tr_b16 a[188:189], v31 offset:24576
    v_cvt_pk_bf16_f32 v130, v192, v193
    v_mfma_f32_16x16x32_bf16 a[40:43], a[148:151], v[156:159], a[40:43]
    v_exp_f32 v194, v194
    v_mfma_f32_16x16x32_bf16 a[44:47], a[148:151], v[168:171], a[44:47]
    v_exp_f32 v195, v195
    v_mfma_f32_16x16x32_bf16 a[44:47], a[144:147], v[172:175], a[44:47]
    ds_read_b64_tr_b16 a[190:191], v31 offset:28672
    v_cvt_pk_bf16_f32 v131, v194, v195
    v_mfma_f32_16x16x32_bf16 a[48:51], a[152:155], v[136:139], a[48:51]
    v_exp_f32 v196, v196
    v_mfma_f32_16x16x32_bf16 a[48:51], a[156:159], v[132:135], a[48:51]
    v_exp_f32 v197, v197
    v_mfma_f32_16x16x32_bf16 a[52:55], a[156:159], v[144:147], a[52:55]
    v_cvt_pk_bf16_f32 v142, v196, v197
    v_mfma_f32_16x16x32_bf16 a[52:55], a[152:155], v[148:151], a[52:55]
    v_exp_f32 v198, v198
    v_mfma_f32_16x16x32_bf16 a[56:59], a[152:155], v[160:163], a[56:59]
    v_exp_f32 v199, v199
    v_mfma_f32_16x16x32_bf16 a[56:59], a[156:159], v[156:159], a[56:59]
    v_cvt_pk_bf16_f32 v143, v198, v199
    v_mfma_f32_16x16x32_bf16 a[60:63], a[156:159], v[168:171], a[60:63]
    v_mfma_f32_16x16x32_bf16 a[60:63], a[152:155], v[172:175], a[60:63]
    buffer_load_dwordx4 v4, s[28:31], s56 offen offset:1024 lds
    v_mfma_f32_16x16x32_bf16 a[64:67], a[160:163], v[136:139], a[64:67]
    v_mfma_f32_16x16x32_bf16 a[64:67], a[164:167], v[132:135], a[64:67]
    s_waitcnt vmcnt(14) lgkmcnt(0)
    s_barrier
    v_mfma_f32_16x16x32_bf16 a[68:71], a[164:167], v[144:147], a[68:71]
    v_mfma_f32_16x16x32_bf16 a[68:71], a[160:163], v[148:151], a[68:71]
    v_exp_f32 v200, v200
    v_mfma_f32_16x16x32_bf16 a[72:75], a[160:163], v[160:163], a[72:75]
    v_exp_f32 v201, v201
    v_mfma_f32_16x16x32_bf16 a[72:75], a[164:167], v[156:159], a[72:75]
    ds_read_b128 a[128:131], v20 offset:49152
    v_cvt_pk_bf16_f32 v154, v200, v201
    v_mfma_f32_16x16x32_bf16 a[76:79], a[164:167], v[168:171], a[76:79]
    v_exp_f32 v202, v202
    v_mfma_f32_16x16x32_bf16 a[76:79], a[160:163], v[172:175], a[76:79]
    v_exp_f32 v203, v203
    v_mfma_f32_16x16x32_bf16 a[80:83], a[168:171], v[136:139], a[80:83]
    ds_read_b128 a[132:135], v21 offset:49152
    v_cvt_pk_bf16_f32 v155, v202, v203
    v_mfma_f32_16x16x32_bf16 a[80:83], a[172:175], v[132:135], a[80:83]
    v_exp_f32 v204, v204
    v_mfma_f32_16x16x32_bf16 a[84:87], a[172:175], v[144:147], a[84:87]
    v_exp_f32 v205, v205
    v_mfma_f32_16x16x32_bf16 a[84:87], a[168:171], v[148:151], a[84:87]
    ds_read_b128 a[136:139], v22 offset:49152
    v_cvt_pk_bf16_f32 v166, v204, v205
    v_mfma_f32_16x16x32_bf16 a[88:91], a[168:171], v[160:163], a[88:91]
    v_exp_f32 v206, v206
    v_mfma_f32_16x16x32_bf16 a[88:91], a[172:175], v[156:159], a[88:91]
    v_exp_f32 v207, v207
    v_mfma_f32_16x16x32_bf16 a[92:95], a[172:175], v[168:171], a[92:95]
    ds_read_b128 a[140:143], v23 offset:49152
    v_cvt_pk_bf16_f32 v167, v206, v207
    v_mfma_f32_16x16x32_bf16 a[92:95], a[168:171], v[172:175], a[92:95]
    ds_read_b128 a[144:147], v20 offset:53248
    v_mfma_f32_16x16x32_bf16 a[96:99], a[176:179], v[136:139], a[96:99]
    buffer_load_dwordx4 v5, s[28:31], s56 offen offset:2048 lds
    v_mfma_f32_16x16x32_bf16 a[96:99], a[180:183], v[132:135], a[96:99]
    ds_read_b128 a[148:151], v21 offset:53248
    v_mfma_f32_16x16x32_bf16 a[100:103], a[180:183], v[144:147], a[100:103]
    buffer_load_dword v13, v12, s[8:11], s5 offen
    v_mfma_f32_16x16x32_bf16 a[100:103], a[176:179], v[148:151], a[100:103]
    v_mfma_f32_16x16x32_bf16 a[104:107], a[176:179], v[160:163], a[104:107]
    v_exp_f32 v208, v208
    v_mfma_f32_16x16x32_bf16 a[104:107], a[180:183], v[156:159], a[104:107]
    v_exp_f32 v209, v209
    v_smfmac_f32_16x16x64_bf16 v[240:243], v[32:35], v[132:139], v61
    ds_read_b128 a[152:155], v22 offset:53248
    v_mfma_f32_16x16x32_bf16 a[108:111], a[180:183], v[168:171], a[108:111]
    v_exp_f32 v210, v210
    v_mfma_f32_16x16x32_bf16 a[108:111], a[176:179], v[172:175], a[108:111]
    v_exp_f32 v211, v211
    v_smfmac_f32_16x16x64_bf16 v[244:247], v[32:35], v[144:151], v61
    ds_read_b128 a[156:159], v23 offset:53248
    v_mfma_f32_16x16x32_bf16 a[112:115], a[184:187], v[136:139], a[112:115]
    v_exp_f32 v212, v212
    v_mfma_f32_16x16x32_bf16 a[112:115], a[188:191], v[132:135], a[112:115]
    v_exp_f32 v213, v213
    v_smfmac_f32_16x16x64_bf16 v[248:251], v[32:35], v[156:163], v61
    ds_read_b128 a[160:163], v20 offset:57344
    v_mfma_f32_16x16x32_bf16 a[116:119], a[188:191], v[144:147], a[116:119]
    v_exp_f32 v214, v214
    v_mfma_f32_16x16x32_bf16 a[116:119], a[184:187], v[148:151], a[116:119]
    v_exp_f32 v215, v215
    v_smfmac_f32_16x16x64_bf16 v[252:255], v[32:35], v[168:175], v61
    ds_read_b128 a[164:167], v21 offset:57344
    v_mfma_f32_16x16x32_bf16 a[120:123], a[184:187], v[160:163], a[120:123]
    ds_read_b128 a[168:171], v22 offset:57344
    v_mfma_f32_16x16x32_bf16 a[120:123], a[188:191], v[156:159], a[120:123]
    buffer_load_dwordx4 v6, s[28:31], s56 offen offset:3072 lds
    v_mfma_f32_16x16x32_bf16 a[124:127], a[188:191], v[168:171], a[124:127]
    ds_read_b128 a[172:175], v23 offset:57344
    v_mfma_f32_16x16x32_bf16 a[124:127], a[184:187], v[172:175], a[124:127]
    s_add_u32 s56, s56, 16384
    s_add_u32 m0, s55, 81920
    s_waitcnt lgkmcnt(4)
    v_mfma_f32_16x16x32_bf16 v[176:179], a[128:131], v[64:67], v[36:39]
    v_exp_f32 v216, v216
    v_mfma_f32_16x16x32_bf16 v[176:179], a[132:135], v[68:71], v[176:179]
    v_exp_f32 v217, v217
    v_mfma_f32_16x16x32_bf16 v[176:179], a[136:139], v[72:75], v[176:179]
    ds_read_b128 a[176:179], v20 offset:61440
    v_cvt_pk_bf16_f32 v156, v216, v217
    v_mfma_f32_16x16x32_bf16 v[176:179], a[140:143], v[76:79], v[176:179]
    v_exp_f32 v218, v218
    v_mfma_f32_16x16x32_bf16 v[180:183], a[140:143], v[92:95], v[40:43]
    v_exp_f32 v219, v219
    v_mfma_f32_16x16x32_bf16 v[180:183], a[136:139], v[88:91], v[180:183]
    ds_read_b128 a[180:183], v21 offset:61440
    v_cvt_pk_bf16_f32 v157, v218, v219
    v_mfma_f32_16x16x32_bf16 v[180:183], a[132:135], v[84:87], v[180:183]
    v_exp_f32 v220, v220
    v_mfma_f32_16x16x32_bf16 v[180:183], a[128:131], v[80:83], v[180:183]
    v_exp_f32 v221, v221
    v_mfma_f32_16x16x32_bf16 v[184:187], a[128:131], v[96:99], v[44:47]
    ds_read_b128 a[184:187], v22 offset:61440
    v_cvt_pk_bf16_f32 v168, v220, v221
    v_mfma_f32_16x16x32_bf16 v[184:187], a[132:135], v[100:103], v[184:187]
    v_exp_f32 v222, v222
    v_mfma_f32_16x16x32_bf16 v[184:187], a[136:139], v[104:107], v[184:187]
    v_exp_f32 v223, v223
    v_mfma_f32_16x16x32_bf16 v[184:187], a[140:143], v[108:111], v[184:187]
    ds_read_b128 a[188:191], v23 offset:61440
    v_cvt_pk_bf16_f32 v169, v222, v223
    v_mfma_f32_16x16x32_bf16 v[188:191], a[140:143], v[124:127], v[48:51]
    v_cvt_pk_bf16_f32 v132, v208, v209
    v_mfma_f32_16x16x32_bf16 v[188:191], a[136:139], v[120:123], v[188:191]
    buffer_load_dwordx4 v16, s[32:35], s57 offen offset:0 lds
    v_mfma_f32_16x16x32_bf16 v[188:191], a[132:135], v[116:119], v[188:191]
    v_cvt_pk_bf16_f32 v133, v210, v211
    v_mfma_f32_16x16x32_bf16 v[188:191], a[128:131], v[112:115], v[188:191]
    v_cvt_pk_bf16_f32 v144, v212, v213
    v_cvt_pk_bf16_f32 v145, v214, v215
    v_mfma_f32_16x16x32_bf16 v[192:195], a[144:147], v[64:67], v[36:39]
    ds_read_b64_tr_b16 a[128:129], v24 offset:32768
    v_mfma_f32_16x16x32_bf16 v[192:195], a[148:151], v[68:71], v[192:195]
    v_exp_f32 v224, v224
    v_mfma_f32_16x16x32_bf16 v[192:195], a[152:155], v[72:75], v[192:195]
    v_exp_f32 v225, v225
    v_mfma_f32_16x16x32_bf16 v[192:195], a[156:159], v[76:79], v[192:195]
    ds_read_b64_tr_b16 a[130:131], v24 offset:36864
    v_cvt_pk_bf16_f32 v134, v224, v225
    v_mfma_f32_16x16x32_bf16 v[196:199], a[156:159], v[92:95], v[40:43]
    v_exp_f32 v226, v226
    v_mfma_f32_16x16x32_bf16 v[196:199], a[152:155], v[88:91], v[196:199]
    v_exp_f32 v227, v227
    v_mfma_f32_16x16x32_bf16 v[196:199], a[148:151], v[84:87], v[196:199]
    ds_read_b64_tr_b16 a[132:133], v24 offset:40960
    v_cvt_pk_bf16_f32 v135, v226, v227
    v_mfma_f32_16x16x32_bf16 v[196:199], a[144:147], v[80:83], v[196:199]
    v_exp_f32 v228, v228
    v_mfma_f32_16x16x32_bf16 v[200:203], a[144:147], v[96:99], v[44:47]
    v_exp_f32 v229, v229
    v_mfma_f32_16x16x32_bf16 v[200:203], a[148:151], v[100:103], v[200:203]
    ds_read_b64_tr_b16 a[134:135], v24 offset:45056
    v_cvt_pk_bf16_f32 v146, v228, v229
    v_mfma_f32_16x16x32_bf16 v[200:203], a[152:155], v[104:107], v[200:203]
    v_exp_f32 v230, v230
    v_mfma_f32_16x16x32_bf16 v[200:203], a[156:159], v[108:111], v[200:203]
    v_exp_f32 v231, v231
    v_mfma_f32_16x16x32_bf16 v[204:207], a[156:159], v[124:127], v[48:51]
    ds_read_b64_tr_b16 a[136:137], v25 offset:32768
    v_cvt_pk_bf16_f32 v147, v230, v231
    v_mfma_f32_16x16x32_bf16 v[204:207], a[152:155], v[120:123], v[204:207]
    ds_read_b64_tr_b16 a[138:139], v25 offset:36864
    v_mfma_f32_16x16x32_bf16 v[204:207], a[148:151], v[116:119], v[204:207]
    buffer_load_dwordx4 v17, s[32:35], s57 offen offset:1024 lds
    v_mfma_f32_16x16x32_bf16 v[204:207], a[144:147], v[112:115], v[204:207]
    ds_read_b64_tr_b16 a[140:141], v25 offset:40960
    s_waitcnt lgkmcnt(7)
    v_mfma_f32_16x16x32_bf16 v[208:211], a[160:163], v[64:67], v[36:39]
    ds_read_b64_tr_b16 a[142:143], v25 offset:45056
    v_mfma_f32_16x16x32_bf16 v[208:211], a[164:167], v[68:71], v[208:211]
    ds_read_b64_tr_b16 a[144:145], v26 offset:32768
    v_mfma_f32_16x16x32_bf16 v[208:211], a[168:171], v[72:75], v[208:211]
    v_exp_f32 v232, v232
    v_mfma_f32_16x16x32_bf16 v[208:211], a[172:175], v[76:79], v[208:211]
    v_exp_f32 v233, v233
    v_mfma_f32_16x16x32_bf16 v[212:215], a[172:175], v[92:95], v[40:43]
    ds_read_b64_tr_b16 a[146:147], v26 offset:36864
    v_cvt_pk_bf16_f32 v158, v232, v233
    v_mfma_f32_16x16x32_bf16 v[212:215], a[168:171], v[88:91], v[212:215]
    v_exp_f32 v234, v234
    v_mfma_f32_16x16x32_bf16 v[212:215], a[164:167], v[84:87], v[212:215]
    v_exp_f32 v235, v235
    v_mfma_f32_16x16x32_bf16 v[212:215], a[160:163], v[80:83], v[212:215]
    ds_read_b64_tr_b16 a[148:149], v26 offset:40960
    v_cvt_pk_bf16_f32 v159, v234, v235
    v_mfma_f32_16x16x32_bf16 v[216:219], a[160:163], v[96:99], v[44:47]
    v_exp_f32 v236, v236
    v_mfma_f32_16x16x32_bf16 v[216:219], a[164:167], v[100:103], v[216:219]
    v_exp_f32 v237, v237
    v_mfma_f32_16x16x32_bf16 v[216:219], a[168:171], v[104:107], v[216:219]
    ds_read_b64_tr_b16 a[150:151], v26 offset:45056
    v_cvt_pk_bf16_f32 v170, v236, v237
    v_mfma_f32_16x16x32_bf16 v[216:219], a[172:175], v[108:111], v[216:219]
    v_exp_f32 v238, v238
    v_mfma_f32_16x16x32_bf16 v[220:223], a[172:175], v[124:127], v[48:51]
    v_exp_f32 v239, v239
    v_mfma_f32_16x16x32_bf16 v[220:223], a[168:171], v[120:123], v[220:223]
    ds_read_b64_tr_b16 a[152:153], v27 offset:32768
    v_cvt_pk_bf16_f32 v171, v238, v239
    v_mfma_f32_16x16x32_bf16 v[220:223], a[164:167], v[116:119], v[220:223]
    ds_read_b64_tr_b16 a[154:155], v27 offset:36864
    v_mfma_f32_16x16x32_bf16 v[220:223], a[160:163], v[112:115], v[220:223]
    buffer_load_dwordx4 v16, s[32:35], s57 offen offset:2048 lds
    v_mfma_f32_16x16x32_bf16 v[224:227], a[176:179], v[64:67], v[36:39]
    ds_read_b64_tr_b16 a[156:157], v27 offset:40960
    v_mfma_f32_16x16x32_bf16 v[224:227], a[180:183], v[68:71], v[224:227]
    ds_read_b64_tr_b16 a[158:159], v27 offset:45056
    v_mfma_f32_16x16x32_bf16 v[224:227], a[184:187], v[72:75], v[224:227]
    v_exp_f32 v176, v176
    v_mfma_f32_16x16x32_bf16 v[224:227], a[188:191], v[76:79], v[224:227]
    v_exp_f32 v177, v177
    v_mfma_f32_16x16x32_bf16 v[228:231], a[188:191], v[92:95], v[40:43]
    ds_read_b64_tr_b16 a[160:161], v28 offset:32768
    v_cvt_pk_bf16_f32 v136, v176, v177
    v_mfma_f32_16x16x32_bf16 v[228:231], a[184:187], v[88:91], v[228:231]
    v_exp_f32 v178, v178
    v_mfma_f32_16x16x32_bf16 v[228:231], a[180:183], v[84:87], v[228:231]
    v_exp_f32 v179, v179
    v_mfma_f32_16x16x32_bf16 v[228:231], a[176:179], v[80:83], v[228:231]
    ds_read_b64_tr_b16 a[162:163], v28 offset:36864
    v_cvt_pk_bf16_f32 v137, v178, v179
    v_mfma_f32_16x16x32_bf16 v[232:235], a[176:179], v[96:99], v[44:47]
    v_exp_f32 v180, v180
    v_mfma_f32_16x16x32_bf16 v[232:235], a[180:183], v[100:103], v[232:235]
    v_exp_f32 v181, v181
    v_mfma_f32_16x16x32_bf16 v[232:235], a[184:187], v[104:107], v[232:235]
    ds_read_b64_tr_b16 a[164:165], v28 offset:40960
    v_cvt_pk_bf16_f32 v148, v180, v181
    v_mfma_f32_16x16x32_bf16 v[232:235], a[188:191], v[108:111], v[232:235]
    v_exp_f32 v182, v182
    v_mfma_f32_16x16x32_bf16 v[236:239], a[188:191], v[124:127], v[48:51]
    v_exp_f32 v183, v183
    v_mfma_f32_16x16x32_bf16 v[236:239], a[184:187], v[120:123], v[236:239]
    ds_read_b64_tr_b16 a[166:167], v28 offset:45056
    v_cvt_pk_bf16_f32 v149, v182, v183
    v_mfma_f32_16x16x32_bf16 v[236:239], a[180:183], v[116:119], v[236:239]
    ds_read_b64_tr_b16 a[168:169], v29 offset:32768
    s_waitcnt lgkmcnt(5)
    v_mfma_f32_16x16x32_bf16 v[236:239], a[176:179], v[112:115], v[236:239]
    buffer_load_dwordx4 v17, s[32:35], s57 offen offset:3072 lds
    v_mfma_f32_16x16x32_bf16 a[0:3], a[128:131], v[128:131], a[0:3]
    ds_read_b64_tr_b16 a[170:171], v29 offset:36864
    v_mfma_f32_16x16x32_bf16 a[0:3], a[132:135], v[132:135], a[0:3]
    s_add_u32 s57, s57, 16384
    s_add_u32 m0, s55, 32768
    ds_read_b64_tr_b16 a[172:173], v29 offset:40960
    v_mfma_f32_16x16x32_bf16 a[4:7], a[132:135], v[144:147], a[4:7]
    v_exp_f32 v184, v184
    v_mfma_f32_16x16x32_bf16 a[4:7], a[128:131], v[140:143], a[4:7]
    v_exp_f32 v185, v185
    v_mfma_f32_16x16x32_bf16 a[8:11], a[128:131], v[152:155], a[8:11]
    ds_read_b64_tr_b16 a[174:175], v29 offset:45056
    v_cvt_pk_bf16_f32 v160, v184, v185
    v_mfma_f32_16x16x32_bf16 a[8:11], a[132:135], v[156:159], a[8:11]
    v_exp_f32 v186, v186
    v_mfma_f32_16x16x32_bf16 a[12:15], a[132:135], v[168:171], a[12:15]
    v_exp_f32 v187, v187
    v_mfma_f32_16x16x32_bf16 a[12:15], a[128:131], v[164:167], a[12:15]
    ds_read_b64_tr_b16 a[176:177], v30 offset:32768
    v_cvt_pk_bf16_f32 v161, v186, v187
    v_mfma_f32_16x16x32_bf16 a[16:19], a[136:139], v[128:131], a[16:19]
    v_exp_f32 v188, v188
    v_mfma_f32_16x16x32_bf16 a[16:19], a[140:143], v[132:135], a[16:19]
    v_exp_f32 v189, v189
    v_mfma_f32_16x16x32_bf16 a[20:23], a[140:143], v[144:147], a[20:23]
    ds_read_b64_tr_b16 a[178:179], v30 offset:36864
    v_cvt_pk_bf16_f32 v172, v188, v189
    v_mfma_f32_16x16x32_bf16 a[20:23], a[136:139], v[140:143], a[20:23]
    v_exp_f32 v190, v190
    v_mfma_f32_16x16x32_bf16 a[24:27], a[136:139], v[152:155], a[24:27]
    v_exp_f32 v191, v191
    v_mfma_f32_16x16x32_bf16 a[24:27], a[140:143], v[156:159], a[24:27]
    ds_read_b64_tr_b16 a[180:181], v30 offset:40960
    v_cvt_pk_bf16_f32 v173, v190, v191
    v_mfma_f32_16x16x32_bf16 a[28:31], a[140:143], v[168:171], a[28:31]
    ds_read_b64_tr_b16 a[182:183], v30 offset:45056
    v_mfma_f32_16x16x32_bf16 a[28:31], a[136:139], v[164:167], a[28:31]
    buffer_load_dwordx4 v3, s[28:31], s56 offen offset:0 lds
    v_mfma_f32_16x16x32_bf16 a[32:35], a[144:147], v[128:131], a[32:35]
    ds_read_b64_tr_b16 a[184:185], v31 offset:32768
    v_mfma_f32_16x16x32_bf16 a[32:35], a[148:151], v[132:135], a[32:35]
    ds_read_b64_tr_b16 a[186:187], v31 offset:36864
    s_waitcnt lgkmcnt(6)
    v_mfma_f32_16x16x32_bf16 a[36:39], a[148:151], v[144:147], a[36:39]
    v_exp_f32 v192, v192
    v_mfma_f32_16x16x32_bf16 a[36:39], a[144:147], v[140:143], a[36:39]
    v_exp_f32 v193, v193
    v_mfma_f32_16x16x32_bf16 a[40:43], a[144:147], v[152:155], a[40:43]
    ds_read_b64_tr_b16 a[188:189], v31 offset:40960
    v_cvt_pk_bf16_f32 v138, v192, v193
    v_mfma_f32_16x16x32_bf16 a[40:43], a[148:151], v[156:159], a[40:43]
    v_exp_f32 v194, v194
    v_mfma_f32_16x16x32_bf16 a[44:47], a[148:151], v[168:171], a[44:47]
    v_exp_f32 v195, v195
    v_mfma_f32_16x16x32_bf16 a[44:47], a[144:147], v[164:167], a[44:47]
    ds_read_b64_tr_b16 a[190:191], v31 offset:45056
    v_cvt_pk_bf16_f32 v139, v194, v195
    v_mfma_f32_16x16x32_bf16 a[48:51], a[152:155], v[128:131], a[48:51]
    v_exp_f32 v196, v196
    v_mfma_f32_16x16x32_bf16 a[48:51], a[156:159], v[132:135], a[48:51]
    v_exp_f32 v197, v197
    v_mfma_f32_16x16x32_bf16 a[52:55], a[156:159], v[144:147], a[52:55]
    v_cvt_pk_bf16_f32 v150, v196, v197
    v_mfma_f32_16x16x32_bf16 a[52:55], a[152:155], v[140:143], a[52:55]
    v_exp_f32 v198, v198
    v_mfma_f32_16x16x32_bf16 a[56:59], a[152:155], v[152:155], a[56:59]
    v_exp_f32 v199, v199
    v_mfma_f32_16x16x32_bf16 a[56:59], a[156:159], v[156:159], a[56:59]
    v_cvt_pk_bf16_f32 v151, v198, v199
    v_mfma_f32_16x16x32_bf16 a[60:63], a[156:159], v[168:171], a[60:63]
    v_mfma_f32_16x16x32_bf16 a[60:63], a[152:155], v[164:167], a[60:63]
    buffer_load_dwordx4 v4, s[28:31], s56 offen offset:1024 lds
    v_mfma_f32_16x16x32_bf16 a[64:67], a[160:163], v[128:131], a[64:67]
    v_mfma_f32_16x16x32_bf16 a[64:67], a[164:167], v[132:135], a[64:67]
    s_waitcnt vmcnt(15) lgkmcnt(0)
    s_barrier
    v_mfma_f32_16x16x32_bf16 a[68:71], a[164:167], v[144:147], a[68:71]
    v_mfma_f32_16x16x32_bf16 a[68:71], a[160:163], v[140:143], a[68:71]
    v_exp_f32 v200, v200
    v_mfma_f32_16x16x32_bf16 a[72:75], a[160:163], v[152:155], a[72:75]
    v_exp_f32 v201, v201
    v_mfma_f32_16x16x32_bf16 a[72:75], a[164:167], v[156:159], a[72:75]
    ds_read_b128 a[128:131], v20 offset:0
    v_cvt_pk_bf16_f32 v162, v200, v201
    v_mfma_f32_16x16x32_bf16 a[76:79], a[164:167], v[168:171], a[76:79]
    v_exp_f32 v202, v202
    v_mfma_f32_16x16x32_bf16 a[76:79], a[160:163], v[164:167], a[76:79]
    v_exp_f32 v203, v203
    v_mfma_f32_16x16x32_bf16 a[80:83], a[168:171], v[128:131], a[80:83]
    ds_read_b128 a[132:135], v21 offset:0
    v_cvt_pk_bf16_f32 v163, v202, v203
    v_mfma_f32_16x16x32_bf16 a[80:83], a[172:175], v[132:135], a[80:83]
    v_exp_f32 v204, v204
    v_mfma_f32_16x16x32_bf16 a[84:87], a[172:175], v[144:147], a[84:87]
    v_exp_f32 v205, v205
    v_mfma_f32_16x16x32_bf16 a[84:87], a[168:171], v[140:143], a[84:87]
    ds_read_b128 a[136:139], v22 offset:0
    v_cvt_pk_bf16_f32 v174, v204, v205
    v_mfma_f32_16x16x32_bf16 a[88:91], a[168:171], v[152:155], a[88:91]
    v_exp_f32 v206, v206
    v_mfma_f32_16x16x32_bf16 a[88:91], a[172:175], v[156:159], a[88:91]
    v_exp_f32 v207, v207
    v_mfma_f32_16x16x32_bf16 a[92:95], a[172:175], v[168:171], a[92:95]
    ds_read_b128 a[140:143], v23 offset:0
    v_cvt_pk_bf16_f32 v175, v206, v207
    v_mfma_f32_16x16x32_bf16 a[92:95], a[168:171], v[164:167], a[92:95]
    ds_read_b128 a[144:147], v20 offset:4096
    v_mfma_f32_16x16x32_bf16 a[96:99], a[176:179], v[128:131], a[96:99]
    buffer_load_dwordx4 v5, s[28:31], s56 offen offset:2048 lds
    v_mfma_f32_16x16x32_bf16 a[96:99], a[180:183], v[132:135], a[96:99]
    ds_read_b128 a[148:151], v21 offset:4096
    v_mfma_f32_16x16x32_bf16 a[100:103], a[180:183], v[144:147], a[100:103]
    buffer_load_dword v13, v12, s[8:11], s7 offen
    v_mfma_f32_16x16x32_bf16 a[100:103], a[176:179], v[140:143], a[100:103]
    v_add_u32 v12, 180224, v12
    v_mfma_f32_16x16x32_bf16 a[104:107], a[176:179], v[152:155], a[104:107]
    v_exp_f32 v208, v208
    v_mfma_f32_16x16x32_bf16 a[104:107], a[180:183], v[156:159], a[104:107]
    v_exp_f32 v209, v209
    v_smfmac_f32_16x16x64_bf16 v[240:243], v[32:35], v[128:135], v61
    ds_read_b128 a[152:155], v22 offset:4096
    v_mfma_f32_16x16x32_bf16 a[108:111], a[180:183], v[168:171], a[108:111]
    v_exp_f32 v210, v210
    v_mfma_f32_16x16x32_bf16 a[108:111], a[176:179], v[164:167], a[108:111]
    v_exp_f32 v211, v211
    v_smfmac_f32_16x16x64_bf16 v[244:247], v[32:35], v[140:147], v61
    ds_read_b128 a[156:159], v23 offset:4096
    v_mfma_f32_16x16x32_bf16 a[112:115], a[184:187], v[128:131], a[112:115]
    v_exp_f32 v212, v212
    v_mfma_f32_16x16x32_bf16 a[112:115], a[188:191], v[132:135], a[112:115]
    v_exp_f32 v213, v213
    v_smfmac_f32_16x16x64_bf16 v[248:251], v[32:35], v[152:159], v61
    ds_read_b128 a[160:163], v20 offset:8192
    v_mfma_f32_16x16x32_bf16 a[116:119], a[188:191], v[144:147], a[116:119]
    v_exp_f32 v214, v214
    v_mfma_f32_16x16x32_bf16 a[116:119], a[184:187], v[140:143], a[116:119]
    v_exp_f32 v215, v215
    v_smfmac_f32_16x16x64_bf16 v[252:255], v[32:35], v[164:171], v61
    ds_read_b128 a[164:167], v21 offset:8192
    v_mfma_f32_16x16x32_bf16 a[120:123], a[184:187], v[152:155], a[120:123]
    ds_read_b128 a[168:171], v22 offset:8192
    v_mfma_f32_16x16x32_bf16 a[120:123], a[188:191], v[156:159], a[120:123]
    buffer_load_dwordx4 v6, s[28:31], s56 offen offset:3072 lds
    v_mfma_f32_16x16x32_bf16 a[124:127], a[188:191], v[168:171], a[124:127]
    ds_read_b128 a[172:175], v23 offset:8192
    v_mfma_f32_16x16x32_bf16 a[124:127], a[184:187], v[164:167], a[124:127]
    s_add_u32 s56, s56, 16384
    s_add_u32 m0, s55, 98304
    s_waitcnt lgkmcnt(4)
    v_mfma_f32_16x16x32_bf16 v[176:179], a[128:131], v[64:67], v[36:39]
    v_exp_f32 v216, v216
    v_mfma_f32_16x16x32_bf16 v[176:179], a[132:135], v[68:71], v[176:179]
    v_exp_f32 v217, v217
    v_mfma_f32_16x16x32_bf16 v[176:179], a[136:139], v[72:75], v[176:179]
    ds_read_b128 a[176:179], v20 offset:12288
    v_cvt_pk_bf16_f32 v156, v216, v217
    v_mfma_f32_16x16x32_bf16 v[176:179], a[140:143], v[76:79], v[176:179]
    v_exp_f32 v218, v218
    v_mfma_f32_16x16x32_bf16 v[180:183], a[140:143], v[92:95], v[40:43]
    v_exp_f32 v219, v219
    v_mfma_f32_16x16x32_bf16 v[180:183], a[136:139], v[88:91], v[180:183]
    ds_read_b128 a[180:183], v21 offset:12288
    v_cvt_pk_bf16_f32 v157, v218, v219
    v_mfma_f32_16x16x32_bf16 v[180:183], a[132:135], v[84:87], v[180:183]
    v_exp_f32 v220, v220
    v_mfma_f32_16x16x32_bf16 v[180:183], a[128:131], v[80:83], v[180:183]
    v_exp_f32 v221, v221
    v_mfma_f32_16x16x32_bf16 v[184:187], a[128:131], v[96:99], v[44:47]
    ds_read_b128 a[184:187], v22 offset:12288
    v_cvt_pk_bf16_f32 v168, v220, v221
    v_mfma_f32_16x16x32_bf16 v[184:187], a[132:135], v[100:103], v[184:187]
    v_exp_f32 v222, v222
    v_mfma_f32_16x16x32_bf16 v[184:187], a[136:139], v[104:107], v[184:187]
    v_exp_f32 v223, v223
    v_mfma_f32_16x16x32_bf16 v[184:187], a[140:143], v[108:111], v[184:187]
    ds_read_b128 a[188:191], v23 offset:12288
    v_cvt_pk_bf16_f32 v169, v222, v223
    v_mfma_f32_16x16x32_bf16 v[188:191], a[140:143], v[124:127], v[48:51]
    v_cvt_pk_bf16_f32 v132, v208, v209
    v_mfma_f32_16x16x32_bf16 v[188:191], a[136:139], v[120:123], v[188:191]
    buffer_load_dwordx4 v16, s[32:35], s57 offen offset:0 lds
    v_mfma_f32_16x16x32_bf16 v[188:191], a[132:135], v[116:119], v[188:191]
    v_cvt_pk_bf16_f32 v133, v210, v211
    v_mfma_f32_16x16x32_bf16 v[188:191], a[128:131], v[112:115], v[188:191]
    v_cvt_pk_bf16_f32 v144, v212, v213
    v_cvt_pk_bf16_f32 v145, v214, v215
    v_mfma_f32_16x16x32_bf16 v[192:195], a[144:147], v[64:67], v[36:39]
    ds_read_b64_tr_b16 a[128:129], v24 offset:49152
    v_mfma_f32_16x16x32_bf16 v[192:195], a[148:151], v[68:71], v[192:195]
    v_exp_f32 v224, v224
    v_mfma_f32_16x16x32_bf16 v[192:195], a[152:155], v[72:75], v[192:195]
    v_exp_f32 v225, v225
    v_mfma_f32_16x16x32_bf16 v[192:195], a[156:159], v[76:79], v[192:195]
    ds_read_b64_tr_b16 a[130:131], v24 offset:53248
    v_cvt_pk_bf16_f32 v134, v224, v225
    v_mfma_f32_16x16x32_bf16 v[196:199], a[156:159], v[92:95], v[40:43]
    v_exp_f32 v226, v226
    v_mfma_f32_16x16x32_bf16 v[196:199], a[152:155], v[88:91], v[196:199]
    v_exp_f32 v227, v227
    v_mfma_f32_16x16x32_bf16 v[196:199], a[148:151], v[84:87], v[196:199]
    ds_read_b64_tr_b16 a[132:133], v24 offset:57344
    v_cvt_pk_bf16_f32 v135, v226, v227
    v_mfma_f32_16x16x32_bf16 v[196:199], a[144:147], v[80:83], v[196:199]
    v_exp_f32 v228, v228
    v_mfma_f32_16x16x32_bf16 v[200:203], a[144:147], v[96:99], v[44:47]
    v_exp_f32 v229, v229
    v_mfma_f32_16x16x32_bf16 v[200:203], a[148:151], v[100:103], v[200:203]
    ds_read_b64_tr_b16 a[134:135], v24 offset:61440
    v_cvt_pk_bf16_f32 v146, v228, v229
    v_mfma_f32_16x16x32_bf16 v[200:203], a[152:155], v[104:107], v[200:203]
    v_exp_f32 v230, v230
    v_mfma_f32_16x16x32_bf16 v[200:203], a[156:159], v[108:111], v[200:203]
    v_exp_f32 v231, v231
    v_mfma_f32_16x16x32_bf16 v[204:207], a[156:159], v[124:127], v[48:51]
    ds_read_b64_tr_b16 a[136:137], v25 offset:49152
    v_cvt_pk_bf16_f32 v147, v230, v231
    v_mfma_f32_16x16x32_bf16 v[204:207], a[152:155], v[120:123], v[204:207]
    ds_read_b64_tr_b16 a[138:139], v25 offset:53248
    v_mfma_f32_16x16x32_bf16 v[204:207], a[148:151], v[116:119], v[204:207]
    buffer_load_dwordx4 v17, s[32:35], s57 offen offset:1024 lds
    v_mfma_f32_16x16x32_bf16 v[204:207], a[144:147], v[112:115], v[204:207]
    ds_read_b64_tr_b16 a[140:141], v25 offset:57344
    s_waitcnt lgkmcnt(7)
    v_mfma_f32_16x16x32_bf16 v[208:211], a[160:163], v[64:67], v[36:39]
    ds_read_b64_tr_b16 a[142:143], v25 offset:61440
    v_mfma_f32_16x16x32_bf16 v[208:211], a[164:167], v[68:71], v[208:211]
    ds_read_b64_tr_b16 a[144:145], v26 offset:49152
    v_mfma_f32_16x16x32_bf16 v[208:211], a[168:171], v[72:75], v[208:211]
    v_exp_f32 v232, v232
    v_mfma_f32_16x16x32_bf16 v[208:211], a[172:175], v[76:79], v[208:211]
    v_exp_f32 v233, v233
    v_mfma_f32_16x16x32_bf16 v[212:215], a[172:175], v[92:95], v[40:43]
    ds_read_b64_tr_b16 a[146:147], v26 offset:53248
    v_cvt_pk_bf16_f32 v158, v232, v233
    v_mfma_f32_16x16x32_bf16 v[212:215], a[168:171], v[88:91], v[212:215]
    v_exp_f32 v234, v234
    v_mfma_f32_16x16x32_bf16 v[212:215], a[164:167], v[84:87], v[212:215]
    v_exp_f32 v235, v235
    v_mfma_f32_16x16x32_bf16 v[212:215], a[160:163], v[80:83], v[212:215]
    ds_read_b64_tr_b16 a[148:149], v26 offset:57344
    v_cvt_pk_bf16_f32 v159, v234, v235
    v_mfma_f32_16x16x32_bf16 v[216:219], a[160:163], v[96:99], v[44:47]
    v_exp_f32 v236, v236
    v_mfma_f32_16x16x32_bf16 v[216:219], a[164:167], v[100:103], v[216:219]
    v_exp_f32 v237, v237
    v_mfma_f32_16x16x32_bf16 v[216:219], a[168:171], v[104:107], v[216:219]
    ds_read_b64_tr_b16 a[150:151], v26 offset:61440
    v_cvt_pk_bf16_f32 v170, v236, v237
    v_mfma_f32_16x16x32_bf16 v[216:219], a[172:175], v[108:111], v[216:219]
    v_exp_f32 v238, v238
    v_mfma_f32_16x16x32_bf16 v[220:223], a[172:175], v[124:127], v[48:51]
    v_exp_f32 v239, v239
    v_mfma_f32_16x16x32_bf16 v[220:223], a[168:171], v[120:123], v[220:223]
    ds_read_b64_tr_b16 a[152:153], v27 offset:49152
    v_cvt_pk_bf16_f32 v171, v238, v239
    v_mfma_f32_16x16x32_bf16 v[220:223], a[164:167], v[116:119], v[220:223]
    ds_read_b64_tr_b16 a[154:155], v27 offset:53248
    v_mfma_f32_16x16x32_bf16 v[220:223], a[160:163], v[112:115], v[220:223]
    buffer_load_dwordx4 v16, s[32:35], s57 offen offset:2048 lds
    v_mfma_f32_16x16x32_bf16 v[224:227], a[176:179], v[64:67], v[36:39]
    ds_read_b64_tr_b16 a[156:157], v27 offset:57344
    v_mfma_f32_16x16x32_bf16 v[224:227], a[180:183], v[68:71], v[224:227]
    ds_read_b64_tr_b16 a[158:159], v27 offset:61440
    v_mfma_f32_16x16x32_bf16 v[224:227], a[184:187], v[72:75], v[224:227]
    v_exp_f32 v176, v176
    v_mfma_f32_16x16x32_bf16 v[224:227], a[188:191], v[76:79], v[224:227]
    v_exp_f32 v177, v177
    v_mfma_f32_16x16x32_bf16 v[228:231], a[188:191], v[92:95], v[40:43]
    ds_read_b64_tr_b16 a[160:161], v28 offset:49152
    v_cvt_pk_bf16_f32 v128, v176, v177
    v_mfma_f32_16x16x32_bf16 v[228:231], a[184:187], v[88:91], v[228:231]
    v_exp_f32 v178, v178
    v_mfma_f32_16x16x32_bf16 v[228:231], a[180:183], v[84:87], v[228:231]
    v_exp_f32 v179, v179
    v_mfma_f32_16x16x32_bf16 v[228:231], a[176:179], v[80:83], v[228:231]
    ds_read_b64_tr_b16 a[162:163], v28 offset:53248
    v_cvt_pk_bf16_f32 v129, v178, v179
    v_mfma_f32_16x16x32_bf16 v[232:235], a[176:179], v[96:99], v[44:47]
    v_exp_f32 v180, v180
    v_mfma_f32_16x16x32_bf16 v[232:235], a[180:183], v[100:103], v[232:235]
    v_exp_f32 v181, v181
    v_mfma_f32_16x16x32_bf16 v[232:235], a[184:187], v[104:107], v[232:235]
    ds_read_b64_tr_b16 a[164:165], v28 offset:57344
    v_cvt_pk_bf16_f32 v140, v180, v181
    v_mfma_f32_16x16x32_bf16 v[232:235], a[188:191], v[108:111], v[232:235]
    v_exp_f32 v182, v182
    v_mfma_f32_16x16x32_bf16 v[236:239], a[188:191], v[124:127], v[48:51]
    v_exp_f32 v183, v183
    v_mfma_f32_16x16x32_bf16 v[236:239], a[184:187], v[120:123], v[236:239]
    ds_read_b64_tr_b16 a[166:167], v28 offset:61440
    v_cvt_pk_bf16_f32 v141, v182, v183
    v_mfma_f32_16x16x32_bf16 v[236:239], a[180:183], v[116:119], v[236:239]
    ds_read_b64_tr_b16 a[168:169], v29 offset:49152
    s_waitcnt lgkmcnt(5)
    v_mfma_f32_16x16x32_bf16 v[236:239], a[176:179], v[112:115], v[236:239]
    buffer_load_dwordx4 v17, s[32:35], s57 offen offset:3072 lds
    v_mfma_f32_16x16x32_bf16 a[0:3], a[128:131], v[136:139], a[0:3]
    ds_read_b64_tr_b16 a[170:171], v29 offset:53248
    v_mfma_f32_16x16x32_bf16 a[0:3], a[132:135], v[132:135], a[0:3]
    s_add_u32 s57, s57, 16384
    s_add_u32 m0, s55, 49152
    ds_read_b64_tr_b16 a[172:173], v29 offset:57344
    v_mfma_f32_16x16x32_bf16 a[4:7], a[132:135], v[144:147], a[4:7]
    v_exp_f32 v184, v184
    v_mfma_f32_16x16x32_bf16 a[4:7], a[128:131], v[148:151], a[4:7]
    v_exp_f32 v185, v185
    v_mfma_f32_16x16x32_bf16 a[8:11], a[128:131], v[160:163], a[8:11]
    ds_read_b64_tr_b16 a[174:175], v29 offset:61440
    v_cvt_pk_bf16_f32 v152, v184, v185
    v_mfma_f32_16x16x32_bf16 a[8:11], a[132:135], v[156:159], a[8:11]
    v_exp_f32 v186, v186
    v_mfma_f32_16x16x32_bf16 a[12:15], a[132:135], v[168:171], a[12:15]
    v_exp_f32 v187, v187
    v_mfma_f32_16x16x32_bf16 a[12:15], a[128:131], v[172:175], a[12:15]
    ds_read_b64_tr_b16 a[176:177], v30 offset:49152
    v_cvt_pk_bf16_f32 v153, v186, v187
    v_mfma_f32_16x16x32_bf16 a[16:19], a[136:139], v[136:139], a[16:19]
    v_exp_f32 v188, v188
    v_mfma_f32_16x16x32_bf16 a[16:19], a[140:143], v[132:135], a[16:19]
    v_exp_f32 v189, v189
    v_mfma_f32_16x16x32_bf16 a[20:23], a[140:143], v[144:147], a[20:23]
    ds_read_b64_tr_b16 a[178:179], v30 offset:53248
    v_cvt_pk_bf16_f32 v164, v188, v189
    v_mfma_f32_16x16x32_bf16 a[20:23], a[136:139], v[148:151], a[20:23]
    v_exp_f32 v190, v190
    v_mfma_f32_16x16x32_bf16 a[24:27], a[136:139], v[160:163], a[24:27]
    v_exp_f32 v191, v191
    v_mfma_f32_16x16x32_bf16 a[24:27], a[140:143], v[156:159], a[24:27]
    ds_read_b64_tr_b16 a[180:181], v30 offset:57344
    v_cvt_pk_bf16_f32 v165, v190, v191
    v_mfma_f32_16x16x32_bf16 a[28:31], a[140:143], v[168:171], a[28:31]
    ds_read_b64_tr_b16 a[182:183], v30 offset:61440
    v_mfma_f32_16x16x32_bf16 a[28:31], a[136:139], v[172:175], a[28:31]
    buffer_load_dwordx4 v3, s[28:31], s56 offen offset:0 lds
    v_mfma_f32_16x16x32_bf16 a[32:35], a[144:147], v[136:139], a[32:35]
    ds_read_b64_tr_b16 a[184:185], v31 offset:49152
    v_mfma_f32_16x16x32_bf16 a[32:35], a[148:151], v[132:135], a[32:35]
    ds_read_b64_tr_b16 a[186:187], v31 offset:53248
    s_waitcnt lgkmcnt(6)
    v_mfma_f32_16x16x32_bf16 a[36:39], a[148:151], v[144:147], a[36:39]
    v_exp_f32 v192, v192
    v_mfma_f32_16x16x32_bf16 a[36:39], a[144:147], v[148:151], a[36:39]
    v_exp_f32 v193, v193
    v_mfma_f32_16x16x32_bf16 a[40:43], a[144:147], v[160:163], a[40:43]
    ds_read_b64_tr_b16 a[188:189], v31 offset:57344
    v_cvt_pk_bf16_f32 v130, v192, v193
    v_mfma_f32_16x16x32_bf16 a[40:43], a[148:151], v[156:159], a[40:43]
    v_exp_f32 v194, v194
    v_mfma_f32_16x16x32_bf16 a[44:47], a[148:151], v[168:171], a[44:47]
    v_exp_f32 v195, v195
    v_mfma_f32_16x16x32_bf16 a[44:47], a[144:147], v[172:175], a[44:47]
    ds_read_b64_tr_b16 a[190:191], v31 offset:61440
    v_cvt_pk_bf16_f32 v131, v194, v195
    v_mfma_f32_16x16x32_bf16 a[48:51], a[152:155], v[136:139], a[48:51]
    v_exp_f32 v196, v196
    v_mfma_f32_16x16x32_bf16 a[48:51], a[156:159], v[132:135], a[48:51]
    v_exp_f32 v197, v197
    v_mfma_f32_16x16x32_bf16 a[52:55], a[156:159], v[144:147], a[52:55]
    v_cvt_pk_bf16_f32 v142, v196, v197
    v_mfma_f32_16x16x32_bf16 a[52:55], a[152:155], v[148:151], a[52:55]
    v_exp_f32 v198, v198
    v_mfma_f32_16x16x32_bf16 a[56:59], a[152:155], v[160:163], a[56:59]
    v_exp_f32 v199, v199
    v_mfma_f32_16x16x32_bf16 a[56:59], a[156:159], v[156:159], a[56:59]
    v_cvt_pk_bf16_f32 v143, v198, v199
    v_mfma_f32_16x16x32_bf16 a[60:63], a[156:159], v[168:171], a[60:63]
    v_mfma_f32_16x16x32_bf16 a[60:63], a[152:155], v[172:175], a[60:63]
    buffer_load_dwordx4 v4, s[28:31], s56 offen offset:1024 lds
    v_mfma_f32_16x16x32_bf16 a[64:67], a[160:163], v[136:139], a[64:67]
    v_mfma_f32_16x16x32_bf16 a[64:67], a[164:167], v[132:135], a[64:67]
    s_waitcnt vmcnt(15) lgkmcnt(0)
    s_barrier
    v_mfma_f32_16x16x32_bf16 a[68:71], a[164:167], v[144:147], a[68:71]
    v_mfma_f32_16x16x32_bf16 a[68:71], a[160:163], v[148:151], a[68:71]
    v_exp_f32 v200, v200
    v_mfma_f32_16x16x32_bf16 a[72:75], a[160:163], v[160:163], a[72:75]
    v_exp_f32 v201, v201
    v_mfma_f32_16x16x32_bf16 a[72:75], a[164:167], v[156:159], a[72:75]
    ds_read_b128 a[128:131], v20 offset:16384
    v_cvt_pk_bf16_f32 v154, v200, v201
    v_mfma_f32_16x16x32_bf16 a[76:79], a[164:167], v[168:171], a[76:79]
    v_exp_f32 v202, v202
    v_mfma_f32_16x16x32_bf16 a[76:79], a[160:163], v[172:175], a[76:79]
    v_exp_f32 v203, v203
    v_mfma_f32_16x16x32_bf16 a[80:83], a[168:171], v[136:139], a[80:83]
    ds_read_b128 a[132:135], v21 offset:16384
    v_cvt_pk_bf16_f32 v155, v202, v203
    v_mfma_f32_16x16x32_bf16 a[80:83], a[172:175], v[132:135], a[80:83]
    v_exp_f32 v204, v204
    v_mfma_f32_16x16x32_bf16 a[84:87], a[172:175], v[144:147], a[84:87]
    v_exp_f32 v205, v205
    v_mfma_f32_16x16x32_bf16 a[84:87], a[168:171], v[148:151], a[84:87]
    ds_read_b128 a[136:139], v22 offset:16384
    v_cvt_pk_bf16_f32 v166, v204, v205
    v_mfma_f32_16x16x32_bf16 a[88:91], a[168:171], v[160:163], a[88:91]
    v_exp_f32 v206, v206
    v_mfma_f32_16x16x32_bf16 a[88:91], a[172:175], v[156:159], a[88:91]
    v_exp_f32 v207, v207
    v_mfma_f32_16x16x32_bf16 a[92:95], a[172:175], v[168:171], a[92:95]
    ds_read_b128 a[140:143], v23 offset:16384
    v_cvt_pk_bf16_f32 v167, v206, v207
    v_mfma_f32_16x16x32_bf16 a[92:95], a[168:171], v[172:175], a[92:95]
    ds_read_b128 a[144:147], v20 offset:20480
    v_mfma_f32_16x16x32_bf16 a[96:99], a[176:179], v[136:139], a[96:99]
    buffer_load_dwordx4 v5, s[28:31], s56 offen offset:2048 lds
    v_mfma_f32_16x16x32_bf16 a[96:99], a[180:183], v[132:135], a[96:99]
    ds_read_b128 a[148:151], v21 offset:20480
    v_mfma_f32_16x16x32_bf16 a[100:103], a[180:183], v[144:147], a[100:103]
    buffer_store_dword v63, v0, s[20:23], 0 offen sc1
    v_mfma_f32_16x16x32_bf16 a[100:103], a[176:179], v[148:151], a[100:103]
    v_mfma_f32_16x16x32_bf16 a[104:107], a[176:179], v[160:163], a[104:107]
    v_exp_f32 v208, v208
    v_mfma_f32_16x16x32_bf16 a[104:107], a[180:183], v[156:159], a[104:107]
    v_exp_f32 v209, v209
    v_smfmac_f32_16x16x64_bf16 v[240:243], v[32:35], v[132:139], v61
    ds_read_b128 a[152:155], v22 offset:20480
    v_mfma_f32_16x16x32_bf16 a[108:111], a[180:183], v[168:171], a[108:111]
    v_exp_f32 v210, v210
    v_mfma_f32_16x16x32_bf16 a[108:111], a[176:179], v[172:175], a[108:111]
    v_exp_f32 v211, v211
    v_smfmac_f32_16x16x64_bf16 v[244:247], v[32:35], v[144:151], v61
    ds_read_b128 a[156:159], v23 offset:20480
    v_mfma_f32_16x16x32_bf16 a[112:115], a[184:187], v[136:139], a[112:115]
    v_exp_f32 v212, v212
    v_mfma_f32_16x16x32_bf16 a[112:115], a[188:191], v[132:135], a[112:115]
    v_exp_f32 v213, v213
    v_smfmac_f32_16x16x64_bf16 v[248:251], v[32:35], v[156:163], v61
    ds_read_b128 a[160:163], v20 offset:24576
    v_mfma_f32_16x16x32_bf16 a[116:119], a[188:191], v[144:147], a[116:119]
    v_exp_f32 v214, v214
    v_mfma_f32_16x16x32_bf16 a[116:119], a[184:187], v[148:151], a[116:119]
    v_exp_f32 v215, v215
    v_smfmac_f32_16x16x64_bf16 v[252:255], v[32:35], v[168:175], v61
    ds_read_b128 a[164:167], v21 offset:24576
    v_mfma_f32_16x16x32_bf16 a[120:123], a[184:187], v[160:163], a[120:123]
    ds_read_b128 a[168:171], v22 offset:24576
    v_mfma_f32_16x16x32_bf16 a[120:123], a[188:191], v[156:159], a[120:123]
    buffer_load_dwordx4 v6, s[28:31], s56 offen offset:3072 lds
    v_mfma_f32_16x16x32_bf16 a[124:127], a[188:191], v[168:171], a[124:127]
    ds_read_b128 a[172:175], v23 offset:24576
    v_mfma_f32_16x16x32_bf16 a[124:127], a[184:187], v[172:175], a[124:127]
    s_add_u32 s56, s56, 16384
    s_add_u32 m0, s55, 114688
    s_waitcnt lgkmcnt(4)
    v_mfma_f32_16x16x32_bf16 v[176:179], a[128:131], v[64:67], v[36:39]
    v_exp_f32 v216, v216
    v_mfma_f32_16x16x32_bf16 v[176:179], a[132:135], v[68:71], v[176:179]
    v_exp_f32 v217, v217
    v_mfma_f32_16x16x32_bf16 v[176:179], a[136:139], v[72:75], v[176:179]
    ds_read_b128 a[176:179], v20 offset:28672
    v_cvt_pk_bf16_f32 v156, v216, v217
    v_mfma_f32_16x16x32_bf16 v[176:179], a[140:143], v[76:79], v[176:179]
    v_exp_f32 v218, v218
    v_mfma_f32_16x16x32_bf16 v[180:183], a[140:143], v[92:95], v[40:43]
    v_exp_f32 v219, v219
    v_mfma_f32_16x16x32_bf16 v[180:183], a[136:139], v[88:91], v[180:183]
    ds_read_b128 a[180:183], v21 offset:28672
    v_cvt_pk_bf16_f32 v157, v218, v219
    v_mfma_f32_16x16x32_bf16 v[180:183], a[132:135], v[84:87], v[180:183]
    v_exp_f32 v220, v220
    v_mfma_f32_16x16x32_bf16 v[180:183], a[128:131], v[80:83], v[180:183]
    v_exp_f32 v221, v221
    v_mfma_f32_16x16x32_bf16 v[184:187], a[128:131], v[96:99], v[44:47]
    ds_read_b128 a[184:187], v22 offset:28672
    v_cvt_pk_bf16_f32 v168, v220, v221
    v_mfma_f32_16x16x32_bf16 v[184:187], a[132:135], v[100:103], v[184:187]
    v_exp_f32 v222, v222
    v_mfma_f32_16x16x32_bf16 v[184:187], a[136:139], v[104:107], v[184:187]
    v_exp_f32 v223, v223
    v_mfma_f32_16x16x32_bf16 v[184:187], a[140:143], v[108:111], v[184:187]
    ds_read_b128 a[188:191], v23 offset:28672
    v_cvt_pk_bf16_f32 v169, v222, v223
    v_mfma_f32_16x16x32_bf16 v[188:191], a[140:143], v[124:127], v[48:51]
    v_cvt_pk_bf16_f32 v132, v208, v209
    v_mfma_f32_16x16x32_bf16 v[188:191], a[136:139], v[120:123], v[188:191]
    buffer_load_dwordx4 v16, s[32:35], s57 offen offset:0 lds
    v_mfma_f32_16x16x32_bf16 v[188:191], a[132:135], v[116:119], v[188:191]
    v_cvt_pk_bf16_f32 v133, v210, v211
    v_mfma_f32_16x16x32_bf16 v[188:191], a[128:131], v[112:115], v[188:191]
    v_cvt_pk_bf16_f32 v144, v212, v213
    v_cvt_pk_bf16_f32 v145, v214, v215
    v_mfma_f32_16x16x32_bf16 v[192:195], a[144:147], v[64:67], v[36:39]
    ds_read_b64_tr_b16 a[128:129], v24 offset:0
    v_mfma_f32_16x16x32_bf16 v[192:195], a[148:151], v[68:71], v[192:195]
    v_exp_f32 v224, v224
    v_mfma_f32_16x16x32_bf16 v[192:195], a[152:155], v[72:75], v[192:195]
    v_exp_f32 v225, v225
    v_mfma_f32_16x16x32_bf16 v[192:195], a[156:159], v[76:79], v[192:195]
    ds_read_b64_tr_b16 a[130:131], v24 offset:4096
    v_cvt_pk_bf16_f32 v134, v224, v225
    v_mfma_f32_16x16x32_bf16 v[196:199], a[156:159], v[92:95], v[40:43]
    v_exp_f32 v226, v226
    v_mfma_f32_16x16x32_bf16 v[196:199], a[152:155], v[88:91], v[196:199]
    v_exp_f32 v227, v227
    v_mfma_f32_16x16x32_bf16 v[196:199], a[148:151], v[84:87], v[196:199]
    ds_read_b64_tr_b16 a[132:133], v24 offset:8192
    v_cvt_pk_bf16_f32 v135, v226, v227
    v_mfma_f32_16x16x32_bf16 v[196:199], a[144:147], v[80:83], v[196:199]
    v_exp_f32 v228, v228
    v_mfma_f32_16x16x32_bf16 v[200:203], a[144:147], v[96:99], v[44:47]
    v_exp_f32 v229, v229
    v_mfma_f32_16x16x32_bf16 v[200:203], a[148:151], v[100:103], v[200:203]
    ds_read_b64_tr_b16 a[134:135], v24 offset:12288
    v_cvt_pk_bf16_f32 v146, v228, v229
    v_mfma_f32_16x16x32_bf16 v[200:203], a[152:155], v[104:107], v[200:203]
    v_exp_f32 v230, v230
    v_mfma_f32_16x16x32_bf16 v[200:203], a[156:159], v[108:111], v[200:203]
    v_exp_f32 v231, v231
    v_mfma_f32_16x16x32_bf16 v[204:207], a[156:159], v[124:127], v[48:51]
    ds_read_b64_tr_b16 a[136:137], v25 offset:0
    v_cvt_pk_bf16_f32 v147, v230, v231
    v_mfma_f32_16x16x32_bf16 v[204:207], a[152:155], v[120:123], v[204:207]
    ds_read_b64_tr_b16 a[138:139], v25 offset:4096
    v_mfma_f32_16x16x32_bf16 v[204:207], a[148:151], v[116:119], v[204:207]
    buffer_load_dwordx4 v17, s[32:35], s57 offen offset:1024 lds
    v_mfma_f32_16x16x32_bf16 v[204:207], a[144:147], v[112:115], v[204:207]
    ds_read_b64_tr_b16 a[140:141], v25 offset:8192
    s_waitcnt lgkmcnt(7)
    v_mfma_f32_16x16x32_bf16 v[208:211], a[160:163], v[64:67], v[36:39]
    ds_read_b64_tr_b16 a[142:143], v25 offset:12288
    v_mfma_f32_16x16x32_bf16 v[208:211], a[164:167], v[68:71], v[208:211]
    ds_read_b64_tr_b16 a[144:145], v26 offset:0
    v_mfma_f32_16x16x32_bf16 v[208:211], a[168:171], v[72:75], v[208:211]
    v_exp_f32 v232, v232
    v_mfma_f32_16x16x32_bf16 v[208:211], a[172:175], v[76:79], v[208:211]
    v_exp_f32 v233, v233
    v_mfma_f32_16x16x32_bf16 v[212:215], a[172:175], v[92:95], v[40:43]
    ds_read_b64_tr_b16 a[146:147], v26 offset:4096
    v_cvt_pk_bf16_f32 v158, v232, v233
    v_mfma_f32_16x16x32_bf16 v[212:215], a[168:171], v[88:91], v[212:215]
    v_exp_f32 v234, v234
    v_mfma_f32_16x16x32_bf16 v[212:215], a[164:167], v[84:87], v[212:215]
    v_exp_f32 v235, v235
    v_mfma_f32_16x16x32_bf16 v[212:215], a[160:163], v[80:83], v[212:215]
    ds_read_b64_tr_b16 a[148:149], v26 offset:8192
    v_cvt_pk_bf16_f32 v159, v234, v235
    v_mfma_f32_16x16x32_bf16 v[216:219], a[160:163], v[96:99], v[44:47]
    v_exp_f32 v236, v236
    v_mfma_f32_16x16x32_bf16 v[216:219], a[164:167], v[100:103], v[216:219]
    v_exp_f32 v237, v237
    v_mfma_f32_16x16x32_bf16 v[216:219], a[168:171], v[104:107], v[216:219]
    ds_read_b64_tr_b16 a[150:151], v26 offset:12288
    v_cvt_pk_bf16_f32 v170, v236, v237
    v_mfma_f32_16x16x32_bf16 v[216:219], a[172:175], v[108:111], v[216:219]
    v_exp_f32 v238, v238
    v_mfma_f32_16x16x32_bf16 v[220:223], a[172:175], v[124:127], v[48:51]
    v_exp_f32 v239, v239
    v_mfma_f32_16x16x32_bf16 v[220:223], a[168:171], v[120:123], v[220:223]
    ds_read_b64_tr_b16 a[152:153], v27 offset:0
    v_cvt_pk_bf16_f32 v171, v238, v239
    v_mfma_f32_16x16x32_bf16 v[220:223], a[164:167], v[116:119], v[220:223]
    ds_read_b64_tr_b16 a[154:155], v27 offset:4096
    v_mfma_f32_16x16x32_bf16 v[220:223], a[160:163], v[112:115], v[220:223]
    buffer_load_dwordx4 v16, s[32:35], s57 offen offset:2048 lds
    v_mfma_f32_16x16x32_bf16 v[224:227], a[176:179], v[64:67], v[36:39]
    ds_read_b64_tr_b16 a[156:157], v27 offset:8192
    v_mfma_f32_16x16x32_bf16 v[224:227], a[180:183], v[68:71], v[224:227]
    ds_read_b64_tr_b16 a[158:159], v27 offset:12288
    v_mfma_f32_16x16x32_bf16 v[224:227], a[184:187], v[72:75], v[224:227]
    v_exp_f32 v176, v176
    v_mfma_f32_16x16x32_bf16 v[224:227], a[188:191], v[76:79], v[224:227]
    v_exp_f32 v177, v177
    v_mfma_f32_16x16x32_bf16 v[228:231], a[188:191], v[92:95], v[40:43]
    ds_read_b64_tr_b16 a[160:161], v28 offset:0
    v_cvt_pk_bf16_f32 v136, v176, v177
    v_mfma_f32_16x16x32_bf16 v[228:231], a[184:187], v[88:91], v[228:231]
    v_exp_f32 v178, v178
    v_mfma_f32_16x16x32_bf16 v[228:231], a[180:183], v[84:87], v[228:231]
    v_exp_f32 v179, v179
    v_mfma_f32_16x16x32_bf16 v[228:231], a[176:179], v[80:83], v[228:231]
    ds_read_b64_tr_b16 a[162:163], v28 offset:4096
    v_cvt_pk_bf16_f32 v137, v178, v179
    v_mfma_f32_16x16x32_bf16 v[232:235], a[176:179], v[96:99], v[44:47]
    v_exp_f32 v180, v180
    v_mfma_f32_16x16x32_bf16 v[232:235], a[180:183], v[100:103], v[232:235]
    v_exp_f32 v181, v181
    v_mfma_f32_16x16x32_bf16 v[232:235], a[184:187], v[104:107], v[232:235]
    ds_read_b64_tr_b16 a[164:165], v28 offset:8192
    v_cvt_pk_bf16_f32 v148, v180, v181
    v_mfma_f32_16x16x32_bf16 v[232:235], a[188:191], v[108:111], v[232:235]
    v_exp_f32 v182, v182
    v_mfma_f32_16x16x32_bf16 v[236:239], a[188:191], v[124:127], v[48:51]
    v_exp_f32 v183, v183
    v_mfma_f32_16x16x32_bf16 v[236:239], a[184:187], v[120:123], v[236:239]
    ds_read_b64_tr_b16 a[166:167], v28 offset:12288
    v_cvt_pk_bf16_f32 v149, v182, v183
    v_mfma_f32_16x16x32_bf16 v[236:239], a[180:183], v[116:119], v[236:239]
    ds_read_b64_tr_b16 a[168:169], v29 offset:0
    s_waitcnt lgkmcnt(5)
    v_mfma_f32_16x16x32_bf16 v[236:239], a[176:179], v[112:115], v[236:239]
    buffer_load_dwordx4 v17, s[32:35], s57 offen offset:3072 lds
    v_mfma_f32_16x16x32_bf16 a[0:3], a[128:131], v[128:131], a[0:3]
    ds_read_b64_tr_b16 a[170:171], v29 offset:4096
    v_mfma_f32_16x16x32_bf16 a[0:3], a[132:135], v[132:135], a[0:3]
    s_add_u32 s57, s57, 16384
    s_add_u32 m0, s55, 0
    ds_read_b64_tr_b16 a[172:173], v29 offset:8192
    v_mfma_f32_16x16x32_bf16 a[4:7], a[132:135], v[144:147], a[4:7]
    v_exp_f32 v184, v184
    v_mfma_f32_16x16x32_bf16 a[4:7], a[128:131], v[140:143], a[4:7]
    v_exp_f32 v185, v185
    v_mfma_f32_16x16x32_bf16 a[8:11], a[128:131], v[152:155], a[8:11]
    ds_read_b64_tr_b16 a[174:175], v29 offset:12288
    v_cvt_pk_bf16_f32 v160, v184, v185
    v_mfma_f32_16x16x32_bf16 a[8:11], a[132:135], v[156:159], a[8:11]
    v_exp_f32 v186, v186
    v_mfma_f32_16x16x32_bf16 a[12:15], a[132:135], v[168:171], a[12:15]
    v_exp_f32 v187, v187
    v_mfma_f32_16x16x32_bf16 a[12:15], a[128:131], v[164:167], a[12:15]
    ds_read_b64_tr_b16 a[176:177], v30 offset:0
    v_cvt_pk_bf16_f32 v161, v186, v187
    v_mfma_f32_16x16x32_bf16 a[16:19], a[136:139], v[128:131], a[16:19]
    v_exp_f32 v188, v188
    v_mfma_f32_16x16x32_bf16 a[16:19], a[140:143], v[132:135], a[16:19]
    v_exp_f32 v189, v189
    v_mfma_f32_16x16x32_bf16 a[20:23], a[140:143], v[144:147], a[20:23]
    ds_read_b64_tr_b16 a[178:179], v30 offset:4096
    v_cvt_pk_bf16_f32 v172, v188, v189
    v_mfma_f32_16x16x32_bf16 a[20:23], a[136:139], v[140:143], a[20:23]
    v_exp_f32 v190, v190
    v_mfma_f32_16x16x32_bf16 a[24:27], a[136:139], v[152:155], a[24:27]
    v_exp_f32 v191, v191
    v_mfma_f32_16x16x32_bf16 a[24:27], a[140:143], v[156:159], a[24:27]
    ds_read_b64_tr_b16 a[180:181], v30 offset:8192
    v_cvt_pk_bf16_f32 v173, v190, v191
    v_mfma_f32_16x16x32_bf16 a[28:31], a[140:143], v[168:171], a[28:31]
    ds_read_b64_tr_b16 a[182:183], v30 offset:12288
    v_mfma_f32_16x16x32_bf16 a[28:31], a[136:139], v[164:167], a[28:31]
    buffer_load_dwordx4 v3, s[28:31], s56 offen offset:0 lds
    v_mfma_f32_16x16x32_bf16 a[32:35], a[144:147], v[128:131], a[32:35]
    ds_read_b64_tr_b16 a[184:185], v31 offset:0
    v_mfma_f32_16x16x32_bf16 a[32:35], a[148:151], v[132:135], a[32:35]
    ds_read_b64_tr_b16 a[186:187], v31 offset:4096
    s_waitcnt lgkmcnt(6)
    v_mfma_f32_16x16x32_bf16 a[36:39], a[148:151], v[144:147], a[36:39]
    v_exp_f32 v192, v192
    v_mfma_f32_16x16x32_bf16 a[36:39], a[144:147], v[140:143], a[36:39]
    v_exp_f32 v193, v193
    v_mfma_f32_16x16x32_bf16 a[40:43], a[144:147], v[152:155], a[40:43]
    ds_read_b64_tr_b16 a[188:189], v31 offset:8192
    v_cvt_pk_bf16_f32 v138, v192, v193
    v_mfma_f32_16x16x32_bf16 a[40:43], a[148:151], v[156:159], a[40:43]
    v_exp_f32 v194, v194
    v_mfma_f32_16x16x32_bf16 a[44:47], a[148:151], v[168:171], a[44:47]
    v_exp_f32 v195, v195
    v_mfma_f32_16x16x32_bf16 a[44:47], a[144:147], v[164:167], a[44:47]
    ds_read_b64_tr_b16 a[190:191], v31 offset:12288
    v_cvt_pk_bf16_f32 v139, v194, v195
    v_mfma_f32_16x16x32_bf16 a[48:51], a[152:155], v[128:131], a[48:51]
    v_exp_f32 v196, v196
    v_mfma_f32_16x16x32_bf16 a[48:51], a[156:159], v[132:135], a[48:51]
    v_exp_f32 v197, v197
    v_mfma_f32_16x16x32_bf16 a[52:55], a[156:159], v[144:147], a[52:55]
    v_cvt_pk_bf16_f32 v150, v196, v197
    v_mfma_f32_16x16x32_bf16 a[52:55], a[152:155], v[140:143], a[52:55]
    v_exp_f32 v198, v198
    v_mfma_f32_16x16x32_bf16 a[56:59], a[152:155], v[152:155], a[56:59]
    v_exp_f32 v199, v199
    v_mfma_f32_16x16x32_bf16 a[56:59], a[156:159], v[156:159], a[56:59]
    v_cvt_pk_bf16_f32 v151, v198, v199
    v_mfma_f32_16x16x32_bf16 a[60:63], a[156:159], v[168:171], a[60:63]
    v_mfma_f32_16x16x32_bf16 a[60:63], a[152:155], v[164:167], a[60:63]
    buffer_load_dwordx4 v4, s[28:31], s56 offen offset:1024 lds
    v_mfma_f32_16x16x32_bf16 a[64:67], a[160:163], v[128:131], a[64:67]
    v_mfma_f32_16x16x32_bf16 a[64:67], a[164:167], v[132:135], a[64:67]
    s_waitcnt vmcnt(15) lgkmcnt(0)
    s_barrier
    v_mfma_f32_16x16x32_bf16 a[68:71], a[164:167], v[144:147], a[68:71]
    buffer_load_dword v15, v62, s[68:71], 0 offen sc1
    v_mfma_f32_16x16x32_bf16 a[68:71], a[160:163], v[140:143], a[68:71]
    v_exp_f32 v200, v200
    v_mfma_f32_16x16x32_bf16 a[72:75], a[160:163], v[152:155], a[72:75]
    v_exp_f32 v201, v201
    v_mfma_f32_16x16x32_bf16 a[72:75], a[164:167], v[156:159], a[72:75]
    ds_read_b128 a[128:131], v20 offset:32768
    v_cvt_pk_bf16_f32 v162, v200, v201
    v_mfma_f32_16x16x32_bf16 a[76:79], a[164:167], v[168:171], a[76:79]
    v_exp_f32 v202, v202
    v_mfma_f32_16x16x32_bf16 a[76:79], a[160:163], v[164:167], a[76:79]
    v_exp_f32 v203, v203
    v_mfma_f32_16x16x32_bf16 a[80:83], a[168:171], v[128:131], a[80:83]
    ds_read_b128 a[132:135], v21 offset:32768
    v_cvt_pk_bf16_f32 v163, v202, v203
    v_mfma_f32_16x16x32_bf16 a[80:83], a[172:175], v[132:135], a[80:83]
    v_exp_f32 v204, v204
    v_mfma_f32_16x16x32_bf16 a[84:87], a[172:175], v[144:147], a[84:87]
    v_exp_f32 v205, v205
    v_mfma_f32_16x16x32_bf16 a[84:87], a[168:171], v[140:143], a[84:87]
    ds_read_b128 a[136:139], v22 offset:32768
    v_cvt_pk_bf16_f32 v174, v204, v205
    v_mfma_f32_16x16x32_bf16 a[88:91], a[168:171], v[152:155], a[88:91]
    v_exp_f32 v206, v206
    v_mfma_f32_16x16x32_bf16 a[88:91], a[172:175], v[156:159], a[88:91]
    v_exp_f32 v207, v207
    v_mfma_f32_16x16x32_bf16 a[92:95], a[172:175], v[168:171], a[92:95]
    ds_read_b128 a[140:143], v23 offset:32768
    v_cvt_pk_bf16_f32 v175, v206, v207
    v_mfma_f32_16x16x32_bf16 a[92:95], a[168:171], v[164:167], a[92:95]
    ds_read_b128 a[144:147], v20 offset:36864
    v_mfma_f32_16x16x32_bf16 a[96:99], a[176:179], v[128:131], a[96:99]
    buffer_load_dwordx4 v5, s[28:31], s56 offen offset:2048 lds
    v_mfma_f32_16x16x32_bf16 a[96:99], a[180:183], v[132:135], a[96:99]
    ds_read_b128 a[148:151], v21 offset:36864
    v_mfma_f32_16x16x32_bf16 a[100:103], a[180:183], v[144:147], a[100:103]
    buffer_load_dword v13, v19, s[24:27], 0 offen
    v_mfma_f32_16x16x32_bf16 a[100:103], a[176:179], v[140:143], a[100:103]
    v_mfma_f32_16x16x32_bf16 a[104:107], a[176:179], v[152:155], a[104:107]
    v_exp_f32 v208, v208
    v_mfma_f32_16x16x32_bf16 a[104:107], a[180:183], v[156:159], a[104:107]
    v_exp_f32 v209, v209
    v_smfmac_f32_16x16x64_bf16 v[240:243], v[32:35], v[128:135], v61
    ds_read_b128 a[152:155], v22 offset:36864
    v_mfma_f32_16x16x32_bf16 a[108:111], a[180:183], v[168:171], a[108:111]
    v_exp_f32 v210, v210
    v_mfma_f32_16x16x32_bf16 a[108:111], a[176:179], v[164:167], a[108:111]
    v_exp_f32 v211, v211
    v_smfmac_f32_16x16x64_bf16 v[244:247], v[32:35], v[140:147], v61
    ds_read_b128 a[156:159], v23 offset:36864
    v_mfma_f32_16x16x32_bf16 a[112:115], a[184:187], v[128:131], a[112:115]
    v_exp_f32 v212, v212
    v_mfma_f32_16x16x32_bf16 a[112:115], a[188:191], v[132:135], a[112:115]
    v_exp_f32 v213, v213
    v_smfmac_f32_16x16x64_bf16 v[248:251], v[32:35], v[152:159], v61
    ds_read_b128 a[160:163], v20 offset:40960
    v_mfma_f32_16x16x32_bf16 a[116:119], a[188:191], v[144:147], a[116:119]
    v_exp_f32 v214, v214
    v_mfma_f32_16x16x32_bf16 a[116:119], a[184:187], v[140:143], a[116:119]
    v_exp_f32 v215, v215
    v_smfmac_f32_16x16x64_bf16 v[252:255], v[32:35], v[164:171], v61
    ds_read_b128 a[164:167], v21 offset:40960
    v_mfma_f32_16x16x32_bf16 a[120:123], a[184:187], v[152:155], a[120:123]
    ds_read_b128 a[168:171], v22 offset:40960
    v_mfma_f32_16x16x32_bf16 a[120:123], a[188:191], v[156:159], a[120:123]
    buffer_load_dwordx4 v6, s[28:31], s56 offen offset:3072 lds
    v_mfma_f32_16x16x32_bf16 a[124:127], a[188:191], v[168:171], a[124:127]
    ds_read_b128 a[172:175], v23 offset:40960
    v_mfma_f32_16x16x32_bf16 a[124:127], a[184:187], v[164:167], a[124:127]
    s_add_u32 s56, s56, 16384
    s_add_u32 m0, s55, 65536
    s_waitcnt lgkmcnt(4)
    s_add_u32 s53, s53, 1
    s_cmp_lt_u32 s53, 7
    s_cbranch_scc1 L_k2_loopB
L_k2_loopB_end:
    v_mfma_f32_16x16x32_bf16 v[176:179], a[128:131], v[64:67], v[36:39]
    v_exp_f32 v216, v216
    v_mfma_f32_16x16x32_bf16 v[176:179], a[132:135], v[68:71], v[176:179]
    v_exp_f32 v217, v217
    v_mfma_f32_16x16x32_bf16 v[176:179], a[136:139], v[72:75], v[176:179]
    ds_read_b128 a[176:179], v20 offset:45056
    v_cvt_pk_bf16_f32 v156, v216, v217
    v_mfma_f32_16x16x32_bf16 v[176:179], a[140:143], v[76:79], v[176:179]
    v_exp_f32 v218, v218
    v_mfma_f32_16x16x32_bf16 v[180:183], a[140:143], v[92:95], v[40:43]
    v_exp_f32 v219, v219
    v_mfma_f32_16x16x32_bf16 v[180:183], a[136:139], v[88:91], v[180:183]
    ds_read_b128 a[180:183], v21 offset:45056
    v_cvt_pk_bf16_f32 v157, v218, v219
    v_mfma_f32_16x16x32_bf16 v[180:183], a[132:135], v[84:87], v[180:183]
    v_exp_f32 v220, v220
    v_mfma_f32_16x16x32_bf16 v[180:183], a[128:131], v[80:83], v[180:183]
    v_exp_f32 v221, v221
    v_mfma_f32_16x16x32_bf16 v[184:187], a[128:131], v[96:99], v[44:47]
    ds_read_b128 a[184:187], v22 offset:45056
    v_cvt_pk_bf16_f32 v168, v220, v221
    v_mfma_f32_16x16x32_bf16 v[184:187], a[132:135], v[100:103], v[184:187]
    v_exp_f32 v222, v222
    v_mfma_f32_16x16x32_bf16 v[184:187], a[136:139], v[104:107], v[184:187]
    v_exp_f32 v223, v223
    v_mfma_f32_16x16x32_bf16 v[184:187], a[140:143], v[108:111], v[184:187]
    ds_read_b128 a[188:191], v23 offset:45056
    v_cvt_pk_bf16_f32 v169, v222, v223
    v_mfma_f32_16x16x32_bf16 v[188:191], a[140:143], v[124:127], v[48:51]
    v_cvt_pk_bf16_f32 v132, v208, v209
    v_add_u32 v2, 128, v18
    v_mfma_f32_16x16x32_bf16 v[188:191], a[136:139], v[120:123], v[188:191]
    s_waitcnt vmcnt(3)
    v_cmp_eq_u32 vcc, 0, v15
    s_cbranch_vccz L_k2_pollH_ok
    s_mov_b32 s3, 0
L_k2_pollH:
    buffer_load_dword v15, v62, s[68:71], 0 offen sc1
    s_add_u32 s3, s3, 1
    s_waitcnt vmcnt(0)
    v_cmp_eq_u32 vcc, 0, v15
    s_cbranch_vccz L_k2_pollH_ok
    s_sleep 4
    s_cmp_lt_u32 s3, 0x40000
    s_cbranch_scc1 L_k2_pollH
L_k2_pollH_ok:
    v_mfma_f32_16x16x32_bf16 v[188:191], a[132:135], v[116:119], v[188:191]
    v_cvt_pk_bf16_f32 v133, v210, v211
    v_mul_u32_u24 v14, 3641, v2
    v_mfma_f32_16x16x32_bf16 v[188:191], a[128:131], v[112:115], v[188:191]
    v_cvt_pk_bf16_f32 v144, v212, v213
    v_cvt_pk_bf16_f32 v145, v214, v215
    v_mfma_f32_16x16x32_bf16 v[192:195], a[144:147], v[64:67], v[36:39]
    ds_read_b64_tr_b16 a[128:129], v24 offset:16384
    v_lshrrev_b32 v14, 16, v14
    v_mul_u32_u24 v14, 864, v14
    v_mfma_f32_16x16x32_bf16 v[192:195], a[148:151], v[68:71], v[192:195]
    v_exp_f32 v224, v224
    v_mfma_f32_16x16x32_bf16 v[192:195], a[152:155], v[72:75], v[192:195]
    v_exp_f32 v225, v225
    v_mfma_f32_16x16x32_bf16 v[192:195], a[156:159], v[76:79], v[192:195]
    ds_read_b64_tr_b16 a[130:131], v24 offset:20480
    v_cvt_pk_bf16_f32 v134, v224, v225
    v_mfma_f32_16x16x32_bf16 v[196:199], a[156:159], v[92:95], v[40:43]
    v_exp_f32 v226, v226
    v_mfma_f32_16x16x32_bf16 v[196:199], a[152:155], v[88:91], v[196:199]
    v_exp_f32 v227, v227
    v_mfma_f32_16x16x32_bf16 v[196:199], a[148:151], v[84:87], v[196:199]
    ds_read_b64_tr_b16 a[132:133], v24 offset:24576
    v_cvt_pk_bf16_f32 v135, v226, v227
    v_mfma_f32_16x16x32_bf16 v[196:199], a[144:147], v[80:83], v[196:199]
    v_exp_f32 v228, v228
    v_mfma_f32_16x16x32_bf16 v[200:203], a[144:147], v[96:99], v[44:47]
    v_exp_f32 v229, v229
    v_mfma_f32_16x16x32_bf16 v[200:203], a[148:151], v[100:103], v[200:203]
    ds_read_b64_tr_b16 a[134:135], v24 offset:28672
    v_cvt_pk_bf16_f32 v146, v228, v229
    v_mfma_f32_16x16x32_bf16 v[200:203], a[152:155], v[104:107], v[200:203]
    v_exp_f32 v230, v230
    v_mfma_f32_16x16x32_bf16 v[200:203], a[156:159], v[108:111], v[200:203]
    v_exp_f32 v231, v231
    v_mfma_f32_16x16x32_bf16 v[204:207], a[156:159], v[124:127], v[48:51]
    ds_read_b64_tr_b16 a[136:137], v25 offset:16384
    v_cvt_pk_bf16_f32 v147, v230, v231
    v_mfma_f32_16x16x32_bf16 v[204:207], a[152:155], v[120:123], v[204:207]
    s_add_u32 s51, s58, 0
    ds_read_b64_tr_b16 a[138:139], v25 offset:20480
    v_lshl_add_u32 v54, v2, 4, v14
    v_add_u32 v2, 192, v18
    v_mfma_f32_16x16x32_bf16 v[204:207], a[148:151], v[116:119], v[204:207]
    buffer_load_dwordx4 a[192:195], v7, s[12:15], s51 offen offset:0 sc1
    v_mfma_f32_16x16x32_bf16 v[204:207], a[144:147], v[112:115], v[204:207]
    ds_read_b64_tr_b16 a[140:141], v25 offset:24576
    s_waitcnt lgkmcnt(7)
    v_mul_u32_u24 v14, 3641, v2
    v_mfma_f32_16x16x32_bf16 v[208:211], a[160:163], v[64:67], v[36:39]
    ds_read_b64_tr_b16 a[142:143], v25 offset:28672
    v_lshrrev_b32 v14, 16, v14
    v_mul_u32_u24 v14, 864, v14
    v_mfma_f32_16x16x32_bf16 v[208:211], a[164:167], v[68:71], v[208:211]
    buffer_load_dwordx4 a[196:199], v7, s[12:15], s51 offen offset:1024 sc1
    ds_read_b64_tr_b16 a[144:145], v26 offset:16384
    v_lshl_add_u32 v55, v2, 4, v14
    v_add_u32 v2, 256, v18
    v_mfma_f32_16x16x32_bf16 v[208:211], a[168:171], v[72:75], v[208:211]
    v_exp_f32 v232, v232
    v_mfma_f32_16x16x32_bf16 v[208:211], a[172:175], v[76:79], v[208:211]
    v_exp_f32 v233, v233
    v_mfma_f32_16x16x32_bf16 v[212:215], a[172:175], v[92:95], v[40:43]
    ds_read_b64_tr_b16 a[146:147], v26 offset:20480
    v_cvt_pk_bf16_f32 v158, v232, v233
    v_mfma_f32_16x16x32_bf16 v[212:215], a[168:171], v[88:91], v[212:215]
    v_exp_f32 v234, v234
    v_mfma_f32_16x16x32_bf16 v[212:215], a[164:167], v[84:87], v[212:215]
    v_exp_f32 v235, v235
    v_mfma_f32_16x16x32_bf16 v[212:215], a[160:163], v[80:83], v[212:215]
    ds_read_b64_tr_b16 a[148:149], v26 offset:24576
    v_cvt_pk_bf16_f32 v159, v234, v235
    v_mfma_f32_16x16x32_bf16 v[216:219], a[160:163], v[96:99], v[44:47]
    v_exp_f32 v236, v236
    v_mfma_f32_16x16x32_bf16 v[216:219], a[164:167], v[100:103], v[216:219]
    v_exp_f32 v237, v237
    v_mfma_f32_16x16x32_bf16 v[216:219], a[168:171], v[104:107], v[216:219]
    ds_read_b64_tr_b16 a[150:151], v26 offset:28672
    v_cvt_pk_bf16_f32 v170, v236, v237
    v_mfma_f32_16x16x32_bf16 v[216:219], a[172:175], v[108:111], v[216:219]
    v_exp_f32 v238, v238
    v_mfma_f32_16x16x32_bf16 v[220:223], a[172:175], v[124:127], v[48:51]
    v_exp_f32 v239, v239
    v_mfma_f32_16x16x32_bf16 v[220:223], a[168:171], v[120:123], v[220:223]
    ds_read_b64_tr_b16 a[152:153], v27 offset:16384
    v_cvt_pk_bf16_f32 v171, v238, v239
    v_mfma_f32_16x16x32_bf16 v[220:223], a[164:167], v[116:119], v[220:223]
    ds_read_b64_tr_b16 a[154:155], v27 offset:20480
    v_mul_u32_u24 v14, 3641, v2
    v_lshrrev_b32 v14, 16, v14
    v_mfma_f32_16x16x32_bf16 v[220:223], a[160:163], v[112:115], v[220:223]
    buffer_load_dwordx4 a[200:203], v7, s[12:15], s51 offen offset:2048 sc1
    v_mfma_f32_16x16x32_bf16 v[224:227], a[176:179], v[64:67], v[36:39]
    ds_read_b64_tr_b16 a[156:157], v27 offset:24576
    v_mul_u32_u24 v14, 864, v14
    v_lshl_add_u32 v56, v2, 4, v14
    v_mfma_f32_16x16x32_bf16 v[224:227], a[180:183], v[68:71], v[224:227]
    buffer_load_dwordx4 a[204:207], v7, s[12:15], s51 offen offset:3072 sc1
    ds_read_b64_tr_b16 a[158:159], v27 offset:28672
    v_add_u32 v2, 320, v18
    v_mul_u32_u24 v14, 3641, v2
    v_mfma_f32_16x16x32_bf16 v[224:227], a[184:187], v[72:75], v[224:227]
    v_exp_f32 v176, v176
    v_mfma_f32_16x16x32_bf16 v[224:227], a[188:191], v[76:79], v[224:227]
    v_exp_f32 v177, v177
    v_mfma_f32_16x16x32_bf16 v[228:231], a[188:191], v[92:95], v[40:43]
    ds_read_b64_tr_b16 a[160:161], v28 offset:16384
    v_cvt_pk_bf16_f32 v128, v176, v177
    v_mfma_f32_16x16x32_bf16 v[228:231], a[184:187], v[88:91], v[228:231]
    v_exp_f32 v178, v178
    v_mfma_f32_16x16x32_bf16 v[228:231], a[180:183], v[84:87], v[228:231]
    v_exp_f32 v179, v179
    v_mfma_f32_16x16x32_bf16 v[228:231], a[176:179], v[80:83], v[228:231]
    ds_read_b64_tr_b16 a[162:163], v28 offset:20480
    v_cvt_pk_bf16_f32 v129, v178, v179
    v_mfma_f32_16x16x32_bf16 v[232:235], a[176:179], v[96:99], v[44:47]
    v_exp_f32 v180, v180
    v_mfma_f32_16x16x32_bf16 v[232:235], a[180:183], v[100:103], v[232:235]
    v_exp_f32 v181, v181
    v_mfma_f32_16x16x32_bf16 v[232:235], a[184:187], v[104:107], v[232:235]
    ds_read_b64_tr_b16 a[164:165], v28 offset:24576
    v_cvt_pk_bf16_f32 v140, v180, v181
    v_mfma_f32_16x16x32_bf16 v[232:235], a[188:191], v[108:111], v[232:235]
    v_exp_f32 v182, v182
    v_mfma_f32_16x16x32_bf16 v[236:239], a[188:191], v[124:127], v[48:51]
    v_exp_f32 v183, v183
    v_mfma_f32_16x16x32_bf16 v[236:239], a[184:187], v[120:123], v[236:239]
    ds_read_b64_tr_b16 a[166:167], v28 offset:28672
    v_cvt_pk_bf16_f32 v141, v182, v183
    v_mfma_f32_16x16x32_bf16 v[236:239], a[180:183], v[116:119], v[236:239]
    s_add_u32 s51, s58, 4096
    ds_read_b64_tr_b16 a[168:169], v29 offset:16384
    s_waitcnt lgkmcnt(5)
    v_lshrrev_b32 v14, 16, v14
    v_mfma_f32_16x16x32_bf16 v[236:239], a[176:179], v[112:115], v[236:239]
    buffer_load_dwordx4 a[208:211], v7, s[12:15], s51 offen offset:0 sc1
    v_mfma_f32_16x16x32_bf16 a[0:3], a[128:131], v[136:139], a[0:3]
    ds_read_b64_tr_b16 a[170:171], v29 offset:20480
    v_mul_u32_u24 v14, 864, v14
    v_lshl_add_u32 v57, v2, 4, v14
    v_mfma_f32_16x16x32_bf16 a[0:3], a[132:135], v[132:135], a[0:3]
    buffer_load_dwordx4 a[212:215], v7, s[12:15], s51 offen offset:1024 sc1
    ds_read_b64_tr_b16 a[172:173], v29 offset:24576
    v_add_u32 v2, 384, v18
    v_mul_u32_u24 v14, 3641, v2
    v_mfma_f32_16x16x32_bf16 a[4:7], a[132:135], v[144:147], a[4:7]
    v_exp_f32 v184, v184
    v_mfma_f32_16x16x32_bf16 a[4:7], a[128:131], v[148:151], a[4:7]
    v_exp_f32 v185, v185
    v_mfma_f32_16x16x32_bf16 a[8:11], a[128:131], v[160:163], a[8:11]
    ds_read_b64_tr_b16 a[174:175], v29 offset:28672
    v_cvt_pk_bf16_f32 v152, v184, v185
    v_mfma_f32_16x16x32_bf16 a[8:11], a[132:135], v[156:159], a[8:11]
    v_exp_f32 v186, v186
    v_mfma_f32_16x16x32_bf16 a[12:15], a[132:135], v[168:171], a[12:15]
    v_exp_f32 v187, v187
    v_mfma_f32_16x16x32_bf16 a[12:15], a[128:131], v[172:175], a[12:15]
    ds_read_b64_tr_b16 a[176:177], v30 offset:16384
    v_cvt_pk_bf16_f32 v153, v186, v187
    v_mfma_f32_16x16x32_bf16 a[16:19], a[136:139], v[136:139], a[16:19]
    v_exp_f32 v188, v188
    v_mfma_f32_16x16x32_bf16 a[16:19], a[140:143], v[132:135], a[16:19]
    v_exp_f32 v189, v189
    v_mfma_f32_16x16x32_bf16 a[20:23], a[140:143], v[144:147], a[20:23]
    ds_read_b64_tr_b16 a[178:179], v30 offset:20480
    v_cvt_pk_bf16_f32 v164, v188, v189
    v_mfma_f32_16x16x32_bf16 a[20:23], a[136:139], v[148:151], a[20:23]
    v_exp_f32 v190, v190
    v_mfma_f32_16x16x32_bf16 a[24:27], a[136:139], v[160:163], a[24:27]
    v_exp_f32 v191, v191
    v_mfma_f32_16x16x32_bf16 a[24:27], a[140:143], v[156:159], a[24:27]
    ds_read_b64_tr_b16 a[180:181], v30 offset:24576
    v_cvt_pk_bf16_f32 v165, v190, v191
    v_mfma_f32_16x16x32_bf16 a[28:31], a[140:143], v[168:171], a[28:31]
    ds_read_b64_tr_b16 a[182:183], v30 offset:28672
    v_lshrrev_b32 v14, 16, v14
    v_mul_u32_u24 v14, 864, v14
    v_mfma_f32_16x16x32_bf16 a[28:31], a[136:139], v[172:175], a[28:31]
    buffer_load_dwordx4 a[216:219], v7, s[12:15], s51 offen offset:2048 sc1
    v_mfma_f32_16x16x32_bf16 a[32:35], a[144:147], v[136:139], a[32:35]
    ds_read_b64_tr_b16 a[184:185], v31 offset:16384
    v_lshl_add_u32 v58, v2, 4, v14
    v_add_u32 v2, 448, v18
    v_mfma_f32_16x16x32_bf16 a[32:35], a[148:151], v[132:135], a[32:35]
    buffer_load_dwordx4 a[220:223], v7, s[12:15], s51 offen offset:3072 sc1
    ds_read_b64_tr_b16 a[186:187], v31 offset:20480
    s_waitcnt lgkmcnt(6)
    v_mul_u32_u24 v14, 3641, v2
    v_mfma_f32_16x16x32_bf16 a[36:39], a[148:151], v[144:147], a[36:39]
    v_exp_f32 v192, v192
    v_mfma_f32_16x16x32_bf16 a[36:39], a[144:147], v[148:151], a[36:39]
    v_exp_f32 v193, v193
    v_mfma_f32_16x16x32_bf16 a[40:43], a[144:147], v[160:163], a[40:43]
    ds_read_b64_tr_b16 a[188:189], v31 offset:24576
    v_cvt_pk_bf16_f32 v130, v192, v193
    v_mfma_f32_16x16x32_bf16 a[40:43], a[148:151], v[156:159], a[40:43]
    v_exp_f32 v194, v194
    v_mfma_f32_16x16x32_bf16 a[44:47], a[148:151], v[168:171], a[44:47]
    v_exp_f32 v195, v195
    v_mfma_f32_16x16x32_bf16 a[44:47], a[144:147], v[172:175], a[44:47]
    ds_read_b64_tr_b16 a[190:191], v31 offset:28672
    v_cvt_pk_bf16_f32 v131, v194, v195
    v_mfma_f32_16x16x32_bf16 a[48:51], a[152:155], v[136:139], a[48:51]
    v_exp_f32 v196, v196
    v_mfma_f32_16x16x32_bf16 a[48:51], a[156:159], v[132:135], a[48:51]
    s_add_u32 s51, s58, 8192
    v_exp_f32 v197, v197
    v_mfma_f32_16x16x32_bf16 a[52:55], a[156:159], v[144:147], a[52:55]
    buffer_load_dwordx4 a[224:227], v7, s[12:15], s51 offen offset:0 sc1
    v_cvt_pk_bf16_f32 v142, v196, v197
    v_lshrrev_b32 v14, 16, v14
    v_mfma_f32_16x16x32_bf16 a[52:55], a[152:155], v[148:151], a[52:55]
    v_exp_f32 v198, v198
    v_mfma_f32_16x16x32_bf16 a[56:59], a[152:155], v[160:163], a[56:59]
    v_exp_f32 v199, v199
    v_mfma_f32_16x16x32_bf16 a[56:59], a[156:159], v[156:159], a[56:59]
    v_cvt_pk_bf16_f32 v143, v198, v199
    v_mul_u32_u24 v14, 864, v14
    v_mfma_f32_16x16x32_bf16 a[60:63], a[156:159], v[168:171], a[60:63]
    v_lshl_add_u32 v59, v2, 4, v14
    v_add_u32 v2, 512, v18
    v_mfma_f32_16x16x32_bf16 a[60:63], a[152:155], v[172:175], a[60:63]
    buffer_load_dwordx4 a[228:231], v7, s[12:15], s51 offen offset:1024 sc1
    v_mfma_f32_16x16x32_bf16 a[64:67], a[160:163], v[136:139], a[64:67]
    v_mul_u32_u24 v14, 3641, v2
    v_lshrrev_b32 v14, 16, v14
    v_mfma_f32_16x16x32_bf16 a[64:67], a[164:167], v[132:135], a[64:67]
    s_add_u32 m0, s49, 0
    s_waitcnt vmcnt(10) lgkmcnt(0)
    s_barrier
    v_mfma_f32_16x16x32_bf16 a[68:71], a[164:167], v[144:147], a[68:71]
    buffer_load_dwordx4 v52, s[8:11], s45 offen lds
    v_mfma_f32_16x16x32_bf16 a[68:71], a[160:163], v[148:151], a[68:71]
    v_exp_f32 v200, v200
    v_mfma_f32_16x16x32_bf16 a[72:75], a[160:163], v[160:163], a[72:75]
    v_exp_f32 v201, v201
    v_mfma_f32_16x16x32_bf16 a[72:75], a[164:167], v[156:159], a[72:75]
    ds_read_b128 a[128:131], v20 offset:49152
    v_cvt_pk_bf16_f32 v154, v200, v201
    v_mfma_f32_16x16x32_bf16 a[76:79], a[164:167], v[168:171], a[76:79]
    v_exp_f32 v202, v202
    v_mfma_f32_16x16x32_bf16 a[76:79], a[160:163], v[172:175], a[76:79]
    v_exp_f32 v203, v203
    v_mfma_f32_16x16x32_bf16 a[80:83], a[168:171], v[136:139], a[80:83]
    ds_read_b128 a[132:135], v21 offset:49152
    v_cvt_pk_bf16_f32 v155, v202, v203
    v_mfma_f32_16x16x32_bf16 a[80:83], a[172:175], v[132:135], a[80:83]
    v_exp_f32 v204, v204
    v_mfma_f32_16x16x32_bf16 a[84:87], a[172:175], v[144:147], a[84:87]
    v_exp_f32 v205, v205
    v_mfma_f32_16x16x32_bf16 a[84:87], a[168:171], v[148:151], a[84:87]
    ds_read_b128 a[136:139], v22 offset:49152
    v_cvt_pk_bf16_f32 v166, v204, v205
    v_mfma_f32_16x16x32_bf16 a[88:91], a[168:171], v[160:163], a[88:91]
    v_exp_f32 v206, v206
    v_mfma_f32_16x16x32_bf16 a[88:91], a[172:175], v[156:159], a[88:91]
    v_exp_f32 v207, v207
    v_mfma_f32_16x16x32_bf16 a[92:95], a[172:175], v[168:171], a[92:95]
    ds_read_b128 a[140:143], v23 offset:49152
    v_cvt_pk_bf16_f32 v167, v206, v207
    v_mfma_f32_16x16x32_bf16 a[92:95], a[168:171], v[172:175], a[92:95]
    s_add_u32 m0, s49, 1024
    ds_read_b128 a[144:147], v20 offset:53248
    v_mul_u32_u24 v14, 864, v14
    v_lshl_add_u32 v60, v2, 4, v14
    v_mfma_f32_16x16x32_bf16 a[96:99], a[176:179], v[136:139], a[96:99]
    buffer_load_dwordx4 v53, s[8:11], s45 offen lds
    v_mfma_f32_16x16x32_bf16 a[96:99], a[180:183], v[132:135], a[96:99]
    s_add_u32 m0, s49, 2048
    ds_read_b128 a[148:151], v21 offset:53248
    v_mfma_f32_16x16x32_bf16 a[100:103], a[180:183], v[144:147], a[100:103]
    buffer_load_dwordx4 v54, s[8:11], s45 offen lds
    v_mfma_f32_16x16x32_bf16 a[100:103], a[176:179], v[148:151], a[100:103]
    v_mfma_f32_16x16x32_bf16 a[104:107], a[176:179], v[160:163], a[104:107]
    v_exp_f32 v208, v208
    v_mfma_f32_16x16x32_bf16 a[104:107], a[180:183], v[156:159], a[104:107]
    v_exp_f32 v209, v209
    v_smfmac_f32_16x16x64_bf16 v[240:243], v[32:35], v[132:139], v61
    ds_read_b128 a[152:155], v22 offset:53248
    v_mfma_f32_16x16x32_bf16 a[108:111], a[180:183], v[168:171], a[108:111]
    v_exp_f32 v210, v210
    v_mfma_f32_16x16x32_bf16 a[108:111], a[176:179], v[172:175], a[108:111]
    v_exp_f32 v211, v211
    v_smfmac_f32_16x16x64_bf16 v[244:247], v[32:35], v[144:151], v61
    ds_read_b128 a[156:159], v23 offset:53248
    v_mfma_f32_16x16x32_bf16 a[112:115], a[184:187], v[136:139], a[112:115]
    v_exp_f32 v212, v212
    v_mfma_f32_16x16x32_bf16 a[112:115], a[188:191], v[132:135], a[112:115]
    v_exp_f32 v213, v213
    v_smfmac_f32_16x16x64_bf16 v[248:251], v[32:35], v[156:163], v61
    ds_read_b128 a[160:163], v20 offset:57344
    v_mfma_f32_16x16x32_bf16 a[116:119], a[188:191], v[144:147], a[116:119]
    v_exp_f32 v214, v214
    v_mfma_f32_16x16x32_bf16 a[116:119], a[184:187], v[148:151], a[116:119]
    v_exp_f32 v215, v215
    v_smfmac_f32_16x16x64_bf16 v[252:255], v[32:35], v[168:175], v61
    ds_read_b128 a[164:167], v21 offset:57344
    v_mfma_f32_16x16x32_bf16 a[120:123], a[184:187], v[160:163], a[120:123]
    s_add_u32 m0, s49, 3072
    ds_read_b128 a[168:171], v22 offset:57344
    v_mfma_f32_16x16x32_bf16 a[120:123], a[188:191], v[156:159], a[120:123]
    buffer_load_dwordx4 v55, s[8:11], s45 offen lds
    v_mfma_f32_16x16x32_bf16 a[124:127], a[188:191], v[168:171], a[124:127]
    s_add_u32 m0, s49, 4096
    ds_read_b128 a[172:175], v23 offset:57344
    v_mfma_f32_16x16x32_bf16 a[124:127], a[184:187], v[172:175], a[124:127]
    buffer_load_dwordx4 v56, s[8:11], s45 offen lds
    s_waitcnt lgkmcnt(4)
    v_mfma_f32_16x16x32_bf16 v[176:179], a[128:131], v[64:67], v[36:39]
    v_exp_f32 v216, v216
    v_mfma_f32_16x16x32_bf16 v[176:179], a[132:135], v[68:71], v[176:179]
    v_exp_f32 v217, v217
    v_mfma_f32_16x16x32_bf16 v[176:179], a[136:139], v[72:75], v[176:179]
    ds_read_b128 a[176:179], v20 offset:61440
    v_cvt_pk_bf16_f32 v156, v216, v217
    v_mfma_f32_16x16x32_bf16 v[176:179], a[140:143], v[76:79], v[176:179]
    v_exp_f32 v218, v218
    v_mfma_f32_16x16x32_bf16 v[180:183], a[140:143], v[92:95], v[40:43]
    v_exp_f32 v219, v219
    v_mfma_f32_16x16x32_bf16 v[180:183], a[136:139], v[88:91], v[180:183]
    ds_read_b128 a[180:183], v21 offset:61440
    v_cvt_pk_bf16_f32 v157, v218, v219
    v_mfma_f32_16x16x32_bf16 v[180:183], a[132:135], v[84:87], v[180:183]
    v_exp_f32 v220, v220
    v_mfma_f32_16x16x32_bf16 v[180:183], a[128:131], v[80:83], v[180:183]
    v_exp_f32 v221, v221
    v_mfma_f32_16x16x32_bf16 v[184:187], a[128:131], v[96:99], v[44:47]
    ds_read_b128 a[184:187], v22 offset:61440
    v_cvt_pk_bf16_f32 v168, v220, v221
    v_mfma_f32_16x16x32_bf16 v[184:187], a[132:135], v[100:103], v[184:187]
    v_exp_f32 v222, v222
    v_mfma_f32_16x16x32_bf16 v[184:187], a[136:139], v[104:107], v[184:187]
    v_exp_f32 v223, v223
    v_mfma_f32_16x16x32_bf16 v[184:187], a[140:143], v[108:111], v[184:187]
    ds_read_b128 a[188:191], v23 offset:61440
    v_cvt_pk_bf16_f32 v169, v222, v223
    v_mfma_f32_16x16x32_bf16 v[188:191], a[140:143], v[124:127], v[48:51]
    s_add_u32 m0, s49, 5120
    v_cvt_pk_bf16_f32 v132, v208, v209
    v_mfma_f32_16x16x32_bf16 v[188:191], a[136:139], v[120:123], v[188:191]
    buffer_load_dwordx4 v57, s[8:11], s45 offen lds
    v_mfma_f32_16x16x32_bf16 v[188:191], a[132:135], v[116:119], v[188:191]
    v_cvt_pk_bf16_f32 v133, v210, v211
    v_mfma_f32_16x16x32_bf16 v[188:191], a[128:131], v[112:115], v[188:191]
    v_cvt_pk_bf16_f32 v144, v212, v213
    v_cvt_pk_bf16_f32 v145, v214, v215
    v_mfma_f32_16x16x32_bf16 v[192:195], a[144:147], v[64:67], v[36:39]
    ds_read_b64_tr_b16 a[128:129], v24 offset:32768
    v_mfma_f32_16x16x32_bf16 v[192:195], a[148:151], v[68:71], v[192:195]
    v_exp_f32 v224, v224
    v_mfma_f32_16x16x32_bf16 v[192:195], a[152:155], v[72:75], v[192:195]
    v_exp_f32 v225, v225
    v_mfma_f32_16x16x32_bf16 v[192:195], a[156:159], v[76:79], v[192:195]
    ds_read_b64_tr_b16 a[130:131], v24 offset:36864
    v_cvt_pk_bf16_f32 v134, v224, v225
    v_mfma_f32_16x16x32_bf16 v[196:199], a[156:159], v[92:95], v[40:43]
    v_exp_f32 v226, v226
    v_mfma_f32_16x16x32_bf16 v[196:199], a[152:155], v[88:91], v[196:199]
    v_exp_f32 v227, v227
    v_mfma_f32_16x16x32_bf16 v[196:199], a[148:151], v[84:87], v[196:199]
    ds_read_b64_tr_b16 a[132:133], v24 offset:40960
    v_cvt_pk_bf16_f32 v135, v226, v227
    v_mfma_f32_16x16x32_bf16 v[196:199], a[144:147], v[80:83], v[196:199]
    v_exp_f32 v228, v228
    v_mfma_f32_16x16x32_bf16 v[200:203], a[144:147], v[96:99], v[44:47]
    v_exp_f32 v229, v229
    v_mfma_f32_16x16x32_bf16 v[200:203], a[148:151], v[100:103], v[200:203]
    ds_read_b64_tr_b16 a[134:135], v24 offset:45056
    v_cvt_pk_bf16_f32 v146, v228, v229
    v_mfma_f32_16x16x32_bf16 v[200:203], a[152:155], v[104:107], v[200:203]
    v_exp_f32 v230, v230
    v_mfma_f32_16x16x32_bf16 v[200:203], a[156:159], v[108:111], v[200:203]
    v_exp_f32 v231, v231
    v_mfma_f32_16x16x32_bf16 v[204:207], a[156:159], v[124:127], v[48:51]
    ds_read_b64_tr_b16 a[136:137], v25 offset:32768
    v_cvt_pk_bf16_f32 v147, v230, v231
    v_mfma_f32_16x16x32_bf16 v[204:207], a[152:155], v[120:123], v[204:207]
    s_add_u32 m0, s49, 6144
    ds_read_b64_tr_b16 a[138:139], v25 offset:36864
    v_mfma_f32_16x16x32_bf16 v[204:207], a[148:151], v[116:119], v[204:207]
    buffer_load_dwordx4 v58, s[8:11], s45 offen lds
    v_mfma_f32_16x16x32_bf16 v[204:207], a[144:147], v[112:115], v[204:207]
    ds_read_b64_tr_b16 a[140:141], v25 offset:40960
    s_waitcnt lgkmcnt(7)
    v_mfma_f32_16x16x32_bf16 v[208:211], a[160:163], v[64:67], v[36:39]
    s_add_u32 m0, s49, 7168
    ds_read_b64_tr_b16 a[142:143], v25 offset:45056
    v_mfma_f32_16x16x32_bf16 v[208:211], a[164:167], v[68:71], v[208:211]
    buffer_load_dwordx4 v59, s[8:11], s45 offen lds
    ds_read_b64_tr_b16 a[144:145], v26 offset:32768
    v_mfma_f32_16x16x32_bf16 v[208:211], a[168:171], v[72:75], v[208:211]
    v_exp_f32 v232, v232
    v_mfma_f32_16x16x32_bf16 v[208:211], a[172:175], v[76:79], v[208:211]
    v_exp_f32 v233, v233
    v_mfma_f32_16x16x32_bf16 v[212:215], a[172:175], v[92:95], v[40:43]
    ds_read_b64_tr_b16 a[146:147], v26 offset:36864
    v_cvt_pk_bf16_f32 v158, v232, v233
    v_mfma_f32_16x16x32_bf16 v[212:215], a[168:171], v[88:91], v[212:215]
    v_exp_f32 v234, v234
    v_mfma_f32_16x16x32_bf16 v[212:215], a[164:167], v[84:87], v[212:215]
    v_exp_f32 v235, v235
    v_mfma_f32_16x16x32_bf16 v[212:215], a[160:163], v[80:83], v[212:215]
    ds_read_b64_tr_b16 a[148:149], v26 offset:40960
    v_cvt_pk_bf16_f32 v159, v234, v235
    v_mfma_f32_16x16x32_bf16 v[216:219], a[160:163], v[96:99], v[44:47]
    v_exp_f32 v236, v236
    v_mfma_f32_16x16x32_bf16 v[216:219], a[164:167], v[100:103], v[216:219]
    v_exp_f32 v237, v237
    v_mfma_f32_16x16x32_bf16 v[216:219], a[168:171], v[104:107], v[216:219]
    ds_read_b64_tr_b16 a[150:151], v26 offset:45056
    v_cvt_pk_bf16_f32 v170, v236, v237
    v_mfma_f32_16x16x32_bf16 v[216:219], a[172:175], v[108:111], v[216:219]
    v_exp_f32 v238, v238
    v_mfma_f32_16x16x32_bf16 v[220:223], a[172:175], v[124:127], v[48:51]
    v_exp_f32 v239, v239
    v_mfma_f32_16x16x32_bf16 v[220:223], a[168:171], v[120:123], v[220:223]
    ds_read_b64_tr_b16 a[152:153], v27 offset:32768
    v_cvt_pk_bf16_f32 v171, v238, v239
    v_mfma_f32_16x16x32_bf16 v[220:223], a[164:167], v[116:119], v[220:223]
    s_add_u32 m0, s49, 8192
    ds_read_b64_tr_b16 a[154:155], v27 offset:36864
    v_mfma_f32_16x16x32_bf16 v[220:223], a[160:163], v[112:115], v[220:223]
    buffer_load_dwordx4 v60, s[8:11], s45 offen lds
    v_mfma_f32_16x16x32_bf16 v[224:227], a[176:179], v[64:67], v[36:39]
    ds_read_b64_tr_b16 a[156:157], v27 offset:40960
    v_mfma_f32_16x16x32_bf16 v[224:227], a[180:183], v[68:71], v[224:227]
    buffer_load_dwordx4 a[232:235], v7, s[12:15], s51 offen offset:2048 sc1
    ds_read_b64_tr_b16 a[158:159], v27 offset:45056
    v_mfma_f32_16x16x32_bf16 v[224:227], a[184:187], v[72:75], v[224:227]
    v_exp_f32 v176, v176
    v_mfma_f32_16x16x32_bf16 v[224:227], a[188:191], v[76:79], v[224:227]
    v_exp_f32 v177, v177
    v_mfma_f32_16x16x32_bf16 v[228:231], a[188:191], v[92:95], v[40:43]
    ds_read_b64_tr_b16 a[160:161], v28 offset:32768
    v_cvt_pk_bf16_f32 v136, v176, v177
    v_mfma_f32_16x16x32_bf16 v[228:231], a[184:187], v[88:91], v[228:231]
    v_exp_f32 v178, v178
    v_mfma_f32_16x16x32_bf16 v[228:231], a[180:183], v[84:87], v[228:231]
    v_exp_f32 v179, v179
    v_mfma_f32_16x16x32_bf16 v[228:231], a[176:179], v[80:83], v[228:231]
    ds_read_b64_tr_b16 a[162:163], v28 offset:36864
    v_cvt_pk_bf16_f32 v137, v178, v179
    v_mfma_f32_16x16x32_bf16 v[232:235], a[176:179], v[96:99], v[44:47]
    v_exp_f32 v180, v180
    v_mfma_f32_16x16x32_bf16 v[232:235], a[180:183], v[100:103], v[232:235]
    v_exp_f32 v181, v181
    v_mfma_f32_16x16x32_bf16 v[232:235], a[184:187], v[104:107], v[232:235]
    ds_read_b64_tr_b16 a[164:165], v28 offset:40960
    v_cvt_pk_bf16_f32 v148, v180, v181
    v_mfma_f32_16x16x32_bf16 v[232:235], a[188:191], v[108:111], v[232:235]
    v_exp_f32 v182, v182
    v_mfma_f32_16x16x32_bf16 v[236:239], a[188:191], v[124:127], v[48:51]
    v_exp_f32 v183, v183
    v_mfma_f32_16x16x32_bf16 v[236:239], a[184:187], v[120:123], v[236:239]
    ds_read_b64_tr_b16 a[166:167], v28 offset:45056
    v_cvt_pk_bf16_f32 v149, v182, v183
    v_mfma_f32_16x16x32_bf16 v[236:239], a[180:183], v[116:119], v[236:239]
    ds_read_b64_tr_b16 a[168:169], v29 offset:32768
    s_waitcnt lgkmcnt(5)
    v_mfma_f32_16x16x32_bf16 v[236:239], a[176:179], v[112:115], v[236:239]
    buffer_load_dwordx4 a[236:239], v7, s[12:15], s51 offen offset:3072 sc1
    v_mfma_f32_16x16x32_bf16 a[0:3], a[128:131], v[128:131], a[0:3]
    s_add_u32 s51, s58, 12288
    ds_read_b64_tr_b16 a[170:171], v29 offset:36864
    v_mfma_f32_16x16x32_bf16 a[0:3], a[132:135], v[132:135], a[0:3]
    buffer_load_dwordx4 a[240:243], v7, s[12:15], s51 offen offset:0 sc1
    ds_read_b64_tr_b16 a[172:173], v29 offset:40960
    v_mfma_f32_16x16x32_bf16 a[4:7], a[132:135], v[144:147], a[4:7]
    v_exp_f32 v184, v184
    v_mfma_f32_16x16x32_bf16 a[4:7], a[128:131], v[140:143], a[4:7]
    v_exp_f32 v185, v185
    v_mfma_f32_16x16x32_bf16 a[8:11], a[128:131], v[152:155], a[8:11]
    ds_read_b64_tr_b16 a[174:175], v29 offset:45056
    v_cvt_pk_bf16_f32 v160, v184, v185
    v_mfma_f32_16x16x32_bf16 a[8:11], a[132:135], v[156:159], a[8:11]
    v_exp_f32 v186, v186
    v_mfma_f32_16x16x32_bf16 a[12:15], a[132:135], v[168:171], a[12:15]
    v_exp_f32 v187, v187
    v_mfma_f32_16x16x32_bf16 a[12:15], a[128:131], v[164:167], a[12:15]
    ds_read_b64_tr_b16 a[176:177], v30 offset:32768
    v_cvt_pk_bf16_f32 v161, v186, v187
    v_mfma_f32_16x16x32_bf16 a[16:19], a[136:139], v[128:131], a[16:19]
    v_exp_f32 v188, v188
    v_mfma_f32_16x16x32_bf16 a[16:19], a[140:143], v[132:135], a[16:19]
    v_exp_f32 v189, v189
    v_mfma_f32_16x16x32_bf16 a[20:23], a[140:143], v[144:147], a[20:23]
    ds_read_b64_tr_b16 a[178:179], v30 offset:36864
    v_cvt_pk_bf16_f32 v172, v188, v189
    v_mfma_f32_16x16x32_bf16 a[20:23], a[136:139], v[140:143], a[20:23]
    v_exp_f32 v190, v190
    v_mfma_f32_16x16x32_bf16 a[24:27], a[136:139], v[152:155], a[24:27]
    v_exp_f32 v191, v191
    v_mfma_f32_16x16x32_bf16 a[24:27], a[140:143], v[156:159], a[24:27]
    ds_read_b64_tr_b16 a[180:181], v30 offset:40960
    v_cvt_pk_bf16_f32 v173, v190, v191
    v_mfma_f32_16x16x32_bf16 a[28:31], a[140:143], v[168:171], a[28:31]
    ds_read_b64_tr_b16 a[182:183], v30 offset:45056
    v_mfma_f32_16x16x32_bf16 a[28:31], a[136:139], v[164:167], a[28:31]
    buffer_load_dwordx4 a[244:247], v7, s[12:15], s51 offen offset:1024 sc1
    v_mfma_f32_16x16x32_bf16 a[32:35], a[144:147], v[128:131], a[32:35]
    ds_read_b64_tr_b16 a[184:185], v31 offset:32768
    v_mfma_f32_16x16x32_bf16 a[32:35], a[148:151], v[132:135], a[32:35]
    buffer_load_dwordx4 a[248:251], v7, s[12:15], s51 offen offset:2048 sc1
    ds_read_b64_tr_b16 a[186:187], v31 offset:36864
    s_waitcnt lgkmcnt(6)
    v_mfma_f32_16x16x32_bf16 a[36:39], a[148:151], v[144:147], a[36:39]
    v_exp_f32 v192, v192
    v_mfma_f32_16x16x32_bf16 a[36:39], a[144:147], v[140:143], a[36:39]
    v_exp_f32 v193, v193
    v_mfma_f32_16x16x32_bf16 a[40:43], a[144:147], v[152:155], a[40:43]
    ds_read_b64_tr_b16 a[188:189], v31 offset:40960
    v_cvt_pk_bf16_f32 v138, v192, v193
    v_mfma_f32_16x16x32_bf16 a[40:43], a[148:151], v[156:159], a[40:43]
    v_exp_f32 v194, v194
    v_mfma_f32_16x16x32_bf16 a[44:47], a[148:151], v[168:171], a[44:47]
    v_exp_f32 v195, v195
    v_mfma_f32_16x16x32_bf16 a[44:47], a[144:147], v[164:167], a[44:47]
    ds_read_b64_tr_b16 a[190:191], v31 offset:45056
    v_cvt_pk_bf16_f32 v139, v194, v195
    v_mfma_f32_16x16x32_bf16 a[48:51], a[152:155], v[128:131], a[48:51]
    v_exp_f32 v196, v196
    v_mfma_f32_16x16x32_bf16 a[48:51], a[156:159], v[132:135], a[48:51]
    v_exp_f32 v197, v197
    v_mfma_f32_16x16x32_bf16 a[52:55], a[156:159], v[144:147], a[52:55]
    buffer_load_dwordx4 a[252:255], v7, s[12:15], s51 offen offset:3072 sc1
    v_cvt_pk_bf16_f32 v150, v196, v197
    v_mfma_f32_16x16x32_bf16 a[52:55], a[152:155], v[140:143], a[52:55]
    v_exp_f32 v198, v198
    v_mfma_f32_16x16x32_bf16 a[56:59], a[152:155], v[152:155], a[56:59]
    v_exp_f32 v199, v199
    v_mfma_f32_16x16x32_bf16 a[56:59], a[156:159], v[156:159], a[56:59]
    v_cvt_pk_bf16_f32 v151, v198, v199
    v_mfma_f32_16x16x32_bf16 a[60:63], a[156:159], v[168:171], a[60:63]
    v_mfma_f32_16x16x32_bf16 a[60:63], a[152:155], v[164:167], a[60:63]
    v_mfma_f32_16x16x32_bf16 a[64:67], a[160:163], v[128:131], a[64:67]
    v_mfma_f32_16x16x32_bf16 a[64:67], a[164:167], v[132:135], a[64:67]
    s_add_u32 m0, s49, 36864
    s_waitcnt lgkmcnt(0)
    s_barrier
    v_mfma_f32_16x16x32_bf16 a[68:71], a[164:167], v[144:147], a[68:71]
    buffer_load_dwordx4 v52, s[8:11], s46 offen lds
    v_mfma_f32_16x16x32_bf16 a[68:71], a[160:163], v[140:143], a[68:71]
    v_exp_f32 v200, v200
    v_mfma_f32_16x16x32_bf16 a[72:75], a[160:163], v[152:155], a[72:75]
    v_exp_f32 v201, v201
    v_mfma_f32_16x16x32_bf16 a[72:75], a[164:167], v[156:159], a[72:75]
    ds_read_b64_tr_b16 a[128:129], v24 offset:49152
    v_cvt_pk_bf16_f32 v162, v200, v201
    v_mfma_f32_16x16x32_bf16 a[76:79], a[164:167], v[168:171], a[76:79]
    v_exp_f32 v202, v202
    v_mfma_f32_16x16x32_bf16 a[76:79], a[160:163], v[164:167], a[76:79]
    v_exp_f32 v203, v203
    v_mfma_f32_16x16x32_bf16 a[80:83], a[168:171], v[128:131], a[80:83]
    ds_read_b64_tr_b16 a[130:131], v24 offset:53248
    v_cvt_pk_bf16_f32 v163, v202, v203
    v_mfma_f32_16x16x32_bf16 a[80:83], a[172:175], v[132:135], a[80:83]
    v_exp_f32 v204, v204
    v_mfma_f32_16x16x32_bf16 a[84:87], a[172:175], v[144:147], a[84:87]
    v_exp_f32 v205, v205
    v_mfma_f32_16x16x32_bf16 a[84:87], a[168:171], v[140:143], a[84:87]
    ds_read_b64_tr_b16 a[132:133], v25 offset:49152
    v_cvt_pk_bf16_f32 v174, v204, v205
    v_mfma_f32_16x16x32_bf16 a[88:91], a[168:171], v[152:155], a[88:91]
    v_exp_f32 v206, v206
    v_mfma_f32_16x16x32_bf16 a[88:91], a[172:175], v[156:159], a[88:91]
    v_exp_f32 v207, v207
    v_mfma_f32_16x16x32_bf16 a[92:95], a[172:175], v[168:171], a[92:95]
    ds_read_b64_tr_b16 a[134:135], v25 offset:53248
    v_cvt_pk_bf16_f32 v175, v206, v207
    v_mfma_f32_16x16x32_bf16 a[92:95], a[168:171], v[164:167], a[92:95]
    s_add_u32 m0, s49, 37888
    ds_read_b64_tr_b16 a[136:137], v26 offset:49152
    ds_read_b64_tr_b16 a[138:139], v26 offset:53248
    v_mfma_f32_16x16x32_bf16 a[96:99], a[176:179], v[128:131], a[96:99]
    buffer_load_dwordx4 v53, s[8:11], s46 offen lds
    v_mfma_f32_16x16x32_bf16 a[96:99], a[180:183], v[132:135], a[96:99]
    s_add_u32 m0, s49, 38912
    ds_read_b64_tr_b16 a[140:141], v27 offset:49152
    ds_read_b64_tr_b16 a[142:143], v27 offset:53248
    v_mfma_f32_16x16x32_bf16 a[100:103], a[180:183], v[144:147], a[100:103]
    buffer_load_dwordx4 v54, s[8:11], s46 offen lds
    v_mfma_f32_16x16x32_bf16 a[100:103], a[176:179], v[140:143], a[100:103]
    ds_read_b64_tr_b16 a[144:145], v28 offset:49152
    ds_read_b64_tr_b16 a[146:147], v28 offset:53248
    v_mfma_f32_16x16x32_bf16 a[104:107], a[176:179], v[152:155], a[104:107]
    v_exp_f32 v208, v208
    v_mfma_f32_16x16x32_bf16 a[104:107], a[180:183], v[156:159], a[104:107]
    v_exp_f32 v209, v209
    v_smfmac_f32_16x16x64_bf16 v[240:243], v[32:35], v[128:135], v61
    ds_read_b64_tr_b16 a[148:149], v29 offset:49152
    v_mfma_f32_16x16x32_bf16 a[108:111], a[180:183], v[168:171], a[108:111]
    v_exp_f32 v210, v210
    v_mfma_f32_16x16x32_bf16 a[108:111], a[176:179], v[164:167], a[108:111]
    v_exp_f32 v211, v211
    v_smfmac_f32_16x16x64_bf16 v[244:247], v[32:35], v[140:147], v61
    ds_read_b64_tr_b16 a[150:151], v29 offset:53248
    v_mfma_f32_16x16x32_bf16 a[112:115], a[184:187], v[128:131], a[112:115]
    v_exp_f32 v212, v212
    v_mfma_f32_16x16x32_bf16 a[112:115], a[188:191], v[132:135], a[112:115]
    v_exp_f32 v213, v213
    v_smfmac_f32_16x16x64_bf16 v[248:251], v[32:35], v[152:159], v61
    ds_read_b64_tr_b16 a[152:153], v30 offset:49152
    v_mfma_f32_16x16x32_bf16 a[116:119], a[188:191], v[144:147], a[116:119]
    v_exp_f32 v214, v214
    v_mfma_f32_16x16x32_bf16 a[116:119], a[184:187], v[140:143], a[116:119]
    v_exp_f32 v215, v215
    v_smfmac_f32_16x16x64_bf16 v[252:255], v[32:35], v[164:171], v61
    ds_read_b64_tr_b16 a[154:155], v30 offset:53248
    v_mfma_f32_16x16x32_bf16 a[120:123], a[184:187], v[152:155], a[120:123]
    s_add_u32 m0, s49, 39936
    ds_read_b64_tr_b16 a[156:157], v31 offset:49152
    ds_read_b64_tr_b16 a[158:159], v31 offset:53248
    v_mfma_f32_16x16x32_bf16 a[120:123], a[188:191], v[156:159], a[120:123]
    buffer_load_dwordx4 v55, s[8:11], s46 offen lds
    v_mfma_f32_16x16x32_bf16 a[124:127], a[188:191], v[168:171], a[124:127]
    s_add_u32 m0, s49, 40960
    v_mfma_f32_16x16x32_bf16 a[124:127], a[184:187], v[164:167], a[124:127]
    buffer_load_dwordx4 v56, s[8:11], s46 offen lds
    s_waitcnt lgkmcnt(14)
    v_mfma_f32_16x16x32_bf16 a[0:3], a[128:131], v[136:139], a[0:3]
    v_exp_f32 v216, v216
    v_mfma_f32_16x16x32_bf16 a[4:7], a[128:131], v[148:151], a[4:7]
    ds_read_b64_tr_b16 a[160:161], v24 offset:57344
    ds_read_b64_tr_b16 a[162:163], v24 offset:61440
    v_exp_f32 v217, v217
    v_mfma_f32_16x16x32_bf16 a[8:11], a[128:131], v[160:163], a[8:11]
    v_cvt_pk_bf16_f32 v156, v216, v217
    v_exp_f32 v218, v218
    v_mfma_f32_16x16x32_bf16 a[12:15], a[128:131], v[172:175], a[12:15]
    ds_read_b64_tr_b16 a[164:165], v25 offset:57344
    ds_read_b64_tr_b16 a[166:167], v25 offset:61440
    v_exp_f32 v219, v219
    s_waitcnt lgkmcnt(15)
    v_mfma_f32_16x16x32_bf16 a[16:19], a[132:135], v[136:139], a[16:19]
    v_cvt_pk_bf16_f32 v157, v218, v219
    v_exp_f32 v220, v220
    v_mfma_f32_16x16x32_bf16 a[20:23], a[132:135], v[148:151], a[20:23]
    ds_read_b64_tr_b16 a[168:169], v26 offset:57344
    ds_read_b64_tr_b16 a[170:171], v26 offset:61440
    v_exp_f32 v221, v221
    v_mfma_f32_16x16x32_bf16 a[24:27], a[132:135], v[160:163], a[24:27]
    v_cvt_pk_bf16_f32 v168, v220, v221
    v_exp_f32 v222, v222
    v_mfma_f32_16x16x32_bf16 a[28:31], a[132:135], v[172:175], a[28:31]
    ds_read_b64_tr_b16 a[172:173], v27 offset:57344
    ds_read_b64_tr_b16 a[174:175], v27 offset:61440
    v_exp_f32 v223, v223
    s_waitcnt lgkmcnt(15)
    v_mfma_f32_16x16x32_bf16 a[32:35], a[136:139], v[136:139], a[32:35]
    v_cvt_pk_bf16_f32 v169, v222, v223
    v_exp_f32 v224, v224
    v_mfma_f32_16x16x32_bf16 a[36:39], a[136:139], v[148:151], a[36:39]
    ds_read_b64_tr_b16 a[176:177], v28 offset:57344
    ds_read_b64_tr_b16 a[178:179], v28 offset:61440
    v_exp_f32 v225, v225
    v_mfma_f32_16x16x32_bf16 a[40:43], a[136:139], v[160:163], a[40:43]
    v_cvt_pk_bf16_f32 v134, v224, v225
    v_exp_f32 v226, v226
    v_mfma_f32_16x16x32_bf16 a[44:47], a[136:139], v[172:175], a[44:47]
    ds_read_b64_tr_b16 a[180:181], v29 offset:57344
    ds_read_b64_tr_b16 a[182:183], v29 offset:61440
    v_exp_f32 v227, v227
    v_mfma_f32_16x16x32_bf16 a[48:51], a[140:143], v[136:139], a[48:51]
    v_cvt_pk_bf16_f32 v135, v226, v227
    v_exp_f32 v228, v228
    v_mfma_f32_16x16x32_bf16 a[52:55], a[140:143], v[148:151], a[52:55]
    ds_read_b64_tr_b16 a[184:185], v30 offset:57344
    ds_read_b64_tr_b16 a[186:187], v30 offset:61440
    v_exp_f32 v229, v229
    v_mfma_f32_16x16x32_bf16 a[56:59], a[140:143], v[160:163], a[56:59]
    v_cvt_pk_bf16_f32 v146, v228, v229
    v_exp_f32 v230, v230
    v_mfma_f32_16x16x32_bf16 a[60:63], a[140:143], v[172:175], a[60:63]
    ds_read_b64_tr_b16 a[188:189], v31 offset:57344
    ds_read_b64_tr_b16 a[190:191], v31 offset:61440
    v_exp_f32 v231, v231
    s_waitcnt lgkmcnt(15)
    v_mfma_f32_16x16x32_bf16 a[64:67], a[144:147], v[136:139], a[64:67]
    v_cvt_pk_bf16_f32 v147, v230, v231
    v_exp_f32 v232, v232
    v_mfma_f32_16x16x32_bf16 a[68:71], a[144:147], v[148:151], a[68:71]
    v_exp_f32 v233, v233
    v_mfma_f32_16x16x32_bf16 a[72:75], a[144:147], v[160:163], a[72:75]
    v_cvt_pk_bf16_f32 v158, v232, v233
    v_exp_f32 v234, v234
    v_mfma_f32_16x16x32_bf16 a[76:79], a[144:147], v[172:175], a[76:79]
    v_exp_f32 v235, v235
    v_mfma_f32_16x16x32_bf16 a[80:83], a[148:151], v[136:139], a[80:83]
    v_cvt_pk_bf16_f32 v159, v234, v235
    v_exp_f32 v236, v236
    v_mfma_f32_16x16x32_bf16 a[84:87], a[148:151], v[148:151], a[84:87]
    v_exp_f32 v237, v237
    v_mfma_f32_16x16x32_bf16 a[88:91], a[148:151], v[160:163], a[88:91]
    v_cvt_pk_bf16_f32 v170, v236, v237
    v_exp_f32 v238, v238
    v_mfma_f32_16x16x32_bf16 a[92:95], a[148:151], v[172:175], a[92:95]
    v_exp_f32 v239, v239
    v_mfma_f32_16x16x32_bf16 a[96:99], a[152:155], v[136:139], a[96:99]
    v_cvt_pk_bf16_f32 v171, v238, v239
    v_mfma_f32_16x16x32_bf16 a[100:103], a[152:155], v[148:151], a[100:103]
    v_mfma_f32_16x16x32_bf16 a[104:107], a[152:155], v[160:163], a[104:107]
    v_cvt_pk_bf16_f32 v132, v208, v209
    v_cvt_pk_bf16_f32 v133, v210, v211
    v_mfma_f32_16x16x32_bf16 a[108:111], a[152:155], v[172:175], a[108:111]
    v_cvt_pk_bf16_f32 v144, v212, v213
    v_cvt_pk_bf16_f32 v145, v214, v215
    v_mfma_f32_16x16x32_bf16 a[112:115], a[156:159], v[136:139], a[112:115]
    s_add_u32 m0, s49, 41984
    v_mfma_f32_16x16x32_bf16 a[116:119], a[156:159], v[148:151], a[116:119]
    buffer_load_dwordx4 v57, s[8:11], s46 offen lds
    v_mfma_f32_16x16x32_bf16 a[120:123], a[156:159], v[160:163], a[120:123]
    s_add_u32 m0, s49, 43008
    v_mfma_f32_16x16x32_bf16 a[124:127], a[156:159], v[172:175], a[124:127]
    buffer_load_dwordx4 v58, s[8:11], s46 offen lds
    v_smfmac_f32_16x16x64_bf16 v[240:243], v[32:35], v[132:139], v61
    s_add_u32 m0, s49, 44032
    v_smfmac_f32_16x16x64_bf16 v[244:247], v[32:35], v[144:151], v61
    buffer_load_dwordx4 v59, s[8:11], s46 offen lds
    v_smfmac_f32_16x16x64_bf16 v[248:251], v[32:35], v[156:163], v61
    s_add_u32 m0, s49, 45056
    v_smfmac_f32_16x16x64_bf16 v[252:255], v[32:35], v[168:175], v61
    buffer_load_dwordx4 v60, s[8:11], s46 offen lds
    s_waitcnt lgkmcnt(14)
    v_mfma_f32_16x16x32_bf16 a[0:3], a[160:163], v[132:135], a[0:3]
    s_add_u32 m0, s49, 73728
    v_mfma_f32_16x16x32_bf16 a[4:7], a[160:163], v[144:147], a[4:7]
    buffer_load_dwordx4 v52, s[8:11], s47 offen lds
    v_mfma_f32_16x16x32_bf16 a[8:11], a[160:163], v[156:159], a[8:11]
    s_add_u32 m0, s49, 74752
    v_mfma_f32_16x16x32_bf16 a[12:15], a[160:163], v[168:171], a[12:15]
    buffer_load_dwordx4 v53, s[8:11], s47 offen lds
    s_waitcnt lgkmcnt(12)
    v_mfma_f32_16x16x32_bf16 a[16:19], a[164:167], v[132:135], a[16:19]
    s_add_u32 m0, s49, 75776
    v_mfma_f32_16x16x32_bf16 a[20:23], a[164:167], v[144:147], a[20:23]
    buffer_load_dwordx4 v54, s[8:11], s47 offen lds
    v_mfma_f32_16x16x32_bf16 a[24:27], a[164:167], v[156:159], a[24:27]
    s_add_u32 m0, s49, 76800
    v_mfma_f32_16x16x32_bf16 a[28:31], a[164:167], v[168:171], a[28:31]
    buffer_load_dwordx4 v55, s[8:11], s47 offen lds
    s_waitcnt lgkmcnt(10)
    v_mfma_f32_16x16x32_bf16 a[32:35], a[168:171], v[132:135], a[32:35]
    s_add_u32 m0, s49, 77824
    v_mfma_f32_16x16x32_bf16 a[36:39], a[168:171], v[144:147], a[36:39]
    buffer_load_dwordx4 v56, s[8:11], s47 offen lds
    v_mfma_f32_16x16x32_bf16 a[40:43], a[168:171], v[156:159], a[40:43]
    s_add_u32 m0, s49, 78848
    v_mfma_f32_16x16x32_bf16 a[44:47], a[168:171], v[168:171], a[44:47]
    buffer_load_dwordx4 v57, s[8:11], s47 offen lds
    s_waitcnt lgkmcnt(8)
    v_mfma_f32_16x16x32_bf16 a[48:51], a[172:175], v[132:135], a[48:51]
    s_add_u32 m0, s49, 79872
    v_mfma_f32_16x16x32_bf16 a[52:55], a[172:175], v[144:147], a[52:55]
    buffer_load_dwordx4 v58, s[8:11], s47 offen lds
    v_mfma_f32_16x16x32_bf16 a[56:59], a[172:175], v[156:159], a[56:59]
    s_add_u32 m0, s49, 80896
    v_mfma_f32_16x16x32_bf16 a[60:63], a[172:175], v[168:171], a[60:63]
    buffer_load_dwordx4 v59, s[8:11], s47 offen lds
    s_waitcnt lgkmcnt(6)
    v_mfma_f32_16x16x32_bf16 a[64:67], a[176:179], v[132:135], a[64:67]
    s_add_u32 m0, s49, 81920
    v_mfma_f32_16x16x32_bf16 a[68:71], a[176:179], v[144:147], a[68:71]
    buffer_load_dwordx4 v60, s[8:11], s47 offen lds
    v_mfma_f32_16x16x32_bf16 a[72:75], a[176:179], v[156:159], a[72:75]
    v_mfma_f32_16x16x32_bf16 a[76:79], a[176:179], v[168:171], a[76:79]
    s_waitcnt lgkmcnt(4)
    v_mfma_f32_16x16x32_bf16 a[80:83], a[180:183], v[132:135], a[80:83]
    v_mfma_f32_16x16x32_bf16 a[84:87], a[180:183], v[144:147], a[84:87]
    v_mfma_f32_16x16x32_bf16 a[88:91], a[180:183], v[156:159], a[88:91]
    v_mfma_f32_16x16x32_bf16 a[92:95], a[180:183], v[168:171], a[92:95]
    s_waitcnt lgkmcnt(2)
    v_mfma_f32_16x16x32_bf16 a[96:99], a[184:187], v[132:135], a[96:99]
    v_mfma_f32_16x16x32_bf16 a[100:103], a[184:187], v[144:147], a[100:103]
    v_mfma_f32_16x16x32_bf16 a[104:107], a[184:187], v[156:159], a[104:107]
    v_add_f32 v240, v240, v241
    v_add_f32 v244, v244, v245
    v_mfma_f32_16x16x32_bf16 a[108:111], a[184:187], v[168:171], a[108:111]
    v_add_f32 v248, v248, v249
    v_add_f32 v252, v252, v253
    s_waitcnt lgkmcnt(0)
    v_mfma_f32_16x16x32_bf16 a[112:115], a[188:191], v[132:135], a[112:115]
    v_add_f32 v2, v240, v244
    v_add_f32 v14, v248, v252
    v_mfma_f32_16x16x32_bf16 a[116:119], a[188:191], v[144:147], a[116:119]
    v_add_f32 v2, v2, v14
    v_mfma_f32_16x16x32_bf16 a[120:123], a[188:191], v[156:159], a[120:123]
    v_cmp_nge_f32 vcc, 0x4f800000, v2
    v_mfma_f32_16x16x32_bf16 a[124:127], a[188:191], v[168:171], a[124:127]
    s_cbranch_vccnz L_k2_fallback
L_k2_attn_done:
    v_rcp_f32 v4, v240
    v_rcp_f32 v5, v244
    v_rcp_f32 v6, v248
    v_rcp_f32 v61, v252
    v_mov_b32 v246, v19
    s_lshl_b32 s54, s41, 14
    s_lshl_b32 s7, s44, 7
    s_add_u32 s7, s7, s19
    s_add_u32 s7, s7, 1536
    s_lshl_b32 s3, s43, 7
    s_add_u32 s3, s3, s19
    s_add_u32 s3, s3, 512
    s_add_u32 s68, s66, s3
    s_addc_u32 s69, s67, 0
    s_lshl_b32 s4, s44, 2
    s_add_u32 s3, s3, s4
    s_add_u32 s3, s3, 16
    s_add_u32 s20, s66, s3
    s_addc_u32 s21, s67, 0
    s_lshl_b32 s3, s42, 2
    s_add_u32 s3, s3, s44
    s_mul_i32 s4, s3, 589824
    s_add_u32 s4, s4, 50331648
    s_add_u32 s28, s66, s4
    s_addc_u32 s29, s67, 0
    s_mov_b32 s30, 589824
    s_mov_b32 s31, 0x00020000
    s_lshl_b32 s3, s43, 2
    s_add_u32 s3, s3, s40
    s_mul_i32 s63, s3, 18432
    s_cmp_ge_u32 s43, 4
    s_cbranch_scc0 L_k2_pathO
    s_waitcnt vmcnt(24)
    s_barrier
    ds_read_b64_tr_b16 v[208:209], v8 offset:0
    ds_read_b64_tr_b16 v[210:211], v8 offset:4608
    ds_read_b64_tr_b16 v[212:213], v8 offset:9216
    ds_read_b64_tr_b16 v[214:215], v8 offset:13824
    ds_read_b64_tr_b16 v[216:217], v8 offset:32
    ds_read_b64_tr_b16 v[218:219], v8 offset:4640
    ds_read_b64_tr_b16 v[220:221], v8 offset:9248
    ds_read_b64_tr_b16 v[222:223], v8 offset:13856
    ds_read_b64_tr_b16 v[224:225], v8 offset:64
    ds_read_b64_tr_b16 v[226:227], v8 offset:4672
    ds_read_b64_tr_b16 v[228:229], v8 offset:9280
    ds_read_b64_tr_b16 v[230:231], v8 offset:13888
    s_add_u32 s51, s59, 0
    s_waitcnt lgkmcnt(8)
    v_mfma_f32_16x16x32_bf16 v[64:67], v[208:211], a[192:195], 0
    ds_read_b64_tr_b16 v[232:233], v8 offset:96
    v_mfma_f32_16x16x32_bf16 v[64:67], v[212:215], a[208:211], v[64:67]
    ds_read_b64_tr_b16 v[234:235], v8 offset:4704
    v_mfma_f32_16x16x32_bf16 v[100:103], v[212:215], a[212:215], 0
    buffer_load_dwordx4 a[128:131], v7, s[36:39], s51 offen offset:0 sc1
    v_mfma_f32_16x16x32_bf16 v[100:103], v[208:211], a[196:199], v[100:103]
    v_mfma_f32_16x16x32_bf16 v[136:139], v[208:211], a[200:203], 0
    ds_read_b64_tr_b16 v[236:237], v8 offset:9312
    v_accvgpr_read_b32 v12, a0
    v_mfma_f32_16x16x32_bf16 v[136:139], v[212:215], a[216:219], v[136:139]
    ds_read_b64_tr_b16 v[238:239], v8 offset:13920
    v_accvgpr_read_b32 v13, a1
    v_mfma_f32_16x16x32_bf16 v[172:175], v[212:215], a[220:223], 0
    buffer_load_dwordx4 a[132:135], v7, s[36:39], s51 offen offset:2048 sc1
    v_mfma_f32_16x16x32_bf16 v[172:175], v[208:211], a[204:207], v[172:175]
    v_accvgpr_read_b32 v14, a2
    v_accvgpr_read_b32 v15, a3
    s_waitcnt lgkmcnt(8)
    v_mfma_f32_16x16x32_bf16 v[68:71], v[216:219], a[192:195], 0
    ds_read_b64_tr_b16 v[208:209], v8 offset:128
    v_accvgpr_read_b32 v16, a16
    v_mfma_f32_16x16x32_bf16 v[68:71], v[220:223], a[208:211], v[68:71]
    ds_read_b64_tr_b16 v[210:211], v8 offset:4736
    v_accvgpr_read_b32 v17, a17
    v_mfma_f32_16x16x32_bf16 v[104:107], v[220:223], a[212:215], 0
    buffer_load_dwordx4 a[136:139], v7, s[36:39], s51 offen offset:1024 sc1
    v_mfma_f32_16x16x32_bf16 v[104:107], v[216:219], a[196:199], v[104:107]
    v_accvgpr_read_b32 v18, a18
    v_accvgpr_read_b32 v19, a19
    v_mfma_f32_16x16x32_bf16 v[140:143], v[216:219], a[200:203], 0
    ds_read_b64_tr_b16 v[212:213], v8 offset:9344
    v_mul_f32 v12, v12, v4
    v_mfma_f32_16x16x32_bf16 v[140:143], v[220:223], a[216:219], v[140:143]
    ds_read_b64_tr_b16 v[214:215], v8 offset:13952
    v_mul_f32 v13, v13, v4
    v_mfma_f32_16x16x32_bf16 v[176:179], v[220:223], a[220:223], 0
    buffer_load_dwordx4 a[140:143], v7, s[36:39], s51 offen offset:3072 sc1
    v_mfma_f32_16x16x32_bf16 v[176:179], v[216:219], a[204:207], v[176:179]
    v_mul_f32 v14, v14, v4
    v_mul_f32 v15, v15, v4
    s_waitcnt lgkmcnt(8)
    v_mfma_f32_16x16x32_bf16 v[72:75], v[224:227], a[192:195], 0
    ds_read_b64_tr_b16 v[216:217], v8 offset:160
    v_mul_f32 v16, v16, v4
    v_mfma_f32_16x16x32_bf16 v[72:75], v[228:231], a[208:211], v[72:75]
    ds_read_b64_tr_b16 v[218:219], v8 offset:4768
    v_mul_f32 v17, v17, v4
    v_mfma_f32_16x16x32_bf16 v[108:111], v[228:231], a[212:215], 0
    v_mfma_f32_16x16x32_bf16 v[108:111], v[224:227], a[196:199], v[108:111]
    s_add_u32 s51, s59, 4096
    v_mul_f32 v18, v18, v4
    v_mul_f32 v19, v19, v4
    v_mfma_f32_16x16x32_bf16 v[144:147], v[224:227], a[200:203], 0
    ds_read_b64_tr_b16 v[220:221], v8 offset:9376
    v_cvt_pk_bf16_f32 v28, v12, v13
    v_mfma_f32_16x16x32_bf16 v[144:147], v[228:231], a[216:219], v[144:147]
    ds_read_b64_tr_b16 v[222:223], v8 offset:13984
    v_cvt_pk_bf16_f32 v29, v14, v15
    v_mfma_f32_16x16x32_bf16 v[180:183], v[228:231], a[220:223], 0
    buffer_load_dwordx4 a[144:147], v7, s[36:39], s51 offen offset:0 sc1
    v_mfma_f32_16x16x32_bf16 v[180:183], v[224:227], a[204:207], v[180:183]
    s_add_u32 s6, s54, 0
    v_cvt_pk_bf16_f32 v30, v16, v17
    v_cvt_pk_bf16_f32 v31, v18, v19
    s_waitcnt lgkmcnt(8)
    v_mfma_f32_16x16x32_bf16 v[76:79], v[232:235], a[192:195], 0
    ds_read_b64_tr_b16 v[224:225], v8 offset:192
    v_accvgpr_read_b32 v20, a4
    v_mfma_f32_16x16x32_bf16 v[76:79], v[236:239], a[208:211], v[76:79]
    ds_read_b64_tr_b16 v[226:227], v8 offset:4800
    v_accvgpr_read_b32 v21, a5
    v_mfma_f32_16x16x32_bf16 v[112:115], v[236:239], a[212:215], 0
    buffer_store_dwordx4 v[28:31], v7, s[36:39], s6 offen offset:0 sc1
    v_mfma_f32_16x16x32_bf16 v[112:115], v[232:235], a[196:199], v[112:115]
    v_accvgpr_read_b32 v22, a6
    v_accvgpr_read_b32 v23, a7
    v_mfma_f32_16x16x32_bf16 v[148:151], v[232:235], a[200:203], 0
    ds_read_b64_tr_b16 v[228:229], v8 offset:9408
    v_accvgpr_read_b32 v24, a20
    v_mfma_f32_16x16x32_bf16 v[148:151], v[236:239], a[216:219], v[148:151]
    ds_read_b64_tr_b16 v[230:231], v8 offset:14016
    v_accvgpr_read_b32 v25, a21
    v_mfma_f32_16x16x32_bf16 v[184:187], v[236:239], a[220:223], 0
    buffer_load_dwordx4 a[148:151], v7, s[36:39], s51 offen offset:1024 sc1
    v_mfma_f32_16x16x32_bf16 v[184:187], v[232:235], a[204:207], v[184:187]
    v_accvgpr_read_b32 v26, a22
    v_accvgpr_read_b32 v27, a23
    s_waitcnt lgkmcnt(8)
    v_mfma_f32_16x16x32_bf16 v[80:83], v[208:211], a[192:195], 0
    ds_read_b64_tr_b16 v[232:233], v8 offset:224
    v_mul_f32 v20, v20, v5
    v_mfma_f32_16x16x32_bf16 v[80:83], v[212:215], a[208:211], v[80:83]
    ds_read_b64_tr_b16 v[234:235], v8 offset:4832
    v_mul_f32 v21, v21, v5
    v_mfma_f32_16x16x32_bf16 v[116:119], v[212:215], a[212:215], 0
    buffer_load_dwordx4 a[152:155], v7, s[36:39], s51 offen offset:2048 sc1
    v_mfma_f32_16x16x32_bf16 v[116:119], v[208:211], a[196:199], v[116:119]
    v_mul_f32 v22, v22, v5
    v_mul_f32 v23, v23, v5
    v_mfma_f32_16x16x32_bf16 v[152:155], v[208:211], a[200:203], 0
    ds_read_b64_tr_b16 v[236:237], v8 offset:9440
    v_mul_f32 v24, v24, v5
    v_mfma_f32_16x16x32_bf16 v[152:155], v[212:215], a[216:219], v[152:155]
    ds_read_b64_tr_b16 v[238:239], v8 offset:14048
    v_mul_f32 v25, v25, v5
    v_mfma_f32_16x16x32_bf16 v[188:191], v[212:215], a[220:223], 0
    v_mfma_f32_16x16x32_bf16 v[188:191], v[208:211], a[204:207], v[188:191]
    v_mul_f32 v26, v26, v5
    v_mul_f32 v27, v27, v5
    s_waitcnt lgkmcnt(8)
    v_mfma_f32_16x16x32_bf16 v[84:87], v[216:219], a[192:195], 0
    ds_read_b64_tr_b16 v[208:209], v8 offset:256
    v_cvt_pk_bf16_f32 v32, v20, v21
    v_mfma_f32_16x16x32_bf16 v[84:87], v[220:223], a[208:211], v[84:87]
    ds_read_b64_tr_b16 v[210:211], v8 offset:4864
    v_cvt_pk_bf16_f32 v33, v22, v23
    v_mfma_f32_16x16x32_bf16 v[120:123], v[220:223], a[212:215], 0
    buffer_load_dwordx4 a[156:159], v7, s[36:39], s51 offen offset:3072 sc1
    v_mfma_f32_16x16x32_bf16 v[120:123], v[216:219], a[196:199], v[120:123]
    s_add_u32 s6, s54, 0
    v_cvt_pk_bf16_f32 v34, v24, v25
    v_cvt_pk_bf16_f32 v35, v26, v27
    v_mfma_f32_16x16x32_bf16 v[156:159], v[216:219], a[200:203], 0
    ds_read_b64_tr_b16 v[212:213], v8 offset:9472
    v_accvgpr_read_b32 v12, a8
    v_mfma_f32_16x16x32_bf16 v[156:159], v[220:223], a[216:219], v[156:159]
    ds_read_b64_tr_b16 v[214:215], v8 offset:14080
    v_accvgpr_read_b32 v13, a9
    v_mfma_f32_16x16x32_bf16 v[192:195], v[220:223], a[220:223], 0
    buffer_store_dwordx4 v[32:35], v7, s[36:39], s6 offen offset:1024 sc1
    v_mfma_f32_16x16x32_bf16 v[192:195], v[216:219], a[204:207], v[192:195]
    s_add_u32 s51, s59, 8192
    v_accvgpr_read_b32 v14, a10
    v_accvgpr_read_b32 v15, a11
    s_waitcnt lgkmcnt(8)
    v_mfma_f32_16x16x32_bf16 v[88:91], v[224:227], a[192:195], 0
    ds_read_b64_tr_b16 v[216:217], v8 offset:18432
    v_accvgpr_read_b32 v16, a24
    v_mfma_f32_16x16x32_bf16 v[88:91], v[228:231], a[208:211], v[88:91]
    ds_read_b64_tr_b16 v[218:219], v8 offset:23040
    v_accvgpr_read_b32 v17, a25
    v_mfma_f32_16x16x32_bf16 v[124:127], v[228:231], a[212:215], 0
    buffer_load_dwordx4 a[160:163], v7, s[36:39], s51 offen offset:0 sc1
    v_mfma_f32_16x16x32_bf16 v[124:127], v[224:227], a[196:199], v[124:127]
    v_accvgpr_read_b32 v18, a26
    v_accvgpr_read_b32 v19, a27
    v_mfma_f32_16x16x32_bf16 v[160:163], v[224:227], a[200:203], 0
    ds_read_b64_tr_b16 v[220:221], v8 offset:27648
    v_mul_f32 v12, v12, v6
    v_mfma_f32_16x16x32_bf16 v[160:163], v[228:231], a[216:219], v[160:163]
    ds_read_b64_tr_b16 v[222:223], v8 offset:32256
    v_mul_f32 v13, v13, v6
    v_mfma_f32_16x16x32_bf16 v[196:199], v[228:231], a[220:223], 0
    buffer_load_dwordx4 a[164:167], v7, s[36:39], s51 offen offset:1024 sc1
    v_mfma_f32_16x16x32_bf16 v[196:199], v[224:227], a[204:207], v[196:199]
    v_mul_f32 v14, v14, v6
    v_mul_f32 v15, v15, v6
    s_waitcnt lgkmcnt(8)
    v_mfma_f32_16x16x32_bf16 v[92:95], v[232:235], a[192:195], 0
    ds_read_b64_tr_b16 v[224:225], v8 offset:18464
    v_mul_f32 v16, v16, v6
    v_mfma_f32_16x16x32_bf16 v[92:95], v[236:239], a[208:211], v[92:95]
    ds_read_b64_tr_b16 v[226:227], v8 offset:23072
    v_mul_f32 v17, v17, v6
    v_mfma_f32_16x16x32_bf16 v[128:131], v[236:239], a[212:215], 0
    v_mfma_f32_16x16x32_bf16 v[128:131], v[232:235], a[196:199], v[128:131]
    v_mul_f32 v18, v18, v6
    v_mul_f32 v19, v19, v6
    v_mfma_f32_16x16x32_bf16 v[164:167], v[232:235], a[200:203], 0
    ds_read_b64_tr_b16 v[228:229], v8 offset:27680
    v_cvt_pk_bf16_f32 v36, v12, v13
    v_mfma_f32_16x16x32_bf16 v[164:167], v[236:239], a[216:219], v[164:167]
    ds_read_b64_tr_b16 v[230:231], v8 offset:32288
    v_cvt_pk_bf16_f32 v37, v14, v15
    v_mfma_f32_16x16x32_bf16 v[200:203], v[236:239], a[220:223], 0
    buffer_load_dwordx4 a[168:171], v7, s[36:39], s51 offen offset:2048 sc1
    v_mfma_f32_16x16x32_bf16 v[200:203], v[232:235], a[204:207], v[200:203]
    s_add_u32 s6, s54, 0
    v_cvt_pk_bf16_f32 v38, v16, v17
    v_cvt_pk_bf16_f32 v39, v18, v19
    s_waitcnt lgkmcnt(8)
    v_mfma_f32_16x16x32_bf16 v[96:99], v[208:211], a[192:195], 0
    ds_read_b64_tr_b16 v[232:233], v8 offset:18496
    v_accvgpr_read_b32 v20, a12
    v_mfma_f32_16x16x32_bf16 v[96:99], v[212:215], a[208:211], v[96:99]
    ds_read_b64_tr_b16 v[234:235], v8 offset:23104
    v_accvgpr_read_b32 v21, a13
    v_mfma_f32_16x16x32_bf16 v[132:135], v[212:215], a[212:215], 0
    buffer_store_dwordx4 v[36:39], v7, s[36:39], s6 offen offset:2048 sc1
    v_mfma_f32_16x16x32_bf16 v[132:135], v[208:211], a[196:199], v[132:135]
    v_accvgpr_read_b32 v22, a14
    v_accvgpr_read_b32 v23, a15
    v_mfma_f32_16x16x32_bf16 v[168:171], v[208:211], a[200:203], 0
    ds_read_b64_tr_b16 v[236:237], v8 offset:27712
    v_accvgpr_read_b32 v24, a28
    v_mfma_f32_16x16x32_bf16 v[168:171], v[212:215], a[216:219], v[168:171]
    ds_read_b64_tr_b16 v[238:239], v8 offset:32320
    v_accvgpr_read_b32 v25, a29
    v_mfma_f32_16x16x32_bf16 v[204:207], v[212:215], a[220:223], 0
    buffer_load_dwordx4 a[172:175], v7, s[36:39], s51 offen offset:3072 sc1
    v_mfma_f32_16x16x32_bf16 v[204:207], v[208:211], a[204:207], v[204:207]
    s_add_u32 s51, s59, 12288
    v_accvgpr_read_b32 v26, a30
    v_accvgpr_read_b32 v27, a31
    s_waitcnt vmcnt(37) lgkmcnt(8)
    v_mfma_f32_16x16x32_bf16 v[64:67], v[216:219], a[224:227], v[64:67]
    ds_read_b64_tr_b16 v[208:209], v8 offset:18528
    v_mul_f32 v20, v20, v61
    s_waitcnt vmcnt(33)
    v_mfma_f32_16x16x32_bf16 v[64:67], v[220:223], a[240:243], v[64:67]
    ds_read_b64_tr_b16 v[210:211], v8 offset:23136
    v_mul_f32 v21, v21, v61
    v_mfma_f32_16x16x32_bf16 v[100:103], v[220:223], a[244:247], v[100:103]
    buffer_load_dwordx4 a[176:179], v7, s[36:39], s51 offen offset:0 sc1
    v_mfma_f32_16x16x32_bf16 v[100:103], v[216:219], a[228:231], v[100:103]
    v_mul_f32 v22, v22, v61
    v_mul_f32 v23, v23, v61
    v_mfma_f32_16x16x32_bf16 v[136:139], v[216:219], a[232:235], v[136:139]
    ds_read_b64_tr_b16 v[212:213], v8 offset:27744
    v_mul_f32 v24, v24, v61
    v_mfma_f32_16x16x32_bf16 v[136:139], v[220:223], a[248:251], v[136:139]
    ds_read_b64_tr_b16 v[214:215], v8 offset:32352
    v_mul_f32 v25, v25, v61
    v_mfma_f32_16x16x32_bf16 v[172:175], v[220:223], a[252:255], v[172:175]
    v_mfma_f32_16x16x32_bf16 v[172:175], v[216:219], a[236:239], v[172:175]
    v_mul_f32 v26, v26, v61
    v_mul_f32 v27, v27, v61
    s_waitcnt lgkmcnt(8)
    v_mfma_f32_16x16x32_bf16 v[68:71], v[224:227], a[224:227], v[68:71]
    ds_read_b64_tr_b16 v[216:217], v8 offset:18560
    v_cvt_pk_bf16_f32 v40, v20, v21
    v_mfma_f32_16x16x32_bf16 v[68:71], v[228:231], a[240:243], v[68:71]
    ds_read_b64_tr_b16 v[218:219], v8 offset:23168
    v_cvt_pk_bf16_f32 v41, v22, v23
    v_mfma_f32_16x16x32_bf16 v[104:107], v[228:231], a[244:247], v[104:107]
    buffer_load_dwordx4 a[180:183], v7, s[36:39], s51 offen offset:1024 sc1
    v_mfma_f32_16x16x32_bf16 v[104:107], v[224:227], a[228:231], v[104:107]
    s_add_u32 s6, s54, 0
    v_cvt_pk_bf16_f32 v42, v24, v25
    v_cvt_pk_bf16_f32 v43, v26, v27
    v_mfma_f32_16x16x32_bf16 v[140:143], v[224:227], a[232:235], v[140:143]
    ds_read_b64_tr_b16 v[220:221], v8 offset:27776
    v_accvgpr_read_b32 v12, a32
    v_mfma_f32_16x16x32_bf16 v[140:143], v[228:231], a[248:251], v[140:143]
    ds_read_b64_tr_b16 v[222:223], v8 offset:32384
    v_accvgpr_read_b32 v13, a33
    v_mfma_f32_16x16x32_bf16 v[176:179], v[228:231], a[252:255], v[176:179]
    buffer_store_dwordx4 v[40:43], v7, s[36:39], s6 offen offset:3072 sc1
    v_mfma_f32_16x16x32_bf16 v[176:179], v[224:227], a[236:239], v[176:179]
    v_accvgpr_read_b32 v14, a34
    v_accvgpr_read_b32 v15, a35
    s_waitcnt lgkmcnt(8)
    v_mfma_f32_16x16x32_bf16 v[72:75], v[232:235], a[224:227], v[72:75]
    ds_read_b64_tr_b16 v[224:225], v8 offset:18592
    v_accvgpr_read_b32 v16, a48
    v_mfma_f32_16x16x32_bf16 v[72:75], v[236:239], a[240:243], v[72:75]
    ds_read_b64_tr_b16 v[226:227], v8 offset:23200
    v_accvgpr_read_b32 v17, a49
    v_mfma_f32_16x16x32_bf16 v[108:111], v[236:239], a[244:247], v[108:111]
    buffer_load_dwordx4 a[184:187], v7, s[36:39], s51 offen offset:2048 sc1
    v_mfma_f32_16x16x32_bf16 v[108:111], v[232:235], a[228:231], v[108:111]
    v_accvgpr_read_b32 v18, a50
    v_accvgpr_read_b32 v19, a51
    v_mfma_f32_16x16x32_bf16 v[144:147], v[232:235], a[232:235], v[144:147]
    ds_read_b64_tr_b16 v[228:229], v8 offset:27808
    v_mul_f32 v12, v12, v4
    v_mfma_f32_16x16x32_bf16 v[144:147], v[236:239], a[248:251], v[144:147]
    ds_read_b64_tr_b16 v[230:231], v8 offset:32416
    v_mul_f32 v13, v13, v4
    v_mfma_f32_16x16x32_bf16 v[180:183], v[236:239], a[252:255], v[180:183]
    buffer_load_dwordx4 a[188:191], v7, s[36:39], s51 offen offset:3072 sc1
    v_mfma_f32_16x16x32_bf16 v[180:183], v[232:235], a[236:239], v[180:183]
    v_mul_f32 v14, v14, v4
    v_mul_f32 v15, v15, v4
    s_waitcnt lgkmcnt(8)
    v_mfma_f32_16x16x32_bf16 v[76:79], v[208:211], a[224:227], v[76:79]
    ds_read_b64_tr_b16 v[232:233], v8 offset:18624
    v_mul_f32 v16, v16, v4
    v_mfma_f32_16x16x32_bf16 v[76:79], v[212:215], a[240:243], v[76:79]
    ds_read_b64_tr_b16 v[234:235], v8 offset:23232
    v_mul_f32 v17, v17, v4
    v_mfma_f32_16x16x32_bf16 v[112:115], v[212:215], a[244:247], v[112:115]
    v_mfma_f32_16x16x32_bf16 v[112:115], v[208:211], a[228:231], v[112:115]
    s_add_u32 s51, s60, 0
    v_mul_f32 v18, v18, v4
    v_mul_f32 v19, v19, v4
    v_mfma_f32_16x16x32_bf16 v[148:151], v[208:211], a[232:235], v[148:151]
    ds_read_b64_tr_b16 v[236:237], v8 offset:27840
    v_cvt_pk_bf16_f32 v28, v12, v13
    v_mfma_f32_16x16x32_bf16 v[148:151], v[212:215], a[248:251], v[148:151]
    ds_read_b64_tr_b16 v[238:239], v8 offset:32448
    v_cvt_pk_bf16_f32 v29, v14, v15
    v_mfma_f32_16x16x32_bf16 v[184:187], v[212:215], a[252:255], v[184:187]
    buffer_load_dwordx4 a[0:3], v7, s[36:39], s51 offen offset:0 sc1
    v_mfma_f32_16x16x32_bf16 v[184:187], v[208:211], a[236:239], v[184:187]
    s_add_u32 s6, s54, 4096
    v_cvt_pk_bf16_f32 v30, v16, v17
    v_cvt_pk_bf16_f32 v31, v18, v19
    s_waitcnt lgkmcnt(8)
    v_mfma_f32_16x16x32_bf16 v[80:83], v[216:219], a[224:227], v[80:83]
    ds_read_b64_tr_b16 v[208:209], v8 offset:18656
    v_accvgpr_read_b32 v20, a36
    v_mfma_f32_16x16x32_bf16 v[80:83], v[220:223], a[240:243], v[80:83]
    ds_read_b64_tr_b16 v[210:211], v8 offset:23264
    v_accvgpr_read_b32 v21, a37
    v_mfma_f32_16x16x32_bf16 v[116:119], v[220:223], a[244:247], v[116:119]
    buffer_store_dwordx4 v[28:31], v7, s[36:39], s6 offen offset:0 sc1
    v_mfma_f32_16x16x32_bf16 v[116:119], v[216:219], a[228:231], v[116:119]
    v_accvgpr_read_b32 v22, a38
    v_accvgpr_read_b32 v23, a39
    v_mfma_f32_16x16x32_bf16 v[152:155], v[216:219], a[232:235], v[152:155]
    ds_read_b64_tr_b16 v[212:213], v8 offset:27872
    v_accvgpr_read_b32 v24, a52
    v_mfma_f32_16x16x32_bf16 v[152:155], v[220:223], a[248:251], v[152:155]
    ds_read_b64_tr_b16 v[214:215], v8 offset:32480
    v_accvgpr_read_b32 v25, a53
    v_mfma_f32_16x16x32_bf16 v[188:191], v[220:223], a[252:255], v[188:191]
    buffer_load_dwordx4 a[4:7], v7, s[36:39], s51 offen offset:1024 sc1
    v_mfma_f32_16x16x32_bf16 v[188:191], v[216:219], a[236:239], v[188:191]
    v_accvgpr_read_b32 v26, a54
    v_accvgpr_read_b32 v27, a55
    s_waitcnt lgkmcnt(8)
    v_mfma_f32_16x16x32_bf16 v[84:87], v[224:227], a[224:227], v[84:87]
    ds_read_b64_tr_b16 v[216:217], v8 offset:18688
    v_mul_f32 v20, v20, v5
    v_mfma_f32_16x16x32_bf16 v[84:87], v[228:231], a[240:243], v[84:87]
    ds_read_b64_tr_b16 v[218:219], v8 offset:23296
    v_mul_f32 v21, v21, v5
    v_mfma_f32_16x16x32_bf16 v[120:123], v[228:231], a[244:247], v[120:123]
    buffer_load_dwordx4 a[8:11], v7, s[36:39], s51 offen offset:2048 sc1
    v_mfma_f32_16x16x32_bf16 v[120:123], v[224:227], a[228:231], v[120:123]
    v_mul_f32 v22, v22, v5
    v_mul_f32 v23, v23, v5
    v_mfma_f32_16x16x32_bf16 v[156:159], v[224:227], a[232:235], v[156:159]
    ds_read_b64_tr_b16 v[220:221], v8 offset:27904
    s_waitcnt vmcnt(20)
    v_accvgpr_read_b32 v240, a130
    v_mfma_f32_16x16x32_bf16 v[156:159], v[228:231], a[248:251], v[156:159]
    ds_read_b64_tr_b16 v[222:223], v8 offset:32512
    v_accvgpr_read_b32 v241, a131
    v_mfma_f32_16x16x32_bf16 v[192:195], v[228:231], a[252:255], v[192:195]
    v_mfma_f32_16x16x32_bf16 v[192:195], v[224:227], a[236:239], v[192:195]
    v_accvgpr_mov_b32 a130, a132
    v_accvgpr_mov_b32 a131, a133
    s_waitcnt lgkmcnt(8)
    v_mfma_f32_16x16x32_bf16 v[88:91], v[232:235], a[224:227], v[88:91]
    v_accvgpr_write_b32 a132, v240
    v_mfma_f32_16x16x32_bf16 v[88:91], v[236:239], a[240:243], v[88:91]
    v_accvgpr_write_b32 a133, v241
    v_mfma_f32_16x16x32_bf16 v[124:127], v[236:239], a[244:247], v[124:127]
    buffer_load_dwordx4 a[12:15], v7, s[36:39], s51 offen offset:3072 sc1
    v_mfma_f32_16x16x32_bf16 v[124:127], v[232:235], a[228:231], v[124:127]
    s_add_u32 s51, s60, 4096
    v_accvgpr_read_b32 v240, a138
    v_accvgpr_read_b32 v241, a139
    v_mfma_f32_16x16x32_bf16 v[160:163], v[232:235], a[232:235], v[160:163]
    v_accvgpr_mov_b32 a138, a140
    v_mfma_f32_16x16x32_bf16 v[160:163], v[236:239], a[248:251], v[160:163]
    v_accvgpr_mov_b32 a139, a141
    v_mfma_f32_16x16x32_bf16 v[196:199], v[236:239], a[252:255], v[196:199]
    buffer_load_dwordx4 a[16:19], v7, s[36:39], s51 offen offset:0 sc1
    v_mfma_f32_16x16x32_bf16 v[196:199], v[232:235], a[236:239], v[196:199]
    v_accvgpr_write_b32 a140, v240
    v_accvgpr_write_b32 a141, v241
    s_waitcnt lgkmcnt(0)
    s_barrier
    v_mfma_f32_16x16x32_bf16 v[92:95], v[208:211], a[224:227], v[92:95]
    ds_read_b64_tr_b16 v[224:225], v9 offset:0
    ds_read_b64_tr_b16 v[226:227], v9 offset:4608
    v_mfma_f32_16x16x32_bf16 v[92:95], v[212:215], a[240:243], v[92:95]
    ds_read_b64_tr_b16 v[228:229], v9 offset:9216
    ds_read_b64_tr_b16 v[230:231], v9 offset:13824
    v_mfma_f32_16x16x32_bf16 v[128:131], v[212:215], a[244:247], v[128:131]
    ds_read_b64_tr_b16 v[232:233], v9 offset:32
    ds_read_b64_tr_b16 v[234:235], v9 offset:4640
    v_mfma_f32_16x16x32_bf16 v[128:131], v[208:211], a[228:231], v[128:131]
    v_mul_f32 v24, v24, v5
    v_mul_f32 v25, v25, v5
    v_mfma_f32_16x16x32_bf16 v[164:167], v[208:211], a[232:235], v[164:167]
    ds_read_b64_tr_b16 v[236:237], v9 offset:9248
    v_mul_f32 v26, v26, v5
    v_mfma_f32_16x16x32_bf16 v[164:167], v[212:215], a[248:251], v[164:167]
    ds_read_b64_tr_b16 v[238:239], v9 offset:13856
    v_mul_f32 v27, v27, v5
    v_mfma_f32_16x16x32_bf16 v[200:203], v[212:215], a[252:255], v[200:203]
    buffer_load_dwordx4 a[20:23], v7, s[36:39], s51 offen offset:1024 sc1
    v_mfma_f32_16x16x32_bf16 v[200:203], v[208:211], a[236:239], v[200:203]
    v_cvt_pk_bf16_f32 v32, v20, v21
    v_cvt_pk_bf16_f32 v33, v22, v23
    v_mfma_f32_16x16x32_bf16 v[96:99], v[216:219], a[224:227], v[96:99]
    ds_read_b64_tr_b16 v[208:209], v9 offset:64
    v_cvt_pk_bf16_f32 v34, v24, v25
    v_mfma_f32_16x16x32_bf16 v[96:99], v[220:223], a[240:243], v[96:99]
    ds_read_b64_tr_b16 v[210:211], v9 offset:4672
    v_cvt_pk_bf16_f32 v35, v26, v27
    v_mfma_f32_16x16x32_bf16 v[132:135], v[220:223], a[244:247], v[132:135]
    buffer_load_dwordx4 a[24:27], v7, s[36:39], s51 offen offset:2048 sc1
    v_mfma_f32_16x16x32_bf16 v[132:135], v[216:219], a[228:231], v[132:135]
    s_add_u32 s6, s54, 4096
    v_accvgpr_read_b32 v12, a40
    v_accvgpr_read_b32 v13, a41
    v_mfma_f32_16x16x32_bf16 v[168:171], v[216:219], a[232:235], v[168:171]
    ds_read_b64_tr_b16 v[212:213], v9 offset:9280
    v_accvgpr_read_b32 v14, a42
    v_mfma_f32_16x16x32_bf16 v[168:171], v[220:223], a[248:251], v[168:171]
    ds_read_b64_tr_b16 v[214:215], v9 offset:13888
    v_accvgpr_read_b32 v15, a43
    v_mfma_f32_16x16x32_bf16 v[204:207], v[220:223], a[252:255], v[204:207]
    buffer_store_dwordx4 v[32:35], v7, s[36:39], s6 offen offset:1024 sc1
    v_mfma_f32_16x16x32_bf16 v[204:207], v[216:219], a[236:239], v[204:207]
    v_accvgpr_read_b32 v16, a56
    v_accvgpr_read_b32 v17, a57
    s_waitcnt lgkmcnt(8)
    v_mfma_f32_16x16x32_bf16 v[64:67], v[224:227], a[128:131], v[64:67]
    ds_read_b64_tr_b16 v[216:217], v9 offset:96
    v_accvgpr_read_b32 v18, a58
    s_waitcnt vmcnt(20)
    v_mfma_f32_16x16x32_bf16 v[64:67], v[228:231], a[144:147], v[64:67]
    ds_read_b64_tr_b16 v[218:219], v9 offset:4704
    v_accvgpr_read_b32 v19, a59
    v_mfma_f32_16x16x32_bf16 v[100:103], v[228:231], a[148:151], v[100:103]
    buffer_load_dwordx4 a[28:31], v7, s[36:39], s51 offen offset:3072 sc1
    v_mfma_f32_16x16x32_bf16 v[100:103], v[224:227], a[132:135], v[100:103]
    v_mul_f32 v12, v12, v6
    v_mul_f32 v13, v13, v6
    v_mfma_f32_16x16x32_bf16 v[136:139], v[224:227], a[136:139], v[136:139]
    ds_read_b64_tr_b16 v[220:221], v9 offset:9312
    v_mul_f32 v14, v14, v6
    v_mfma_f32_16x16x32_bf16 v[136:139], v[228:231], a[152:155], v[136:139]
    ds_read_b64_tr_b16 v[222:223], v9 offset:13920
    v_mul_f32 v15, v15, v6
    v_mfma_f32_16x16x32_bf16 v[172:175], v[228:231], a[156:159], v[172:175]
    v_mfma_f32_16x16x32_bf16 v[172:175], v[224:227], a[140:143], v[172:175]
    s_add_u32 m0, s49, 110592
    v_mul_f32 v16, v16, v6
    v_mul_f32 v17, v17, v6
    s_waitcnt lgkmcnt(8)
    v_mfma_f32_16x16x32_bf16 v[68:71], v[232:235], a[128:131], v[68:71]
    ds_read_b64_tr_b16 v[224:225], v9 offset:128
    v_mul_f32 v18, v18, v6
    v_mfma_f32_16x16x32_bf16 v[68:71], v[236:239], a[144:147], v[68:71]
    ds_read_b64_tr_b16 v[226:227], v9 offset:4736
    v_mul_f32 v19, v19, v6
    v_mfma_f32_16x16x32_bf16 v[104:107], v[236:239], a[148:151], v[104:107]
    buffer_load_dwordx4 v52, s[8:11], s48 offen lds
    v_mfma_f32_16x16x32_bf16 v[104:107], v[232:235], a[132:135], v[104:107]
    s_add_u32 m0, s49, 111616
    v_cvt_pk_bf16_f32 v36, v12, v13
    v_cvt_pk_bf16_f32 v37, v14, v15
    v_mfma_f32_16x16x32_bf16 v[140:143], v[232:235], a[136:139], v[140:143]
    ds_read_b64_tr_b16 v[228:229], v9 offset:9344
    v_cvt_pk_bf16_f32 v38, v16, v17
    v_mfma_f32_16x16x32_bf16 v[140:143], v[236:239], a[152:155], v[140:143]
    ds_read_b64_tr_b16 v[230:231], v9 offset:13952
    v_cvt_pk_bf16_f32 v39, v18, v19
    v_mfma_f32_16x16x32_bf16 v[176:179], v[236:239], a[156:159], v[176:179]
    buffer_load_dwordx4 v53, s[8:11], s48 offen lds
    v_mfma_f32_16x16x32_bf16 v[176:179], v[232:235], a[140:143], v[176:179]
    s_add_u32 s6, s54, 4096
    v_accvgpr_read_b32 v20, a44
    v_accvgpr_read_b32 v21, a45
    s_waitcnt lgkmcnt(8)
    v_mfma_f32_16x16x32_bf16 v[72:75], v[208:211], a[128:131], v[72:75]
    ds_read_b64_tr_b16 v[232:233], v9 offset:160
    v_accvgpr_read_b32 v22, a46
    v_mfma_f32_16x16x32_bf16 v[72:75], v[212:215], a[144:147], v[72:75]
    ds_read_b64_tr_b16 v[234:235], v9 offset:4768
    v_accvgpr_read_b32 v23, a47
    v_mfma_f32_16x16x32_bf16 v[108:111], v[212:215], a[148:151], v[108:111]
    buffer_store_dwordx4 v[36:39], v7, s[36:39], s6 offen offset:2048 sc1
    v_mfma_f32_16x16x32_bf16 v[108:111], v[208:211], a[132:135], v[108:111]
    s_add_u32 m0, s49, 112640
    v_accvgpr_read_b32 v24, a60
    v_accvgpr_read_b32 v25, a61
    v_mfma_f32_16x16x32_bf16 v[144:147], v[208:211], a[136:139], v[144:147]
    ds_read_b64_tr_b16 v[236:237], v9 offset:9376
    v_accvgpr_read_b32 v26, a62
    v_mfma_f32_16x16x32_bf16 v[144:147], v[212:215], a[152:155], v[144:147]
    ds_read_b64_tr_b16 v[238:239], v9 offset:13984
    v_accvgpr_read_b32 v27, a63
    v_mfma_f32_16x16x32_bf16 v[180:183], v[212:215], a[156:159], v[180:183]
    buffer_load_dwordx4 v54, s[8:11], s48 offen lds
    v_mfma_f32_16x16x32_bf16 v[180:183], v[208:211], a[140:143], v[180:183]
    v_mul_f32 v20, v20, v61
    v_mul_f32 v21, v21, v61
    s_waitcnt lgkmcnt(8)
    v_mfma_f32_16x16x32_bf16 v[76:79], v[216:219], a[128:131], v[76:79]
    ds_read_b64_tr_b16 v[208:209], v9 offset:192
    v_mul_f32 v22, v22, v61
    v_mfma_f32_16x16x32_bf16 v[76:79], v[220:223], a[144:147], v[76:79]
    ds_read_b64_tr_b16 v[210:211], v9 offset:4800
    v_mul_f32 v23, v23, v61
    v_mfma_f32_16x16x32_bf16 v[112:115], v[220:223], a[148:151], v[112:115]
    v_mfma_f32_16x16x32_bf16 v[112:115], v[216:219], a[132:135], v[112:115]
    s_add_u32 m0, s49, 113664
    v_mul_f32 v24, v24, v61
    v_mul_f32 v25, v25, v61
    v_mfma_f32_16x16x32_bf16 v[148:151], v[216:219], a[136:139], v[148:151]
    ds_read_b64_tr_b16 v[212:213], v9 offset:9408
    v_mul_f32 v26, v26, v61
    v_mfma_f32_16x16x32_bf16 v[148:151], v[220:223], a[152:155], v[148:151]
    ds_read_b64_tr_b16 v[214:215], v9 offset:14016
    v_mul_f32 v27, v27, v61
    v_mfma_f32_16x16x32_bf16 v[184:187], v[220:223], a[156:159], v[184:187]
    buffer_load_dwordx4 v55, s[8:11], s48 offen lds
    v_mfma_f32_16x16x32_bf16 v[184:187], v[216:219], a[140:143], v[184:187]
    s_add_u32 m0, s49, 114688
    v_cvt_pk_bf16_f32 v40, v20, v21
    v_cvt_pk_bf16_f32 v41, v22, v23
    s_waitcnt lgkmcnt(8)
    v_mfma_f32_16x16x32_bf16 v[80:83], v[224:227], a[128:131], v[80:83]
    ds_read_b64_tr_b16 v[216:217], v9 offset:224
    v_cvt_pk_bf16_f32 v42, v24, v25
    v_mfma_f32_16x16x32_bf16 v[80:83], v[228:231], a[144:147], v[80:83]
    ds_read_b64_tr_b16 v[218:219], v9 offset:4832
    v_cvt_pk_bf16_f32 v43, v26, v27
    v_mfma_f32_16x16x32_bf16 v[116:119], v[228:231], a[148:151], v[116:119]
    buffer_load_dwordx4 v56, s[8:11], s48 offen lds
    v_mfma_f32_16x16x32_bf16 v[116:119], v[224:227], a[132:135], v[116:119]
    s_add_u32 s6, s54, 4096
    v_accvgpr_read_b32 v12, a64
    v_accvgpr_read_b32 v13, a65
    v_mfma_f32_16x16x32_bf16 v[152:155], v[224:227], a[136:139], v[152:155]
    ds_read_b64_tr_b16 v[220:221], v9 offset:9440
    v_accvgpr_read_b32 v14, a66
    v_mfma_f32_16x16x32_bf16 v[152:155], v[228:231], a[152:155], v[152:155]
    ds_read_b64_tr_b16 v[222:223], v9 offset:14048
    v_accvgpr_read_b32 v15, a67
    v_mfma_f32_16x16x32_bf16 v[188:191], v[228:231], a[156:159], v[188:191]
    buffer_store_dwordx4 v[40:43], v7, s[36:39], s6 offen offset:3072 sc1
    v_mfma_f32_16x16x32_bf16 v[188:191], v[224:227], a[140:143], v[188:191]
    s_add_u32 s51, s60, 8192
    v_accvgpr_read_b32 v16, a80
    v_accvgpr_read_b32 v17, a81
    s_waitcnt lgkmcnt(8)
    v_mfma_f32_16x16x32_bf16 v[84:87], v[232:235], a[128:131], v[84:87]
    ds_read_b64_tr_b16 v[224:225], v9 offset:256
    v_accvgpr_read_b32 v18, a82
    v_mfma_f32_16x16x32_bf16 v[84:87], v[236:239], a[144:147], v[84:87]
    ds_read_b64_tr_b16 v[226:227], v9 offset:4864
    v_accvgpr_read_b32 v19, a83
    v_mfma_f32_16x16x32_bf16 v[120:123], v[236:239], a[148:151], v[120:123]
    buffer_load_dwordx4 a[32:35], v7, s[36:39], s51 offen offset:0 sc1
    v_mfma_f32_16x16x32_bf16 v[120:123], v[232:235], a[132:135], v[120:123]
    v_mul_f32 v12, v12, v4
    v_mul_f32 v13, v13, v4
    v_mfma_f32_16x16x32_bf16 v[156:159], v[232:235], a[136:139], v[156:159]
    ds_read_b64_tr_b16 v[228:229], v9 offset:9472
    v_mul_f32 v14, v14, v4
    v_mfma_f32_16x16x32_bf16 v[156:159], v[236:239], a[152:155], v[156:159]
    ds_read_b64_tr_b16 v[230:231], v9 offset:14080
    v_mul_f32 v15, v15, v4
    v_mfma_f32_16x16x32_bf16 v[192:195], v[236:239], a[156:159], v[192:195]
    v_mfma_f32_16x16x32_bf16 v[192:195], v[232:235], a[140:143], v[192:195]
    v_mul_f32 v16, v16, v4
    v_mul_f32 v17, v17, v4
    s_waitcnt lgkmcnt(8)
    v_mfma_f32_16x16x32_bf16 v[88:91], v[208:211], a[128:131], v[88:91]
    ds_read_b64_tr_b16 v[232:233], v9 offset:18432
    v_mul_f32 v18, v18, v4
    v_mfma_f32_16x16x32_bf16 v[88:91], v[212:215], a[144:147], v[88:91]
    ds_read_b64_tr_b16 v[234:235], v9 offset:23040
    v_mul_f32 v19, v19, v4
    v_mfma_f32_16x16x32_bf16 v[124:127], v[212:215], a[148:151], v[124:127]
    buffer_load_dwordx4 a[36:39], v7, s[36:39], s51 offen offset:1024 sc1
    v_mfma_f32_16x16x32_bf16 v[124:127], v[208:211], a[132:135], v[124:127]
    v_cvt_pk_bf16_f32 v28, v12, v13
    v_cvt_pk_bf16_f32 v29, v14, v15
    v_mfma_f32_16x16x32_bf16 v[160:163], v[208:211], a[136:139], v[160:163]
    ds_read_b64_tr_b16 v[236:237], v9 offset:27648
    v_cvt_pk_bf16_f32 v30, v16, v17
    v_mfma_f32_16x16x32_bf16 v[160:163], v[212:215], a[152:155], v[160:163]
    ds_read_b64_tr_b16 v[238:239], v9 offset:32256
    v_cvt_pk_bf16_f32 v31, v18, v19
    v_mfma_f32_16x16x32_bf16 v[196:199], v[212:215], a[156:159], v[196:199]
    buffer_load_dwordx4 a[40:43], v7, s[36:39], s51 offen offset:2048 sc1
    v_mfma_f32_16x16x32_bf16 v[196:199], v[208:211], a[140:143], v[196:199]
    s_add_u32 s6, s54, 8192
    v_accvgpr_read_b32 v20, a68
    v_accvgpr_read_b32 v21, a69
    s_waitcnt lgkmcnt(8)
    v_mfma_f32_16x16x32_bf16 v[92:95], v[216:219], a[128:131], v[92:95]
    ds_read_b64_tr_b16 v[208:209], v9 offset:18464
    v_accvgpr_read_b32 v22, a70
    v_mfma_f32_16x16x32_bf16 v[92:95], v[220:223], a[144:147], v[92:95]
    ds_read_b64_tr_b16 v[210:211], v9 offset:23072
    v_accvgpr_read_b32 v23, a71
    v_mfma_f32_16x16x32_bf16 v[128:131], v[220:223], a[148:151], v[128:131]
    buffer_store_dwordx4 v[28:31], v7, s[36:39], s6 offen offset:0 sc1
    v_mfma_f32_16x16x32_bf16 v[128:131], v[216:219], a[132:135], v[128:131]
    v_accvgpr_read_b32 v24, a84
    v_accvgpr_read_b32 v25, a85
    v_mfma_f32_16x16x32_bf16 v[164:167], v[216:219], a[136:139], v[164:167]
    ds_read_b64_tr_b16 v[212:213], v9 offset:27680
    v_accvgpr_read_b32 v26, a86
    v_mfma_f32_16x16x32_bf16 v[164:167], v[220:223], a[152:155], v[164:167]
    ds_read_b64_tr_b16 v[214:215], v9 offset:32288
    v_accvgpr_read_b32 v27, a87
    v_mfma_f32_16x16x32_bf16 v[200:203], v[220:223], a[156:159], v[200:203]
    buffer_load_dwordx4 a[44:47], v7, s[36:39], s51 offen offset:3072 sc1
    v_mfma_f32_16x16x32_bf16 v[200:203], v[216:219], a[140:143], v[200:203]
    v_mul_f32 v20, v20, v5
    v_mul_f32 v21, v21, v5
    s_waitcnt lgkmcnt(8)
    v_mfma_f32_16x16x32_bf16 v[96:99], v[224:227], a[128:131], v[96:99]
    ds_read_b64_tr_b16 v[216:217], v9 offset:18496
    v_mul_f32 v22, v22, v5
    v_mfma_f32_16x16x32_bf16 v[96:99], v[228:231], a[144:147], v[96:99]
    ds_read_b64_tr_b16 v[218:219], v9 offset:23104
    v_mul_f32 v23, v23, v5
    v_mfma_f32_16x16x32_bf16 v[132:135], v[228:231], a[148:151], v[132:135]
    v_mfma_f32_16x16x32_bf16 v[132:135], v[224:227], a[132:135], v[132:135]
    s_add_u32 s51, s60, 12288
    v_mul_f32 v24, v24, v5
    v_mul_f32 v25, v25, v5
    v_mfma_f32_16x16x32_bf16 v[168:171], v[224:227], a[136:139], v[168:171]
    ds_read_b64_tr_b16 v[220:221], v9 offset:27712
    v_mul_f32 v26, v26, v5
    v_mfma_f32_16x16x32_bf16 v[168:171], v[228:231], a[152:155], v[168:171]
    ds_read_b64_tr_b16 v[222:223], v9 offset:32320
    v_mul_f32 v27, v27, v5
    v_mfma_f32_16x16x32_bf16 v[204:207], v[228:231], a[156:159], v[204:207]
    buffer_load_dwordx4 a[48:51], v7, s[36:39], s51 offen offset:0 sc1
    v_mfma_f32_16x16x32_bf16 v[204:207], v[224:227], a[140:143], v[204:207]
    v_cvt_pk_bf16_f32 v32, v20, v21
    v_cvt_pk_bf16_f32 v33, v22, v23
    s_waitcnt vmcnt(28) lgkmcnt(8)
    v_mfma_f32_16x16x32_bf16 v[64:67], v[232:235], a[160:163], v[64:67]
    ds_read_b64_tr_b16 v[224:225], v9 offset:18528
    v_cvt_pk_bf16_f32 v34, v24, v25
    s_waitcnt vmcnt(23)
    v_mfma_f32_16x16x32_bf16 v[64:67], v[236:239], a[176:179], v[64:67]
    ds_read_b64_tr_b16 v[226:227], v9 offset:23136
    v_cvt_pk_bf16_f32 v35, v26, v27
    v_mfma_f32_16x16x32_bf16 v[100:103], v[236:239], a[180:183], v[100:103]
    buffer_load_dwordx4 a[52:55], v7, s[36:39], s51 offen offset:1024 sc1
    v_mfma_f32_16x16x32_bf16 v[100:103], v[232:235], a[164:167], v[100:103]
    s_add_u32 s6, s54, 8192
    v_accvgpr_read_b32 v12, a72
    v_accvgpr_read_b32 v13, a73
    v_mfma_f32_16x16x32_bf16 v[136:139], v[232:235], a[168:171], v[136:139]
    ds_read_b64_tr_b16 v[228:229], v9 offset:27744
    v_accvgpr_read_b32 v14, a74
    v_mfma_f32_16x16x32_bf16 v[136:139], v[236:239], a[184:187], v[136:139]
    ds_read_b64_tr_b16 v[230:231], v9 offset:32352
    v_accvgpr_read_b32 v15, a75
    v_mfma_f32_16x16x32_bf16 v[172:175], v[236:239], a[188:191], v[172:175]
    buffer_store_dwordx4 v[32:35], v7, s[36:39], s6 offen offset:1024 sc1
    v_mfma_f32_16x16x32_bf16 v[172:175], v[232:235], a[172:175], v[172:175]
    v_accvgpr_read_b32 v16, a88
    v_accvgpr_read_b32 v17, a89
    s_waitcnt lgkmcnt(8)
    v_mfma_f32_16x16x32_bf16 v[68:71], v[208:211], a[160:163], v[68:71]
    ds_read_b64_tr_b16 v[232:233], v9 offset:18560
    v_accvgpr_read_b32 v18, a90
    v_mfma_f32_16x16x32_bf16 v[68:71], v[212:215], a[176:179], v[68:71]
    ds_read_b64_tr_b16 v[234:235], v9 offset:23168
    v_accvgpr_read_b32 v19, a91
    v_mfma_f32_16x16x32_bf16 v[104:107], v[212:215], a[180:183], v[104:107]
    buffer_load_dwordx4 a[56:59], v7, s[36:39], s51 offen offset:2048 sc1
    v_mfma_f32_16x16x32_bf16 v[104:107], v[208:211], a[164:167], v[104:107]
    v_mul_f32 v12, v12, v6
    v_mul_f32 v13, v13, v6
    v_mfma_f32_16x16x32_bf16 v[140:143], v[208:211], a[168:171], v[140:143]
    ds_read_b64_tr_b16 v[236:237], v9 offset:27776
    v_mul_f32 v14, v14, v6
    v_mfma_f32_16x16x32_bf16 v[140:143], v[212:215], a[184:187], v[140:143]
    ds_read_b64_tr_b16 v[238:239], v9 offset:32384
    v_mul_f32 v15, v15, v6
    v_mfma_f32_16x16x32_bf16 v[176:179], v[212:215], a[188:191], v[176:179]
    v_mfma_f32_16x16x32_bf16 v[176:179], v[208:211], a[172:175], v[176:179]
    v_mul_f32 v16, v16, v6
    v_mul_f32 v17, v17, v6
    s_waitcnt lgkmcnt(8)
    v_mfma_f32_16x16x32_bf16 v[72:75], v[216:219], a[160:163], v[72:75]
    ds_read_b64_tr_b16 v[208:209], v9 offset:18592
    v_mul_f32 v18, v18, v6
    v_mfma_f32_16x16x32_bf16 v[72:75], v[220:223], a[176:179], v[72:75]
    ds_read_b64_tr_b16 v[210:211], v9 offset:23200
    v_mul_f32 v19, v19, v6
    v_mfma_f32_16x16x32_bf16 v[108:111], v[220:223], a[180:183], v[108:111]
    buffer_load_dwordx4 a[60:63], v7, s[36:39], s51 offen offset:3072 sc1
    v_mfma_f32_16x16x32_bf16 v[108:111], v[216:219], a[164:167], v[108:111]
    s_add_u32 m0, s49, 115712
    v_cvt_pk_bf16_f32 v36, v12, v13
    v_cvt_pk_bf16_f32 v37, v14, v15
    v_mfma_f32_16x16x32_bf16 v[144:147], v[216:219], a[168:171], v[144:147]
    ds_read_b64_tr_b16 v[212:213], v9 offset:27808
    v_cvt_pk_bf16_f32 v38, v16, v17
    v_mfma_f32_16x16x32_bf16 v[144:147], v[220:223], a[184:187], v[144:147]
    ds_read_b64_tr_b16 v[214:215], v9 offset:32416
    v_cvt_pk_bf16_f32 v39, v18, v19
    v_mfma_f32_16x16x32_bf16 v[180:183], v[220:223], a[188:191], v[180:183]
    buffer_load_dwordx4 v57, s[8:11], s48 offen lds
    v_mfma_f32_16x16x32_bf16 v[180:183], v[216:219], a[172:175], v[180:183]
    s_add_u32 s6, s54, 8192
    v_accvgpr_read_b32 v20, a76
    v_accvgpr_read_b32 v21, a77
    s_waitcnt lgkmcnt(8)
    v_mfma_f32_16x16x32_bf16 v[76:79], v[224:227], a[160:163], v[76:79]
    ds_read_b64_tr_b16 v[216:217], v9 offset:18624
    v_accvgpr_read_b32 v22, a78
    v_mfma_f32_16x16x32_bf16 v[76:79], v[228:231], a[176:179], v[76:79]
    ds_read_b64_tr_b16 v[218:219], v9 offset:23232
    v_accvgpr_read_b32 v23, a79
    v_mfma_f32_16x16x32_bf16 v[112:115], v[228:231], a[180:183], v[112:115]
    buffer_store_dwordx4 v[36:39], v7, s[36:39], s6 offen offset:2048 sc1
    v_mfma_f32_16x16x32_bf16 v[112:115], v[224:227], a[164:167], v[112:115]
    s_add_u32 m0, s49, 116736
    v_accvgpr_read_b32 v24, a92
    v_accvgpr_read_b32 v25, a93
    v_mfma_f32_16x16x32_bf16 v[148:151], v[224:227], a[168:171], v[148:151]
    ds_read_b64_tr_b16 v[220:221], v9 offset:27840
    v_accvgpr_read_b32 v26, a94
    v_mfma_f32_16x16x32_bf16 v[148:151], v[228:231], a[184:187], v[148:151]
    ds_read_b64_tr_b16 v[222:223], v9 offset:32448
    v_accvgpr_read_b32 v27, a95
    v_mfma_f32_16x16x32_bf16 v[184:187], v[228:231], a[188:191], v[184:187]
    buffer_load_dwordx4 v58, s[8:11], s48 offen lds
    v_mfma_f32_16x16x32_bf16 v[184:187], v[224:227], a[172:175], v[184:187]
    v_mul_f32 v20, v20, v61
    v_mul_f32 v21, v21, v61
    s_waitcnt lgkmcnt(8)
    v_mfma_f32_16x16x32_bf16 v[80:83], v[232:235], a[160:163], v[80:83]
    ds_read_b64_tr_b16 v[224:225], v9 offset:18656
    v_mul_f32 v22, v22, v61
    v_mfma_f32_16x16x32_bf16 v[80:83], v[236:239], a[176:179], v[80:83]
    ds_read_b64_tr_b16 v[226:227], v9 offset:23264
    v_mul_f32 v23, v23, v61
    v_mfma_f32_16x16x32_bf16 v[116:119], v[236:239], a[180:183], v[116:119]
    v_mfma_f32_16x16x32_bf16 v[116:119], v[232:235], a[164:167], v[116:119]
    s_add_u32 m0, s49, 117760
    v_mul_f32 v24, v24, v61
    v_mul_f32 v25, v25, v61
    v_mfma_f32_16x16x32_bf16 v[152:155], v[232:235], a[168:171], v[152:155]
    ds_read_b64_tr_b16 v[228:229], v9 offset:27872
    v_mul_f32 v26, v26, v61
    v_mfma_f32_16x16x32_bf16 v[152:155], v[236:239], a[184:187], v[152:155]
    ds_read_b64_tr_b16 v[230:231], v9 offset:32480
    v_mul_f32 v27, v27, v61
    v_mfma_f32_16x16x32_bf16 v[188:191], v[236:239], a[188:191], v[188:191]
    buffer_load_dwordx4 v59, s[8:11], s48 offen lds
    v_mfma_f32_16x16x32_bf16 v[188:191], v[232:235], a[172:175], v[188:191]
    s_add_u32 m0, s49, 118784
    v_cvt_pk_bf16_f32 v40, v20, v21
    v_cvt_pk_bf16_f32 v41, v22, v23
    s_waitcnt lgkmcnt(8)
    v_mfma_f32_16x16x32_bf16 v[84:87], v[208:211], a[160:163], v[84:87]
    ds_read_b64_tr_b16 v[232:233], v9 offset:18688
    v_cvt_pk_bf16_f32 v42, v24, v25
    v_mfma_f32_16x16x32_bf16 v[84:87], v[212:215], a[176:179], v[84:87]
    ds_read_b64_tr_b16 v[234:235], v9 offset:23296
    v_cvt_pk_bf16_f32 v43, v26, v27
    v_mfma_f32_16x16x32_bf16 v[120:123], v[212:215], a[180:183], v[120:123]
    buffer_load_dwordx4 v60, s[8:11], s48 offen lds
    v_mfma_f32_16x16x32_bf16 v[120:123], v[208:211], a[164:167], v[120:123]
    s_add_u32 s6, s54, 8192
    v_accvgpr_read_b32 v12, a96
    v_accvgpr_read_b32 v13, a97
    v_mfma_f32_16x16x32_bf16 v[156:159], v[208:211], a[168:171], v[156:159]
    ds_read_b64_tr_b16 v[236:237], v9 offset:27904
    v_accvgpr_read_b32 v14, a98
    v_mfma_f32_16x16x32_bf16 v[156:159], v[212:215], a[184:187], v[156:159]
    ds_read_b64_tr_b16 v[238:239], v9 offset:32512
    v_accvgpr_read_b32 v15, a99
    v_mfma_f32_16x16x32_bf16 v[192:195], v[212:215], a[188:191], v[192:195]
    buffer_store_dwordx4 v[40:43], v7, s[36:39], s6 offen offset:3072 sc1
    v_mfma_f32_16x16x32_bf16 v[192:195], v[208:211], a[172:175], v[192:195]
    s_add_u32 s51, s61, 0
    v_accvgpr_read_b32 v16, a112
    v_accvgpr_read_b32 v17, a113
    s_waitcnt lgkmcnt(8)
    v_mfma_f32_16x16x32_bf16 v[88:91], v[216:219], a[160:163], v[88:91]
    v_accvgpr_read_b32 v18, a114
    v_mfma_f32_16x16x32_bf16 v[88:91], v[220:223], a[176:179], v[88:91]
    v_accvgpr_read_b32 v19, a115
    v_mfma_f32_16x16x32_bf16 v[124:127], v[220:223], a[180:183], v[124:127]
    buffer_load_dwordx4 a[64:67], v7, s[36:39], s51 offen offset:0 sc1
    v_mfma_f32_16x16x32_bf16 v[124:127], v[216:219], a[164:167], v[124:127]
    v_mul_f32 v12, v12, v4
    v_mul_f32 v13, v13, v4
    v_mfma_f32_16x16x32_bf16 v[160:163], v[216:219], a[168:171], v[160:163]
    v_mul_f32 v14, v14, v4
    v_mfma_f32_16x16x32_bf16 v[160:163], v[220:223], a[184:187], v[160:163]
    v_mul_f32 v15, v15, v4
    v_mfma_f32_16x16x32_bf16 v[196:199], v[220:223], a[188:191], v[196:199]
    v_mfma_f32_16x16x32_bf16 v[196:199], v[216:219], a[172:175], v[196:199]
    v_mul_f32 v16, v16, v4
    v_mul_f32 v17, v17, v4
    s_waitcnt lgkmcnt(0)
    s_barrier
    v_mfma_f32_16x16x32_bf16 v[92:95], v[224:227], a[160:163], v[92:95]
    ds_read_b64_tr_b16 v[208:209], v10 offset:0
    ds_read_b64_tr_b16 v[210:211], v10 offset:4608
    v_mfma_f32_16x16x32_bf16 v[92:95], v[228:231], a[176:179], v[92:95]
    ds_read_b64_tr_b16 v[212:213], v10 offset:9216
    ds_read_b64_tr_b16 v[214:215], v10 offset:13824
    v_mfma_f32_16x16x32_bf16 v[128:131], v[228:231], a[180:183], v[128:131]
    ds_read_b64_tr_b16 v[216:217], v10 offset:32
    ds_read_b64_tr_b16 v[218:219], v10 offset:4640
    v_mfma_f32_16x16x32_bf16 v[128:131], v[224:227], a[164:167], v[128:131]
    v_mul_f32 v18, v18, v4
    v_mul_f32 v19, v19, v4
    v_mfma_f32_16x16x32_bf16 v[164:167], v[224:227], a[168:171], v[164:167]
    ds_read_b64_tr_b16 v[220:221], v10 offset:9248
    v_cvt_pk_bf16_f32 v28, v12, v13
    v_mfma_f32_16x16x32_bf16 v[164:167], v[228:231], a[184:187], v[164:167]
    ds_read_b64_tr_b16 v[222:223], v10 offset:13856
    v_cvt_pk_bf16_f32 v29, v14, v15
    v_mfma_f32_16x16x32_bf16 v[200:203], v[228:231], a[188:191], v[200:203]
    buffer_load_dwordx4 a[68:71], v7, s[36:39], s51 offen offset:1024 sc1
    v_mfma_f32_16x16x32_bf16 v[200:203], v[224:227], a[172:175], v[200:203]
    s_add_u32 s6, s54, 12288
    v_cvt_pk_bf16_f32 v30, v16, v17
    v_cvt_pk_bf16_f32 v31, v18, v19
    v_mfma_f32_16x16x32_bf16 v[96:99], v[232:235], a[160:163], v[96:99]
    ds_read_b64_tr_b16 v[224:225], v10 offset:64
    v_accvgpr_read_b32 v20, a100
    v_mfma_f32_16x16x32_bf16 v[96:99], v[236:239], a[176:179], v[96:99]
    ds_read_b64_tr_b16 v[226:227], v10 offset:4672
    v_accvgpr_read_b32 v21, a101
    v_mfma_f32_16x16x32_bf16 v[132:135], v[236:239], a[180:183], v[132:135]
    buffer_store_dwordx4 v[28:31], v7, s[36:39], s6 offen offset:0 sc1
    v_mfma_f32_16x16x32_bf16 v[132:135], v[232:235], a[164:167], v[132:135]
    v_accvgpr_read_b32 v22, a102
    v_accvgpr_read_b32 v23, a103
    v_mfma_f32_16x16x32_bf16 v[168:171], v[232:235], a[168:171], v[168:171]
    ds_read_b64_tr_b16 v[228:229], v10 offset:9280
    v_accvgpr_read_b32 v24, a116
    v_mfma_f32_16x16x32_bf16 v[168:171], v[236:239], a[184:187], v[168:171]
    ds_read_b64_tr_b16 v[230:231], v10 offset:13888
    v_accvgpr_read_b32 v25, a117
    v_mfma_f32_16x16x32_bf16 v[204:207], v[236:239], a[188:191], v[204:207]
    buffer_load_dwordx4 a[72:75], v7, s[36:39], s51 offen offset:2048 sc1
    v_mfma_f32_16x16x32_bf16 v[204:207], v[232:235], a[172:175], v[204:207]
    v_accvgpr_read_b32 v26, a118
    v_accvgpr_read_b32 v27, a119
    s_waitcnt vmcnt(32) lgkmcnt(8)
    v_mfma_f32_16x16x32_bf16 v[64:67], v[208:211], a[0:3], v[64:67]
    ds_read_b64_tr_b16 v[232:233], v10 offset:96
    v_mul_f32 v20, v20, v5
    s_waitcnt vmcnt(27)
    v_mfma_f32_16x16x32_bf16 v[64:67], v[212:215], a[16:19], v[64:67]
    ds_read_b64_tr_b16 v[234:235], v10 offset:4704
    v_mul_f32 v21, v21, v5
    v_mfma_f32_16x16x32_bf16 v[100:103], v[212:215], a[20:23], v[100:103]
    buffer_load_dwordx4 a[76:79], v7, s[36:39], s51 offen offset:3072 sc1
    v_mfma_f32_16x16x32_bf16 v[100:103], v[208:211], a[4:7], v[100:103]
    v_mul_f32 v22, v22, v5
    v_mul_f32 v23, v23, v5
    v_mfma_f32_16x16x32_bf16 v[136:139], v[208:211], a[8:11], v[136:139]
    ds_read_b64_tr_b16 v[236:237], v10 offset:9312
    v_mul_f32 v24, v24, v5
    v_mfma_f32_16x16x32_bf16 v[136:139], v[212:215], a[24:27], v[136:139]
    ds_read_b64_tr_b16 v[238:239], v10 offset:13920
    v_mul_f32 v25, v25, v5
    v_mfma_f32_16x16x32_bf16 v[172:175], v[212:215], a[28:31], v[172:175]
    v_mfma_f32_16x16x32_bf16 v[172:175], v[208:211], a[12:15], v[172:175]
    s_add_u32 s51, s61, 4096
    v_mul_f32 v26, v26, v5
    v_mul_f32 v27, v27, v5
    s_waitcnt lgkmcnt(8)
    v_mfma_f32_16x16x32_bf16 v[68:71], v[216:219], a[0:3], v[68:71]
    ds_read_b64_tr_b16 v[208:209], v10 offset:128
    v_cvt_pk_bf16_f32 v32, v20, v21
    v_mfma_f32_16x16x32_bf16 v[68:71], v[220:223], a[16:19], v[68:71]
    ds_read_b64_tr_b16 v[210:211], v10 offset:4736
    v_cvt_pk_bf16_f32 v33, v22, v23
    v_mfma_f32_16x16x32_bf16 v[104:107], v[220:223], a[20:23], v[104:107]
    buffer_load_dwordx4 a[80:83], v7, s[36:39], s51 offen offset:0 sc1
    v_mfma_f32_16x16x32_bf16 v[104:107], v[216:219], a[4:7], v[104:107]
    s_add_u32 s6, s54, 12288
    v_cvt_pk_bf16_f32 v34, v24, v25
    v_cvt_pk_bf16_f32 v35, v26, v27
    v_mfma_f32_16x16x32_bf16 v[140:143], v[216:219], a[8:11], v[140:143]
    ds_read_b64_tr_b16 v[212:213], v10 offset:9344
    v_accvgpr_read_b32 v12, a104
    v_mfma_f32_16x16x32_bf16 v[140:143], v[220:223], a[24:27], v[140:143]
    ds_read_b64_tr_b16 v[214:215], v10 offset:13952
    v_accvgpr_read_b32 v13, a105
    v_mfma_f32_16x16x32_bf16 v[176:179], v[220:223], a[28:31], v[176:179]
    buffer_store_dwordx4 v[32:35], v7, s[36:39], s6 offen offset:1024 sc1
    v_mfma_f32_16x16x32_bf16 v[176:179], v[216:219], a[12:15], v[176:179]
    v_accvgpr_read_b32 v14, a106
    v_accvgpr_read_b32 v15, a107
    s_waitcnt lgkmcnt(8)
    v_mfma_f32_16x16x32_bf16 v[72:75], v[224:227], a[0:3], v[72:75]
    ds_read_b64_tr_b16 v[216:217], v10 offset:160
    v_accvgpr_read_b32 v16, a120
    v_mfma_f32_16x16x32_bf16 v[72:75], v[228:231], a[16:19], v[72:75]
    ds_read_b64_tr_b16 v[218:219], v10 offset:4768
    v_accvgpr_read_b32 v17, a121
    v_mfma_f32_16x16x32_bf16 v[108:111], v[228:231], a[20:23], v[108:111]
    buffer_load_dwordx4 a[84:87], v7, s[36:39], s51 offen offset:2048 sc1
    v_mfma_f32_16x16x32_bf16 v[108:111], v[224:227], a[4:7], v[108:111]
    v_accvgpr_read_b32 v18, a122
    v_accvgpr_read_b32 v19, a123
    v_mfma_f32_16x16x32_bf16 v[144:147], v[224:227], a[8:11], v[144:147]
    ds_read_b64_tr_b16 v[220:221], v10 offset:9376
    v_mul_f32 v12, v12, v6
    v_mfma_f32_16x16x32_bf16 v[144:147], v[228:231], a[24:27], v[144:147]
    ds_read_b64_tr_b16 v[222:223], v10 offset:13984
    v_mul_f32 v13, v13, v6
    v_mfma_f32_16x16x32_bf16 v[180:183], v[228:231], a[28:31], v[180:183]
    buffer_load_dwordx4 a[88:91], v7, s[36:39], s51 offen offset:1024 sc1
    v_mfma_f32_16x16x32_bf16 v[180:183], v[224:227], a[12:15], v[180:183]
    v_mul_f32 v14, v14, v6
    v_mul_f32 v15, v15, v6
    s_waitcnt lgkmcnt(8)
    v_mfma_f32_16x16x32_bf16 v[76:79], v[232:235], a[0:3], v[76:79]
    ds_read_b64_tr_b16 v[224:225], v10 offset:192
    v_mul_f32 v16, v16, v6
    v_mfma_f32_16x16x32_bf16 v[76:79], v[236:239], a[16:19], v[76:79]
    ds_read_b64_tr_b16 v[226:227], v10 offset:4800
    v_mul_f32 v17, v17, v6
    v_mfma_f32_16x16x32_bf16 v[112:115], v[236:239], a[20:23], v[112:115]
    v_mfma_f32_16x16x32_bf16 v[112:115], v[232:235], a[4:7], v[112:115]
    v_mul_f32 v18, v18, v6
    v_mul_f32 v19, v19, v6
    v_mfma_f32_16x16x32_bf16 v[148:151], v[232:235], a[8:11], v[148:151]
    ds_read_b64_tr_b16 v[228:229], v10 offset:9408
    v_cvt_pk_bf16_f32 v36, v12, v13
    v_mfma_f32_16x16x32_bf16 v[148:151], v[236:239], a[24:27], v[148:151]
    ds_read_b64_tr_b16 v[230:231], v10 offset:14016
    v_cvt_pk_bf16_f32 v37, v14, v15
    v_mfma_f32_16x16x32_bf16 v[184:187], v[236:239], a[28:31], v[184:187]
    buffer_load_dwordx4 a[92:95], v7, s[36:39], s51 offen offset:3072 sc1
    v_mfma_f32_16x16x32_bf16 v[184:187], v[232:235], a[12:15], v[184:187]
    s_add_u32 s6, s54, 12288
    v_cvt_pk_bf16_f32 v38, v16, v17
    v_cvt_pk_bf16_f32 v39, v18, v19
    s_waitcnt lgkmcnt(8)
    v_mfma_f32_16x16x32_bf16 v[80:83], v[208:211], a[0:3], v[80:83]
    ds_read_b64_tr_b16 v[232:233], v10 offset:224
    v_accvgpr_read_b32 v20, a108
    v_mfma_f32_16x16x32_bf16 v[80:83], v[212:215], a[16:19], v[80:83]
    ds_read_b64_tr_b16 v[234:235], v10 offset:4832
    v_accvgpr_read_b32 v21, a109
    v_mfma_f32_16x16x32_bf16 v[116:119], v[212:215], a[20:23], v[116:119]
    buffer_store_dwordx4 v[36:39], v7, s[36:39], s6 offen offset:2048 sc1
    v_mfma_f32_16x16x32_bf16 v[116:119], v[208:211], a[4:7], v[116:119]
    s_add_u32 m0, s49, 0
    v_accvgpr_read_b32 v22, a110
    v_accvgpr_read_b32 v23, a111
    v_mfma_f32_16x16x32_bf16 v[152:155], v[208:211], a[8:11], v[152:155]
    ds_read_b64_tr_b16 v[236:237], v10 offset:9440
    v_accvgpr_read_b32 v24, a124
    v_mfma_f32_16x16x32_bf16 v[152:155], v[212:215], a[24:27], v[152:155]
    ds_read_b64_tr_b16 v[238:239], v10 offset:14048
    v_accvgpr_read_b32 v25, a125
    v_mfma_f32_16x16x32_bf16 v[188:191], v[212:215], a[28:31], v[188:191]
    buffer_load_dwordx4 v52, s[8:11], s52 offen lds
    v_mfma_f32_16x16x32_bf16 v[188:191], v[208:211], a[12:15], v[188:191]
    s_add_u32 m0, s49, 1024
    v_accvgpr_read_b32 v26, a126
    v_accvgpr_read_b32 v27, a127
    s_waitcnt lgkmcnt(8)
    v_mfma_f32_16x16x32_bf16 v[84:87], v[216:219], a[0:3], v[84:87]
    ds_read_b64_tr_b16 v[208:209], v10 offset:256
    v_mul_f32 v20, v20, v61
    v_mfma_f32_16x16x32_bf16 v[84:87], v[220:223], a[16:19], v[84:87]
    ds_read_b64_tr_b16 v[210:211], v10 offset:4864
    v_mul_f32 v21, v21, v61
    v_mfma_f32_16x16x32_bf16 v[120:123], v[220:223], a[20:23], v[120:123]
    buffer_load_dwordx4 v53, s[8:11], s52 offen lds
    v_mfma_f32_16x16x32_bf16 v[120:123], v[216:219], a[4:7], v[120:123]
    v_mul_f32 v22, v22, v61
    v_mul_f32 v23, v23, v61
    v_mfma_f32_16x16x32_bf16 v[156:159], v[216:219], a[8:11], v[156:159]
    ds_read_b64_tr_b16 v[212:213], v10 offset:9472
    v_mul_f32 v24, v24, v61
    v_mfma_f32_16x16x32_bf16 v[156:159], v[220:223], a[24:27], v[156:159]
    ds_read_b64_tr_b16 v[214:215], v10 offset:14080
    v_mul_f32 v25, v25, v61
    v_mfma_f32_16x16x32_bf16 v[192:195], v[220:223], a[28:31], v[192:195]
    v_mfma_f32_16x16x32_bf16 v[192:195], v[216:219], a[12:15], v[192:195]
    s_add_u32 m0, s49, 2048
    v_mul_f32 v26, v26, v61
    v_mul_f32 v27, v27, v61
    s_waitcnt lgkmcnt(8)
    v_mfma_f32_16x16x32_bf16 v[88:91], v[224:227], a[0:3], v[88:91]
    ds_read_b64_tr_b16 v[216:217], v10 offset:18432
    v_cvt_pk_bf16_f32 v40, v20, v21
    v_mfma_f32_16x16x32_bf16 v[88:91], v[228:231], a[16:19], v[88:91]
    ds_read_b64_tr_b16 v[218:219], v10 offset:23040
    v_cvt_pk_bf16_f32 v41, v22, v23
    v_mfma_f32_16x16x32_bf16 v[124:127], v[228:231], a[20:23], v[124:127]
    buffer_load_dwordx4 v54, s[8:11], s52 offen lds
    v_mfma_f32_16x16x32_bf16 v[124:127], v[224:227], a[4:7], v[124:127]
    s_add_u32 s6, s54, 12288
    v_cvt_pk_bf16_f32 v42, v24, v25
    v_cvt_pk_bf16_f32 v43, v26, v27
    v_mfma_f32_16x16x32_bf16 v[160:163], v[224:227], a[8:11], v[160:163]
    ds_read_b64_tr_b16 v[220:221], v10 offset:27648
    v_mfma_f32_16x16x32_bf16 v[160:163], v[228:231], a[24:27], v[160:163]
    ds_read_b64_tr_b16 v[222:223], v10 offset:32256
    v_mfma_f32_16x16x32_bf16 v[196:199], v[228:231], a[28:31], v[196:199]
    buffer_store_dwordx4 v[40:43], v7, s[36:39], s6 offen offset:3072 sc1
    v_mfma_f32_16x16x32_bf16 v[196:199], v[224:227], a[12:15], v[196:199]
    s_add_u32 s51, s61, 8192
    s_waitcnt lgkmcnt(8)
    v_mfma_f32_16x16x32_bf16 v[92:95], v[232:235], a[0:3], v[92:95]
    ds_read_b64_tr_b16 v[224:225], v10 offset:18464
    v_mfma_f32_16x16x32_bf16 v[92:95], v[236:239], a[16:19], v[92:95]
    ds_read_b64_tr_b16 v[226:227], v10 offset:23072
    v_mfma_f32_16x16x32_bf16 v[128:131], v[236:239], a[20:23], v[128:131]
    buffer_load_dwordx4 a[96:99], v7, s[36:39], s51 offen offset:0 sc1
    v_mfma_f32_16x16x32_bf16 v[128:131], v[232:235], a[4:7], v[128:131]
    v_mfma_f32_16x16x32_bf16 v[164:167], v[232:235], a[8:11], v[164:167]
    ds_read_b64_tr_b16 v[228:229], v10 offset:27680
    v_mfma_f32_16x16x32_bf16 v[164:167], v[236:239], a[24:27], v[164:167]
    ds_read_b64_tr_b16 v[230:231], v10 offset:32288
    v_mfma_f32_16x16x32_bf16 v[200:203], v[236:239], a[28:31], v[200:203]
    buffer_load_dwordx4 a[100:103], v7, s[36:39], s51 offen offset:1024 sc1
    v_mfma_f32_16x16x32_bf16 v[200:203], v[232:235], a[12:15], v[200:203]
    s_waitcnt lgkmcnt(8)
    v_mfma_f32_16x16x32_bf16 v[96:99], v[208:211], a[0:3], v[96:99]
    ds_read_b64_tr_b16 v[232:233], v10 offset:18496
    v_mfma_f32_16x16x32_bf16 v[96:99], v[212:215], a[16:19], v[96:99]
    ds_read_b64_tr_b16 v[234:235], v10 offset:23104
    v_mfma_f32_16x16x32_bf16 v[132:135], v[212:215], a[20:23], v[132:135]
    v_mfma_f32_16x16x32_bf16 v[132:135], v[208:211], a[4:7], v[132:135]
    v_mfma_f32_16x16x32_bf16 v[168:171], v[208:211], a[8:11], v[168:171]
    ds_read_b64_tr_b16 v[236:237], v10 offset:27712
    v_mfma_f32_16x16x32_bf16 v[168:171], v[212:215], a[24:27], v[168:171]
    ds_read_b64_tr_b16 v[238:239], v10 offset:32320
    v_mfma_f32_16x16x32_bf16 v[204:207], v[212:215], a[28:31], v[204:207]
    buffer_load_dwordx4 a[104:107], v7, s[36:39], s51 offen offset:2048 sc1
    v_mfma_f32_16x16x32_bf16 v[204:207], v[208:211], a[12:15], v[204:207]
    s_waitcnt vmcnt(29) lgkmcnt(8)
    v_mfma_f32_16x16x32_bf16 v[64:67], v[216:219], a[32:35], v[64:67]
    ds_read_b64_tr_b16 v[208:209], v10 offset:18528
    s_waitcnt vmcnt(24)
    v_mfma_f32_16x16x32_bf16 v[64:67], v[220:223], a[48:51], v[64:67]
    ds_read_b64_tr_b16 v[210:211], v10 offset:23136
    v_mfma_f32_16x16x32_bf16 v[100:103], v[220:223], a[52:55], v[100:103]
    buffer_load_dwordx4 a[108:111], v7, s[36:39], s51 offen offset:3072 sc1
    v_mfma_f32_16x16x32_bf16 v[100:103], v[216:219], a[36:39], v[100:103]
    s_add_u32 s51, s61, 12288
    v_mfma_f32_16x16x32_bf16 v[136:139], v[216:219], a[40:43], v[136:139]
    ds_read_b64_tr_b16 v[212:213], v10 offset:27744
    v_mfma_f32_16x16x32_bf16 v[136:139], v[220:223], a[56:59], v[136:139]
    ds_read_b64_tr_b16 v[214:215], v10 offset:32352
    v_mfma_f32_16x16x32_bf16 v[172:175], v[220:223], a[60:63], v[172:175]
    buffer_load_dwordx4 a[112:115], v7, s[36:39], s51 offen offset:0 sc1
    v_mfma_f32_16x16x32_bf16 v[172:175], v[216:219], a[44:47], v[172:175]
    s_waitcnt lgkmcnt(8)
    v_mfma_f32_16x16x32_bf16 v[68:71], v[224:227], a[32:35], v[68:71]
    ds_read_b64_tr_b16 v[216:217], v10 offset:18560
    v_mfma_f32_16x16x32_bf16 v[68:71], v[228:231], a[48:51], v[68:71]
    ds_read_b64_tr_b16 v[218:219], v10 offset:23168
    v_mfma_f32_16x16x32_bf16 v[104:107], v[228:231], a[52:55], v[104:107]
    buffer_load_dwordx4 a[116:119], v7, s[36:39], s51 offen offset:1024 sc1
    v_mfma_f32_16x16x32_bf16 v[104:107], v[224:227], a[36:39], v[104:107]
    v_mfma_f32_16x16x32_bf16 v[140:143], v[224:227], a[40:43], v[140:143]
    ds_read_b64_tr_b16 v[220:221], v10 offset:27776
    v_mfma_f32_16x16x32_bf16 v[140:143], v[228:231], a[56:59], v[140:143]
    ds_read_b64_tr_b16 v[222:223], v10 offset:32384
    v_mfma_f32_16x16x32_bf16 v[176:179], v[228:231], a[60:63], v[176:179]
    v_mfma_f32_16x16x32_bf16 v[176:179], v[224:227], a[44:47], v[176:179]
    s_waitcnt lgkmcnt(8)
    v_mfma_f32_16x16x32_bf16 v[72:75], v[232:235], a[32:35], v[72:75]
    ds_read_b64_tr_b16 v[224:225], v10 offset:18592
    v_mfma_f32_16x16x32_bf16 v[72:75], v[236:239], a[48:51], v[72:75]
    ds_read_b64_tr_b16 v[226:227], v10 offset:23200
    v_mfma_f32_16x16x32_bf16 v[108:111], v[236:239], a[52:55], v[108:111]
    buffer_load_dwordx4 a[120:123], v7, s[36:39], s51 offen offset:2048 sc1
    v_mfma_f32_16x16x32_bf16 v[108:111], v[232:235], a[36:39], v[108:111]
    v_mfma_f32_16x16x32_bf16 v[144:147], v[232:235], a[40:43], v[144:147]
    ds_read_b64_tr_b16 v[228:229], v10 offset:27808
    v_mfma_f32_16x16x32_bf16 v[144:147], v[236:239], a[56:59], v[144:147]
    ds_read_b64_tr_b16 v[230:231], v10 offset:32416
    v_mfma_f32_16x16x32_bf16 v[180:183], v[236:239], a[60:63], v[180:183]
    buffer_load_dwordx4 a[124:127], v7, s[36:39], s51 offen offset:3072 sc1
    v_mfma_f32_16x16x32_bf16 v[180:183], v[232:235], a[44:47], v[180:183]
    s_add_u32 m0, s49, 3072
    s_waitcnt lgkmcnt(8)
    v_mfma_f32_16x16x32_bf16 v[76:79], v[208:211], a[32:35], v[76:79]
    ds_read_b64_tr_b16 v[232:233], v10 offset:18624
    v_mfma_f32_16x16x32_bf16 v[76:79], v[212:215], a[48:51], v[76:79]
    ds_read_b64_tr_b16 v[234:235], v10 offset:23232
    v_mfma_f32_16x16x32_bf16 v[112:115], v[212:215], a[52:55], v[112:115]
    buffer_load_dwordx4 v55, s[8:11], s52 offen lds
    v_mfma_f32_16x16x32_bf16 v[112:115], v[208:211], a[36:39], v[112:115]
    s_add_u32 m0, s49, 4096
    v_mfma_f32_16x16x32_bf16 v[148:151], v[208:211], a[40:43], v[148:151]
    ds_read_b64_tr_b16 v[236:237], v10 offset:27840
    v_mfma_f32_16x16x32_bf16 v[148:151], v[212:215], a[56:59], v[148:151]
    ds_read_b64_tr_b16 v[238:239], v10 offset:32448
    v_mfma_f32_16x16x32_bf16 v[184:187], v[212:215], a[60:63], v[184:187]
    buffer_load_dwordx4 v56, s[8:11], s52 offen lds
    v_mfma_f32_16x16x32_bf16 v[184:187], v[208:211], a[44:47], v[184:187]
    s_waitcnt lgkmcnt(8)
    v_mfma_f32_16x16x32_bf16 v[80:83], v[216:219], a[32:35], v[80:83]
    ds_read_b64_tr_b16 v[208:209], v10 offset:18656
    v_mfma_f32_16x16x32_bf16 v[80:83], v[220:223], a[48:51], v[80:83]
    ds_read_b64_tr_b16 v[210:211], v10 offset:23264
    v_mfma_f32_16x16x32_bf16 v[116:119], v[220:223], a[52:55], v[116:119]
    v_mfma_f32_16x16x32_bf16 v[116:119], v[216:219], a[36:39], v[116:119]
    s_add_u32 m0, s49, 5120
    v_mfma_f32_16x16x32_bf16 v[152:155], v[216:219], a[40:43], v[152:155]
    ds_read_b64_tr_b16 v[212:213], v10 offset:27872
    v_mfma_f32_16x16x32_bf16 v[152:155], v[220:223], a[56:59], v[152:155]
    ds_read_b64_tr_b16 v[214:215], v10 offset:32480
    v_mfma_f32_16x16x32_bf16 v[188:191], v[220:223], a[60:63], v[188:191]
    buffer_load_dwordx4 v57, s[8:11], s52 offen lds
    v_mfma_f32_16x16x32_bf16 v[188:191], v[216:219], a[44:47], v[188:191]
    s_waitcnt lgkmcnt(8)
    v_mfma_f32_16x16x32_bf16 v[84:87], v[224:227], a[32:35], v[84:87]
    ds_read_b64_tr_b16 v[216:217], v10 offset:18688
    v_mfma_f32_16x16x32_bf16 v[84:87], v[228:231], a[48:51], v[84:87]
    ds_read_b64_tr_b16 v[218:219], v10 offset:23296
    v_mfma_f32_16x16x32_bf16 v[120:123], v[228:231], a[52:55], v[120:123]
    buffer_load_dword v247, v246, s[24:27], 0 offen
    v_mfma_f32_16x16x32_bf16 v[120:123], v[224:227], a[36:39], v[120:123]
    s_add_u32 m0, s49, 6144
    v_mfma_f32_16x16x32_bf16 v[156:159], v[224:227], a[40:43], v[156:159]
    ds_read_b64_tr_b16 v[220:221], v10 offset:27904
    s_waitcnt vmcnt(17)
    v_accvgpr_read_b32 v240, a82
    v_mfma_f32_16x16x32_bf16 v[156:159], v[228:231], a[56:59], v[156:159]
    ds_read_b64_tr_b16 v[222:223], v10 offset:32512
    v_accvgpr_read_b32 v241, a83
    v_mfma_f32_16x16x32_bf16 v[192:195], v[228:231], a[60:63], v[192:195]
    buffer_load_dwordx4 v58, s[8:11], s52 offen lds
    v_mfma_f32_16x16x32_bf16 v[192:195], v[224:227], a[44:47], v[192:195]
    s_add_u32 m0, s49, 7168
    v_accvgpr_mov_b32 a82, a84
    v_accvgpr_mov_b32 a83, a85
    s_waitcnt lgkmcnt(8)
    v_mfma_f32_16x16x32_bf16 v[88:91], v[232:235], a[32:35], v[88:91]
    v_accvgpr_write_b32 a84, v240
    v_mfma_f32_16x16x32_bf16 v[88:91], v[236:239], a[48:51], v[88:91]
    v_accvgpr_write_b32 a85, v241
    v_mfma_f32_16x16x32_bf16 v[124:127], v[236:239], a[52:55], v[124:127]
    buffer_load_dwordx4 v59, s[8:11], s52 offen lds
    v_mfma_f32_16x16x32_bf16 v[124:127], v[232:235], a[36:39], v[124:127]
    v_accvgpr_read_b32 v240, a90
    v_accvgpr_read_b32 v241, a91
    v_mfma_f32_16x16x32_bf16 v[160:163], v[232:235], a[40:43], v[160:163]
    v_accvgpr_mov_b32 a90, a92
    v_mfma_f32_16x16x32_bf16 v[160:163], v[236:239], a[56:59], v[160:163]
    v_accvgpr_mov_b32 a91, a93
    v_mfma_f32_16x16x32_bf16 v[196:199], v[236:239], a[60:63], v[196:199]
    v_mfma_f32_16x16x32_bf16 v[196:199], v[232:235], a[44:47], v[196:199]
    v_accvgpr_write_b32 a92, v240
    v_accvgpr_write_b32 a93, v241
    s_waitcnt lgkmcnt(0)
    s_barrier
    v_mfma_f32_16x16x32_bf16 v[92:95], v[208:211], a[32:35], v[92:95]
    ds_read_b64_tr_b16 v[224:225], v11 offset:0
    ds_read_b64_tr_b16 v[226:227], v11 offset:4608
    v_mfma_f32_16x16x32_bf16 v[92:95], v[212:215], a[48:51], v[92:95]
    ds_read_b64_tr_b16 v[228:229], v11 offset:9216
    ds_read_b64_tr_b16 v[230:231], v11 offset:13824
    v_mfma_f32_16x16x32_bf16 v[128:131], v[212:215], a[52:55], v[128:131]
    ds_read_b64_tr_b16 v[232:233], v11 offset:32
    ds_read_b64_tr_b16 v[234:235], v11 offset:4640
    v_mfma_f32_16x16x32_bf16 v[128:131], v[208:211], a[36:39], v[128:131]
    s_waitcnt vmcnt(14)
    s_barrier
    v_mfma_f32_16x16x32_bf16 v[164:167], v[208:211], a[40:43], v[164:167]
    ds_read_b64_tr_b16 v[236:237], v11 offset:9248
    v_mfma_f32_16x16x32_bf16 v[164:167], v[212:215], a[56:59], v[164:167]
    ds_read_b64_tr_b16 v[238:239], v11 offset:13856
    v_mfma_f32_16x16x32_bf16 v[200:203], v[212:215], a[60:63], v[200:203]
    buffer_store_dword v63, v0, s[20:23], 0 offen sc1
    v_mfma_f32_16x16x32_bf16 v[200:203], v[208:211], a[44:47], v[200:203]
    s_add_u32 m0, s49, 8192
    v_mfma_f32_16x16x32_bf16 v[96:99], v[216:219], a[32:35], v[96:99]
    ds_read_b64_tr_b16 v[208:209], v11 offset:64
    v_mfma_f32_16x16x32_bf16 v[96:99], v[220:223], a[48:51], v[96:99]
    ds_read_b64_tr_b16 v[210:211], v11 offset:4672
    v_mfma_f32_16x16x32_bf16 v[132:135], v[220:223], a[52:55], v[132:135]
    buffer_load_dwordx4 v60, s[8:11], s52 offen lds
    v_mfma_f32_16x16x32_bf16 v[132:135], v[216:219], a[36:39], v[132:135]
    s_add_u32 s51, s62, 0
    v_mfma_f32_16x16x32_bf16 v[168:171], v[216:219], a[40:43], v[168:171]
    ds_read_b64_tr_b16 v[212:213], v11 offset:9280
    v_and_b32 v62, 28, v0
    v_mfma_f32_16x16x32_bf16 v[168:171], v[220:223], a[56:59], v[168:171]
    ds_read_b64_tr_b16 v[214:215], v11 offset:13888
    v_and_b32 v2, 15, v1
    v_mfma_f32_16x16x32_bf16 v[204:207], v[220:223], a[60:63], v[204:207]
    buffer_load_dwordx4 a[192:195], v7, s[36:39], s51 offen offset:0 sc1
    v_mfma_f32_16x16x32_bf16 v[204:207], v[216:219], a[44:47], v[204:207]
    s_add_u32 s68, s66, s7
    s_addc_u32 s69, s67, 0
    v_mul_u32_u24 v2, 1152, v2
    v_lshrrev_b32 v3, 4, v1
    s_waitcnt lgkmcnt(8)
    v_mfma_f32_16x16x32_bf16 v[64:67], v[224:227], a[64:67], v[64:67]
    ds_read_b64_tr_b16 v[216:217], v11 offset:96
    v_lshl_add_u32 v2, v3, 3, v2
    v_mfma_f32_16x16x32_bf16 v[64:67], v[228:231], a[80:83], v[64:67]
    ds_read_b64_tr_b16 v[218:219], v11 offset:4704
    v_add_u32 v3, 18432, v2
    v_mfma_f32_16x16x32_bf16 v[100:103], v[228:231], a[84:87], v[100:103]
    buffer_load_dwordx4 a[196:199], v7, s[36:39], s51 offen offset:1024 sc1
    v_mfma_f32_16x16x32_bf16 v[100:103], v[224:227], a[68:71], v[100:103]
    s_lshl_b32 s3, s43, 2
    s_add_u32 s7, s7, s3
    v_mfma_f32_16x16x32_bf16 v[136:139], v[224:227], a[72:75], v[136:139]
    ds_read_b64_tr_b16 v[220:221], v11 offset:9312
    v_mfma_f32_16x16x32_bf16 v[136:139], v[228:231], a[88:91], v[136:139]
    ds_read_b64_tr_b16 v[222:223], v11 offset:13920
    v_mfma_f32_16x16x32_bf16 v[172:175], v[228:231], a[92:95], v[172:175]
    v_mfma_f32_16x16x32_bf16 v[172:175], v[224:227], a[76:79], v[172:175]
    s_add_u32 s20, s66, s7
    s_addc_u32 s21, s67, 0
    s_waitcnt lgkmcnt(8)
    v_mfma_f32_16x16x32_bf16 v[68:71], v[232:235], a[64:67], v[68:71]
    ds_read_b64_tr_b16 v[224:225], v11 offset:128
    v_mfma_f32_16x16x32_bf16 v[68:71], v[236:239], a[80:83], v[68:71]
    ds_read_b64_tr_b16 v[226:227], v11 offset:4736
    v_mfma_f32_16x16x32_bf16 v[104:107], v[236:239], a[84:87], v[104:107]
    buffer_load_dwordx4 a[200:203], v7, s[36:39], s51 offen offset:2048 sc1
    v_mfma_f32_16x16x32_bf16 v[104:107], v[232:235], a[68:71], v[104:107]
    v_mfma_f32_16x16x32_bf16 v[140:143], v[232:235], a[72:75], v[140:143]
    ds_read_b64_tr_b16 v[228:229], v11 offset:9344
    v_mfma_f32_16x16x32_bf16 v[140:143], v[236:239], a[88:91], v[140:143]
    ds_read_b64_tr_b16 v[230:231], v11 offset:13952
    v_mfma_f32_16x16x32_bf16 v[176:179], v[236:239], a[92:95], v[176:179]
    buffer_load_dwordx4 a[204:207], v7, s[36:39], s51 offen offset:3072 sc1
    v_mfma_f32_16x16x32_bf16 v[176:179], v[232:235], a[76:79], v[176:179]
    s_add_u32 s51, s62, 4096
    s_waitcnt lgkmcnt(8)
    v_mfma_f32_16x16x32_bf16 v[72:75], v[208:211], a[64:67], v[72:75]
    ds_read_b64_tr_b16 v[232:233], v11 offset:160
    v_mfma_f32_16x16x32_bf16 v[72:75], v[212:215], a[80:83], v[72:75]
    ds_read_b64_tr_b16 v[234:235], v11 offset:4768
    v_mfma_f32_16x16x32_bf16 v[108:111], v[212:215], a[84:87], v[108:111]
    buffer_load_dwordx4 a[208:211], v7, s[36:39], s51 offen offset:0 sc1
    v_mfma_f32_16x16x32_bf16 v[108:111], v[208:211], a[68:71], v[108:111]
    v_mfma_f32_16x16x32_bf16 v[144:147], v[208:211], a[72:75], v[144:147]
    ds_read_b64_tr_b16 v[236:237], v11 offset:9376
    v_mfma_f32_16x16x32_bf16 v[144:147], v[212:215], a[88:91], v[144:147]
    ds_read_b64_tr_b16 v[238:239], v11 offset:13984
    v_mfma_f32_16x16x32_bf16 v[180:183], v[212:215], a[92:95], v[180:183]
    buffer_load_dwordx4 a[212:215], v7, s[36:39], s51 offen offset:1024 sc1
    v_mfma_f32_16x16x32_bf16 v[180:183], v[208:211], a[76:79], v[180:183]
    s_waitcnt lgkmcnt(8)
    v_mfma_f32_16x16x32_bf16 v[76:79], v[216:219], a[64:67], v[76:79]
    ds_read_b64_tr_b16 v[208:209], v11 offset:192
    v_mfma_f32_16x16x32_bf16 v[76:79], v[220:223], a[80:83], v[76:79]
    ds_read_b64_tr_b16 v[210:211], v11 offset:4800
    v_mfma_f32_16x16x32_bf16 v[112:115], v[220:223], a[84:87], v[112:115]
    v_mfma_f32_16x16x32_bf16 v[112:115], v[216:219], a[68:71], v[112:115]
    v_mfma_f32_16x16x32_bf16 v[148:151], v[216:219], a[72:75], v[148:151]
    ds_read_b64_tr_b16 v[212:213], v11 offset:9408
    v_mfma_f32_16x16x32_bf16 v[148:151], v[220:223], a[88:91], v[148:151]
    ds_read_b64_tr_b16 v[214:215], v11 offset:14016
    v_mfma_f32_16x16x32_bf16 v[184:187], v[220:223], a[92:95], v[184:187]
    buffer_load_dwordx4 a[216:219], v7, s[36:39], s51 offen offset:2048 sc1
    v_mfma_f32_16x16x32_bf16 v[184:187], v[216:219], a[76:79], v[184:187]
    s_waitcnt lgkmcnt(8)
    v_mfma_f32_16x16x32_bf16 v[80:83], v[224:227], a[64:67], v[80:83]
    ds_read_b64_tr_b16 v[216:217], v11 offset:224
    v_mfma_f32_16x16x32_bf16 v[80:83], v[228:231], a[80:83], v[80:83]
    ds_read_b64_tr_b16 v[218:219], v11 offset:4832
    v_mfma_f32_16x16x32_bf16 v[116:119], v[228:231], a[84:87], v[116:119]
    buffer_load_dwordx4 a[220:223], v7, s[36:39], s51 offen offset:3072 sc1
    v_mfma_f32_16x16x32_bf16 v[116:119], v[224:227], a[68:71], v[116:119]
    s_add_u32 s51, s62, 8192
    v_mfma_f32_16x16x32_bf16 v[152:155], v[224:227], a[72:75], v[152:155]
    ds_read_b64_tr_b16 v[220:221], v11 offset:9440
    v_mfma_f32_16x16x32_bf16 v[152:155], v[228:231], a[88:91], v[152:155]
    ds_read_b64_tr_b16 v[222:223], v11 offset:14048
    v_mfma_f32_16x16x32_bf16 v[188:191], v[228:231], a[92:95], v[188:191]
    buffer_load_dwordx4 a[224:227], v7, s[36:39], s51 offen offset:0 sc1
    v_mfma_f32_16x16x32_bf16 v[188:191], v[224:227], a[76:79], v[188:191]
    s_waitcnt lgkmcnt(8)
    v_mfma_f32_16x16x32_bf16 v[84:87], v[232:235], a[64:67], v[84:87]
    ds_read_b64_tr_b16 v[224:225], v11 offset:256
    v_mfma_f32_16x16x32_bf16 v[84:87], v[236:239], a[80:83], v[84:87]
    ds_read_b64_tr_b16 v[226:227], v11 offset:4864
    v_mfma_f32_16x16x32_bf16 v[120:123], v[236:239], a[84:87], v[120:123]
    buffer_load_dwordx4 a[228:231], v7, s[36:39], s51 offen offset:1024 sc1
    v_mfma_f32_16x16x32_bf16 v[120:123], v[232:235], a[68:71], v[120:123]
    v_mfma_f32_16x16x32_bf16 v[156:159], v[232:235], a[72:75], v[156:159]
    ds_read_b64_tr_b16 v[228:229], v11 offset:9472
    v_mfma_f32_16x16x32_bf16 v[156:159], v[236:239], a[88:91], v[156:159]
    ds_read_b64_tr_b16 v[230:231], v11 offset:14080
    v_mfma_f32_16x16x32_bf16 v[192:195], v[236:239], a[92:95], v[192:195]
    v_mfma_f32_16x16x32_bf16 v[192:195], v[232:235], a[76:79], v[192:195]
    s_waitcnt lgkmcnt(8)
    v_mfma_f32_16x16x32_bf16 v[88:91], v[208:211], a[64:67], v[88:91]
    ds_read_b64_tr_b16 v[232:233], v11 offset:18432
    v_mfma_f32_16x16x32_bf16 v[88:91], v[212:215], a[80:83], v[88:91]
    ds_read_b64_tr_b16 v[234:235], v11 offset:23040
    v_mfma_f32_16x16x32_bf16 v[124:127], v[212:215], a[84:87], v[124:127]
    buffer_load_dwordx4 a[232:235], v7, s[36:39], s51 offen offset:2048 sc1
    v_mfma_f32_16x16x32_bf16 v[124:127], v[208:211], a[68:71], v[124:127]
    v_mfma_f32_16x16x32_bf16 v[160:163], v[208:211], a[72:75], v[160:163]
    ds_read_b64_tr_b16 v[236:237], v11 offset:27648
    v_mfma_f32_16x16x32_bf16 v[160:163], v[212:215], a[88:91], v[160:163]
    ds_read_b64_tr_b16 v[238:239], v11 offset:32256
    v_mfma_f32_16x16x32_bf16 v[196:199], v[212:215], a[92:95], v[196:199]
    buffer_load_dwordx4 a[236:239], v7, s[36:39], s51 offen offset:3072 sc1
    v_mfma_f32_16x16x32_bf16 v[196:199], v[208:211], a[76:79], v[196:199]
    s_add_u32 s51, s62, 12288
    s_waitcnt lgkmcnt(8)
    v_mfma_f32_16x16x32_bf16 v[92:95], v[216:219], a[64:67], v[92:95]
    ds_read_b64_tr_b16 v[208:209], v11 offset:18464
    v_mfma_f32_16x16x32_bf16 v[92:95], v[220:223], a[80:83], v[92:95]
    ds_read_b64_tr_b16 v[210:211], v11 offset:23072
    v_mfma_f32_16x16x32_bf16 v[128:131], v[220:223], a[84:87], v[128:131]
    buffer_load_dwordx4 a[240:243], v7, s[36:39], s51 offen offset:0 sc1
    v_mfma_f32_16x16x32_bf16 v[128:131], v[216:219], a[68:71], v[128:131]
    v_mfma_f32_16x16x32_bf16 v[164:167], v[216:219], a[72:75], v[164:167]
    ds_read_b64_tr_b16 v[212:213], v11 offset:27680
    v_mfma_f32_16x16x32_bf16 v[164:167], v[220:223], a[88:91], v[164:167]
    ds_read_b64_tr_b16 v[214:215], v11 offset:32288
    v_mfma_f32_16x16x32_bf16 v[200:203], v[220:223], a[92:95], v[200:203]
    buffer_load_dwordx4 a[244:247], v7, s[36:39], s51 offen offset:1024 sc1
    v_mfma_f32_16x16x32_bf16 v[200:203], v[216:219], a[76:79], v[200:203]
    s_waitcnt lgkmcnt(8)
    v_mfma_f32_16x16x32_bf16 v[96:99], v[224:227], a[64:67], v[96:99]
    ds_read_b64_tr_b16 v[216:217], v11 offset:18496
    v_mfma_f32_16x16x32_bf16 v[96:99], v[228:231], a[80:83], v[96:99]
    ds_read_b64_tr_b16 v[218:219], v11 offset:23104
    v_mfma_f32_16x16x32_bf16 v[132:135], v[228:231], a[84:87], v[132:135]
    v_mfma_f32_16x16x32_bf16 v[132:135], v[224:227], a[68:71], v[132:135]
    v_mfma_f32_16x16x32_bf16 v[168:171], v[224:227], a[72:75], v[168:171]
    ds_read_b64_tr_b16 v[220:221], v11 offset:27712
    v_mfma_f32_16x16x32_bf16 v[168:171], v[228:231], a[88:91], v[168:171]
    ds_read_b64_tr_b16 v[222:223], v11 offset:32320
    v_mfma_f32_16x16x32_bf16 v[204:207], v[228:231], a[92:95], v[204:207]
    buffer_load_dwordx4 a[248:251], v7, s[36:39], s51 offen offset:2048 sc1
    v_mfma_f32_16x16x32_bf16 v[204:207], v[224:227], a[76:79], v[204:207]
    s_waitcnt vmcnt(27) lgkmcnt(8)
    v_mfma_f32_16x16x32_bf16 v[64:67], v[232:235], a[96:99], v[64:67]
    ds_read_b64_tr_b16 v[224:225], v11 offset:18528
    s_waitcnt vmcnt(23)
    v_mfma_f32_16x16x32_bf16 v[64:67], v[236:239], a[112:115], v[64:67]
    ds_read_b64_tr_b16 v[226:227], v11 offset:23136
    v_mfma_f32_16x16x32_bf16 v[100:103], v[236:239], a[116:119], v[100:103]
    buffer_load_dwordx4 a[252:255], v7, s[36:39], s51 offen offset:3072 sc1
    v_mfma_f32_16x16x32_bf16 v[100:103], v[232:235], a[100:103], v[100:103]
    s_add_u32 s50, s52, 147456
    s_add_u32 m0, s49, 36864
    v_mfma_f32_16x16x32_bf16 v[136:139], v[232:235], a[104:107], v[136:139]
    ds_read_b64_tr_b16 v[228:229], v11 offset:27744
    v_mfma_f32_16x16x32_bf16 v[136:139], v[236:239], a[120:123], v[136:139]
    ds_read_b64_tr_b16 v[230:231], v11 offset:32352
    v_mfma_f32_16x16x32_bf16 v[172:175], v[236:239], a[124:127], v[172:175]
    buffer_load_dwordx4 v52, s[8:11], s50 offen lds
    v_mfma_f32_16x16x32_bf16 v[172:175], v[232:235], a[108:111], v[172:175]
    s_add_u32 m0, s49, 37888
    s_waitcnt lgkmcnt(8)
    v_mfma_f32_16x16x32_bf16 v[68:71], v[208:211], a[96:99], v[68:71]
    ds_read_b64_tr_b16 v[232:233], v11 offset:18560
    v_mfma_f32_16x16x32_bf16 v[68:71], v[212:215], a[112:115], v[68:71]
    ds_read_b64_tr_b16 v[234:235], v11 offset:23168
    v_mfma_f32_16x16x32_bf16 v[104:107], v[212:215], a[116:119], v[104:107]
    buffer_load_dwordx4 v53, s[8:11], s50 offen lds
    v_mfma_f32_16x16x32_bf16 v[104:107], v[208:211], a[100:103], v[104:107]
    v_mfma_f32_16x16x32_bf16 v[140:143], v[208:211], a[104:107], v[140:143]
    ds_read_b64_tr_b16 v[236:237], v11 offset:27776
    v_mfma_f32_16x16x32_bf16 v[140:143], v[212:215], a[120:123], v[140:143]
    ds_read_b64_tr_b16 v[238:239], v11 offset:32384
    v_mfma_f32_16x16x32_bf16 v[176:179], v[212:215], a[124:127], v[176:179]
    v_mfma_f32_16x16x32_bf16 v[176:179], v[208:211], a[108:111], v[176:179]
    s_add_u32 m0, s49, 38912
    s_waitcnt lgkmcnt(8)
    v_mfma_f32_16x16x32_bf16 v[72:75], v[216:219], a[96:99], v[72:75]
    ds_read_b64_tr_b16 v[208:209], v11 offset:18592
    v_mfma_f32_16x16x32_bf16 v[72:75], v[220:223], a[112:115], v[72:75]
    ds_read_b64_tr_b16 v[210:211], v11 offset:23200
    v_mfma_f32_16x16x32_bf16 v[108:111], v[220:223], a[116:119], v[108:111]
    buffer_load_dwordx4 v54, s[8:11], s50 offen lds
    v_mfma_f32_16x16x32_bf16 v[108:111], v[216:219], a[100:103], v[108:111]
    s_add_u32 m0, s49, 39936
    v_mfma_f32_16x16x32_bf16 v[144:147], v[216:219], a[104:107], v[144:147]
    ds_read_b64_tr_b16 v[212:213], v11 offset:27808
    v_mfma_f32_16x16x32_bf16 v[144:147], v[220:223], a[120:123], v[144:147]
    ds_read_b64_tr_b16 v[214:215], v11 offset:32416
    v_mfma_f32_16x16x32_bf16 v[180:183], v[220:223], a[124:127], v[180:183]
    buffer_load_dwordx4 v55, s[8:11], s50 offen lds
    v_mfma_f32_16x16x32_bf16 v[180:183], v[216:219], a[108:111], v[180:183]
    s_add_u32 m0, s49, 40960
    s_waitcnt lgkmcnt(8)
    v_mfma_f32_16x16x32_bf16 v[76:79], v[224:227], a[96:99], v[76:79]
    ds_read_b64_tr_b16 v[216:217], v11 offset:18624
    v_mfma_f32_16x16x32_bf16 v[76:79], v[228:231], a[112:115], v[76:79]
    ds_read_b64_tr_b16 v[218:219], v11 offset:23232
    v_mfma_f32_16x16x32_bf16 v[112:115], v[228:231], a[116:119], v[112:115]
    buffer_load_dwordx4 v56, s[8:11], s50 offen lds
    v_mfma_f32_16x16x32_bf16 v[112:115], v[224:227], a[100:103], v[112:115]
    s_add_u32 m0, s49, 41984
    v_mfma_f32_16x16x32_bf16 v[148:151], v[224:227], a[104:107], v[148:151]
    ds_read_b64_tr_b16 v[220:221], v11 offset:27840
    v_mfma_f32_16x16x32_bf16 v[148:151], v[228:231], a[120:123], v[148:151]
    ds_read_b64_tr_b16 v[222:223], v11 offset:32448
    v_mfma_f32_16x16x32_bf16 v[184:187], v[228:231], a[124:127], v[184:187]
    buffer_load_dwordx4 v57, s[8:11], s50 offen lds
    v_mfma_f32_16x16x32_bf16 v[184:187], v[224:227], a[108:111], v[184:187]
    s_waitcnt lgkmcnt(8)
    v_mfma_f32_16x16x32_bf16 v[80:83], v[232:235], a[96:99], v[80:83]
    ds_read_b64_tr_b16 v[224:225], v11 offset:18656
    v_mfma_f32_16x16x32_bf16 v[80:83], v[236:239], a[112:115], v[80:83]
    ds_read_b64_tr_b16 v[226:227], v11 offset:23264
    v_mfma_f32_16x16x32_bf16 v[116:119], v[236:239], a[116:119], v[116:119]
    v_mfma_f32_16x16x32_bf16 v[116:119], v[232:235], a[100:103], v[116:119]
    s_add_u32 m0, s49, 43008
    v_mfma_f32_16x16x32_bf16 v[152:155], v[232:235], a[104:107], v[152:155]
    ds_read_b64_tr_b16 v[228:229], v11 offset:27872
    v_mfma_f32_16x16x32_bf16 v[152:155], v[236:239], a[120:123], v[152:155]
    ds_read_b64_tr_b16 v[230:231], v11 offset:32480
    v_mfma_f32_16x16x32_bf16 v[188:191], v[236:239], a[124:127], v[188:191]
    buffer_load_dwordx4 v58, s[8:11], s50 offen lds
    v_mfma_f32_16x16x32_bf16 v[188:191], v[232:235], a[108:111], v[188:191]
    s_add_u32 m0, s49, 44032
    s_waitcnt lgkmcnt(8)
    v_mfma_f32_16x16x32_bf16 v[84:87], v[208:211], a[96:99], v[84:87]
    ds_read_b64_tr_b16 v[232:233], v11 offset:18688
    v_mfma_f32_16x16x32_bf16 v[84:87], v[212:215], a[112:115], v[84:87]
    ds_read_b64_tr_b16 v[234:235], v11 offset:23296
    v_mfma_f32_16x16x32_bf16 v[120:123], v[212:215], a[116:119], v[120:123]
    buffer_load_dwordx4 v59, s[8:11], s50 offen lds
    v_mfma_f32_16x16x32_bf16 v[120:123], v[208:211], a[100:103], v[120:123]
    s_add_u32 m0, s49, 45056
    v_mfma_f32_16x16x32_bf16 v[156:159], v[208:211], a[104:107], v[156:159]
    ds_read_b64_tr_b16 v[236:237], v11 offset:27904
    v_mfma_f32_16x16x32_bf16 v[156:159], v[212:215], a[120:123], v[156:159]
    ds_read_b64_tr_b16 v[238:239], v11 offset:32512
    v_mfma_f32_16x16x32_bf16 v[192:195], v[212:215], a[124:127], v[192:195]
    buffer_load_dwordx4 v60, s[8:11], s50 offen lds
    v_mfma_f32_16x16x32_bf16 v[192:195], v[208:211], a[108:111], v[192:195]
    s_add_u32 s51, s62, 16384
    s_waitcnt lgkmcnt(8)
    v_mfma_f32_16x16x32_bf16 v[88:91], v[216:219], a[96:99], v[88:91]
    v_mfma_f32_16x16x32_bf16 v[88:91], v[220:223], a[112:115], v[88:91]
    v_mfma_f32_16x16x32_bf16 v[124:127], v[220:223], a[116:119], v[124:127]
    buffer_load_dwordx4 a[128:131], v7, s[36:39], s51 offen offset:0 sc1
    v_mfma_f32_16x16x32_bf16 v[124:127], v[216:219], a[100:103], v[124:127]
    v_mfma_f32_16x16x32_bf16 v[160:163], v[216:219], a[104:107], v[160:163]
    v_mfma_f32_16x16x32_bf16 v[160:163], v[220:223], a[120:123], v[160:163]
    v_mfma_f32_16x16x32_bf16 v[196:199], v[220:223], a[124:127], v[196:199]
    v_mfma_f32_16x16x32_bf16 v[196:199], v[216:219], a[108:111], v[196:199]
    s_waitcnt vmcnt(26) lgkmcnt(0)
    s_barrier
    v_mfma_f32_16x16x32_bf16 v[92:95], v[224:227], a[96:99], v[92:95]
    ds_read_b64_tr_b16 v[208:209], v8 offset:0
    ds_read_b64_tr_b16 v[210:211], v8 offset:4608
    v_mfma_f32_16x16x32_bf16 v[92:95], v[228:231], a[112:115], v[92:95]
    ds_read_b64_tr_b16 v[212:213], v8 offset:9216
    ds_read_b64_tr_b16 v[214:215], v8 offset:13824
    v_mfma_f32_16x16x32_bf16 v[128:131], v[228:231], a[116:119], v[128:131]
    ds_read_b64_tr_b16 v[216:217], v8 offset:32
    ds_read_b64_tr_b16 v[218:219], v8 offset:4640
    v_mfma_f32_16x16x32_bf16 v[128:131], v[224:227], a[100:103], v[128:131]
    v_mfma_f32_16x16x32_bf16 v[164:167], v[224:227], a[104:107], v[164:167]
    ds_read_b64_tr_b16 v[220:221], v8 offset:9248
    v_mfma_f32_16x16x32_bf16 v[164:167], v[228:231], a[120:123], v[164:167]
    ds_read_b64_tr_b16 v[222:223], v8 offset:13856
    v_mfma_f32_16x16x32_bf16 v[200:203], v[228:231], a[124:127], v[200:203]
    buffer_load_dwordx4 a[132:135], v7, s[36:39], s51 offen offset:1024 sc1
    v_mfma_f32_16x16x32_bf16 v[200:203], v[224:227], a[108:111], v[200:203]
    v_mfma_f32_16x16x32_bf16 v[96:99], v[232:235], a[96:99], v[96:99]
    ds_read_b64_tr_b16 v[224:225], v8 offset:64
    v_mfma_f32_16x16x32_bf16 v[96:99], v[236:239], a[112:115], v[96:99]
    ds_read_b64_tr_b16 v[226:227], v8 offset:4672
    v_mfma_f32_16x16x32_bf16 v[132:135], v[236:239], a[116:119], v[132:135]
    buffer_load_dwordx4 a[136:139], v7, s[36:39], s51 offen offset:2048 sc1
    v_mfma_f32_16x16x32_bf16 v[132:135], v[232:235], a[100:103], v[132:135]
    v_mfma_f32_16x16x32_bf16 v[168:171], v[232:235], a[104:107], v[168:171]
    ds_read_b64_tr_b16 v[228:229], v8 offset:9280
    v_mfma_f32_16x16x32_bf16 v[168:171], v[236:239], a[120:123], v[168:171]
    ds_read_b64_tr_b16 v[230:231], v8 offset:13888
    v_mfma_f32_16x16x32_bf16 v[204:207], v[236:239], a[124:127], v[204:207]
    buffer_load_dwordx4 a[140:143], v7, s[36:39], s51 offen offset:3072 sc1
    v_mfma_f32_16x16x32_bf16 v[204:207], v[232:235], a[108:111], v[204:207]
    s_add_u32 s51, s62, 20480
    s_waitcnt vmcnt(25) lgkmcnt(8)
    v_mfma_f32_16x16x32_bf16 v[64:67], v[208:211], a[192:195], v[64:67]
    ds_read_b64_tr_b16 v[232:233], v8 offset:96
    s_waitcnt vmcnt(21)
    v_mfma_f32_16x16x32_bf16 v[64:67], v[212:215], a[208:211], v[64:67]
    ds_read_b64_tr_b16 v[234:235], v8 offset:4704
    v_mfma_f32_16x16x32_bf16 v[100:103], v[212:215], a[212:215], v[100:103]
    buffer_load_dwordx4 a[144:147], v7, s[36:39], s51 offen offset:0 sc1
    v_mfma_f32_16x16x32_bf16 v[100:103], v[208:211], a[196:199], v[100:103]
    v_mfma_f32_16x16x32_bf16 v[136:139], v[208:211], a[200:203], v[136:139]
    ds_read_b64_tr_b16 v[236:237], v8 offset:9312
    v_mfma_f32_16x16x32_bf16 v[136:139], v[212:215], a[216:219], v[136:139]
    ds_read_b64_tr_b16 v[238:239], v8 offset:13920
    v_mfma_f32_16x16x32_bf16 v[172:175], v[212:215], a[220:223], v[172:175]
    v_mfma_f32_16x16x32_bf16 v[172:175], v[208:211], a[204:207], v[172:175]
    s_waitcnt lgkmcnt(8)
    v_mfma_f32_16x16x32_bf16 v[68:71], v[216:219], a[192:195], v[68:71]
    ds_read_b64_tr_b16 v[208:209], v8 offset:128
    v_mfma_f32_16x16x32_bf16 v[68:71], v[220:223], a[208:211], v[68:71]
    ds_read_b64_tr_b16 v[210:211], v8 offset:4736
    v_mfma_f32_16x16x32_bf16 v[104:107], v[220:223], a[212:215], v[104:107]
    buffer_load_dwordx4 a[148:151], v7, s[36:39], s51 offen offset:1024 sc1
    v_mfma_f32_16x16x32_bf16 v[104:107], v[216:219], a[196:199], v[104:107]
    v_mfma_f32_16x16x32_bf16 v[140:143], v[216:219], a[200:203], v[140:143]
    ds_read_b64_tr_b16 v[212:213], v8 offset:9344
    v_mfma_f32_16x16x32_bf16 v[140:143], v[220:223], a[216:219], v[140:143]
    ds_read_b64_tr_b16 v[214:215], v8 offset:13952
    v_mfma_f32_16x16x32_bf16 v[176:179], v[220:223], a[220:223], v[176:179]
    buffer_load_dwordx4 a[152:155], v7, s[36:39], s51 offen offset:2048 sc1
    v_mfma_f32_16x16x32_bf16 v[176:179], v[216:219], a[204:207], v[176:179]
    s_waitcnt lgkmcnt(8)
    v_mfma_f32_16x16x32_bf16 v[72:75], v[224:227], a[192:195], v[72:75]
    ds_read_b64_tr_b16 v[216:217], v8 offset:160
    v_mfma_f32_16x16x32_bf16 v[72:75], v[228:231], a[208:211], v[72:75]
    ds_read_b64_tr_b16 v[218:219], v8 offset:4768
    v_mfma_f32_16x16x32_bf16 v[108:111], v[228:231], a[212:215], v[108:111]
    buffer_load_dwordx4 a[156:159], v7, s[36:39], s51 offen offset:3072 sc1
    v_mfma_f32_16x16x32_bf16 v[108:111], v[224:227], a[196:199], v[108:111]
    s_add_u32 s51, s62, 24576
    v_mfma_f32_16x16x32_bf16 v[144:147], v[224:227], a[200:203], v[144:147]
    ds_read_b64_tr_b16 v[220:221], v8 offset:9376
    v_mfma_f32_16x16x32_bf16 v[144:147], v[228:231], a[216:219], v[144:147]
    ds_read_b64_tr_b16 v[222:223], v8 offset:13984
    v_mfma_f32_16x16x32_bf16 v[180:183], v[228:231], a[220:223], v[180:183]
    buffer_load_dwordx4 a[160:163], v7, s[36:39], s51 offen offset:0 sc1
    v_mfma_f32_16x16x32_bf16 v[180:183], v[224:227], a[204:207], v[180:183]
    s_waitcnt lgkmcnt(8)
    v_mfma_f32_16x16x32_bf16 v[76:79], v[232:235], a[192:195], v[76:79]
    ds_read_b64_tr_b16 v[224:225], v8 offset:192
    v_mfma_f32_16x16x32_bf16 v[76:79], v[236:239], a[208:211], v[76:79]
    ds_read_b64_tr_b16 v[226:227], v8 offset:4800
    v_mfma_f32_16x16x32_bf16 v[112:115], v[236:239], a[212:215], v[112:115]
    v_mfma_f32_16x16x32_bf16 v[112:115], v[232:235], a[196:199], v[112:115]
    v_mfma_f32_16x16x32_bf16 v[148:151], v[232:235], a[200:203], v[148:151]
    ds_read_b64_tr_b16 v[228:229], v8 offset:9408
    v_mfma_f32_16x16x32_bf16 v[148:151], v[236:239], a[216:219], v[148:151]
    ds_read_b64_tr_b16 v[230:231], v8 offset:14016
    v_mfma_f32_16x16x32_bf16 v[184:187], v[236:239], a[220:223], v[184:187]
    buffer_load_dwordx4 a[164:167], v7, s[36:39], s51 offen offset:2048 sc1
    v_mfma_f32_16x16x32_bf16 v[184:187], v[232:235], a[204:207], v[184:187]
    s_waitcnt lgkmcnt(8)
    v_mfma_f32_16x16x32_bf16 v[80:83], v[208:211], a[192:195], v[80:83]
    ds_read_b64_tr_b16 v[232:233], v8 offset:224
    v_mfma_f32_16x16x32_bf16 v[80:83], v[212:215], a[208:211], v[80:83]
    ds_read_b64_tr_b16 v[234:235], v8 offset:4832
    v_mfma_f32_16x16x32_bf16 v[116:119], v[212:215], a[212:215], v[116:119]
    buffer_load_dwordx4 a[168:171], v7, s[36:39], s51 offen offset:1024 sc1
    v_mfma_f32_16x16x32_bf16 v[116:119], v[208:211], a[196:199], v[116:119]
    v_mfma_f32_16x16x32_bf16 v[152:155], v[208:211], a[200:203], v[152:155]
    ds_read_b64_tr_b16 v[236:237], v8 offset:9440
    v_mfma_f32_16x16x32_bf16 v[152:155], v[212:215], a[216:219], v[152:155]
    ds_read_b64_tr_b16 v[238:239], v8 offset:14048
    v_mfma_f32_16x16x32_bf16 v[188:191], v[212:215], a[220:223], v[188:191]
    buffer_load_dwordx4 a[172:175], v7, s[36:39], s51 offen offset:3072 sc1
    v_mfma_f32_16x16x32_bf16 v[188:191], v[208:211], a[204:207], v[188:191]
    s_add_u32 s51, s62, 28672
    s_waitcnt lgkmcnt(8)
    v_mfma_f32_16x16x32_bf16 v[84:87], v[216:219], a[192:195], v[84:87]
    ds_read_b64_tr_b16 v[208:209], v8 offset:256
    v_mfma_f32_16x16x32_bf16 v[84:87], v[220:223], a[208:211], v[84:87]
    ds_read_b64_tr_b16 v[210:211], v8 offset:4864
    v_mfma_f32_16x16x32_bf16 v[120:123], v[220:223], a[212:215], v[120:123]
    buffer_load_dwordx4 a[176:179], v7, s[36:39], s51 offen offset:0 sc1
    v_mfma_f32_16x16x32_bf16 v[120:123], v[216:219], a[196:199], v[120:123]
    v_mfma_f32_16x16x32_bf16 v[156:159], v[216:219], a[200:203], v[156:159]
    ds_read_b64_tr_b16 v[212:213], v8 offset:9472
    v_mfma_f32_16x16x32_bf16 v[156:159], v[220:223], a[216:219], v[156:159]
    ds_read_b64_tr_b16 v[214:215], v8 offset:14080
    v_mfma_f32_16x16x32_bf16 v[192:195], v[220:223], a[220:223], v[192:195]
    v_mfma_f32_16x16x32_bf16 v[192:195], v[216:219], a[204:207], v[192:195]
    s_waitcnt lgkmcnt(8)
    v_mfma_f32_16x16x32_bf16 v[88:91], v[224:227], a[192:195], v[88:91]
    ds_read_b64_tr_b16 v[216:217], v8 offset:18432
    v_mfma_f32_16x16x32_bf16 v[88:91], v[228:231], a[208:211], v[88:91]
    ds_read_b64_tr_b16 v[218:219], v8 offset:23040
    v_mfma_f32_16x16x32_bf16 v[124:127], v[228:231], a[212:215], v[124:127]
    buffer_load_dwordx4 a[180:183], v7, s[36:39], s51 offen offset:1024 sc1
    v_mfma_f32_16x16x32_bf16 v[124:127], v[224:227], a[196:199], v[124:127]
    v_mfma_f32_16x16x32_bf16 v[160:163], v[224:227], a[200:203], v[160:163]
    ds_read_b64_tr_b16 v[220:221], v8 offset:27648
    v_mfma_f32_16x16x32_bf16 v[160:163], v[228:231], a[216:219], v[160:163]
    ds_read_b64_tr_b16 v[222:223], v8 offset:32256
    v_mfma_f32_16x16x32_bf16 v[196:199], v[228:231], a[220:223], v[196:199]
    buffer_load_dwordx4 a[184:187], v7, s[36:39], s51 offen offset:2048 sc1
    v_mfma_f32_16x16x32_bf16 v[196:199], v[224:227], a[204:207], v[196:199]
    s_waitcnt lgkmcnt(8)
    v_mfma_f32_16x16x32_bf16 v[92:95], v[232:235], a[192:195], v[92:95]
    ds_read_b64_tr_b16 v[224:225], v8 offset:18464
    v_mfma_f32_16x16x32_bf16 v[92:95], v[236:239], a[208:211], v[92:95]
    ds_read_b64_tr_b16 v[226:227], v8 offset:23072
    v_mfma_f32_16x16x32_bf16 v[128:131], v[236:239], a[212:215], v[128:131]
    buffer_load_dwordx4 a[188:191], v7, s[36:39], s51 offen offset:3072 sc1
    v_mfma_f32_16x16x32_bf16 v[128:131], v[232:235], a[196:199], v[128:131]
    s_add_u32 s50, s52, 294912
    s_add_u32 m0, s49, 73728
    v_mfma_f32_16x16x32_bf16 v[164:167], v[232:235], a[200:203], v[164:167]
    ds_read_b64_tr_b16 v[228:229], v8 offset:27680
    v_mfma_f32_16x16x32_bf16 v[164:167], v[236:239], a[216:219], v[164:167]
    ds_read_b64_tr_b16 v[230:231], v8 offset:32288
    v_mfma_f32_16x16x32_bf16 v[200:203], v[236:239], a[220:223], v[200:203]
    buffer_load_dwordx4 v52, s[8:11], s50 offen lds
    v_mfma_f32_16x16x32_bf16 v[200:203], v[232:235], a[204:207], v[200:203]
    s_waitcnt lgkmcnt(8)
    v_mfma_f32_16x16x32_bf16 v[96:99], v[208:211], a[192:195], v[96:99]
    ds_read_b64_tr_b16 v[232:233], v8 offset:18496
    v_mfma_f32_16x16x32_bf16 v[96:99], v[212:215], a[208:211], v[96:99]
    ds_read_b64_tr_b16 v[234:235], v8 offset:23104
    v_mfma_f32_16x16x32_bf16 v[132:135], v[212:215], a[212:215], v[132:135]
    v_mfma_f32_16x16x32_bf16 v[132:135], v[208:211], a[196:199], v[132:135]
    s_add_u32 m0, s49, 74752
    v_mfma_f32_16x16x32_bf16 v[168:171], v[208:211], a[200:203], v[168:171]
    ds_read_b64_tr_b16 v[236:237], v8 offset:27712
    v_mfma_f32_16x16x32_bf16 v[168:171], v[212:215], a[216:219], v[168:171]
    ds_read_b64_tr_b16 v[238:239], v8 offset:32320
    v_mfma_f32_16x16x32_bf16 v[204:207], v[212:215], a[220:223], v[204:207]
    buffer_load_dwordx4 v53, s[8:11], s50 offen lds
    v_mfma_f32_16x16x32_bf16 v[204:207], v[208:211], a[204:207], v[204:207]
    s_add_u32 m0, s49, 75776
    s_waitcnt vmcnt(31) lgkmcnt(8)
    v_mfma_f32_16x16x32_bf16 v[64:67], v[216:219], a[224:227], v[64:67]
    ds_read_b64_tr_b16 v[208:209], v8 offset:18528
    s_waitcnt vmcnt(27)
    v_mfma_f32_16x16x32_bf16 v[64:67], v[220:223], a[240:243], v[64:67]
    ds_read_b64_tr_b16 v[210:211], v8 offset:23136
    v_mfma_f32_16x16x32_bf16 v[100:103], v[220:223], a[244:247], v[100:103]
    buffer_load_dwordx4 v54, s[8:11], s50 offen lds
    v_mfma_f32_16x16x32_bf16 v[100:103], v[216:219], a[228:231], v[100:103]
    s_add_u32 m0, s49, 76800
    v_mfma_f32_16x16x32_bf16 v[136:139], v[216:219], a[232:235], v[136:139]
    ds_read_b64_tr_b16 v[212:213], v8 offset:27744
    v_mfma_f32_16x16x32_bf16 v[136:139], v[220:223], a[248:251], v[136:139]
    ds_read_b64_tr_b16 v[214:215], v8 offset:32352
    v_mfma_f32_16x16x32_bf16 v[172:175], v[220:223], a[252:255], v[172:175]
    buffer_load_dwordx4 v55, s[8:11], s50 offen lds
    v_mfma_f32_16x16x32_bf16 v[172:175], v[216:219], a[236:239], v[172:175]
    s_add_u32 m0, s49, 77824
    s_waitcnt lgkmcnt(8)
    v_mfma_f32_16x16x32_bf16 v[68:71], v[224:227], a[224:227], v[68:71]
    ds_read_b64_tr_b16 v[216:217], v8 offset:18560
    v_mfma_f32_16x16x32_bf16 v[68:71], v[228:231], a[240:243], v[68:71]
    ds_read_b64_tr_b16 v[218:219], v8 offset:23168
    v_mfma_f32_16x16x32_bf16 v[104:107], v[228:231], a[244:247], v[104:107]
    buffer_load_dwordx4 v56, s[8:11], s50 offen lds
    v_mfma_f32_16x16x32_bf16 v[104:107], v[224:227], a[228:231], v[104:107]
    v_mfma_f32_16x16x32_bf16 v[140:143], v[224:227], a[232:235], v[140:143]
    ds_read_b64_tr_b16 v[220:221], v8 offset:27776
    v_mfma_f32_16x16x32_bf16 v[140:143], v[228:231], a[248:251], v[140:143]
    ds_read_b64_tr_b16 v[222:223], v8 offset:32384
    v_mfma_f32_16x16x32_bf16 v[176:179], v[228:231], a[252:255], v[176:179]
    v_mfma_f32_16x16x32_bf16 v[176:179], v[224:227], a[236:239], v[176:179]
    s_add_u32 m0, s49, 78848
    s_waitcnt lgkmcnt(8)
    v_mfma_f32_16x16x32_bf16 v[72:75], v[232:235], a[224:227], v[72:75]
    ds_read_b64_tr_b16 v[224:225], v8 offset:18592
    v_mfma_f32_16x16x32_bf16 v[72:75], v[236:239], a[240:243], v[72:75]
    ds_read_b64_tr_b16 v[226:227], v8 offset:23200
    v_mfma_f32_16x16x32_bf16 v[108:111], v[236:239], a[244:247], v[108:111]
    buffer_load_dwordx4 v57, s[8:11], s50 offen lds
    v_mfma_f32_16x16x32_bf16 v[108:111], v[232:235], a[228:231], v[108:111]
    s_add_u32 m0, s49, 79872
    v_mfma_f32_16x16x32_bf16 v[144:147], v[232:235], a[232:235], v[144:147]
    ds_read_b64_tr_b16 v[228:229], v8 offset:27808
    v_mfma_f32_16x16x32_bf16 v[144:147], v[236:239], a[248:251], v[144:147]
    ds_read_b64_tr_b16 v[230:231], v8 offset:32416
    v_mfma_f32_16x16x32_bf16 v[180:183], v[236:239], a[252:255], v[180:183]
    buffer_load_dwordx4 v58, s[8:11], s50 offen lds
    v_mfma_f32_16x16x32_bf16 v[180:183], v[232:235], a[236:239], v[180:183]
    s_add_u32 m0, s49, 80896
    s_waitcnt lgkmcnt(8)
    v_mfma_f32_16x16x32_bf16 v[76:79], v[208:211], a[224:227], v[76:79]
    ds_read_b64_tr_b16 v[232:233], v8 offset:18624
    v_mfma_f32_16x16x32_bf16 v[76:79], v[212:215], a[240:243], v[76:79]
    ds_read_b64_tr_b16 v[234:235], v8 offset:23232
    v_mfma_f32_16x16x32_bf16 v[112:115], v[212:215], a[244:247], v[112:115]
    buffer_load_dwordx4 v59, s[8:11], s50 offen lds
    v_mfma_f32_16x16x32_bf16 v[112:115], v[208:211], a[228:231], v[112:115]
    s_add_u32 m0, s49, 81920
    v_mfma_f32_16x16x32_bf16 v[148:151], v[208:211], a[232:235], v[148:151]
    ds_read_b64_tr_b16 v[236:237], v8 offset:27840
    v_mfma_f32_16x16x32_bf16 v[148:151], v[212:215], a[248:251], v[148:151]
    ds_read_b64_tr_b16 v[238:239], v8 offset:32448
    v_mfma_f32_16x16x32_bf16 v[184:187], v[212:215], a[252:255], v[184:187]
    buffer_load_dwordx4 v60, s[8:11], s50 offen lds
    v_mfma_f32_16x16x32_bf16 v[184:187], v[208:211], a[236:239], v[184:187]
    s_waitcnt lgkmcnt(8)
    v_mfma_f32_16x16x32_bf16 v[80:83], v[216:219], a[224:227], v[80:83]
    ds_read_b64_tr_b16 v[208:209], v8 offset:18656
    v_mfma_f32_16x16x32_bf16 v[80:83], v[220:223], a[240:243], v[80:83]
    ds_read_b64_tr_b16 v[210:211], v8 offset:23264
    v_mfma_f32_16x16x32_bf16 v[116:119], v[220:223], a[244:247], v[116:119]
    v_mfma_f32_16x16x32_bf16 v[116:119], v[216:219], a[228:231], v[116:119]
    s_add_u32 s51, s62, 32768
    v_mfma_f32_16x16x32_bf16 v[152:155], v[216:219], a[232:235], v[152:155]
    ds_read_b64_tr_b16 v[212:213], v8 offset:27872
    v_mfma_f32_16x16x32_bf16 v[152:155], v[220:223], a[248:251], v[152:155]
    ds_read_b64_tr_b16 v[214:215], v8 offset:32480
    v_mfma_f32_16x16x32_bf16 v[188:191], v[220:223], a[252:255], v[188:191]
    buffer_load_dwordx4 a[0:3], v7, s[36:39], s51 offen offset:0 sc1
    v_mfma_f32_16x16x32_bf16 v[188:191], v[216:219], a[236:239], v[188:191]
    s_waitcnt lgkmcnt(8)
    v_mfma_f32_16x16x32_bf16 v[84:87], v[224:227], a[224:227], v[84:87]
    ds_read_b64_tr_b16 v[216:217], v8 offset:18688
    v_mfma_f32_16x16x32_bf16 v[84:87], v[228:231], a[240:243], v[84:87]
    ds_read_b64_tr_b16 v[218:219], v8 offset:23296
    v_mfma_f32_16x16x32_bf16 v[120:123], v[228:231], a[244:247], v[120:123]
    buffer_load_dwordx4 a[4:7], v7, s[36:39], s51 offen offset:1024 sc1
    v_mfma_f32_16x16x32_bf16 v[120:123], v[224:227], a[228:231], v[120:123]
    v_mfma_f32_16x16x32_bf16 v[156:159], v[224:227], a[232:235], v[156:159]
    ds_read_b64_tr_b16 v[220:221], v8 offset:27904
    v_mfma_f32_16x16x32_bf16 v[156:159], v[228:231], a[248:251], v[156:159]
    ds_read_b64_tr_b16 v[222:223], v8 offset:32512
    v_mfma_f32_16x16x32_bf16 v[192:195], v[228:231], a[252:255], v[192:195]
    buffer_load_dwordx4 a[8:11], v7, s[36:39], s51 offen offset:2048 sc1
    v_mfma_f32_16x16x32_bf16 v[192:195], v[224:227], a[236:239], v[192:195]
    s_waitcnt lgkmcnt(8)
    v_mfma_f32_16x16x32_bf16 v[88:91], v[232:235], a[224:227], v[88:91]
    v_mfma_f32_16x16x32_bf16 v[88:91], v[236:239], a[240:243], v[88:91]
    v_mfma_f32_16x16x32_bf16 v[124:127], v[236:239], a[244:247], v[124:127]
    buffer_load_dwordx4 a[12:15], v7, s[36:39], s51 offen offset:3072 sc1
    v_mfma_f32_16x16x32_bf16 v[124:127], v[232:235], a[228:231], v[124:127]
    v_mfma_f32_16x16x32_bf16 v[160:163], v[232:235], a[232:235], v[160:163]
    v_mfma_f32_16x16x32_bf16 v[160:163], v[236:239], a[248:251], v[160:163]
    v_mfma_f32_16x16x32_bf16 v[196:199], v[236:239], a[252:255], v[196:199]
    v_mfma_f32_16x16x32_bf16 v[196:199], v[232:235], a[236:239], v[196:199]
    s_waitcnt vmcnt(29) lgkmcnt(0)
    s_barrier
    v_mfma_f32_16x16x32_bf16 v[92:95], v[208:211], a[224:227], v[92:95]
    ds_read_b64_tr_b16 v[224:225], v9 offset:0
    ds_read_b64_tr_b16 v[226:227], v9 offset:4608
    v_mfma_f32_16x16x32_bf16 v[92:95], v[212:215], a[240:243], v[92:95]
    ds_read_b64_tr_b16 v[228:229], v9 offset:9216
    ds_read_b64_tr_b16 v[230:231], v9 offset:13824
    v_mfma_f32_16x16x32_bf16 v[128:131], v[212:215], a[244:247], v[128:131]
    ds_read_b64_tr_b16 v[232:233], v9 offset:32
    ds_read_b64_tr_b16 v[234:235], v9 offset:4640
    v_mfma_f32_16x16x32_bf16 v[128:131], v[208:211], a[228:231], v[128:131]
    s_add_u32 s51, s62, 36864
    v_mfma_f32_16x16x32_bf16 v[164:167], v[208:211], a[232:235], v[164:167]
    ds_read_b64_tr_b16 v[236:237], v9 offset:9248
    v_mfma_f32_16x16x32_bf16 v[164:167], v[212:215], a[248:251], v[164:167]
    ds_read_b64_tr_b16 v[238:239], v9 offset:13856
    v_mfma_f32_16x16x32_bf16 v[200:203], v[212:215], a[252:255], v[200:203]
    buffer_load_dwordx4 a[16:19], v7, s[36:39], s51 offen offset:0 sc1
    v_mfma_f32_16x16x32_bf16 v[200:203], v[208:211], a[236:239], v[200:203]
    v_mfma_f32_16x16x32_bf16 v[96:99], v[216:219], a[224:227], v[96:99]
    ds_read_b64_tr_b16 v[208:209], v9 offset:64
    v_mfma_f32_16x16x32_bf16 v[96:99], v[220:223], a[240:243], v[96:99]
    ds_read_b64_tr_b16 v[210:211], v9 offset:4672
    v_mfma_f32_16x16x32_bf16 v[132:135], v[220:223], a[244:247], v[132:135]
    buffer_load_dwordx4 a[20:23], v7, s[36:39], s51 offen offset:1024 sc1
    v_mfma_f32_16x16x32_bf16 v[132:135], v[216:219], a[228:231], v[132:135]
    v_mfma_f32_16x16x32_bf16 v[168:171], v[216:219], a[232:235], v[168:171]
    ds_read_b64_tr_b16 v[212:213], v9 offset:9280
    v_mfma_f32_16x16x32_bf16 v[168:171], v[220:223], a[248:251], v[168:171]
    ds_read_b64_tr_b16 v[214:215], v9 offset:13888
    v_mfma_f32_16x16x32_bf16 v[204:207], v[220:223], a[252:255], v[204:207]
    buffer_load_dwordx4 a[24:27], v7, s[36:39], s51 offen offset:2048 sc1
    v_mfma_f32_16x16x32_bf16 v[204:207], v[216:219], a[236:239], v[204:207]
    s_waitcnt vmcnt(28) lgkmcnt(8)
    v_mfma_f32_16x16x32_bf16 v[64:67], v[224:227], a[128:131], v[64:67]
    ds_read_b64_tr_b16 v[216:217], v9 offset:96
    s_waitcnt vmcnt(24)
    v_mfma_f32_16x16x32_bf16 v[64:67], v[228:231], a[144:147], v[64:67]
    ds_read_b64_tr_b16 v[218:219], v9 offset:4704
    v_mfma_f32_16x16x32_bf16 v[100:103], v[228:231], a[148:151], v[100:103]
    buffer_load_dwordx4 a[28:31], v7, s[36:39], s51 offen offset:3072 sc1
    v_mfma_f32_16x16x32_bf16 v[100:103], v[224:227], a[132:135], v[100:103]
    v_mfma_f32_16x16x32_bf16 v[136:139], v[224:227], a[136:139], v[136:139]
    ds_read_b64_tr_b16 v[220:221], v9 offset:9312
    v_mfma_f32_16x16x32_bf16 v[136:139], v[228:231], a[152:155], v[136:139]
    ds_read_b64_tr_b16 v[222:223], v9 offset:13920
    v_mfma_f32_16x16x32_bf16 v[172:175], v[228:231], a[156:159], v[172:175]
    v_mfma_f32_16x16x32_bf16 v[172:175], v[224:227], a[140:143], v[172:175]
    s_add_u32 s51, s62, 40960
    s_waitcnt lgkmcnt(8)
    v_mfma_f32_16x16x32_bf16 v[68:71], v[232:235], a[128:131], v[68:71]
    ds_read_b64_tr_b16 v[224:225], v9 offset:128
    v_mfma_f32_16x16x32_bf16 v[68:71], v[236:239], a[144:147], v[68:71]
    ds_read_b64_tr_b16 v[226:227], v9 offset:4736
    v_mfma_f32_16x16x32_bf16 v[104:107], v[236:239], a[148:151], v[104:107]
    buffer_load_dwordx4 a[32:35], v7, s[36:39], s51 offen offset:0 sc1
    v_mfma_f32_16x16x32_bf16 v[104:107], v[232:235], a[132:135], v[104:107]
    v_mfma_f32_16x16x32_bf16 v[140:143], v[232:235], a[136:139], v[140:143]
    ds_read_b64_tr_b16 v[228:229], v9 offset:9344
    v_mfma_f32_16x16x32_bf16 v[140:143], v[236:239], a[152:155], v[140:143]
    ds_read_b64_tr_b16 v[230:231], v9 offset:13952
    v_mfma_f32_16x16x32_bf16 v[176:179], v[236:239], a[156:159], v[176:179]
    buffer_load_dwordx4 a[36:39], v7, s[36:39], s51 offen offset:1024 sc1
    v_mfma_f32_16x16x32_bf16 v[176:179], v[232:235], a[140:143], v[176:179]
    s_waitcnt lgkmcnt(8)
    v_mfma_f32_16x16x32_bf16 v[72:75], v[208:211], a[128:131], v[72:75]
    ds_read_b64_tr_b16 v[232:233], v9 offset:160
    v_mfma_f32_16x16x32_bf16 v[72:75], v[212:215], a[144:147], v[72:75]
    ds_read_b64_tr_b16 v[234:235], v9 offset:4768
    v_mfma_f32_16x16x32_bf16 v[108:111], v[212:215], a[148:151], v[108:111]
    buffer_load_dwordx4 a[40:43], v7, s[36:39], s51 offen offset:2048 sc1
    v_mfma_f32_16x16x32_bf16 v[108:111], v[208:211], a[132:135], v[108:111]
    v_mfma_f32_16x16x32_bf16 v[144:147], v[208:211], a[136:139], v[144:147]
    ds_read_b64_tr_b16 v[236:237], v9 offset:9376
    v_mfma_f32_16x16x32_bf16 v[144:147], v[212:215], a[152:155], v[144:147]
    ds_read_b64_tr_b16 v[238:239], v9 offset:13984
    v_mfma_f32_16x16x32_bf16 v[180:183], v[212:215], a[156:159], v[180:183]
    buffer_load_dwordx4 a[44:47], v7, s[36:39], s51 offen offset:3072 sc1
    v_mfma_f32_16x16x32_bf16 v[180:183], v[208:211], a[140:143], v[180:183]
    s_waitcnt lgkmcnt(8)
    v_mfma_f32_16x16x32_bf16 v[76:79], v[216:219], a[128:131], v[76:79]
    ds_read_b64_tr_b16 v[208:209], v9 offset:192
    v_mfma_f32_16x16x32_bf16 v[76:79], v[220:223], a[144:147], v[76:79]
    ds_read_b64_tr_b16 v[210:211], v9 offset:4800
    v_mfma_f32_16x16x32_bf16 v[112:115], v[220:223], a[148:151], v[112:115]
    v_mfma_f32_16x16x32_bf16 v[112:115], v[216:219], a[132:135], v[112:115]
    s_add_u32 s51, s62, 45056
    v_mfma_f32_16x16x32_bf16 v[148:151], v[216:219], a[136:139], v[148:151]
    ds_read_b64_tr_b16 v[212:213], v9 offset:9408
    v_mfma_f32_16x16x32_bf16 v[148:151], v[220:223], a[152:155], v[148:151]
    ds_read_b64_tr_b16 v[214:215], v9 offset:14016
    v_mfma_f32_16x16x32_bf16 v[184:187], v[220:223], a[156:159], v[184:187]
    buffer_load_dwordx4 a[48:51], v7, s[36:39], s51 offen offset:0 sc1
    v_mfma_f32_16x16x32_bf16 v[184:187], v[216:219], a[140:143], v[184:187]
    s_waitcnt lgkmcnt(8)
    v_mfma_f32_16x16x32_bf16 v[80:83], v[224:227], a[128:131], v[80:83]
    ds_read_b64_tr_b16 v[216:217], v9 offset:224
    v_mfma_f32_16x16x32_bf16 v[80:83], v[228:231], a[144:147], v[80:83]
    ds_read_b64_tr_b16 v[218:219], v9 offset:4832
    v_mfma_f32_16x16x32_bf16 v[116:119], v[228:231], a[148:151], v[116:119]
    buffer_load_dwordx4 a[52:55], v7, s[36:39], s51 offen offset:1024 sc1
    v_mfma_f32_16x16x32_bf16 v[116:119], v[224:227], a[132:135], v[116:119]
    v_mfma_f32_16x16x32_bf16 v[152:155], v[224:227], a[136:139], v[152:155]
    ds_read_b64_tr_b16 v[220:221], v9 offset:9440
    v_mfma_f32_16x16x32_bf16 v[152:155], v[228:231], a[152:155], v[152:155]
    ds_read_b64_tr_b16 v[222:223], v9 offset:14048
    v_mfma_f32_16x16x32_bf16 v[188:191], v[228:231], a[156:159], v[188:191]
    buffer_load_dwordx4 a[56:59], v7, s[36:39], s51 offen offset:2048 sc1
    v_mfma_f32_16x16x32_bf16 v[188:191], v[224:227], a[140:143], v[188:191]
    s_waitcnt lgkmcnt(8)
    v_mfma_f32_16x16x32_bf16 v[84:87], v[232:235], a[128:131], v[84:87]
    ds_read_b64_tr_b16 v[224:225], v9 offset:256
    v_mfma_f32_16x16x32_bf16 v[84:87], v[236:239], a[144:147], v[84:87]
    ds_read_b64_tr_b16 v[226:227], v9 offset:4864
    v_mfma_f32_16x16x32_bf16 v[120:123], v[236:239], a[148:151], v[120:123]
    buffer_load_dword v247, v246, s[24:27], 0 offen
    v_mfma_f32_16x16x32_bf16 v[120:123], v[232:235], a[132:135], v[120:123]
    v_mfma_f32_16x16x32_bf16 v[156:159], v[232:235], a[136:139], v[156:159]
    ds_read_b64_tr_b16 v[228:229], v9 offset:9472
    s_waitcnt vmcnt(29)
    v_accvgpr_read_b32 v240, a162
    v_mfma_f32_16x16x32_bf16 v[156:159], v[236:239], a[152:155], v[156:159]
    ds_read_b64_tr_b16 v[230:231], v9 offset:14080
    v_accvgpr_read_b32 v241, a163
    v_mfma_f32_16x16x32_bf16 v[192:195], v[236:239], a[156:159], v[192:195]
    v_mfma_f32_16x16x32_bf16 v[192:195], v[232:235], a[140:143], v[192:195]
    v_accvgpr_mov_b32 a162, a164
    v_accvgpr_mov_b32 a163, a165
    s_waitcnt lgkmcnt(8)
    v_mfma_f32_16x16x32_bf16 v[88:91], v[208:211], a[128:131], v[88:91]
    ds_read_b64_tr_b16 v[232:233], v9 offset:18432
    v_accvgpr_write_b32 a164, v240
    v_mfma_f32_16x16x32_bf16 v[88:91], v[212:215], a[144:147], v[88:91]
    ds_read_b64_tr_b16 v[234:235], v9 offset:23040
    v_accvgpr_write_b32 a165, v241
    v_mfma_f32_16x16x32_bf16 v[124:127], v[212:215], a[148:151], v[124:127]
    buffer_load_dwordx4 a[60:63], v7, s[36:39], s51 offen offset:3072 sc1
    v_mfma_f32_16x16x32_bf16 v[124:127], v[208:211], a[132:135], v[124:127]
    s_add_u32 s50, s52, 442368
    s_add_u32 m0, s49, 110592
    v_accvgpr_read_b32 v240, a170
    v_accvgpr_read_b32 v241, a171
    v_mfma_f32_16x16x32_bf16 v[160:163], v[208:211], a[136:139], v[160:163]
    ds_read_b64_tr_b16 v[236:237], v9 offset:27648
    v_accvgpr_mov_b32 a170, a172
    v_mfma_f32_16x16x32_bf16 v[160:163], v[212:215], a[152:155], v[160:163]
    ds_read_b64_tr_b16 v[238:239], v9 offset:32256
    v_accvgpr_mov_b32 a171, a173
    v_mfma_f32_16x16x32_bf16 v[196:199], v[212:215], a[156:159], v[196:199]
    buffer_load_dwordx4 v52, s[8:11], s50 offen lds
    v_mfma_f32_16x16x32_bf16 v[196:199], v[208:211], a[140:143], v[196:199]
    s_add_u32 m0, s49, 111616
    v_accvgpr_write_b32 a172, v240
    v_accvgpr_write_b32 a173, v241
    s_waitcnt lgkmcnt(8)
    v_mfma_f32_16x16x32_bf16 v[92:95], v[216:219], a[128:131], v[92:95]
    ds_read_b64_tr_b16 v[208:209], v9 offset:18464
    v_mfma_f32_16x16x32_bf16 v[92:95], v[220:223], a[144:147], v[92:95]
    ds_read_b64_tr_b16 v[210:211], v9 offset:23072
    v_mfma_f32_16x16x32_bf16 v[128:131], v[220:223], a[148:151], v[128:131]
    buffer_load_dwordx4 v53, s[8:11], s50 offen lds
    v_mfma_f32_16x16x32_bf16 v[128:131], v[216:219], a[132:135], v[128:131]
    s_add_u32 m0, s49, 112640
    v_mfma_f32_16x16x32_bf16 v[164:167], v[216:219], a[136:139], v[164:167]
    ds_read_b64_tr_b16 v[212:213], v9 offset:27680
    v_mfma_f32_16x16x32_bf16 v[164:167], v[220:223], a[152:155], v[164:167]
    ds_read_b64_tr_b16 v[214:215], v9 offset:32288
    v_mfma_f32_16x16x32_bf16 v[200:203], v[220:223], a[156:159], v[200:203]
    buffer_load_dwordx4 v54, s[8:11], s50 offen lds
    v_mfma_f32_16x16x32_bf16 v[200:203], v[216:219], a[140:143], v[200:203]
    s_waitcnt lgkmcnt(8)
    v_mfma_f32_16x16x32_bf16 v[96:99], v[224:227], a[128:131], v[96:99]
    ds_read_b64_tr_b16 v[216:217], v9 offset:18496
    v_mfma_f32_16x16x32_bf16 v[96:99], v[228:231], a[144:147], v[96:99]
    ds_read_b64_tr_b16 v[218:219], v9 offset:23104
    v_mfma_f32_16x16x32_bf16 v[132:135], v[228:231], a[148:151], v[132:135]
    v_mfma_f32_16x16x32_bf16 v[132:135], v[224:227], a[132:135], v[132:135]
    s_add_u32 m0, s49, 113664
    v_mfma_f32_16x16x32_bf16 v[168:171], v[224:227], a[136:139], v[168:171]
    ds_read_b64_tr_b16 v[220:221], v9 offset:27712
    v_mfma_f32_16x16x32_bf16 v[168:171], v[228:231], a[152:155], v[168:171]
    ds_read_b64_tr_b16 v[222:223], v9 offset:32320
    v_mfma_f32_16x16x32_bf16 v[204:207], v[228:231], a[156:159], v[204:207]
    buffer_load_dwordx4 v55, s[8:11], s50 offen lds
    v_mfma_f32_16x16x32_bf16 v[204:207], v[224:227], a[140:143], v[204:207]
    s_add_u32 m0, s49, 114688
    s_waitcnt lgkmcnt(8)
    v_mfma_f32_16x16x32_bf16 v[64:67], v[232:235], a[160:163], v[64:67]
    ds_read_b64_tr_b16 v[224:225], v9 offset:18528
    s_waitcnt vmcnt(30)
    v_mfma_f32_16x16x32_bf16 v[64:67], v[236:239], a[176:179], v[64:67]
    ds_read_b64_tr_b16 v[226:227], v9 offset:23136
    v_mfma_f32_16x16x32_bf16 v[100:103], v[236:239], a[180:183], v[100:103]
    buffer_load_dwordx4 v56, s[8:11], s50 offen lds
    v_mfma_f32_16x16x32_bf16 v[100:103], v[232:235], a[164:167], v[100:103]
    s_add_u32 m0, s49, 115712
    v_mfma_f32_16x16x32_bf16 v[136:139], v[232:235], a[168:171], v[136:139]
    ds_read_b64_tr_b16 v[228:229], v9 offset:27744
    v_mfma_f32_16x16x32_bf16 v[136:139], v[236:239], a[184:187], v[136:139]
    ds_read_b64_tr_b16 v[230:231], v9 offset:32352
    v_mfma_f32_16x16x32_bf16 v[172:175], v[236:239], a[188:191], v[172:175]
    buffer_load_dwordx4 v57, s[8:11], s50 offen lds
    v_mfma_f32_16x16x32_bf16 v[172:175], v[232:235], a[172:175], v[172:175]
    s_add_u32 m0, s49, 116736
    s_waitcnt lgkmcnt(8)
    v_mfma_f32_16x16x32_bf16 v[68:71], v[208:211], a[160:163], v[68:71]
    ds_read_b64_tr_b16 v[232:233], v9 offset:18560
    v_mfma_f32_16x16x32_bf16 v[68:71], v[212:215], a[176:179], v[68:71]
    ds_read_b64_tr_b16 v[234:235], v9 offset:23168
    v_mfma_f32_16x16x32_bf16 v[104:107], v[212:215], a[180:183], v[104:107]
    buffer_load_dwordx4 v58, s[8:11], s50 offen lds
    v_mfma_f32_16x16x32_bf16 v[104:107], v[208:211], a[164:167], v[104:107]
    v_mfma_f32_16x16x32_bf16 v[140:143], v[208:211], a[168:171], v[140:143]
    ds_read_b64_tr_b16 v[236:237], v9 offset:27776
    v_mfma_f32_16x16x32_bf16 v[140:143], v[212:215], a[184:187], v[140:143]
    ds_read_b64_tr_b16 v[238:239], v9 offset:32384
    v_mfma_f32_16x16x32_bf16 v[176:179], v[212:215], a[188:191], v[176:179]
    v_mfma_f32_16x16x32_bf16 v[176:179], v[208:211], a[172:175], v[176:179]
    s_add_u32 m0, s49, 117760
    s_waitcnt lgkmcnt(8)
    v_mfma_f32_16x16x32_bf16 v[72:75], v[216:219], a[160:163], v[72:75]
    ds_read_b64_tr_b16 v[208:209], v9 offset:18592
    v_mfma_f32_16x16x32_bf16 v[72:75], v[220:223], a[176:179], v[72:75]
    ds_read_b64_tr_b16 v[210:211], v9 offset:23200
    v_mfma_f32_16x16x32_bf16 v[108:111], v[220:223], a[180:183], v[108:111]
    buffer_load_dwordx4 v59, s[8:11], s50 offen lds
    v_mfma_f32_16x16x32_bf16 v[108:111], v[216:219], a[164:167], v[108:111]
    s_add_u32 m0, s49, 118784
    v_mfma_f32_16x16x32_bf16 v[144:147], v[216:219], a[168:171], v[144:147]
    ds_read_b64_tr_b16 v[212:213], v9 offset:27808
    v_mfma_f32_16x16x32_bf16 v[144:147], v[220:223], a[184:187], v[144:147]
    ds_read_b64_tr_b16 v[214:215], v9 offset:32416
    v_mfma_f32_16x16x32_bf16 v[180:183], v[220:223], a[188:191], v[180:183]
    buffer_load_dwordx4 v60, s[8:11], s50 offen lds
    v_mfma_f32_16x16x32_bf16 v[180:183], v[216:219], a[172:175], v[180:183]
    s_add_u32 s51, s62, 49152
    s_waitcnt lgkmcnt(8)
    v_mfma_f32_16x16x32_bf16 v[76:79], v[224:227], a[160:163], v[76:79]
    ds_read_b64_tr_b16 v[216:217], v9 offset:18624
    v_mfma_f32_16x16x32_bf16 v[76:79], v[228:231], a[176:179], v[76:79]
    ds_read_b64_tr_b16 v[218:219], v9 offset:23232
    v_mfma_f32_16x16x32_bf16 v[112:115], v[228:231], a[180:183], v[112:115]
    buffer_load_dwordx4 a[64:67], v7, s[36:39], s51 offen offset:0 sc1
    v_mfma_f32_16x16x32_bf16 v[112:115], v[224:227], a[164:167], v[112:115]
    v_mfma_f32_16x16x32_bf16 v[148:151], v[224:227], a[168:171], v[148:151]
    ds_read_b64_tr_b16 v[220:221], v9 offset:27840
    v_mfma_f32_16x16x32_bf16 v[148:151], v[228:231], a[184:187], v[148:151]
    ds_read_b64_tr_b16 v[222:223], v9 offset:32448
    v_mfma_f32_16x16x32_bf16 v[184:187], v[228:231], a[188:191], v[184:187]
    buffer_load_dwordx4 a[68:71], v7, s[36:39], s51 offen offset:1024 sc1
    v_mfma_f32_16x16x32_bf16 v[184:187], v[224:227], a[172:175], v[184:187]
    s_waitcnt lgkmcnt(8)
    v_mfma_f32_16x16x32_bf16 v[80:83], v[232:235], a[160:163], v[80:83]
    ds_read_b64_tr_b16 v[224:225], v9 offset:18656
    v_mfma_f32_16x16x32_bf16 v[80:83], v[236:239], a[176:179], v[80:83]
    ds_read_b64_tr_b16 v[226:227], v9 offset:23264
    v_mfma_f32_16x16x32_bf16 v[116:119], v[236:239], a[180:183], v[116:119]
    v_mfma_f32_16x16x32_bf16 v[116:119], v[232:235], a[164:167], v[116:119]
    v_mfma_f32_16x16x32_bf16 v[152:155], v[232:235], a[168:171], v[152:155]
    ds_read_b64_tr_b16 v[228:229], v9 offset:27872
    v_mfma_f32_16x16x32_bf16 v[152:155], v[236:239], a[184:187], v[152:155]
    ds_read_b64_tr_b16 v[230:231], v9 offset:32480
    v_mfma_f32_16x16x32_bf16 v[188:191], v[236:239], a[188:191], v[188:191]
    buffer_load_dwordx4 a[72:75], v7, s[36:39], s51 offen offset:2048 sc1
    v_mfma_f32_16x16x32_bf16 v[188:191], v[232:235], a[172:175], v[188:191]
    s_waitcnt lgkmcnt(8)
    v_mfma_f32_16x16x32_bf16 v[84:87], v[208:211], a[160:163], v[84:87]
    ds_read_b64_tr_b16 v[232:233], v9 offset:18688
    v_mfma_f32_16x16x32_bf16 v[84:87], v[212:215], a[176:179], v[84:87]
    ds_read_b64_tr_b16 v[234:235], v9 offset:23296
    v_mfma_f32_16x16x32_bf16 v[120:123], v[212:215], a[180:183], v[120:123]
    buffer_load_dwordx4 a[76:79], v7, s[36:39], s51 offen offset:3072 sc1
    v_mfma_f32_16x16x32_bf16 v[120:123], v[208:211], a[164:167], v[120:123]
    s_add_u32 s51, s62, 53248
    v_mfma_f32_16x16x32_bf16 v[156:159], v[208:211], a[168:171], v[156:159]
    ds_read_b64_tr_b16 v[236:237], v9 offset:27904
    v_mfma_f32_16x16x32_bf16 v[156:159], v[212:215], a[184:187], v[156:159]
    ds_read_b64_tr_b16 v[238:239], v9 offset:32512
    v_mfma_f32_16x16x32_bf16 v[192:195], v[212:215], a[188:191], v[192:195]
    buffer_load_dwordx4 a[80:83], v7, s[36:39], s51 offen offset:0 sc1
    v_mfma_f32_16x16x32_bf16 v[192:195], v[208:211], a[172:175], v[192:195]
    s_waitcnt lgkmcnt(8)
    v_mfma_f32_16x16x32_bf16 v[88:91], v[216:219], a[160:163], v[88:91]
    v_mfma_f32_16x16x32_bf16 v[88:91], v[220:223], a[176:179], v[88:91]
    v_mfma_f32_16x16x32_bf16 v[124:127], v[220:223], a[180:183], v[124:127]
    buffer_load_dwordx4 a[84:87], v7, s[36:39], s51 offen offset:1024 sc1
    v_mfma_f32_16x16x32_bf16 v[124:127], v[216:219], a[164:167], v[124:127]
    v_mfma_f32_16x16x32_bf16 v[160:163], v[216:219], a[168:171], v[160:163]
    v_mfma_f32_16x16x32_bf16 v[160:163], v[220:223], a[184:187], v[160:163]
    v_mfma_f32_16x16x32_bf16 v[196:199], v[220:223], a[188:191], v[196:199]
    v_mfma_f32_16x16x32_bf16 v[196:199], v[216:219], a[172:175], v[196:199]
    s_waitcnt vmcnt(32) lgkmcnt(0)
    s_barrier
    v_mfma_f32_16x16x32_bf16 v[92:95], v[224:227], a[160:163], v[92:95]
    ds_read_b64_tr_b16 v[208:209], v10 offset:0
    ds_read_b64_tr_b16 v[210:211], v10 offset:4608
    v_mfma_f32_16x16x32_bf16 v[92:95], v[228:231], a[176:179], v[92:95]
    ds_read_b64_tr_b16 v[212:213], v10 offset:9216
    ds_read_b64_tr_b16 v[214:215], v10 offset:13824
    v_mfma_f32_16x16x32_bf16 v[128:131], v[228:231], a[180:183], v[128:131]
    ds_read_b64_tr_b16 v[216:217], v10 offset:32
    ds_read_b64_tr_b16 v[218:219], v10 offset:4640
    v_mfma_f32_16x16x32_bf16 v[128:131], v[224:227], a[164:167], v[128:131]
    v_mfma_f32_16x16x32_bf16 v[164:167], v[224:227], a[168:171], v[164:167]
    ds_read_b64_tr_b16 v[220:221], v10 offset:9248
    v_mfma_f32_16x16x32_bf16 v[164:167], v[228:231], a[184:187], v[164:167]
    ds_read_b64_tr_b16 v[222:223], v10 offset:13856
    v_mfma_f32_16x16x32_bf16 v[200:203], v[228:231], a[188:191], v[200:203]
    buffer_load_dwordx4 a[88:91], v7, s[36:39], s51 offen offset:2048 sc1
    v_mfma_f32_16x16x32_bf16 v[200:203], v[224:227], a[172:175], v[200:203]
    v_mfma_f32_16x16x32_bf16 v[96:99], v[232:235], a[160:163], v[96:99]
    ds_read_b64_tr_b16 v[224:225], v10 offset:64
    v_mfma_f32_16x16x32_bf16 v[96:99], v[236:239], a[176:179], v[96:99]
    ds_read_b64_tr_b16 v[226:227], v10 offset:4672
    v_mfma_f32_16x16x32_bf16 v[132:135], v[236:239], a[180:183], v[132:135]
    buffer_load_dwordx4 a[92:95], v7, s[36:39], s51 offen offset:3072 sc1
    v_mfma_f32_16x16x32_bf16 v[132:135], v[232:235], a[164:167], v[132:135]
    s_add_u32 s50, s52, 589824
    s_add_u32 m0, s49, 0
    v_mfma_f32_16x16x32_bf16 v[168:171], v[232:235], a[168:171], v[168:171]
    ds_read_b64_tr_b16 v[228:229], v10 offset:9280
    v_mfma_f32_16x16x32_bf16 v[168:171], v[236:239], a[184:187], v[168:171]
    ds_read_b64_tr_b16 v[230:231], v10 offset:13888
    v_mfma_f32_16x16x32_bf16 v[204:207], v[236:239], a[188:191], v[204:207]
    buffer_load_dwordx4 v52, s[8:11], s50 offen lds
    v_mfma_f32_16x16x32_bf16 v[204:207], v[232:235], a[172:175], v[204:207]
    s_add_u32 m0, s49, 1024
    s_waitcnt vmcnt(31) lgkmcnt(8)
    v_mfma_f32_16x16x32_bf16 v[64:67], v[208:211], a[0:3], v[64:67]
    ds_read_b64_tr_b16 v[232:233], v10 offset:96
    s_waitcnt vmcnt(27)
    v_mfma_f32_16x16x32_bf16 v[64:67], v[212:215], a[16:19], v[64:67]
    ds_read_b64_tr_b16 v[234:235], v10 offset:4704
    v_mfma_f32_16x16x32_bf16 v[100:103], v[212:215], a[20:23], v[100:103]
    buffer_load_dwordx4 v53, s[8:11], s50 offen lds
    v_mfma_f32_16x16x32_bf16 v[100:103], v[208:211], a[4:7], v[100:103]
    v_mfma_f32_16x16x32_bf16 v[136:139], v[208:211], a[8:11], v[136:139]
    ds_read_b64_tr_b16 v[236:237], v10 offset:9312
    v_mfma_f32_16x16x32_bf16 v[136:139], v[212:215], a[24:27], v[136:139]
    ds_read_b64_tr_b16 v[238:239], v10 offset:13920
    v_mfma_f32_16x16x32_bf16 v[172:175], v[212:215], a[28:31], v[172:175]
    v_mfma_f32_16x16x32_bf16 v[172:175], v[208:211], a[12:15], v[172:175]
    s_add_u32 m0, s49, 2048
    s_waitcnt lgkmcnt(8)
    v_mfma_f32_16x16x32_bf16 v[68:71], v[216:219], a[0:3], v[68:71]
    ds_read_b64_tr_b16 v[208:209], v10 offset:128
    v_mfma_f32_16x16x32_bf16 v[68:71], v[220:223], a[16:19], v[68:71]
    ds_read_b64_tr_b16 v[210:211], v10 offset:4736
    v_mfma_f32_16x16x32_bf16 v[104:107], v[220:223], a[20:23], v[104:107]
    buffer_load_dwordx4 v54, s[8:11], s50 offen lds
    v_mfma_f32_16x16x32_bf16 v[104:107], v[216:219], a[4:7], v[104:107]
    s_add_u32 m0, s49, 3072
    v_mfma_f32_16x16x32_bf16 v[140:143], v[216:219], a[8:11], v[140:143]
    ds_read_b64_tr_b16 v[212:213], v10 offset:9344
    v_mfma_f32_16x16x32_bf16 v[140:143], v[220:223], a[24:27], v[140:143]
    ds_read_b64_tr_b16 v[214:215], v10 offset:13952
    v_mfma_f32_16x16x32_bf16 v[176:179], v[220:223], a[28:31], v[176:179]
    buffer_load_dwordx4 v55, s[8:11], s50 offen lds
    v_mfma_f32_16x16x32_bf16 v[176:179], v[216:219], a[12:15], v[176:179]
    s_add_u32 m0, s49, 4096
    s_waitcnt lgkmcnt(8)
    v_mfma_f32_16x16x32_bf16 v[72:75], v[224:227], a[0:3], v[72:75]
    ds_read_b64_tr_b16 v[216:217], v10 offset:160
    v_mfma_f32_16x16x32_bf16 v[72:75], v[228:231], a[16:19], v[72:75]
    ds_read_b64_tr_b16 v[218:219], v10 offset:4768
    v_mfma_f32_16x16x32_bf16 v[108:111], v[228:231], a[20:23], v[108:111]
    buffer_load_dwordx4 v56, s[8:11], s50 offen lds
    v_mfma_f32_16x16x32_bf16 v[108:111], v[224:227], a[4:7], v[108:111]
    s_add_u32 m0, s49, 5120
    v_mfma_f32_16x16x32_bf16 v[144:147], v[224:227], a[8:11], v[144:147]
    ds_read_b64_tr_b16 v[220:221], v10 offset:9376
    v_mfma_f32_16x16x32_bf16 v[144:147], v[228:231], a[24:27], v[144:147]
    ds_read_b64_tr_b16 v[222:223], v10 offset:13984
    v_mfma_f32_16x16x32_bf16 v[180:183], v[228:231], a[28:31], v[180:183]
    buffer_load_dwordx4 v57, s[8:11], s50 offen lds
    v_mfma_f32_16x16x32_bf16 v[180:183], v[224:227], a[12:15], v[180:183]
    s_waitcnt lgkmcnt(8)
    v_mfma_f32_16x16x32_bf16 v[76:79], v[232:235], a[0:3], v[76:79]
    ds_read_b64_tr_b16 v[224:225], v10 offset:192
    v_mfma_f32_16x16x32_bf16 v[76:79], v[236:239], a[16:19], v[76:79]
    ds_read_b64_tr_b16 v[226:227], v10 offset:4800
    v_mfma_f32_16x16x32_bf16 v[112:115], v[236:239], a[20:23], v[112:115]
    v_mfma_f32_16x16x32_bf16 v[112:115], v[232:235], a[4:7], v[112:115]
    s_add_u32 m0, s49, 6144
    v_mfma_f32_16x16x32_bf16 v[148:151], v[232:235], a[8:11], v[148:151]
    ds_read_b64_tr_b16 v[228:229], v10 offset:9408
    v_mfma_f32_16x16x32_bf16 v[148:151], v[236:239], a[24:27], v[148:151]
    ds_read_b64_tr_b16 v[230:231], v10 offset:14016
    v_mfma_f32_16x16x32_bf16 v[184:187], v[236:239], a[28:31], v[184:187]
    buffer_load_dwordx4 v58, s[8:11], s50 offen lds
    v_mfma_f32_16x16x32_bf16 v[184:187], v[232:235], a[12:15], v[184:187]
    s_add_u32 m0, s49, 7168
    s_waitcnt lgkmcnt(8)
    v_mfma_f32_16x16x32_bf16 v[80:83], v[208:211], a[0:3], v[80:83]
    ds_read_b64_tr_b16 v[232:233], v10 offset:224
    v_mfma_f32_16x16x32_bf16 v[80:83], v[212:215], a[16:19], v[80:83]
    ds_read_b64_tr_b16 v[234:235], v10 offset:4832
    v_mfma_f32_16x16x32_bf16 v[116:119], v[212:215], a[20:23], v[116:119]
    buffer_load_dwordx4 v59, s[8:11], s50 offen lds
    v_mfma_f32_16x16x32_bf16 v[116:119], v[208:211], a[4:7], v[116:119]
    s_add_u32 m0, s49, 8192
    v_mfma_f32_16x16x32_bf16 v[152:155], v[208:211], a[8:11], v[152:155]
    ds_read_b64_tr_b16 v[236:237], v10 offset:9440
    v_mfma_f32_16x16x32_bf16 v[152:155], v[212:215], a[24:27], v[152:155]
    ds_read_b64_tr_b16 v[238:239], v10 offset:14048
    v_mfma_f32_16x16x32_bf16 v[188:191], v[212:215], a[28:31], v[188:191]
    buffer_load_dwordx4 v60, s[8:11], s50 offen lds
    v_mfma_f32_16x16x32_bf16 v[188:191], v[208:211], a[12:15], v[188:191]
    s_add_u32 s51, s62, 57344
    s_waitcnt lgkmcnt(8)
    v_mfma_f32_16x16x32_bf16 v[84:87], v[216:219], a[0:3], v[84:87]
    ds_read_b64_tr_b16 v[208:209], v10 offset:256
    v_mfma_f32_16x16x32_bf16 v[84:87], v[220:223], a[16:19], v[84:87]
    ds_read_b64_tr_b16 v[210:211], v10 offset:4864
    v_mfma_f32_16x16x32_bf16 v[120:123], v[220:223], a[20:23], v[120:123]
    buffer_load_dwordx4 a[96:99], v7, s[36:39], s51 offen offset:0 sc1
    v_mfma_f32_16x16x32_bf16 v[120:123], v[216:219], a[4:7], v[120:123]
    v_mfma_f32_16x16x32_bf16 v[156:159], v[216:219], a[8:11], v[156:159]
    ds_read_b64_tr_b16 v[212:213], v10 offset:9472
    v_mfma_f32_16x16x32_bf16 v[156:159], v[220:223], a[24:27], v[156:159]
    ds_read_b64_tr_b16 v[214:215], v10 offset:14080
    v_mfma_f32_16x16x32_bf16 v[192:195], v[220:223], a[28:31], v[192:195]
    v_mfma_f32_16x16x32_bf16 v[192:195], v[216:219], a[12:15], v[192:195]
    s_waitcnt lgkmcnt(8)
    v_mfma_f32_16x16x32_bf16 v[88:91], v[224:227], a[0:3], v[88:91]
    ds_read_b64_tr_b16 v[216:217], v10 offset:18432
    v_mfma_f32_16x16x32_bf16 v[88:91], v[228:231], a[16:19], v[88:91]
    ds_read_b64_tr_b16 v[218:219], v10 offset:23040
    v_mfma_f32_16x16x32_bf16 v[124:127], v[228:231], a[20:23], v[124:127]
    buffer_load_dwordx4 a[100:103], v7, s[36:39], s51 offen offset:1024 sc1
    v_mfma_f32_16x16x32_bf16 v[124:127], v[224:227], a[4:7], v[124:127]
    v_mfma_f32_16x16x32_bf16 v[160:163], v[224:227], a[8:11], v[160:163]
    ds_read_b64_tr_b16 v[220:221], v10 offset:27648
    v_mfma_f32_16x16x32_bf16 v[160:163], v[228:231], a[24:27], v[160:163]
    ds_read_b64_tr_b16 v[222:223], v10 offset:32256
    v_mfma_f32_16x16x32_bf16 v[196:199], v[228:231], a[28:31], v[196:199]
    buffer_load_dwordx4 a[104:107], v7, s[36:39], s51 offen offset:2048 sc1
    v_mfma_f32_16x16x32_bf16 v[196:199], v[224:227], a[12:15], v[196:199]
    s_waitcnt lgkmcnt(8)
    v_mfma_f32_16x16x32_bf16 v[92:95], v[232:235], a[0:3], v[92:95]
    ds_read_b64_tr_b16 v[224:225], v10 offset:18464
    v_mfma_f32_16x16x32_bf16 v[92:95], v[236:239], a[16:19], v[92:95]
    ds_read_b64_tr_b16 v[226:227], v10 offset:23072
    v_mfma_f32_16x16x32_bf16 v[128:131], v[236:239], a[20:23], v[128:131]
    buffer_load_dwordx4 a[108:111], v7, s[36:39], s51 offen offset:3072 sc1
    v_mfma_f32_16x16x32_bf16 v[128:131], v[232:235], a[4:7], v[128:131]
    s_add_u32 s51, s62, 61440
    v_mfma_f32_16x16x32_bf16 v[164:167], v[232:235], a[8:11], v[164:167]
    ds_read_b64_tr_b16 v[228:229], v10 offset:27680
    v_mfma_f32_16x16x32_bf16 v[164:167], v[236:239], a[24:27], v[164:167]
    ds_read_b64_tr_b16 v[230:231], v10 offset:32288
    v_mfma_f32_16x16x32_bf16 v[200:203], v[236:239], a[28:31], v[200:203]
    buffer_load_dwordx4 a[112:115], v7, s[36:39], s51 offen offset:0 sc1
    v_mfma_f32_16x16x32_bf16 v[200:203], v[232:235], a[12:15], v[200:203]
    s_waitcnt lgkmcnt(8)
    v_mfma_f32_16x16x32_bf16 v[96:99], v[208:211], a[0:3], v[96:99]
    ds_read_b64_tr_b16 v[232:233], v10 offset:18496
    v_mfma_f32_16x16x32_bf16 v[96:99], v[212:215], a[16:19], v[96:99]
    ds_read_b64_tr_b16 v[234:235], v10 offset:23104
    v_mfma_f32_16x16x32_bf16 v[132:135], v[212:215], a[20:23], v[132:135]
    v_mfma_f32_16x16x32_bf16 v[132:135], v[208:211], a[4:7], v[132:135]
    v_mfma_f32_16x16x32_bf16 v[168:171], v[208:211], a[8:11], v[168:171]
    ds_read_b64_tr_b16 v[236:237], v10 offset:27712
    v_mfma_f32_16x16x32_bf16 v[168:171], v[212:215], a[24:27], v[168:171]
    ds_read_b64_tr_b16 v[238:239], v10 offset:32320
    v_mfma_f32_16x16x32_bf16 v[204:207], v[212:215], a[28:31], v[204:207]
    buffer_load_dwordx4 a[116:119], v7, s[36:39], s51 offen offset:2048 sc1
    v_mfma_f32_16x16x32_bf16 v[204:207], v[208:211], a[12:15], v[204:207]
    s_waitcnt vmcnt(37) lgkmcnt(8)
    v_mfma_f32_16x16x32_bf16 v[64:67], v[216:219], a[32:35], v[64:67]
    ds_read_b64_tr_b16 v[208:209], v10 offset:18528
    s_waitcnt vmcnt(32)
    v_mfma_f32_16x16x32_bf16 v[64:67], v[220:223], a[48:51], v[64:67]
    ds_read_b64_tr_b16 v[210:211], v10 offset:23136
    v_mfma_f32_16x16x32_bf16 v[100:103], v[220:223], a[52:55], v[100:103]
    buffer_load_dwordx4 a[120:123], v7, s[36:39], s51 offen offset:1024 sc1
    v_mfma_f32_16x16x32_bf16 v[100:103], v[216:219], a[36:39], v[100:103]
    v_mfma_f32_16x16x32_bf16 v[136:139], v[216:219], a[40:43], v[136:139]
    ds_read_b64_tr_b16 v[212:213], v10 offset:27744
    v_mfma_f32_16x16x32_bf16 v[136:139], v[220:223], a[56:59], v[136:139]
    ds_read_b64_tr_b16 v[214:215], v10 offset:32352
    v_mfma_f32_16x16x32_bf16 v[172:175], v[220:223], a[60:63], v[172:175]
    buffer_load_dwordx4 a[124:127], v7, s[36:39], s51 offen offset:3072 sc1
    v_mfma_f32_16x16x32_bf16 v[172:175], v[216:219], a[44:47], v[172:175]
    s_add_u32 s51, s62, 65536
    s_waitcnt lgkmcnt(8)
    v_mfma_f32_16x16x32_bf16 v[68:71], v[224:227], a[32:35], v[68:71]
    ds_read_b64_tr_b16 v[216:217], v10 offset:18560
    v_mfma_f32_16x16x32_bf16 v[68:71], v[228:231], a[48:51], v[68:71]
    ds_read_b64_tr_b16 v[218:219], v10 offset:23168
    v_mfma_f32_16x16x32_bf16 v[104:107], v[228:231], a[52:55], v[104:107]
    buffer_load_dwordx4 a[192:195], v7, s[36:39], s51 offen offset:0 sc1
    v_mfma_f32_16x16x32_bf16 v[104:107], v[224:227], a[36:39], v[104:107]
    v_mfma_f32_16x16x32_bf16 v[140:143], v[224:227], a[40:43], v[140:143]
    ds_read_b64_tr_b16 v[220:221], v10 offset:27776
    v_mfma_f32_16x16x32_bf16 v[140:143], v[228:231], a[56:59], v[140:143]
    ds_read_b64_tr_b16 v[222:223], v10 offset:32384
    v_mfma_f32_16x16x32_bf16 v[176:179], v[228:231], a[60:63], v[176:179]
    v_mfma_f32_16x16x32_bf16 v[176:179], v[224:227], a[44:47], v[176:179]
    s_waitcnt lgkmcnt(8)
    v_mfma_f32_16x16x32_bf16 v[72:75], v[232:235], a[32:35], v[72:75]
    ds_read_b64_tr_b16 v[224:225], v10 offset:18592
    v_mfma_f32_16x16x32_bf16 v[72:75], v[236:239], a[48:51], v[72:75]
    ds_read_b64_tr_b16 v[226:227], v10 offset:23200
    v_mfma_f32_16x16x32_bf16 v[108:111], v[236:239], a[52:55], v[108:111]
    buffer_load_dwordx4 a[196:199], v7, s[36:39], s51 offen offset:1024 sc1
    v_mfma_f32_16x16x32_bf16 v[108:111], v[232:235], a[36:39], v[108:111]
    v_mfma_f32_16x16x32_bf16 v[144:147], v[232:235], a[40:43], v[144:147]
    ds_read_b64_tr_b16 v[228:229], v10 offset:27808
    v_mfma_f32_16x16x32_bf16 v[144:147], v[236:239], a[56:59], v[144:147]
    ds_read_b64_tr_b16 v[230:231], v10 offset:32416
    v_mfma_f32_16x16x32_bf16 v[180:183], v[236:239], a[60:63], v[180:183]
    buffer_load_dwordx4 a[200:203], v7, s[36:39], s51 offen offset:2048 sc1
    v_mfma_f32_16x16x32_bf16 v[180:183], v[232:235], a[44:47], v[180:183]
    s_waitcnt lgkmcnt(8)
    v_mfma_f32_16x16x32_bf16 v[76:79], v[208:211], a[32:35], v[76:79]
    ds_read_b64_tr_b16 v[232:233], v10 offset:18624
    v_mfma_f32_16x16x32_bf16 v[76:79], v[212:215], a[48:51], v[76:79]
    ds_read_b64_tr_b16 v[234:235], v10 offset:23232
    v_mfma_f32_16x16x32_bf16 v[112:115], v[212:215], a[52:55], v[112:115]
    buffer_load_dwordx4 a[204:207], v7, s[36:39], s51 offen offset:3072 sc1
    v_mfma_f32_16x16x32_bf16 v[112:115], v[208:211], a[36:39], v[112:115]
    s_add_u32 s51, s62, 69632
    v_mfma_f32_16x16x32_bf16 v[148:151], v[208:211], a[40:43], v[148:151]
    ds_read_b64_tr_b16 v[236:237], v10 offset:27840
    v_mfma_f32_16x16x32_bf16 v[148:151], v[212:215], a[56:59], v[148:151]
    ds_read_b64_tr_b16 v[238:239], v10 offset:32448
    v_mfma_f32_16x16x32_bf16 v[184:187], v[212:215], a[60:63], v[184:187]
    buffer_load_dwordx4 a[208:211], v7, s[36:39], s51 offen offset:0 sc1
    v_mfma_f32_16x16x32_bf16 v[184:187], v[208:211], a[44:47], v[184:187]
    s_waitcnt lgkmcnt(8)
    v_mfma_f32_16x16x32_bf16 v[80:83], v[216:219], a[32:35], v[80:83]
    ds_read_b64_tr_b16 v[208:209], v10 offset:18656
    v_mfma_f32_16x16x32_bf16 v[80:83], v[220:223], a[48:51], v[80:83]
    ds_read_b64_tr_b16 v[210:211], v10 offset:23264
    v_mfma_f32_16x16x32_bf16 v[116:119], v[220:223], a[52:55], v[116:119]
    v_mfma_f32_16x16x32_bf16 v[116:119], v[216:219], a[36:39], v[116:119]
    v_mfma_f32_16x16x32_bf16 v[152:155], v[216:219], a[40:43], v[152:155]
    ds_read_b64_tr_b16 v[212:213], v10 offset:27872
    v_mfma_f32_16x16x32_bf16 v[152:155], v[220:223], a[56:59], v[152:155]
    ds_read_b64_tr_b16 v[214:215], v10 offset:32480
    v_mfma_f32_16x16x32_bf16 v[188:191], v[220:223], a[60:63], v[188:191]
    buffer_load_dwordx4 a[212:215], v7, s[36:39], s51 offen offset:1024 sc1
    v_mfma_f32_16x16x32_bf16 v[188:191], v[216:219], a[44:47], v[188:191]
    s_waitcnt lgkmcnt(8)
    v_mfma_f32_16x16x32_bf16 v[84:87], v[224:227], a[32:35], v[84:87]
    ds_read_b64_tr_b16 v[216:217], v10 offset:18688
    v_mfma_f32_16x16x32_bf16 v[84:87], v[228:231], a[48:51], v[84:87]
    ds_read_b64_tr_b16 v[218:219], v10 offset:23296
    v_mfma_f32_16x16x32_bf16 v[120:123], v[228:231], a[52:55], v[120:123]
    buffer_load_dwordx4 a[216:219], v7, s[36:39], s51 offen offset:2048 sc1
    v_mfma_f32_16x16x32_bf16 v[120:123], v[224:227], a[36:39], v[120:123]
    v_mfma_f32_16x16x32_bf16 v[156:159], v[224:227], a[40:43], v[156:159]
    ds_read_b64_tr_b16 v[220:221], v10 offset:27904
    v_mfma_f32_16x16x32_bf16 v[156:159], v[228:231], a[56:59], v[156:159]
    ds_read_b64_tr_b16 v[222:223], v10 offset:32512
    v_mfma_f32_16x16x32_bf16 v[192:195], v[228:231], a[60:63], v[192:195]
    buffer_load_dwordx4 a[220:223], v7, s[36:39], s51 offen offset:3072 sc1
    v_mfma_f32_16x16x32_bf16 v[192:195], v[224:227], a[44:47], v[192:195]
    s_add_u32 s51, s62, 73728
    s_waitcnt lgkmcnt(8)
    v_mfma_f32_16x16x32_bf16 v[88:91], v[232:235], a[32:35], v[88:91]
    v_mfma_f32_16x16x32_bf16 v[88:91], v[236:239], a[48:51], v[88:91]
    v_mfma_f32_16x16x32_bf16 v[124:127], v[236:239], a[52:55], v[124:127]
    buffer_load_dwordx4 a[224:227], v7, s[36:39], s51 offen offset:0 sc1
    v_mfma_f32_16x16x32_bf16 v[124:127], v[232:235], a[36:39], v[124:127]
    v_mfma_f32_16x16x32_bf16 v[160:163], v[232:235], a[40:43], v[160:163]
    v_mfma_f32_16x16x32_bf16 v[160:163], v[236:239], a[56:59], v[160:163]
    v_mfma_f32_16x16x32_bf16 v[196:199], v[236:239], a[60:63], v[196:199]
    v_mfma_f32_16x16x32_bf16 v[196:199], v[232:235], a[44:47], v[196:199]
    s_waitcnt vmcnt(34) lgkmcnt(0)
    s_barrier
    v_mfma_f32_16x16x32_bf16 v[92:95], v[208:211], a[32:35], v[92:95]
    ds_read_b64_tr_b16 v[224:225], v11 offset:0
    ds_read_b64_tr_b16 v[226:227], v11 offset:4608
    v_mfma_f32_16x16x32_bf16 v[92:95], v[212:215], a[48:51], v[92:95]
    ds_read_b64_tr_b16 v[228:229], v11 offset:9216
    ds_read_b64_tr_b16 v[230:231], v11 offset:13824
    v_mfma_f32_16x16x32_bf16 v[128:131], v[212:215], a[52:55], v[128:131]
    ds_read_b64_tr_b16 v[232:233], v11 offset:32
    ds_read_b64_tr_b16 v[234:235], v11 offset:4640
    v_mfma_f32_16x16x32_bf16 v[128:131], v[208:211], a[36:39], v[128:131]
    v_mfma_f32_16x16x32_bf16 v[164:167], v[208:211], a[40:43], v[164:167]
    ds_read_b64_tr_b16 v[236:237], v11 offset:9248
    v_mfma_f32_16x16x32_bf16 v[164:167], v[212:215], a[56:59], v[164:167]
    ds_read_b64_tr_b16 v[238:239], v11 offset:13856
    v_mfma_f32_16x16x32_bf16 v[200:203], v[212:215], a[60:63], v[200:203]
    buffer_load_dwordx4 a[228:231], v7, s[36:39], s51 offen offset:1024 sc1
    v_mfma_f32_16x16x32_bf16 v[200:203], v[208:211], a[44:47], v[200:203]
    v_mfma_f32_16x16x32_bf16 v[96:99], v[216:219], a[32:35], v[96:99]
    ds_read_b64_tr_b16 v[208:209], v11 offset:64
    v_mfma_f32_16x16x32_bf16 v[96:99], v[220:223], a[48:51], v[96:99]
    ds_read_b64_tr_b16 v[210:211], v11 offset:4672
    v_mfma_f32_16x16x32_bf16 v[132:135], v[220:223], a[52:55], v[132:135]
    buffer_load_dwordx4 a[232:235], v7, s[36:39], s51 offen offset:2048 sc1
    v_mfma_f32_16x16x32_bf16 v[132:135], v[216:219], a[36:39], v[132:135]
    v_mfma_f32_16x16x32_bf16 v[168:171], v[216:219], a[40:43], v[168:171]
    ds_read_b64_tr_b16 v[212:213], v11 offset:9280
    v_mfma_f32_16x16x32_bf16 v[168:171], v[220:223], a[56:59], v[168:171]
    ds_read_b64_tr_b16 v[214:215], v11 offset:13888
    v_mfma_f32_16x16x32_bf16 v[204:207], v[220:223], a[60:63], v[204:207]
    buffer_load_dwordx4 a[236:239], v7, s[36:39], s51 offen offset:3072 sc1
    v_mfma_f32_16x16x32_bf16 v[204:207], v[216:219], a[44:47], v[204:207]
    s_add_u32 s51, s62, 77824
    s_waitcnt vmcnt(33) lgkmcnt(8)
    v_mfma_f32_16x16x32_bf16 v[64:67], v[224:227], a[64:67], v[64:67]
    ds_read_b64_tr_b16 v[216:217], v11 offset:96
    s_waitcnt vmcnt(29)
    v_mfma_f32_16x16x32_bf16 v[64:67], v[228:231], a[80:83], v[64:67]
    ds_read_b64_tr_b16 v[218:219], v11 offset:4704
    v_mfma_f32_16x16x32_bf16 v[100:103], v[228:231], a[84:87], v[100:103]
    buffer_load_dwordx4 a[240:243], v7, s[36:39], s51 offen offset:0 sc1
    v_mfma_f32_16x16x32_bf16 v[100:103], v[224:227], a[68:71], v[100:103]
    v_mfma_f32_16x16x32_bf16 v[136:139], v[224:227], a[72:75], v[136:139]
    ds_read_b64_tr_b16 v[220:221], v11 offset:9312
    v_mfma_f32_16x16x32_bf16 v[136:139], v[228:231], a[88:91], v[136:139]
    ds_read_b64_tr_b16 v[222:223], v11 offset:13920
    v_mfma_f32_16x16x32_bf16 v[172:175], v[228:231], a[92:95], v[172:175]
    v_mfma_f32_16x16x32_bf16 v[172:175], v[224:227], a[76:79], v[172:175]
    s_waitcnt lgkmcnt(8)
    v_mfma_f32_16x16x32_bf16 v[68:71], v[232:235], a[64:67], v[68:71]
    ds_read_b64_tr_b16 v[224:225], v11 offset:128
    v_mfma_f32_16x16x32_bf16 v[68:71], v[236:239], a[80:83], v[68:71]
    ds_read_b64_tr_b16 v[226:227], v11 offset:4736
    v_mfma_f32_16x16x32_bf16 v[104:107], v[236:239], a[84:87], v[104:107]
    buffer_load_dwordx4 a[244:247], v7, s[36:39], s51 offen offset:1024 sc1
    v_mfma_f32_16x16x32_bf16 v[104:107], v[232:235], a[68:71], v[104:107]
    v_mfma_f32_16x16x32_bf16 v[140:143], v[232:235], a[72:75], v[140:143]
    ds_read_b64_tr_b16 v[228:229], v11 offset:9344
    v_mfma_f32_16x16x32_bf16 v[140:143], v[236:239], a[88:91], v[140:143]
    ds_read_b64_tr_b16 v[230:231], v11 offset:13952
    v_mfma_f32_16x16x32_bf16 v[176:179], v[236:239], a[92:95], v[176:179]
    buffer_load_dwordx4 a[248:251], v7, s[36:39], s51 offen offset:2048 sc1
    v_mfma_f32_16x16x32_bf16 v[176:179], v[232:235], a[76:79], v[176:179]
    s_waitcnt lgkmcnt(8)
    v_mfma_f32_16x16x32_bf16 v[72:75], v[208:211], a[64:67], v[72:75]
    ds_read_b64_tr_b16 v[232:233], v11 offset:160
    v_mfma_f32_16x16x32_bf16 v[72:75], v[212:215], a[80:83], v[72:75]
    ds_read_b64_tr_b16 v[234:235], v11 offset:4768
    v_mfma_f32_16x16x32_bf16 v[108:111], v[212:215], a[84:87], v[108:111]
    buffer_load_dwordx4 a[252:255], v7, s[36:39], s51 offen offset:3072 sc1
    v_mfma_f32_16x16x32_bf16 v[108:111], v[208:211], a[68:71], v[108:111]
    v_mfma_f32_16x16x32_bf16 v[144:147], v[208:211], a[72:75], v[144:147]
    ds_read_b64_tr_b16 v[236:237], v11 offset:9376
    v_mfma_f32_16x16x32_bf16 v[144:147], v[212:215], a[88:91], v[144:147]
    ds_read_b64_tr_b16 v[238:239], v11 offset:13984
    v_mfma_f32_16x16x32_bf16 v[180:183], v[212:215], a[92:95], v[180:183]
    v_mfma_f32_16x16x32_bf16 v[180:183], v[208:211], a[76:79], v[180:183]
    s_waitcnt lgkmcnt(8)
    v_mfma_f32_16x16x32_bf16 v[76:79], v[216:219], a[64:67], v[76:79]
    ds_read_b64_tr_b16 v[208:209], v11 offset:192
    v_mfma_f32_16x16x32_bf16 v[76:79], v[220:223], a[80:83], v[76:79]
    ds_read_b64_tr_b16 v[210:211], v11 offset:4800
    v_mfma_f32_16x16x32_bf16 v[112:115], v[220:223], a[84:87], v[112:115]
    v_mfma_f32_16x16x32_bf16 v[112:115], v[216:219], a[68:71], v[112:115]
    v_mfma_f32_16x16x32_bf16 v[148:151], v[216:219], a[72:75], v[148:151]
    ds_read_b64_tr_b16 v[212:213], v11 offset:9408
    v_mfma_f32_16x16x32_bf16 v[148:151], v[220:223], a[88:91], v[148:151]
    ds_read_b64_tr_b16 v[214:215], v11 offset:14016
    v_mfma_f32_16x16x32_bf16 v[184:187], v[220:223], a[92:95], v[184:187]
    v_mfma_f32_16x16x32_bf16 v[184:187], v[216:219], a[76:79], v[184:187]
    s_waitcnt lgkmcnt(8)
    v_mfma_f32_16x16x32_bf16 v[80:83], v[224:227], a[64:67], v[80:83]
    ds_read_b64_tr_b16 v[216:217], v11 offset:224
    v_mfma_f32_16x16x32_bf16 v[80:83], v[228:231], a[80:83], v[80:83]
    ds_read_b64_tr_b16 v[218:219], v11 offset:4832
    v_mfma_f32_16x16x32_bf16 v[116:119], v[228:231], a[84:87], v[116:119]
    v_mfma_f32_16x16x32_bf16 v[116:119], v[224:227], a[68:71], v[116:119]
    v_mfma_f32_16x16x32_bf16 v[152:155], v[224:227], a[72:75], v[152:155]
    ds_read_b64_tr_b16 v[220:221], v11 offset:9440
    v_mfma_f32_16x16x32_bf16 v[152:155], v[228:231], a[88:91], v[152:155]
    ds_read_b64_tr_b16 v[222:223], v11 offset:14048
    v_mfma_f32_16x16x32_bf16 v[188:191], v[228:231], a[92:95], v[188:191]
    v_mfma_f32_16x16x32_bf16 v[188:191], v[224:227], a[76:79], v[188:191]
    s_waitcnt lgkmcnt(8)
    v_mfma_f32_16x16x32_bf16 v[84:87], v[232:235], a[64:67], v[84:87]
    ds_read_b64_tr_b16 v[224:225], v11 offset:256
    v_mfma_f32_16x16x32_bf16 v[84:87], v[236:239], a[80:83], v[84:87]
    ds_read_b64_tr_b16 v[226:227], v11 offset:4864
    v_mfma_f32_16x16x32_bf16 v[120:123], v[236:239], a[84:87], v[120:123]
    v_mfma_f32_16x16x32_bf16 v[120:123], v[232:235], a[68:71], v[120:123]
    v_mfma_f32_16x16x32_bf16 v[156:159], v[232:235], a[72:75], v[156:159]
    ds_read_b64_tr_b16 v[228:229], v11 offset:9472
    s_waitcnt vmcnt(16)
    v_accvgpr_read_b32 v240, a114
    v_mfma_f32_16x16x32_bf16 v[156:159], v[236:239], a[88:91], v[156:159]
    ds_read_b64_tr_b16 v[230:231], v11 offset:14080
    v_accvgpr_read_b32 v241, a115
    v_mfma_f32_16x16x32_bf16 v[192:195], v[236:239], a[92:95], v[192:195]
    v_mfma_f32_16x16x32_bf16 v[192:195], v[232:235], a[76:79], v[192:195]
    v_accvgpr_mov_b32 a114, a116
    v_accvgpr_mov_b32 a115, a117
    s_waitcnt lgkmcnt(8)
    v_mfma_f32_16x16x32_bf16 v[88:91], v[208:211], a[64:67], v[88:91]
    ds_read_b64_tr_b16 v[232:233], v11 offset:18432
    v_accvgpr_write_b32 a116, v240
    v_mfma_f32_16x16x32_bf16 v[88:91], v[212:215], a[80:83], v[88:91]
    ds_read_b64_tr_b16 v[234:235], v11 offset:23040
    v_accvgpr_write_b32 a117, v241
    v_mfma_f32_16x16x32_bf16 v[124:127], v[212:215], a[84:87], v[124:127]
    buffer_load_dword v247, v246, s[24:27], 0 offen
    v_mfma_f32_16x16x32_bf16 v[124:127], v[208:211], a[68:71], v[124:127]
    v_accvgpr_read_b32 v240, a122
    v_accvgpr_read_b32 v241, a123
    v_mfma_f32_16x16x32_bf16 v[160:163], v[208:211], a[72:75], v[160:163]
    ds_read_b64_tr_b16 v[236:237], v11 offset:27648
    v_accvgpr_mov_b32 a122, a124
    v_mfma_f32_16x16x32_bf16 v[160:163], v[212:215], a[88:91], v[160:163]
    ds_read_b64_tr_b16 v[238:239], v11 offset:32256
    v_accvgpr_mov_b32 a123, a125
    v_mfma_f32_16x16x32_bf16 v[196:199], v[212:215], a[92:95], v[196:199]
    v_mfma_f32_16x16x32_bf16 v[196:199], v[208:211], a[76:79], v[196:199]
    v_accvgpr_write_b32 a124, v240
    v_accvgpr_write_b32 a125, v241
    s_waitcnt lgkmcnt(8)
    v_mfma_f32_16x16x32_bf16 v[92:95], v[216:219], a[64:67], v[92:95]
    v_mfma_f32_16x16x32_bf16 v[92:95], v[220:223], a[80:83], v[92:95]
    v_mfma_f32_16x16x32_bf16 v[128:131], v[220:223], a[84:87], v[128:131]
    v_mfma_f32_16x16x32_bf16 v[128:131], v[216:219], a[68:71], v[128:131]
    v_mfma_f32_16x16x32_bf16 v[164:167], v[216:219], a[72:75], v[164:167]
    v_mfma_f32_16x16x32_bf16 v[164:167], v[220:223], a[88:91], v[164:167]
    v_mfma_f32_16x16x32_bf16 v[200:203], v[220:223], a[92:95], v[200:203]
    v_mfma_f32_16x16x32_bf16 v[200:203], v[216:219], a[76:79], v[200:203]
    s_waitcnt lgkmcnt(0)
    s_barrier
    v_mfma_f32_16x16x32_bf16 v[96:99], v[224:227], a[64:67], v[96:99]
    ds_read_b64_tr_b16 v[208:209], v8 offset:0
    ds_read_b64_tr_b16 v[210:211], v8 offset:4608
    v_mfma_f32_16x16x32_bf16 v[96:99], v[228:231], a[80:83], v[96:99]
    ds_read_b64_tr_b16 v[212:213], v8 offset:9216
    ds_read_b64_tr_b16 v[214:215], v8 offset:13824
    v_mfma_f32_16x16x32_bf16 v[132:135], v[228:231], a[84:87], v[132:135]
    ds_read_b64_tr_b16 v[216:217], v8 offset:18432
    ds_read_b64_tr_b16 v[218:219], v8 offset:23040
    v_mfma_f32_16x16x32_bf16 v[132:135], v[224:227], a[68:71], v[132:135]
    v_mfma_f32_16x16x32_bf16 v[168:171], v[224:227], a[72:75], v[168:171]
    ds_read_b64_tr_b16 v[220:221], v8 offset:27648
    v_mfma_f32_16x16x32_bf16 v[168:171], v[228:231], a[88:91], v[168:171]
    ds_read_b64_tr_b16 v[222:223], v8 offset:32256
    v_mfma_f32_16x16x32_bf16 v[204:207], v[228:231], a[92:95], v[204:207]
    v_mfma_f32_16x16x32_bf16 v[204:207], v[224:227], a[76:79], v[204:207]
    v_mfma_f32_16x16x32_bf16 v[64:67], v[232:235], a[96:99], v[64:67]
    ds_read_b64_tr_b16 v[224:225], v11 offset:18464
    v_mfma_f32_16x16x32_bf16 v[64:67], v[236:239], a[112:115], v[64:67]
    ds_read_b64_tr_b16 v[226:227], v11 offset:23072
    v_mfma_f32_16x16x32_bf16 v[100:103], v[236:239], a[116:119], v[100:103]
    v_mfma_f32_16x16x32_bf16 v[100:103], v[232:235], a[100:103], v[100:103]
    v_mfma_f32_16x16x32_bf16 v[136:139], v[232:235], a[104:107], v[136:139]
    ds_read_b64_tr_b16 v[228:229], v11 offset:27680
    v_mfma_f32_16x16x32_bf16 v[136:139], v[236:239], a[120:123], v[136:139]
    ds_read_b64_tr_b16 v[230:231], v11 offset:32288
    v_mfma_f32_16x16x32_bf16 v[172:175], v[236:239], a[124:127], v[172:175]
    v_mfma_f32_16x16x32_bf16 v[172:175], v[232:235], a[108:111], v[172:175]
    s_waitcnt vmcnt(13) lgkmcnt(8)
    v_mfma_f32_16x16x32_bf16 v[64:67], v[208:211], a[192:195], v[64:67]
    ds_read_b64_tr_b16 v[232:233], v8 offset:32
    s_waitcnt vmcnt(9)
    v_mfma_f32_16x16x32_bf16 v[64:67], v[212:215], a[208:211], v[64:67]
    ds_read_b64_tr_b16 v[234:235], v8 offset:4640
    v_mfma_f32_16x16x32_bf16 v[100:103], v[212:215], a[212:215], v[100:103]
    v_mfma_f32_16x16x32_bf16 v[100:103], v[208:211], a[196:199], v[100:103]
    v_mfma_f32_16x16x32_bf16 v[136:139], v[208:211], a[200:203], v[136:139]
    ds_read_b64_tr_b16 v[236:237], v8 offset:9248
    v_mfma_f32_16x16x32_bf16 v[136:139], v[212:215], a[216:219], v[136:139]
    ds_read_b64_tr_b16 v[238:239], v8 offset:13856
    v_mfma_f32_16x16x32_bf16 v[172:175], v[212:215], a[220:223], v[172:175]
    v_mfma_f32_16x16x32_bf16 v[172:175], v[208:211], a[204:207], v[172:175]
    s_waitcnt vmcnt(5) lgkmcnt(8)
    v_mfma_f32_16x16x32_bf16 v[64:67], v[216:219], a[224:227], v[64:67]
    ds_read_b64_tr_b16 v[208:209], v8 offset:18464
    s_waitcnt vmcnt(1)
    v_mfma_f32_16x16x32_bf16 v[64:67], v[220:223], a[240:243], v[64:67]
    ds_read_b64_tr_b16 v[210:211], v8 offset:23072
    v_mfma_f32_16x16x32_bf16 v[100:103], v[220:223], a[244:247], v[100:103]
    v_mfma_f32_16x16x32_bf16 v[100:103], v[216:219], a[228:231], v[100:103]
    v_mfma_f32_16x16x32_bf16 v[136:139], v[216:219], a[232:235], v[136:139]
    ds_read_b64_tr_b16 v[212:213], v8 offset:27680
    v_mfma_f32_16x16x32_bf16 v[136:139], v[220:223], a[248:251], v[136:139]
    ds_read_b64_tr_b16 v[214:215], v8 offset:32288
    v_mfma_f32_16x16x32_bf16 v[172:175], v[220:223], a[252:255], v[172:175]
    v_mfma_f32_16x16x32_bf16 v[172:175], v[216:219], a[236:239], v[172:175]
    s_waitcnt lgkmcnt(8)
    v_mfma_f32_16x16x32_bf16 v[68:71], v[224:227], a[96:99], v[68:71]
    ds_read_b64_tr_b16 v[216:217], v11 offset:18496
    v_mfma_f32_16x16x32_bf16 v[68:71], v[228:231], a[112:115], v[68:71]
    ds_read_b64_tr_b16 v[218:219], v11 offset:23104
    v_mfma_f32_16x16x32_bf16 v[104:107], v[228:231], a[116:119], v[104:107]
    v_mfma_f32_16x16x32_bf16 v[104:107], v[224:227], a[100:103], v[104:107]
    v_mfma_f32_16x16x32_bf16 v[140:143], v[224:227], a[104:107], v[140:143]
    ds_read_b64_tr_b16 v[220:221], v11 offset:27712
    v_cvt_pk_bf16_f32 v12, v64, v65
    v_mfma_f32_16x16x32_bf16 v[140:143], v[228:231], a[120:123], v[140:143]
    ds_read_b64_tr_b16 v[222:223], v11 offset:32320
    v_cvt_pk_bf16_f32 v13, v66, v67
    v_mfma_f32_16x16x32_bf16 v[176:179], v[228:231], a[124:127], v[176:179]
    v_mfma_f32_16x16x32_bf16 v[176:179], v[224:227], a[108:111], v[176:179]
    s_add_u32 s6, s63, 0
    v_cvt_pk_bf16_f32 v14, v100, v101
    v_cvt_pk_bf16_f32 v15, v102, v103
    s_waitcnt lgkmcnt(8)
    v_mfma_f32_16x16x32_bf16 v[68:71], v[232:235], a[192:195], v[68:71]
    ds_read_b64_tr_b16 v[224:225], v8 offset:64
    v_cvt_pk_bf16_f32 v16, v136, v137
    v_mfma_f32_16x16x32_bf16 v[68:71], v[236:239], a[208:211], v[68:71]
    ds_read_b64_tr_b16 v[226:227], v8 offset:4672
    v_cvt_pk_bf16_f32 v17, v138, v139
    v_mfma_f32_16x16x32_bf16 v[104:107], v[236:239], a[212:215], v[104:107]
    buffer_store_dwordx4 v[12:15], v7, s[28:31], s6 offen sc1
    v_mfma_f32_16x16x32_bf16 v[104:107], v[232:235], a[196:199], v[104:107]
    v_cvt_pk_bf16_f32 v18, v172, v173
    v_cvt_pk_bf16_f32 v19, v174, v175
    v_mfma_f32_16x16x32_bf16 v[140:143], v[232:235], a[200:203], v[140:143]
    ds_read_b64_tr_b16 v[228:229], v8 offset:9280
    v_mfma_f32_16x16x32_bf16 v[140:143], v[236:239], a[216:219], v[140:143]
    ds_read_b64_tr_b16 v[230:231], v8 offset:13888
    v_mfma_f32_16x16x32_bf16 v[176:179], v[236:239], a[220:223], v[176:179]
    v_mfma_f32_16x16x32_bf16 v[176:179], v[232:235], a[204:207], v[176:179]
    s_waitcnt lgkmcnt(8)
    v_mfma_f32_16x16x32_bf16 v[68:71], v[208:211], a[224:227], v[68:71]
    ds_read_b64_tr_b16 v[232:233], v8 offset:18496
    v_mfma_f32_16x16x32_bf16 v[68:71], v[212:215], a[240:243], v[68:71]
    ds_read_b64_tr_b16 v[234:235], v8 offset:23104
    v_mfma_f32_16x16x32_bf16 v[104:107], v[212:215], a[244:247], v[104:107]
    v_mfma_f32_16x16x32_bf16 v[104:107], v[208:211], a[228:231], v[104:107]
    s_add_u32 s6, s63, 9216
    v_mfma_f32_16x16x32_bf16 v[140:143], v[208:211], a[232:235], v[140:143]
    ds_read_b64_tr_b16 v[236:237], v8 offset:27712
    v_mfma_f32_16x16x32_bf16 v[140:143], v[212:215], a[248:251], v[140:143]
    ds_read_b64_tr_b16 v[238:239], v8 offset:32320
    v_mfma_f32_16x16x32_bf16 v[176:179], v[212:215], a[252:255], v[176:179]
    buffer_store_dwordx4 v[16:19], v7, s[28:31], s6 offen sc1
    v_mfma_f32_16x16x32_bf16 v[176:179], v[208:211], a[236:239], v[176:179]
    s_waitcnt lgkmcnt(8)
    v_mfma_f32_16x16x32_bf16 v[72:75], v[216:219], a[96:99], v[72:75]
    ds_read_b64_tr_b16 v[208:209], v11 offset:18528
    v_mfma_f32_16x16x32_bf16 v[72:75], v[220:223], a[112:115], v[72:75]
    ds_read_b64_tr_b16 v[210:211], v11 offset:23136
    v_mfma_f32_16x16x32_bf16 v[108:111], v[220:223], a[116:119], v[108:111]
    v_mfma_f32_16x16x32_bf16 v[108:111], v[216:219], a[100:103], v[108:111]
    v_mfma_f32_16x16x32_bf16 v[144:147], v[216:219], a[104:107], v[144:147]
    ds_read_b64_tr_b16 v[212:213], v11 offset:27744
    v_cvt_pk_bf16_f32 v20, v68, v69
    v_mfma_f32_16x16x32_bf16 v[144:147], v[220:223], a[120:123], v[144:147]
    ds_read_b64_tr_b16 v[214:215], v11 offset:32352
    v_cvt_pk_bf16_f32 v21, v70, v71
    v_mfma_f32_16x16x32_bf16 v[180:183], v[220:223], a[124:127], v[180:183]
    v_mfma_f32_16x16x32_bf16 v[180:183], v[216:219], a[108:111], v[180:183]
    s_add_u32 s6, s63, 1024
    v_cvt_pk_bf16_f32 v22, v104, v105
    v_cvt_pk_bf16_f32 v23, v106, v107
    s_waitcnt lgkmcnt(8)
    v_mfma_f32_16x16x32_bf16 v[72:75], v[224:227], a[192:195], v[72:75]
    ds_read_b64_tr_b16 v[216:217], v8 offset:96
    v_cvt_pk_bf16_f32 v24, v140, v141
    v_mfma_f32_16x16x32_bf16 v[72:75], v[228:231], a[208:211], v[72:75]
    ds_read_b64_tr_b16 v[218:219], v8 offset:4704
    v_cvt_pk_bf16_f32 v25, v142, v143
    v_mfma_f32_16x16x32_bf16 v[108:111], v[228:231], a[212:215], v[108:111]
    buffer_store_dwordx4 v[20:23], v7, s[28:31], s6 offen sc1
    v_mfma_f32_16x16x32_bf16 v[108:111], v[224:227], a[196:199], v[108:111]
    v_cvt_pk_bf16_f32 v26, v176, v177
    v_cvt_pk_bf16_f32 v27, v178, v179
    v_mfma_f32_16x16x32_bf16 v[144:147], v[224:227], a[200:203], v[144:147]
    ds_read_b64_tr_b16 v[220:221], v8 offset:9312
    v_mfma_f32_16x16x32_bf16 v[144:147], v[228:231], a[216:219], v[144:147]
    ds_read_b64_tr_b16 v[222:223], v8 offset:13920
    v_mfma_f32_16x16x32_bf16 v[180:183], v[228:231], a[220:223], v[180:183]
    v_mfma_f32_16x16x32_bf16 v[180:183], v[224:227], a[204:207], v[180:183]
    s_waitcnt lgkmcnt(8)
    v_mfma_f32_16x16x32_bf16 v[72:75], v[232:235], a[224:227], v[72:75]
    ds_read_b64_tr_b16 v[224:225], v8 offset:18528
    v_mfma_f32_16x16x32_bf16 v[72:75], v[236:239], a[240:243], v[72:75]
    ds_read_b64_tr_b16 v[226:227], v8 offset:23136
    v_mfma_f32_16x16x32_bf16 v[108:111], v[236:239], a[244:247], v[108:111]
    v_mfma_f32_16x16x32_bf16 v[108:111], v[232:235], a[228:231], v[108:111]
    s_add_u32 s6, s63, 10240
    v_mfma_f32_16x16x32_bf16 v[144:147], v[232:235], a[232:235], v[144:147]
    ds_read_b64_tr_b16 v[228:229], v8 offset:27744
    v_mfma_f32_16x16x32_bf16 v[144:147], v[236:239], a[248:251], v[144:147]
    ds_read_b64_tr_b16 v[230:231], v8 offset:32352
    v_mfma_f32_16x16x32_bf16 v[180:183], v[236:239], a[252:255], v[180:183]
    buffer_store_dwordx4 v[24:27], v7, s[28:31], s6 offen sc1
    v_mfma_f32_16x16x32_bf16 v[180:183], v[232:235], a[236:239], v[180:183]
    s_waitcnt lgkmcnt(8)
    v_mfma_f32_16x16x32_bf16 v[76:79], v[208:211], a[96:99], v[76:79]
    ds_read_b64_tr_b16 v[232:233], v11 offset:18560
    v_mfma_f32_16x16x32_bf16 v[76:79], v[212:215], a[112:115], v[76:79]
    ds_read_b64_tr_b16 v[234:235], v11 offset:23168
    v_mfma_f32_16x16x32_bf16 v[112:115], v[212:215], a[116:119], v[112:115]
    v_mfma_f32_16x16x32_bf16 v[112:115], v[208:211], a[100:103], v[112:115]
    v_mfma_f32_16x16x32_bf16 v[148:151], v[208:211], a[104:107], v[148:151]
    ds_read_b64_tr_b16 v[236:237], v11 offset:27776
    v_cvt_pk_bf16_f32 v28, v72, v73
    v_mfma_f32_16x16x32_bf16 v[148:151], v[212:215], a[120:123], v[148:151]
    ds_read_b64_tr_b16 v[238:239], v11 offset:32384
    v_cvt_pk_bf16_f32 v29, v74, v75
    v_mfma_f32_16x16x32_bf16 v[184:187], v[212:215], a[124:127], v[184:187]
    v_mfma_f32_16x16x32_bf16 v[184:187], v[208:211], a[108:111], v[184:187]
    s_add_u32 s6, s63, 2048
    v_cvt_pk_bf16_f32 v30, v108, v109
    v_cvt_pk_bf16_f32 v31, v110, v111
    s_waitcnt lgkmcnt(8)
    v_mfma_f32_16x16x32_bf16 v[76:79], v[216:219], a[192:195], v[76:79]
    ds_read_b64_tr_b16 v[208:209], v8 offset:128
    v_cvt_pk_bf16_f32 v32, v144, v145
    v_mfma_f32_16x16x32_bf16 v[76:79], v[220:223], a[208:211], v[76:79]
    ds_read_b64_tr_b16 v[210:211], v8 offset:4736
    v_cvt_pk_bf16_f32 v33, v146, v147
    v_mfma_f32_16x16x32_bf16 v[112:115], v[220:223], a[212:215], v[112:115]
    buffer_store_dwordx4 v[28:31], v7, s[28:31], s6 offen sc1
    v_mfma_f32_16x16x32_bf16 v[112:115], v[216:219], a[196:199], v[112:115]
    v_cvt_pk_bf16_f32 v34, v180, v181
    v_cvt_pk_bf16_f32 v35, v182, v183
    v_mfma_f32_16x16x32_bf16 v[148:151], v[216:219], a[200:203], v[148:151]
    ds_read_b64_tr_b16 v[212:213], v8 offset:9344
    v_mfma_f32_16x16x32_bf16 v[148:151], v[220:223], a[216:219], v[148:151]
    ds_read_b64_tr_b16 v[214:215], v8 offset:13952
    v_mfma_f32_16x16x32_bf16 v[184:187], v[220:223], a[220:223], v[184:187]
    v_mfma_f32_16x16x32_bf16 v[184:187], v[216:219], a[204:207], v[184:187]
    s_waitcnt lgkmcnt(8)
    v_mfma_f32_16x16x32_bf16 v[76:79], v[224:227], a[224:227], v[76:79]
    ds_read_b64_tr_b16 v[216:217], v8 offset:18560
    v_mfma_f32_16x16x32_bf16 v[76:79], v[228:231], a[240:243], v[76:79]
    ds_read_b64_tr_b16 v[218:219], v8 offset:23168
    v_mfma_f32_16x16x32_bf16 v[112:115], v[228:231], a[244:247], v[112:115]
    v_mfma_f32_16x16x32_bf16 v[112:115], v[224:227], a[228:231], v[112:115]
    s_add_u32 s6, s63, 11264
    v_mfma_f32_16x16x32_bf16 v[148:151], v[224:227], a[232:235], v[148:151]
    ds_read_b64_tr_b16 v[220:221], v8 offset:27776
    v_mfma_f32_16x16x32_bf16 v[148:151], v[228:231], a[248:251], v[148:151]
    ds_read_b64_tr_b16 v[222:223], v8 offset:32384
    v_mfma_f32_16x16x32_bf16 v[184:187], v[228:231], a[252:255], v[184:187]
    buffer_store_dwordx4 v[32:35], v7, s[28:31], s6 offen sc1
    v_mfma_f32_16x16x32_bf16 v[184:187], v[224:227], a[236:239], v[184:187]
    s_waitcnt lgkmcnt(8)
    v_mfma_f32_16x16x32_bf16 v[80:83], v[232:235], a[96:99], v[80:83]
    ds_read_b64_tr_b16 v[224:225], v11 offset:18592
    v_mfma_f32_16x16x32_bf16 v[80:83], v[236:239], a[112:115], v[80:83]
    ds_read_b64_tr_b16 v[226:227], v11 offset:23200
    v_mfma_f32_16x16x32_bf16 v[116:119], v[236:239], a[116:119], v[116:119]
    v_mfma_f32_16x16x32_bf16 v[116:119], v[232:235], a[100:103], v[116:119]
    v_mfma_f32_16x16x32_bf16 v[152:155], v[232:235], a[104:107], v[152:155]
    ds_read_b64_tr_b16 v[228:229], v11 offset:27808
    v_cvt_pk_bf16_f32 v36, v76, v77
    v_mfma_f32_16x16x32_bf16 v[152:155], v[236:239], a[120:123], v[152:155]
    ds_read_b64_tr_b16 v[230:231], v11 offset:32416
    v_cvt_pk_bf16_f32 v37, v78, v79
    v_mfma_f32_16x16x32_bf16 v[188:191], v[236:239], a[124:127], v[188:191]
    v_mfma_f32_16x16x32_bf16 v[188:191], v[232:235], a[108:111], v[188:191]
    s_add_u32 s6, s63, 3072
    v_cvt_pk_bf16_f32 v38, v112, v113
    v_cvt_pk_bf16_f32 v39, v114, v115
    s_waitcnt lgkmcnt(8)
    v_mfma_f32_16x16x32_bf16 v[80:83], v[208:211], a[192:195], v[80:83]
    ds_read_b64_tr_b16 v[232:233], v8 offset:160
    v_cvt_pk_bf16_f32 v40, v148, v149
    v_mfma_f32_16x16x32_bf16 v[80:83], v[212:215], a[208:211], v[80:83]
    ds_read_b64_tr_b16 v[234:235], v8 offset:4768
    v_cvt_pk_bf16_f32 v41, v150, v151
    v_mfma_f32_16x16x32_bf16 v[116:119], v[212:215], a[212:215], v[116:119]
    buffer_store_dwordx4 v[36:39], v7, s[28:31], s6 offen sc1
    v_mfma_f32_16x16x32_bf16 v[116:119], v[208:211], a[196:199], v[116:119]
    v_cvt_pk_bf16_f32 v42, v184, v185
    v_cvt_pk_bf16_f32 v43, v186, v187
    v_mfma_f32_16x16x32_bf16 v[152:155], v[208:211], a[200:203], v[152:155]
    ds_read_b64_tr_b16 v[236:237], v8 offset:9376
    v_mfma_f32_16x16x32_bf16 v[152:155], v[212:215], a[216:219], v[152:155]
    ds_read_b64_tr_b16 v[238:239], v8 offset:13984
    v_mfma_f32_16x16x32_bf16 v[188:191], v[212:215], a[220:223], v[188:191]
    v_mfma_f32_16x16x32_bf16 v[188:191], v[208:211], a[204:207], v[188:191]
    s_waitcnt lgkmcnt(8)
    v_mfma_f32_16x16x32_bf16 v[80:83], v[216:219], a[224:227], v[80:83]
    ds_read_b64_tr_b16 v[208:209], v8 offset:18592
    v_mfma_f32_16x16x32_bf16 v[80:83], v[220:223], a[240:243], v[80:83]
    ds_read_b64_tr_b16 v[210:211], v8 offset:23200
    v_mfma_f32_16x16x32_bf16 v[116:119], v[220:223], a[244:247], v[116:119]
    v_mfma_f32_16x16x32_bf16 v[116:119], v[216:219], a[228:231], v[116:119]
    s_add_u32 s6, s63, 12288
    v_mfma_f32_16x16x32_bf16 v[152:155], v[216:219], a[232:235], v[152:155]
    ds_read_b64_tr_b16 v[212:213], v8 offset:27808
    v_mfma_f32_16x16x32_bf16 v[152:155], v[220:223], a[248:251], v[152:155]
    ds_read_b64_tr_b16 v[214:215], v8 offset:32416
    v_mfma_f32_16x16x32_bf16 v[188:191], v[220:223], a[252:255], v[188:191]
    buffer_store_dwordx4 v[40:43], v7, s[28:31], s6 offen sc1
    v_mfma_f32_16x16x32_bf16 v[188:191], v[216:219], a[236:239], v[188:191]
    s_waitcnt lgkmcnt(8)
    v_mfma_f32_16x16x32_bf16 v[84:87], v[224:227], a[96:99], v[84:87]
    ds_read_b64_tr_b16 v[216:217], v11 offset:18624
    v_mfma_f32_16x16x32_bf16 v[84:87], v[228:231], a[112:115], v[84:87]
    ds_read_b64_tr_b16 v[218:219], v11 offset:23232
    v_mfma_f32_16x16x32_bf16 v[120:123], v[228:231], a[116:119], v[120:123]
    v_mfma_f32_16x16x32_bf16 v[120:123], v[224:227], a[100:103], v[120:123]
    v_mfma_f32_16x16x32_bf16 v[156:159], v[224:227], a[104:107], v[156:159]
    ds_read_b64_tr_b16 v[220:221], v11 offset:27840
    v_cvt_pk_bf16_f32 v44, v80, v81
    v_mfma_f32_16x16x32_bf16 v[156:159], v[228:231], a[120:123], v[156:159]
    ds_read_b64_tr_b16 v[222:223], v11 offset:32448
    v_cvt_pk_bf16_f32 v45, v82, v83
    v_mfma_f32_16x16x32_bf16 v[192:195], v[228:231], a[124:127], v[192:195]
    v_mfma_f32_16x16x32_bf16 v[192:195], v[224:227], a[108:111], v[192:195]
    s_add_u32 s6, s63, 4096
    v_cvt_pk_bf16_f32 v46, v116, v117
    v_cvt_pk_bf16_f32 v47, v118, v119
    s_waitcnt lgkmcnt(8)
    v_mfma_f32_16x16x32_bf16 v[84:87], v[232:235], a[192:195], v[84:87]
    ds_read_b64_tr_b16 v[224:225], v8 offset:192
    v_cvt_pk_bf16_f32 v48, v152, v153
    v_mfma_f32_16x16x32_bf16 v[84:87], v[236:239], a[208:211], v[84:87]
    ds_read_b64_tr_b16 v[226:227], v8 offset:4800
    v_cvt_pk_bf16_f32 v49, v154, v155
    v_mfma_f32_16x16x32_bf16 v[120:123], v[236:239], a[212:215], v[120:123]
    buffer_store_dwordx4 v[44:47], v7, s[28:31], s6 offen sc1
    v_mfma_f32_16x16x32_bf16 v[120:123], v[232:235], a[196:199], v[120:123]
    v_cvt_pk_bf16_f32 v50, v188, v189
    v_cvt_pk_bf16_f32 v51, v190, v191
    v_mfma_f32_16x16x32_bf16 v[156:159], v[232:235], a[200:203], v[156:159]
    ds_read_b64_tr_b16 v[228:229], v8 offset:9408
    v_mfma_f32_16x16x32_bf16 v[156:159], v[236:239], a[216:219], v[156:159]
    ds_read_b64_tr_b16 v[230:231], v8 offset:14016
    v_mfma_f32_16x16x32_bf16 v[192:195], v[236:239], a[220:223], v[192:195]
    v_mfma_f32_16x16x32_bf16 v[192:195], v[232:235], a[204:207], v[192:195]
    s_waitcnt lgkmcnt(8)
    v_mfma_f32_16x16x32_bf16 v[84:87], v[208:211], a[224:227], v[84:87]
    ds_read_b64_tr_b16 v[232:233], v8 offset:18624
    v_mfma_f32_16x16x32_bf16 v[84:87], v[212:215], a[240:243], v[84:87]
    ds_read_b64_tr_b16 v[234:235], v8 offset:23232
    v_mfma_f32_16x16x32_bf16 v[120:123], v[212:215], a[244:247], v[120:123]
    v_mfma_f32_16x16x32_bf16 v[120:123], v[208:211], a[228:231], v[120:123]
    s_add_u32 s6, s63, 13312
    v_mfma_f32_16x16x32_bf16 v[156:159], v[208:211], a[232:235], v[156:159]
    ds_read_b64_tr_b16 v[236:237], v8 offset:27840
    v_mfma_f32_16x16x32_bf16 v[156:159], v[212:215], a[248:251], v[156:159]
    ds_read_b64_tr_b16 v[238:239], v8 offset:32448
    v_mfma_f32_16x16x32_bf16 v[192:195], v[212:215], a[252:255], v[192:195]
    buffer_store_dwordx4 v[48:51], v7, s[28:31], s6 offen sc1
    v_mfma_f32_16x16x32_bf16 v[192:195], v[208:211], a[236:239], v[192:195]
    s_waitcnt lgkmcnt(8)
    v_mfma_f32_16x16x32_bf16 v[88:91], v[216:219], a[96:99], v[88:91]
    ds_read_b64_tr_b16 v[208:209], v11 offset:18656
    v_mfma_f32_16x16x32_bf16 v[88:91], v[220:223], a[112:115], v[88:91]
    ds_read_b64_tr_b16 v[210:211], v11 offset:23264
    v_mfma_f32_16x16x32_bf16 v[124:127], v[220:223], a[116:119], v[124:127]
    v_mfma_f32_16x16x32_bf16 v[124:127], v[216:219], a[100:103], v[124:127]
    v_mfma_f32_16x16x32_bf16 v[160:163], v[216:219], a[104:107], v[160:163]
    ds_read_b64_tr_b16 v[212:213], v11 offset:27872
    v_cvt_pk_bf16_f32 v240, v84, v85
    v_mfma_f32_16x16x32_bf16 v[160:163], v[220:223], a[120:123], v[160:163]
    ds_read_b64_tr_b16 v[214:215], v11 offset:32480
    v_cvt_pk_bf16_f32 v241, v86, v87
    v_mfma_f32_16x16x32_bf16 v[196:199], v[220:223], a[124:127], v[196:199]
    v_mfma_f32_16x16x32_bf16 v[196:199], v[216:219], a[108:111], v[196:199]
    s_add_u32 s6, s63, 5120
    v_cvt_pk_bf16_f32 v242, v120, v121
    v_cvt_pk_bf16_f32 v243, v122, v123
    s_waitcnt lgkmcnt(8)
    v_mfma_f32_16x16x32_bf16 v[88:91], v[224:227], a[192:195], v[88:91]
    ds_read_b64_tr_b16 v[216:217], v8 offset:224
    v_cvt_pk_bf16_f32 v248, v156, v157
    v_mfma_f32_16x16x32_bf16 v[88:91], v[228:231], a[208:211], v[88:91]
    ds_read_b64_tr_b16 v[218:219], v8 offset:4832
    v_cvt_pk_bf16_f32 v249, v158, v159
    v_mfma_f32_16x16x32_bf16 v[124:127], v[228:231], a[212:215], v[124:127]
    buffer_store_dwordx4 v[240:243], v7, s[28:31], s6 offen sc1
    v_mfma_f32_16x16x32_bf16 v[124:127], v[224:227], a[196:199], v[124:127]
    v_cvt_pk_bf16_f32 v250, v192, v193
    v_cvt_pk_bf16_f32 v251, v194, v195
    v_mfma_f32_16x16x32_bf16 v[160:163], v[224:227], a[200:203], v[160:163]
    ds_read_b64_tr_b16 v[220:221], v8 offset:9440
    v_mfma_f32_16x16x32_bf16 v[160:163], v[228:231], a[216:219], v[160:163]
    ds_read_b64_tr_b16 v[222:223], v8 offset:14048
    v_mfma_f32_16x16x32_bf16 v[196:199], v[228:231], a[220:223], v[196:199]
    v_mfma_f32_16x16x32_bf16 v[196:199], v[224:227], a[204:207], v[196:199]
    s_waitcnt lgkmcnt(8)
    v_mfma_f32_16x16x32_bf16 v[88:91], v[232:235], a[224:227], v[88:91]
    ds_read_b64_tr_b16 v[224:225], v8 offset:18656
    v_mfma_f32_16x16x32_bf16 v[88:91], v[236:239], a[240:243], v[88:91]
    ds_read_b64_tr_b16 v[226:227], v8 offset:23264
    v_mfma_f32_16x16x32_bf16 v[124:127], v[236:239], a[244:247], v[124:127]
    v_mfma_f32_16x16x32_bf16 v[124:127], v[232:235], a[228:231], v[124:127]
    s_add_u32 s6, s63, 14336
    v_mfma_f32_16x16x32_bf16 v[160:163], v[232:235], a[232:235], v[160:163]
    ds_read_b64_tr_b16 v[228:229], v8 offset:27872
    v_mfma_f32_16x16x32_bf16 v[160:163], v[236:239], a[248:251], v[160:163]
    ds_read_b64_tr_b16 v[230:231], v8 offset:32480
    v_mfma_f32_16x16x32_bf16 v[196:199], v[236:239], a[252:255], v[196:199]
    buffer_store_dwordx4 v[248:251], v7, s[28:31], s6 offen sc1
    v_mfma_f32_16x16x32_bf16 v[196:199], v[232:235], a[236:239], v[196:199]
    s_waitcnt lgkmcnt(8)
    v_mfma_f32_16x16x32_bf16 v[92:95], v[208:211], a[96:99], v[92:95]
    ds_read_b64_tr_b16 v[232:233], v11 offset:18688
    v_mfma_f32_16x16x32_bf16 v[92:95], v[212:215], a[112:115], v[92:95]
    ds_read_b64_tr_b16 v[234:235], v11 offset:23296
    v_mfma_f32_16x16x32_bf16 v[128:131], v[212:215], a[116:119], v[128:131]
    v_mfma_f32_16x16x32_bf16 v[128:131], v[208:211], a[100:103], v[128:131]
    v_mfma_f32_16x16x32_bf16 v[164:167], v[208:211], a[104:107], v[164:167]
    ds_read_b64_tr_b16 v[236:237], v11 offset:27904
    v_cvt_pk_bf16_f32 v252, v88, v89
    v_mfma_f32_16x16x32_bf16 v[164:167], v[212:215], a[120:123], v[164:167]
    ds_read_b64_tr_b16 v[238:239], v11 offset:32512
    v_cvt_pk_bf16_f32 v253, v90, v91
    v_mfma_f32_16x16x32_bf16 v[200:203], v[212:215], a[124:127], v[200:203]
    v_mfma_f32_16x16x32_bf16 v[200:203], v[208:211], a[108:111], v[200:203]
    s_add_u32 s6, s63, 6144
    v_cvt_pk_bf16_f32 v254, v124, v125
    v_cvt_pk_bf16_f32 v255, v126, v127
    s_waitcnt lgkmcnt(8)
    v_mfma_f32_16x16x32_bf16 v[92:95], v[216:219], a[192:195], v[92:95]
    ds_read_b64_tr_b16 v[208:209], v8 offset:256
    v_cvt_pk_bf16_f32 v12, v160, v161
    v_mfma_f32_16x16x32_bf16 v[92:95], v[220:223], a[208:211], v[92:95]
    ds_read_b64_tr_b16 v[210:211], v8 offset:4864
    v_cvt_pk_bf16_f32 v13, v162, v163
    v_mfma_f32_16x16x32_bf16 v[128:131], v[220:223], a[212:215], v[128:131]
    buffer_store_dwordx4 v[252:255], v7, s[28:31], s6 offen sc1
    v_mfma_f32_16x16x32_bf16 v[128:131], v[216:219], a[196:199], v[128:131]
    v_cvt_pk_bf16_f32 v14, v196, v197
    v_cvt_pk_bf16_f32 v15, v198, v199
    v_mfma_f32_16x16x32_bf16 v[164:167], v[216:219], a[200:203], v[164:167]
    ds_read_b64_tr_b16 v[212:213], v8 offset:9472
    v_mfma_f32_16x16x32_bf16 v[164:167], v[220:223], a[216:219], v[164:167]
    ds_read_b64_tr_b16 v[214:215], v8 offset:14080
    v_mfma_f32_16x16x32_bf16 v[200:203], v[220:223], a[220:223], v[200:203]
    v_mfma_f32_16x16x32_bf16 v[200:203], v[216:219], a[204:207], v[200:203]
    s_waitcnt lgkmcnt(8)
    v_mfma_f32_16x16x32_bf16 v[92:95], v[224:227], a[224:227], v[92:95]
    ds_read_b64_tr_b16 v[216:217], v8 offset:18688
    v_mfma_f32_16x16x32_bf16 v[92:95], v[228:231], a[240:243], v[92:95]
    ds_read_b64_tr_b16 v[218:219], v8 offset:23296
    v_mfma_f32_16x16x32_bf16 v[128:131], v[228:231], a[244:247], v[128:131]
    v_mfma_f32_16x16x32_bf16 v[128:131], v[224:227], a[228:231], v[128:131]
    s_add_u32 s6, s63, 15360
    v_mfma_f32_16x16x32_bf16 v[164:167], v[224:227], a[232:235], v[164:167]
    ds_read_b64_tr_b16 v[220:221], v8 offset:27904
    v_mfma_f32_16x16x32_bf16 v[164:167], v[228:231], a[248:251], v[164:167]
    ds_read_b64_tr_b16 v[222:223], v8 offset:32512
    v_mfma_f32_16x16x32_bf16 v[200:203], v[228:231], a[252:255], v[200:203]
    buffer_store_dwordx4 v[12:15], v7, s[28:31], s6 offen sc1
    v_mfma_f32_16x16x32_bf16 v[200:203], v[224:227], a[236:239], v[200:203]
    s_waitcnt lgkmcnt(8)
    v_mfma_f32_16x16x32_bf16 v[96:99], v[232:235], a[96:99], v[96:99]
    v_mfma_f32_16x16x32_bf16 v[96:99], v[236:239], a[112:115], v[96:99]
    v_mfma_f32_16x16x32_bf16 v[132:135], v[236:239], a[116:119], v[132:135]
    v_mfma_f32_16x16x32_bf16 v[132:135], v[232:235], a[100:103], v[132:135]
    v_mfma_f32_16x16x32_bf16 v[168:171], v[232:235], a[104:107], v[168:171]
    v_cvt_pk_bf16_f32 v16, v92, v93
    v_mfma_f32_16x16x32_bf16 v[168:171], v[236:239], a[120:123], v[168:171]
    v_cvt_pk_bf16_f32 v17, v94, v95
    v_mfma_f32_16x16x32_bf16 v[204:207], v[236:239], a[124:127], v[204:207]
    v_mfma_f32_16x16x32_bf16 v[204:207], v[232:235], a[108:111], v[204:207]
    s_add_u32 s6, s63, 7168
    v_cvt_pk_bf16_f32 v18, v128, v129
    v_cvt_pk_bf16_f32 v19, v130, v131
    s_waitcnt lgkmcnt(4)
    v_mfma_f32_16x16x32_bf16 v[96:99], v[208:211], a[192:195], v[96:99]
    v_cvt_pk_bf16_f32 v20, v164, v165
    v_mfma_f32_16x16x32_bf16 v[96:99], v[212:215], a[208:211], v[96:99]
    v_cvt_pk_bf16_f32 v21, v166, v167
    v_mfma_f32_16x16x32_bf16 v[132:135], v[212:215], a[212:215], v[132:135]
    buffer_store_dwordx4 v[16:19], v7, s[28:31], s6 offen sc1
    v_mfma_f32_16x16x32_bf16 v[132:135], v[208:211], a[196:199], v[132:135]
    v_cvt_pk_bf16_f32 v22, v200, v201
    v_cvt_pk_bf16_f32 v23, v202, v203
    v_mfma_f32_16x16x32_bf16 v[168:171], v[208:211], a[200:203], v[168:171]
    v_mfma_f32_16x16x32_bf16 v[168:171], v[212:215], a[216:219], v[168:171]
    v_mfma_f32_16x16x32_bf16 v[204:207], v[212:215], a[220:223], v[204:207]
    v_mfma_f32_16x16x32_bf16 v[204:207], v[208:211], a[204:207], v[204:207]
    s_waitcnt lgkmcnt(0)
    v_mfma_f32_16x16x32_bf16 v[96:99], v[216:219], a[224:227], v[96:99]
    v_mfma_f32_16x16x32_bf16 v[96:99], v[220:223], a[240:243], v[96:99]
    v_mfma_f32_16x16x32_bf16 v[132:135], v[220:223], a[244:247], v[132:135]
    v_mfma_f32_16x16x32_bf16 v[132:135], v[216:219], a[228:231], v[132:135]
    v_mfma_f32_16x16x32_bf16 v[168:171], v[216:219], a[232:235], v[168:171]
    v_mfma_f32_16x16x32_bf16 v[168:171], v[220:223], a[248:251], v[168:171]
    v_mfma_f32_16x16x32_bf16 v[204:207], v[220:223], a[252:255], v[204:207]
    v_mfma_f32_16x16x32_bf16 v[204:207], v[216:219], a[236:239], v[204:207]
    s_load_dwordx2 s[76:77], s[0:1], 0
    s_load_dwordx2 s[78:79], s[0:1], 72
    s_nop 7
    s_add_u32 s6, s63, 16384
    buffer_store_dwordx4 v[20:23], v7, s[28:31], s6 offen sc1
    v_cvt_pk_bf16_f32 v24, v96, v97
    v_cvt_pk_bf16_f32 v25, v98, v99
    v_cvt_pk_bf16_f32 v26, v132, v133
    v_cvt_pk_bf16_f32 v27, v134, v135
    s_add_u32 s6, s63, 8192
    buffer_store_dwordx4 v[24:27], v7, s[28:31], s6 offen sc1
    v_cvt_pk_bf16_f32 v28, v168, v169
    v_cvt_pk_bf16_f32 v29, v170, v171
    v_cvt_pk_bf16_f32 v30, v204, v205
    v_cvt_pk_bf16_f32 v31, v206, v207
    s_add_u32 s6, s63, 17408
    buffer_store_dwordx4 v[28:31], v7, s[28:31], s6 offen sc1
    s_branch L_k2_join
L_k2_pathO:
    v_and_b32 v62, 12, v0
    s_waitcnt vmcnt(18)
    v_accvgpr_read_b32 v12, a0
    v_accvgpr_read_b32 v13, a1
    v_accvgpr_read_b32 v14, a2
    v_accvgpr_read_b32 v15, a3
    v_accvgpr_read_b32 v16, a16
    v_accvgpr_read_b32 v17, a17
    v_accvgpr_read_b32 v18, a18
    v_accvgpr_read_b32 v19, a19
    v_mul_f32 v12, v12, v4
    v_mul_f32 v13, v13, v4
    v_mul_f32 v14, v14, v4
    v_mul_f32 v15, v15, v4
    v_mul_f32 v16, v16, v4
    v_mul_f32 v17, v17, v4
    v_mul_f32 v18, v18, v4
    v_mul_f32 v19, v19, v4
    v_cvt_pk_bf16_f32 v28, v12, v13
    v_cvt_pk_bf16_f32 v29, v14, v15
    v_cvt_pk_bf16_f32 v30, v16, v17
    v_cvt_pk_bf16_f32 v31, v18, v19
    s_add_u32 s6, s54, 0
    buffer_store_dwordx4 v[28:31], v7, s[36:39], s6 offen offset:0 sc1
    v_accvgpr_write_b32 a192, v28
    v_accvgpr_write_b32 a193, v29
    v_accvgpr_write_b32 a194, v30
    v_accvgpr_write_b32 a195, v31
    v_accvgpr_read_b32 v20, a4
    v_accvgpr_read_b32 v21, a5
    v_accvgpr_read_b32 v22, a6
    v_accvgpr_read_b32 v23, a7
    v_accvgpr_read_b32 v24, a20
    v_accvgpr_read_b32 v25, a21
    v_accvgpr_read_b32 v26, a22
    v_accvgpr_read_b32 v27, a23
    v_mul_f32 v20, v20, v5
    v_mul_f32 v21, v21, v5
    v_mul_f32 v22, v22, v5
    v_mul_f32 v23, v23, v5
    v_mul_f32 v24, v24, v5
    v_mul_f32 v25, v25, v5
    v_mul_f32 v26, v26, v5
    v_mul_f32 v27, v27, v5
    v_cvt_pk_bf16_f32 v32, v20, v21
    v_cvt_pk_bf16_f32 v33, v22, v23
    v_cvt_pk_bf16_f32 v34, v24, v25
    v_cvt_pk_bf16_f32 v35, v26, v27
    s_add_u32 s6, s54, 0
    buffer_store_dwordx4 v[32:35], v7, s[36:39], s6 offen offset:1024 sc1
    v_accvgpr_write_b32 a196, v32
    v_accvgpr_write_b32 a197, v33
    v_accvgpr_write_b32 a198, v34
    v_accvgpr_write_b32 a199, v35
    v_accvgpr_read_b32 v12, a8
    v_accvgpr_read_b32 v13, a9
    v_accvgpr_read_b32 v14, a10
    v_accvgpr_read_b32 v15, a11
    v_accvgpr_read_b32 v16, a24
    v_accvgpr_read_b32 v17, a25
    v_accvgpr_read_b32 v18, a26
    v_accvgpr_read_b32 v19, a27
    v_mul_f32 v12, v12, v6
    v_mul_f32 v13, v13, v6
    v_mul_f32 v14, v14, v6
    v_mul_f32 v15, v15, v6
    v_mul_f32 v16, v16, v6
    v_mul_f32 v17, v17, v6
    v_mul_f32 v18, v18, v6
    v_mul_f32 v19, v19, v6
    v_cvt_pk_bf16_f32 v36, v12, v13
    v_cvt_pk_bf16_f32 v37, v14, v15
    v_cvt_pk_bf16_f32 v38, v16, v17
    v_cvt_pk_bf16_f32 v39, v18, v19
    s_add_u32 s6, s54, 0
    buffer_store_dwordx4 v[36:39], v7, s[36:39], s6 offen offset:2048 sc1
    v_accvgpr_write_b32 a200, v36
    v_accvgpr_write_b32 a201, v37
    v_accvgpr_write_b32 a202, v38
    v_accvgpr_write_b32 a203, v39
    v_accvgpr_read_b32 v20, a12
    v_accvgpr_read_b32 v21, a13
    v_accvgpr_read_b32 v22, a14
    v_accvgpr_read_b32 v23, a15
    v_accvgpr_read_b32 v24, a28
    v_accvgpr_read_b32 v25, a29
    v_accvgpr_read_b32 v26, a30
    v_accvgpr_read_b32 v27, a31
    v_mul_f32 v20, v20, v61
    v_mul_f32 v21, v21, v61
    v_mul_f32 v22, v22, v61
    v_mul_f32 v23, v23, v61
    v_mul_f32 v24, v24, v61
    v_mul_f32 v25, v25, v61
    v_mul_f32 v26, v26, v61
    v_mul_f32 v27, v27, v61
    v_cvt_pk_bf16_f32 v40, v20, v21
    v_cvt_pk_bf16_f32 v41, v22, v23
    v_cvt_pk_bf16_f32 v42, v24, v25
    v_cvt_pk_bf16_f32 v43, v26, v27
    s_add_u32 s6, s54, 0
    buffer_store_dwordx4 v[40:43], v7, s[36:39], s6 offen offset:3072 sc1
    v_accvgpr_write_b32 a204, v40
    v_accvgpr_write_b32 a205, v41
    v_accvgpr_write_b32 a206, v42
    v_accvgpr_write_b32 a207, v43
    v_accvgpr_read_b32 v12, a32
    v_accvgpr_read_b32 v13, a33
    v_accvgpr_read_b32 v14, a34
    v_accvgpr_read_b32 v15, a35
    v_accvgpr_read_b32 v16, a48
    v_accvgpr_read_b32 v17, a49
    v_accvgpr_read_b32 v18, a50
    v_accvgpr_read_b32 v19, a51
    v_mul_f32 v12, v12, v4
    v_mul_f32 v13, v13, v4
    v_mul_f32 v14, v14, v4
    v_mul_f32 v15, v15, v4
    v_mul_f32 v16, v16, v4
    v_mul_f32 v17, v17, v4
    v_mul_f32 v18, v18, v4
    v_mul_f32 v19, v19, v4
    v_cvt_pk_bf16_f32 v28, v12, v13
    v_cvt_pk_bf16_f32 v29, v14, v15
    v_cvt_pk_bf16_f32 v30, v16, v17
    v_cvt_pk_bf16_f32 v31, v18, v19
    s_add_u32 s6, s54, 4096
    buffer_store_dwordx4 v[28:31], v7, s[36:39], s6 offen offset:0 sc1
    v_accvgpr_write_b32 a208, v28
    v_accvgpr_write_b32 a209, v29
    v_accvgpr_write_b32 a210, v30
    v_accvgpr_write_b32 a211, v31
    v_accvgpr_read_b32 v20, a36
    v_accvgpr_read_b32 v21, a37
    v_accvgpr_read_b32 v22, a38
    v_accvgpr_read_b32 v23, a39
    v_accvgpr_read_b32 v24, a52
    v_accvgpr_read_b32 v25, a53
    v_accvgpr_read_b32 v26, a54
    v_accvgpr_read_b32 v27, a55
    v_mul_f32 v20, v20, v5
    v_mul_f32 v21, v21, v5
    v_mul_f32 v22, v22, v5
    v_mul_f32 v23, v23, v5
    v_mul_f32 v24, v24, v5
    v_mul_f32 v25, v25, v5
    v_mul_f32 v26, v26, v5
    v_mul_f32 v27, v27, v5
    v_cvt_pk_bf16_f32 v32, v20, v21
    v_cvt_pk_bf16_f32 v33, v22, v23
    v_cvt_pk_bf16_f32 v34, v24, v25
    v_cvt_pk_bf16_f32 v35, v26, v27
    s_add_u32 s6, s54, 4096
    buffer_store_dwordx4 v[32:35], v7, s[36:39], s6 offen offset:1024 sc1
    v_accvgpr_write_b32 a212, v32
    v_accvgpr_write_b32 a213, v33
    v_accvgpr_write_b32 a214, v34
    v_accvgpr_write_b32 a215, v35
    v_accvgpr_read_b32 v12, a40
    v_accvgpr_read_b32 v13, a41
    v_accvgpr_read_b32 v14, a42
    v_accvgpr_read_b32 v15, a43
    v_accvgpr_read_b32 v16, a56
    v_accvgpr_read_b32 v17, a57
    v_accvgpr_read_b32 v18, a58
    v_accvgpr_read_b32 v19, a59
    v_mul_f32 v12, v12, v6
    v_mul_f32 v13, v13, v6
    v_mul_f32 v14, v14, v6
    v_mul_f32 v15, v15, v6
    v_mul_f32 v16, v16, v6
    v_mul_f32 v17, v17, v6
    v_mul_f32 v18, v18, v6
    v_mul_f32 v19, v19, v6
    v_cvt_pk_bf16_f32 v36, v12, v13
    v_cvt_pk_bf16_f32 v37, v14, v15
    v_cvt_pk_bf16_f32 v38, v16, v17
    v_cvt_pk_bf16_f32 v39, v18, v19
    s_add_u32 s6, s54, 4096
    buffer_store_dwordx4 v[36:39], v7, s[36:39], s6 offen offset:2048 sc1
    v_accvgpr_write_b32 a216, v36
    v_accvgpr_write_b32 a217, v37
    v_accvgpr_write_b32 a218, v38
    v_accvgpr_write_b32 a219, v39
    v_accvgpr_read_b32 v20, a44
    v_accvgpr_read_b32 v21, a45
    v_accvgpr_read_b32 v22, a46
    v_accvgpr_read_b32 v23, a47
    v_accvgpr_read_b32 v24, a60
    v_accvgpr_read_b32 v25, a61
    v_accvgpr_read_b32 v26, a62
    v_accvgpr_read_b32 v27, a63
    v_mul_f32 v20, v20, v61
    v_mul_f32 v21, v21, v61
    v_mul_f32 v22, v22, v61
    v_mul_f32 v23, v23, v61
    v_mul_f32 v24, v24, v61
    v_mul_f32 v25, v25, v61
    v_mul_f32 v26, v26, v61
    v_mul_f32 v27, v27, v61
    v_cvt_pk_bf16_f32 v40, v20, v21
    v_cvt_pk_bf16_f32 v41, v22, v23
    v_cvt_pk_bf16_f32 v42, v24, v25
    v_cvt_pk_bf16_f32 v43, v26, v27
    s_add_u32 s6, s54, 4096
    buffer_store_dwordx4 v[40:43], v7, s[36:39], s6 offen offset:3072 sc1
    v_accvgpr_write_b32 a220, v40
    v_accvgpr_write_b32 a221, v41
    v_accvgpr_write_b32 a222, v42
    v_accvgpr_write_b32 a223, v43
    v_accvgpr_read_b32 v12, a64
    v_accvgpr_read_b32 v13, a65
    v_accvgpr_read_b32 v14, a66
    v_accvgpr_read_b32 v15, a67
    v_accvgpr_read_b32 v16, a80
    v_accvgpr_read_b32 v17, a81
    v_accvgpr_read_b32 v18, a82
    v_accvgpr_read_b32 v19, a83
    v_mul_f32 v12, v12, v4
    v_mul_f32 v13, v13, v4
    v_mul_f32 v14, v14, v4
    v_mul_f32 v15, v15, v4
    v_mul_f32 v16, v16, v4
    v_mul_f32 v17, v17, v4
    v_mul_f32 v18, v18, v4
    v_mul_f32 v19, v19, v4
    v_cvt_pk_bf16_f32 v28, v12, v13
    v_cvt_pk_bf16_f32 v29, v14, v15
    v_cvt_pk_bf16_f32 v30, v16, v17
    v_cvt_pk_bf16_f32 v31, v18, v19
    s_add_u32 s6, s54, 8192
    buffer_store_dwordx4 v[28:31], v7, s[36:39], s6 offen offset:0 sc1
    v_accvgpr_write_b32 a224, v28
    v_accvgpr_write_b32 a225, v29
    v_accvgpr_write_b32 a226, v30
    v_accvgpr_write_b32 a227, v31
    v_accvgpr_read_b32 v20, a68
    v_accvgpr_read_b32 v21, a69
    v_accvgpr_read_b32 v22, a70
    v_accvgpr_read_b32 v23, a71
    v_accvgpr_read_b32 v24, a84
    v_accvgpr_read_b32 v25, a85
    v_accvgpr_read_b32 v26, a86
    v_accvgpr_read_b32 v27, a87
    v_mul_f32 v20, v20, v5
    v_mul_f32 v21, v21, v5
    v_mul_f32 v22, v22, v5
    v_mul_f32 v23, v23, v5
    v_mul_f32 v24, v24, v5
    v_mul_f32 v25, v25, v5
    v_mul_f32 v26, v26, v5
    v_mul_f32 v27, v27, v5
    v_cvt_pk_bf16_f32 v32, v20, v21
    v_cvt_pk_bf16_f32 v33, v22, v23
    v_cvt_pk_bf16_f32 v34, v24, v25
    v_cvt_pk_bf16_f32 v35, v26, v27
    s_add_u32 s6, s54, 8192
    buffer_store_dwordx4 v[32:35], v7, s[36:39], s6 offen offset:1024 sc1
    v_accvgpr_write_b32 a228, v32
    v_accvgpr_write_b32 a229, v33
    v_accvgpr_write_b32 a230, v34
    v_accvgpr_write_b32 a231, v35
    v_accvgpr_read_b32 v12, a72
    v_accvgpr_read_b32 v13, a73
    v_accvgpr_read_b32 v14, a74
    v_accvgpr_read_b32 v15, a75
    v_accvgpr_read_b32 v16, a88
    v_accvgpr_read_b32 v17, a89
    v_accvgpr_read_b32 v18, a90
    v_accvgpr_read_b32 v19, a91
    v_mul_f32 v12, v12, v6
    v_mul_f32 v13, v13, v6
    v_mul_f32 v14, v14, v6
    v_mul_f32 v15, v15, v6
    v_mul_f32 v16, v16, v6
    v_mul_f32 v17, v17, v6
    v_mul_f32 v18, v18, v6
    v_mul_f32 v19, v19, v6
    v_cvt_pk_bf16_f32 v36, v12, v13
    v_cvt_pk_bf16_f32 v37, v14, v15
    v_cvt_pk_bf16_f32 v38, v16, v17
    v_cvt_pk_bf16_f32 v39, v18, v19
    s_add_u32 s6, s54, 8192
    buffer_store_dwordx4 v[36:39], v7, s[36:39], s6 offen offset:2048 sc1
    v_accvgpr_write_b32 a232, v36
    v_accvgpr_write_b32 a233, v37
    v_accvgpr_write_b32 a234, v38
    v_accvgpr_write_b32 a235, v39
    v_accvgpr_read_b32 v20, a76
    v_accvgpr_read_b32 v21, a77
    v_accvgpr_read_b32 v22, a78
    v_accvgpr_read_b32 v23, a79
    v_accvgpr_read_b32 v24, a92
    v_accvgpr_read_b32 v25, a93
    v_accvgpr_read_b32 v26, a94
    v_accvgpr_read_b32 v27, a95
    v_mul_f32 v20, v20, v61
    v_mul_f32 v21, v21, v61
    v_mul_f32 v22, v22, v61
    v_mul_f32 v23, v23, v61
    v_mul_f32 v24, v24, v61
    v_mul_f32 v25, v25, v61
    v_mul_f32 v26, v26, v61
    v_mul_f32 v27, v27, v61
    v_cvt_pk_bf16_f32 v40, v20, v21
    v_cvt_pk_bf16_f32 v41, v22, v23
    v_cvt_pk_bf16_f32 v42, v24, v25
    v_cvt_pk_bf16_f32 v43, v26, v27
    s_add_u32 s6, s54, 8192
    buffer_store_dwordx4 v[40:43], v7, s[36:39], s6 offen offset:3072 sc1
    v_accvgpr_write_b32 a236, v40
    v_accvgpr_write_b32 a237, v41
    v_accvgpr_write_b32 a238, v42
    v_accvgpr_write_b32 a239, v43
    s_waitcnt vmcnt(4)
    s_barrier
    s_sub_u32 s20, s20, 16
    s_subb_u32 s21, s21, 0
    buffer_store_dword v63, v0, s[20:23], 0 offen sc1
    s_add_u32 s20, s20, 16
    s_addc_u32 s21, s21, 0
    v_accvgpr_read_b32 v12, a96
    v_accvgpr_read_b32 v13, a97
    v_accvgpr_read_b32 v14, a98
    v_accvgpr_read_b32 v15, a99
    v_accvgpr_read_b32 v16, a112
    v_accvgpr_read_b32 v17, a113
    v_accvgpr_read_b32 v18, a114
    v_accvgpr_read_b32 v19, a115
    v_mul_f32 v12, v12, v4
    v_mul_f32 v13, v13, v4
    v_mul_f32 v14, v14, v4
    v_mul_f32 v15, v15, v4
    v_mul_f32 v16, v16, v4
    v_mul_f32 v17, v17, v4
    v_mul_f32 v18, v18, v4
    v_mul_f32 v19, v19, v4
    v_cvt_pk_bf16_f32 v28, v12, v13
    v_cvt_pk_bf16_f32 v29, v14, v15
    v_cvt_pk_bf16_f32 v30, v16, v17
    v_cvt_pk_bf16_f32 v31, v18, v19
    s_add_u32 s6, s54, 12288
    buffer_store_dwordx4 v[28:31], v7, s[36:39], s6 offen offset:0 sc1
    v_accvgpr_write_b32 a240, v28
    v_accvgpr_write_b32 a241, v29
    v_accvgpr_write_b32 a242, v30
    v_accvgpr_write_b32 a243, v31
    v_accvgpr_read_b32 v20, a100
    v_accvgpr_read_b32 v21, a101
    v_accvgpr_read_b32 v22, a102
    v_accvgpr_read_b32 v23, a103
    v_accvgpr_read_b32 v24, a116
    v_accvgpr_read_b32 v25, a117
    v_accvgpr_read_b32 v26, a118
    v_accvgpr_read_b32 v27, a119
    v_mul_f32 v20, v20, v5
    v_mul_f32 v21, v21, v5
    v_mul_f32 v22, v22, v5
    v_mul_f32 v23, v23, v5
    v_mul_f32 v24, v24, v5
    v_mul_f32 v25, v25, v5
    v_mul_f32 v26, v26, v5
    v_mul_f32 v27, v27, v5
    v_cvt_pk_bf16_f32 v32, v20, v21
    v_cvt_pk_bf16_f32 v33, v22, v23
    v_cvt_pk_bf16_f32 v34, v24, v25
    v_cvt_pk_bf16_f32 v35, v26, v27
    s_add_u32 s6, s54, 12288
    buffer_store_dwordx4 v[32:35], v7, s[36:39], s6 offen offset:1024 sc1
    v_accvgpr_write_b32 a244, v32
    v_accvgpr_write_b32 a245, v33
    v_accvgpr_write_b32 a246, v34
    v_accvgpr_write_b32 a247, v35
    v_accvgpr_read_b32 v12, a104
    v_accvgpr_read_b32 v13, a105
    v_accvgpr_read_b32 v14, a106
    v_accvgpr_read_b32 v15, a107
    v_accvgpr_read_b32 v16, a120
    v_accvgpr_read_b32 v17, a121
    v_accvgpr_read_b32 v18, a122
    v_accvgpr_read_b32 v19, a123
    v_mul_f32 v12, v12, v6
    v_mul_f32 v13, v13, v6
    v_mul_f32 v14, v14, v6
    v_mul_f32 v15, v15, v6
    v_mul_f32 v16, v16, v6
    v_mul_f32 v17, v17, v6
    v_mul_f32 v18, v18, v6
    v_mul_f32 v19, v19, v6
    v_cvt_pk_bf16_f32 v36, v12, v13
    v_cvt_pk_bf16_f32 v37, v14, v15
    v_cvt_pk_bf16_f32 v38, v16, v17
    v_cvt_pk_bf16_f32 v39, v18, v19
    s_add_u32 s6, s54, 12288
    buffer_store_dwordx4 v[36:39], v7, s[36:39], s6 offen offset:2048 sc1
    v_accvgpr_write_b32 a248, v36
    v_accvgpr_write_b32 a249, v37
    v_accvgpr_write_b32 a250, v38
    v_accvgpr_write_b32 a251, v39
    v_accvgpr_read_b32 v20, a108
    v_accvgpr_read_b32 v21, a109
    v_accvgpr_read_b32 v22, a110
    v_accvgpr_read_b32 v23, a111
    v_accvgpr_read_b32 v24, a124
    v_accvgpr_read_b32 v25, a125
    v_accvgpr_read_b32 v26, a126
    v_accvgpr_read_b32 v27, a127
    v_mul_f32 v20, v20, v61
    v_mul_f32 v21, v21, v61
    v_mul_f32 v22, v22, v61
    v_mul_f32 v23, v23, v61
    v_mul_f32 v24, v24, v61
    v_mul_f32 v25, v25, v61
    v_mul_f32 v26, v26, v61
    v_mul_f32 v27, v27, v61
    v_cvt_pk_bf16_f32 v40, v20, v21
    v_cvt_pk_bf16_f32 v41, v22, v23
    v_cvt_pk_bf16_f32 v42, v24, v25
    v_cvt_pk_bf16_f32 v43, v26, v27
    s_add_u32 s6, s54, 12288
    buffer_store_dwordx4 v[40:43], v7, s[36:39], s6 offen offset:3072 sc1
    v_accvgpr_write_b32 a252, v40
    v_accvgpr_write_b32 a253, v41
    v_accvgpr_write_b32 a254, v42
    v_accvgpr_write_b32 a255, v43
    ds_read_b64_tr_b16 v[208:209], v8 offset:0
    ds_read_b64_tr_b16 v[210:211], v8 offset:4608
    ds_read_b64_tr_b16 v[212:213], v8 offset:9216
    ds_read_b64_tr_b16 v[214:215], v8 offset:13824
    ds_read_b64_tr_b16 v[216:217], v8 offset:32
    ds_read_b64_tr_b16 v[218:219], v8 offset:4640
    ds_read_b64_tr_b16 v[220:221], v8 offset:9248
    ds_read_b64_tr_b16 v[222:223], v8 offset:13856
    ds_read_b64_tr_b16 v[224:225], v8 offset:64
    ds_read_b64_tr_b16 v[226:227], v8 offset:4672
    ds_read_b64_tr_b16 v[228:229], v8 offset:9280
    ds_read_b64_tr_b16 v[230:231], v8 offset:13888
    s_add_u32 m0, s49, 110592
    s_waitcnt lgkmcnt(8)
    v_mfma_f32_16x16x32_bf16 v[64:67], v[208:211], a[192:195], 0
    ds_read_b64_tr_b16 v[232:233], v8 offset:96
    v_mfma_f32_16x16x32_bf16 v[64:67], v[212:215], a[208:211], v[64:67]
    ds_read_b64_tr_b16 v[234:235], v8 offset:4704
    v_mfma_f32_16x16x32_bf16 v[100:103], v[212:215], a[212:215], 0
    buffer_load_dwordx4 v52, s[8:11], s48 offen lds
    v_mfma_f32_16x16x32_bf16 v[100:103], v[208:211], a[196:199], v[100:103]
    s_add_u32 m0, s49, 111616
    v_mfma_f32_16x16x32_bf16 v[136:139], v[208:211], a[200:203], 0
    ds_read_b64_tr_b16 v[236:237], v8 offset:9312
    v_mfma_f32_16x16x32_bf16 v[136:139], v[212:215], a[216:219], v[136:139]
    ds_read_b64_tr_b16 v[238:239], v8 offset:13920
    v_mfma_f32_16x16x32_bf16 v[172:175], v[212:215], a[220:223], 0
    buffer_load_dwordx4 v53, s[8:11], s48 offen lds
    v_mfma_f32_16x16x32_bf16 v[172:175], v[208:211], a[204:207], v[172:175]
    s_add_u32 m0, s49, 112640
    s_waitcnt lgkmcnt(8)
    v_mfma_f32_16x16x32_bf16 v[68:71], v[216:219], a[192:195], 0
    ds_read_b64_tr_b16 v[208:209], v8 offset:128
    v_mfma_f32_16x16x32_bf16 v[68:71], v[220:223], a[208:211], v[68:71]
    ds_read_b64_tr_b16 v[210:211], v8 offset:4736
    v_mfma_f32_16x16x32_bf16 v[104:107], v[220:223], a[212:215], 0
    buffer_load_dwordx4 v54, s[8:11], s48 offen lds
    v_mfma_f32_16x16x32_bf16 v[104:107], v[216:219], a[196:199], v[104:107]
    s_add_u32 m0, s49, 113664
    v_mfma_f32_16x16x32_bf16 v[140:143], v[216:219], a[200:203], 0
    ds_read_b64_tr_b16 v[212:213], v8 offset:9344
    v_mfma_f32_16x16x32_bf16 v[140:143], v[220:223], a[216:219], v[140:143]
    ds_read_b64_tr_b16 v[214:215], v8 offset:13952
    v_mfma_f32_16x16x32_bf16 v[176:179], v[220:223], a[220:223], 0
    buffer_load_dwordx4 v55, s[8:11], s48 offen lds
    v_mfma_f32_16x16x32_bf16 v[176:179], v[216:219], a[204:207], v[176:179]
    s_add_u32 m0, s49, 114688
    s_waitcnt lgkmcnt(8)
    v_mfma_f32_16x16x32_bf16 v[72:75], v[224:227], a[192:195], 0
    ds_read_b64_tr_b16 v[216:217], v8 offset:160
    v_mfma_f32_16x16x32_bf16 v[72:75], v[228:231], a[208:211], v[72:75]
    ds_read_b64_tr_b16 v[218:219], v8 offset:4768
    v_mfma_f32_16x16x32_bf16 v[108:111], v[228:231], a[212:215], 0
    buffer_load_dwordx4 v56, s[8:11], s48 offen lds
    v_mfma_f32_16x16x32_bf16 v[108:111], v[224:227], a[196:199], v[108:111]
    s_add_u32 m0, s49, 115712
    v_mfma_f32_16x16x32_bf16 v[144:147], v[224:227], a[200:203], 0
    ds_read_b64_tr_b16 v[220:221], v8 offset:9376
    v_mfma_f32_16x16x32_bf16 v[144:147], v[228:231], a[216:219], v[144:147]
    ds_read_b64_tr_b16 v[222:223], v8 offset:13984
    v_mfma_f32_16x16x32_bf16 v[180:183], v[228:231], a[220:223], 0
    buffer_load_dwordx4 v57, s[8:11], s48 offen lds
    v_mfma_f32_16x16x32_bf16 v[180:183], v[224:227], a[204:207], v[180:183]
    s_add_u32 m0, s49, 116736
    s_waitcnt lgkmcnt(8)
    v_mfma_f32_16x16x32_bf16 v[76:79], v[232:235], a[192:195], 0
    ds_read_b64_tr_b16 v[224:225], v8 offset:192
    v_mfma_f32_16x16x32_bf16 v[76:79], v[236:239], a[208:211], v[76:79]
    ds_read_b64_tr_b16 v[226:227], v8 offset:4800
    v_mfma_f32_16x16x32_bf16 v[112:115], v[236:239], a[212:215], 0
    buffer_load_dwordx4 v58, s[8:11], s48 offen lds
    v_mfma_f32_16x16x32_bf16 v[112:115], v[232:235], a[196:199], v[112:115]
    v_mfma_f32_16x16x32_bf16 v[148:151], v[232:235], a[200:203], 0
    ds_read_b64_tr_b16 v[228:229], v8 offset:9408
    v_mfma_f32_16x16x32_bf16 v[148:151], v[236:239], a[216:219], v[148:151]
    ds_read_b64_tr_b16 v[230:231], v8 offset:14016
    v_mfma_f32_16x16x32_bf16 v[184:187], v[236:239], a[220:223], 0
    v_mfma_f32_16x16x32_bf16 v[184:187], v[232:235], a[204:207], v[184:187]
    s_add_u32 m0, s49, 117760
    s_waitcnt lgkmcnt(8)
    v_mfma_f32_16x16x32_bf16 v[80:83], v[208:211], a[192:195], 0
    ds_read_b64_tr_b16 v[232:233], v8 offset:224
    v_mfma_f32_16x16x32_bf16 v[80:83], v[212:215], a[208:211], v[80:83]
    ds_read_b64_tr_b16 v[234:235], v8 offset:4832
    v_mfma_f32_16x16x32_bf16 v[116:119], v[212:215], a[212:215], 0
    buffer_load_dwordx4 v59, s[8:11], s48 offen lds
    v_mfma_f32_16x16x32_bf16 v[116:119], v[208:211], a[196:199], v[116:119]
    s_waitcnt vmcnt(8)
    s_barrier
    v_mfma_f32_16x16x32_bf16 v[152:155], v[208:211], a[200:203], 0
    ds_read_b64_tr_b16 v[236:237], v8 offset:9440
    v_mfma_f32_16x16x32_bf16 v[152:155], v[212:215], a[216:219], v[152:155]
    ds_read_b64_tr_b16 v[238:239], v8 offset:14048
    v_mfma_f32_16x16x32_bf16 v[188:191], v[212:215], a[220:223], 0
    buffer_store_dword v63, v0, s[20:23], 0 offen sc1
    v_mfma_f32_16x16x32_bf16 v[188:191], v[208:211], a[204:207], v[188:191]
    s_add_u32 m0, s49, 118784
    s_waitcnt lgkmcnt(8)
    v_mfma_f32_16x16x32_bf16 v[84:87], v[216:219], a[192:195], 0
    ds_read_b64_tr_b16 v[208:209], v8 offset:256
    v_mfma_f32_16x16x32_bf16 v[84:87], v[220:223], a[208:211], v[84:87]
    ds_read_b64_tr_b16 v[210:211], v8 offset:4864
    v_mfma_f32_16x16x32_bf16 v[120:123], v[220:223], a[212:215], 0
    buffer_load_dwordx4 v60, s[8:11], s48 offen lds
    v_mfma_f32_16x16x32_bf16 v[120:123], v[216:219], a[196:199], v[120:123]
    v_mfma_f32_16x16x32_bf16 v[156:159], v[216:219], a[200:203], 0
    ds_read_b64_tr_b16 v[212:213], v8 offset:9472
    v_mfma_f32_16x16x32_bf16 v[156:159], v[220:223], a[216:219], v[156:159]
    ds_read_b64_tr_b16 v[214:215], v8 offset:14080
    v_mfma_f32_16x16x32_bf16 v[192:195], v[220:223], a[220:223], 0
    v_mfma_f32_16x16x32_bf16 v[192:195], v[216:219], a[204:207], v[192:195]
    s_waitcnt lgkmcnt(8)
    v_mfma_f32_16x16x32_bf16 v[88:91], v[224:227], a[192:195], 0
    ds_read_b64_tr_b16 v[216:217], v8 offset:18432
    v_mfma_f32_16x16x32_bf16 v[88:91], v[228:231], a[208:211], v[88:91]
    ds_read_b64_tr_b16 v[218:219], v8 offset:23040
    v_mfma_f32_16x16x32_bf16 v[124:127], v[228:231], a[212:215], 0
    buffer_load_dword v244, v62, s[68:71], 0 offen sc1
    v_mfma_f32_16x16x32_bf16 v[124:127], v[224:227], a[196:199], v[124:127]
    v_mfma_f32_16x16x32_bf16 v[160:163], v[224:227], a[200:203], 0
    ds_read_b64_tr_b16 v[220:221], v8 offset:27648
    v_mfma_f32_16x16x32_bf16 v[160:163], v[228:231], a[216:219], v[160:163]
    ds_read_b64_tr_b16 v[222:223], v8 offset:32256
    v_mfma_f32_16x16x32_bf16 v[196:199], v[228:231], a[220:223], 0
    v_mfma_f32_16x16x32_bf16 v[196:199], v[224:227], a[204:207], v[196:199]
    s_waitcnt lgkmcnt(8)
    v_mfma_f32_16x16x32_bf16 v[92:95], v[232:235], a[192:195], 0
    ds_read_b64_tr_b16 v[224:225], v8 offset:18464
    v_mfma_f32_16x16x32_bf16 v[92:95], v[236:239], a[208:211], v[92:95]
    ds_read_b64_tr_b16 v[226:227], v8 offset:23072
    v_mfma_f32_16x16x32_bf16 v[128:131], v[236:239], a[212:215], 0
    v_mfma_f32_16x16x32_bf16 v[128:131], v[232:235], a[196:199], v[128:131]
    v_mfma_f32_16x16x32_bf16 v[164:167], v[232:235], a[200:203], 0
    ds_read_b64_tr_b16 v[228:229], v8 offset:27680
    v_mfma_f32_16x16x32_bf16 v[164:167], v[236:239], a[216:219], v[164:167]
    ds_read_b64_tr_b16 v[230:231], v8 offset:32288
    v_mfma_f32_16x16x32_bf16 v[200:203], v[236:239], a[220:223], 0
    v_mfma_f32_16x16x32_bf16 v[200:203], v[232:235], a[204:207], v[200:203]
    s_waitcnt lgkmcnt(8)
    v_mfma_f32_16x16x32_bf16 v[96:99], v[208:211], a[192:195], 0
    ds_read_b64_tr_b16 v[232:233], v8 offset:18496
    v_mfma_f32_16x16x32_bf16 v[96:99], v[212:215], a[208:211], v[96:99]
    ds_read_b64_tr_b16 v[234:235], v8 offset:23104
    v_mfma_f32_16x16x32_bf16 v[132:135], v[212:215], a[212:215], 0
    v_mfma_f32_16x16x32_bf16 v[132:135], v[208:211], a[196:199], v[132:135]
    v_mfma_f32_16x16x32_bf16 v[168:171], v[208:211], a[200:203], 0
    ds_read_b64_tr_b16 v[236:237], v8 offset:27712
    v_mfma_f32_16x16x32_bf16 v[168:171], v[212:215], a[216:219], v[168:171]
    ds_read_b64_tr_b16 v[238:239], v8 offset:32320
    v_mfma_f32_16x16x32_bf16 v[204:207], v[212:215], a[220:223], 0
    v_mfma_f32_16x16x32_bf16 v[204:207], v[208:211], a[204:207], v[204:207]
    s_waitcnt lgkmcnt(8)
    v_mfma_f32_16x16x32_bf16 v[64:67], v[216:219], a[224:227], v[64:67]
    ds_read_b64_tr_b16 v[208:209], v8 offset:18528
    v_mfma_f32_16x16x32_bf16 v[64:67], v[220:223], a[240:243], v[64:67]
    ds_read_b64_tr_b16 v[210:211], v8 offset:23136
    v_mfma_f32_16x16x32_bf16 v[100:103], v[220:223], a[244:247], v[100:103]
    v_mfma_f32_16x16x32_bf16 v[100:103], v[216:219], a[228:231], v[100:103]
    v_mfma_f32_16x16x32_bf16 v[136:139], v[216:219], a[232:235], v[136:139]
    ds_read_b64_tr_b16 v[212:213], v8 offset:27744
    v_mfma_f32_16x16x32_bf16 v[136:139], v[220:223], a[248:251], v[136:139]
    ds_read_b64_tr_b16 v[214:215], v8 offset:32352
    v_mfma_f32_16x16x32_bf16 v[172:175], v[220:223], a[252:255], v[172:175]
    v_mfma_f32_16x16x32_bf16 v[172:175], v[216:219], a[236:239], v[172:175]
    s_add_u32 s51, s59, 0
    s_waitcnt vmcnt(0)
    v_cmp_eq_u32 vcc, 0, v244
    s_cbranch_vccz L_k2_pollO0_ok
    s_mov_b32 s3, 0
L_k2_pollO0:
    buffer_load_dword v244, v62, s[68:71], 0 offen sc1
    s_add_u32 s3, s3, 1
    s_waitcnt vmcnt(0)
    v_cmp_eq_u32 vcc, 0, v244
    s_cbranch_vccz L_k2_pollO0_ok
    s_sleep 4
    s_cmp_lt_u32 s3, 0x40000
    s_cbranch_scc1 L_k2_pollO0
L_k2_pollO0_ok:
    s_waitcnt lgkmcnt(8)
    v_mfma_f32_16x16x32_bf16 v[68:71], v[224:227], a[224:227], v[68:71]
    ds_read_b64_tr_b16 v[216:217], v8 offset:18560
    v_mfma_f32_16x16x32_bf16 v[68:71], v[228:231], a[240:243], v[68:71]
    ds_read_b64_tr_b16 v[218:219], v8 offset:23168
    v_mfma_f32_16x16x32_bf16 v[104:107], v[228:231], a[244:247], v[104:107]
    buffer_load_dwordx4 a[128:131], v7, s[36:39], s51 offen offset:0 sc1
    v_mfma_f32_16x16x32_bf16 v[104:107], v[224:227], a[228:231], v[104:107]
    s_add_u32 s68, s68, 16
    s_addc_u32 s69, s69, 0
    v_mfma_f32_16x16x32_bf16 v[140:143], v[224:227], a[232:235], v[140:143]
    ds_read_b64_tr_b16 v[220:221], v8 offset:27776
    v_mfma_f32_16x16x32_bf16 v[140:143], v[228:231], a[248:251], v[140:143]
    ds_read_b64_tr_b16 v[222:223], v8 offset:32384
    v_mfma_f32_16x16x32_bf16 v[176:179], v[228:231], a[252:255], v[176:179]
    buffer_load_dwordx4 a[132:135], v7, s[36:39], s51 offen offset:1024 sc1
    v_mfma_f32_16x16x32_bf16 v[176:179], v[224:227], a[236:239], v[176:179]
    s_waitcnt lgkmcnt(8)
    v_mfma_f32_16x16x32_bf16 v[72:75], v[232:235], a[224:227], v[72:75]
    ds_read_b64_tr_b16 v[224:225], v8 offset:18592
    v_mfma_f32_16x16x32_bf16 v[72:75], v[236:239], a[240:243], v[72:75]
    ds_read_b64_tr_b16 v[226:227], v8 offset:23200
    v_mfma_f32_16x16x32_bf16 v[108:111], v[236:239], a[244:247], v[108:111]
    buffer_load_dwordx4 a[136:139], v7, s[36:39], s51 offen offset:2048 sc1
    v_mfma_f32_16x16x32_bf16 v[108:111], v[232:235], a[228:231], v[108:111]
    v_mfma_f32_16x16x32_bf16 v[144:147], v[232:235], a[232:235], v[144:147]
    ds_read_b64_tr_b16 v[228:229], v8 offset:27808
    v_mfma_f32_16x16x32_bf16 v[144:147], v[236:239], a[248:251], v[144:147]
    ds_read_b64_tr_b16 v[230:231], v8 offset:32416
    v_mfma_f32_16x16x32_bf16 v[180:183], v[236:239], a[252:255], v[180:183]
    buffer_load_dwordx4 a[140:143], v7, s[36:39], s51 offen offset:3072 sc1
    v_mfma_f32_16x16x32_bf16 v[180:183], v[232:235], a[236:239], v[180:183]
    s_add_u32 s51, s59, 4096
    s_waitcnt lgkmcnt(8)
    v_mfma_f32_16x16x32_bf16 v[76:79], v[208:211], a[224:227], v[76:79]
    ds_read_b64_tr_b16 v[232:233], v8 offset:18624
    v_mfma_f32_16x16x32_bf16 v[76:79], v[212:215], a[240:243], v[76:79]
    ds_read_b64_tr_b16 v[234:235], v8 offset:23232
    v_mfma_f32_16x16x32_bf16 v[112:115], v[212:215], a[244:247], v[112:115]
    buffer_load_dwordx4 a[144:147], v7, s[36:39], s51 offen offset:0 sc1
    v_mfma_f32_16x16x32_bf16 v[112:115], v[208:211], a[228:231], v[112:115]
    v_mfma_f32_16x16x32_bf16 v[148:151], v[208:211], a[232:235], v[148:151]
    ds_read_b64_tr_b16 v[236:237], v8 offset:27840
    v_mfma_f32_16x16x32_bf16 v[148:151], v[212:215], a[248:251], v[148:151]
    ds_read_b64_tr_b16 v[238:239], v8 offset:32448
    v_mfma_f32_16x16x32_bf16 v[184:187], v[212:215], a[252:255], v[184:187]
    buffer_load_dwordx4 a[148:151], v7, s[36:39], s51 offen offset:1024 sc1
    v_mfma_f32_16x16x32_bf16 v[184:187], v[208:211], a[236:239], v[184:187]
    s_waitcnt lgkmcnt(8)
    v_mfma_f32_16x16x32_bf16 v[80:83], v[216:219], a[224:227], v[80:83]
    ds_read_b64_tr_b16 v[208:209], v8 offset:18656
    v_mfma_f32_16x16x32_bf16 v[80:83], v[220:223], a[240:243], v[80:83]
    ds_read_b64_tr_b16 v[210:211], v8 offset:23264
    v_mfma_f32_16x16x32_bf16 v[116:119], v[220:223], a[244:247], v[116:119]
    buffer_load_dwordx4 a[152:155], v7, s[36:39], s51 offen offset:2048 sc1
    v_mfma_f32_16x16x32_bf16 v[116:119], v[216:219], a[228:231], v[116:119]
    v_mfma_f32_16x16x32_bf16 v[152:155], v[216:219], a[232:235], v[152:155]
    ds_read_b64_tr_b16 v[212:213], v8 offset:27872
    v_mfma_f32_16x16x32_bf16 v[152:155], v[220:223], a[248:251], v[152:155]
    ds_read_b64_tr_b16 v[214:215], v8 offset:32480
    v_mfma_f32_16x16x32_bf16 v[188:191], v[220:223], a[252:255], v[188:191]
    v_mfma_f32_16x16x32_bf16 v[188:191], v[216:219], a[236:239], v[188:191]
    s_waitcnt lgkmcnt(8)
    v_mfma_f32_16x16x32_bf16 v[84:87], v[224:227], a[224:227], v[84:87]
    ds_read_b64_tr_b16 v[216:217], v8 offset:18688
    v_mfma_f32_16x16x32_bf16 v[84:87], v[228:231], a[240:243], v[84:87]
    ds_read_b64_tr_b16 v[218:219], v8 offset:23296
    v_mfma_f32_16x16x32_bf16 v[120:123], v[228:231], a[244:247], v[120:123]
    buffer_load_dwordx4 a[156:159], v7, s[36:39], s51 offen offset:3072 sc1
    v_mfma_f32_16x16x32_bf16 v[120:123], v[224:227], a[228:231], v[120:123]
    s_add_u32 s51, s60, 0
    v_mfma_f32_16x16x32_bf16 v[156:159], v[224:227], a[232:235], v[156:159]
    ds_read_b64_tr_b16 v[220:221], v8 offset:27904
    v_mfma_f32_16x16x32_bf16 v[156:159], v[228:231], a[248:251], v[156:159]
    ds_read_b64_tr_b16 v[222:223], v8 offset:32512
    v_mfma_f32_16x16x32_bf16 v[192:195], v[228:231], a[252:255], v[192:195]
    buffer_load_dwordx4 a[0:3], v7, s[36:39], s51 offen offset:0 sc1
    v_mfma_f32_16x16x32_bf16 v[192:195], v[224:227], a[236:239], v[192:195]
    s_waitcnt lgkmcnt(8)
    v_mfma_f32_16x16x32_bf16 v[88:91], v[232:235], a[224:227], v[88:91]
    v_mfma_f32_16x16x32_bf16 v[88:91], v[236:239], a[240:243], v[88:91]
    v_mfma_f32_16x16x32_bf16 v[124:127], v[236:239], a[244:247], v[124:127]
    buffer_load_dwordx4 a[4:7], v7, s[36:39], s51 offen offset:1024 sc1
    v_mfma_f32_16x16x32_bf16 v[124:127], v[232:235], a[228:231], v[124:127]
    v_mfma_f32_16x16x32_bf16 v[160:163], v[232:235], a[232:235], v[160:163]
    v_mfma_f32_16x16x32_bf16 v[160:163], v[236:239], a[248:251], v[160:163]
    v_mfma_f32_16x16x32_bf16 v[196:199], v[236:239], a[252:255], v[196:199]
    buffer_load_dwordx4 a[8:11], v7, s[36:39], s51 offen offset:2048 sc1
    v_mfma_f32_16x16x32_bf16 v[196:199], v[232:235], a[236:239], v[196:199]
    s_waitcnt lgkmcnt(0)
    s_barrier
    v_mfma_f32_16x16x32_bf16 v[92:95], v[208:211], a[224:227], v[92:95]
    ds_read_b64_tr_b16 v[224:225], v9 offset:0
    ds_read_b64_tr_b16 v[226:227], v9 offset:4608
    v_mfma_f32_16x16x32_bf16 v[92:95], v[212:215], a[240:243], v[92:95]
    ds_read_b64_tr_b16 v[228:229], v9 offset:9216
    ds_read_b64_tr_b16 v[230:231], v9 offset:13824
    v_mfma_f32_16x16x32_bf16 v[128:131], v[212:215], a[244:247], v[128:131]
    ds_read_b64_tr_b16 v[232:233], v9 offset:32
    ds_read_b64_tr_b16 v[234:235], v9 offset:4640
    v_mfma_f32_16x16x32_bf16 v[128:131], v[208:211], a[228:231], v[128:131]
    v_mfma_f32_16x16x32_bf16 v[164:167], v[208:211], a[232:235], v[164:167]
    ds_read_b64_tr_b16 v[236:237], v9 offset:9248
    v_mfma_f32_16x16x32_bf16 v[164:167], v[212:215], a[248:251], v[164:167]
    ds_read_b64_tr_b16 v[238:239], v9 offset:13856
    v_mfma_f32_16x16x32_bf16 v[200:203], v[212:215], a[252:255], v[200:203]
    buffer_load_dwordx4 a[12:15], v7, s[36:39], s51 offen offset:3072 sc1
    v_mfma_f32_16x16x32_bf16 v[200:203], v[208:211], a[236:239], v[200:203]
    s_add_u32 s51, s60, 4096
    v_mfma_f32_16x16x32_bf16 v[96:99], v[216:219], a[224:227], v[96:99]
    ds_read_b64_tr_b16 v[208:209], v9 offset:64
    v_mfma_f32_16x16x32_bf16 v[96:99], v[220:223], a[240:243], v[96:99]
    ds_read_b64_tr_b16 v[210:211], v9 offset:4672
    v_mfma_f32_16x16x32_bf16 v[132:135], v[220:223], a[244:247], v[132:135]
    buffer_load_dwordx4 a[16:19], v7, s[36:39], s51 offen offset:0 sc1
    v_mfma_f32_16x16x32_bf16 v[132:135], v[216:219], a[228:231], v[132:135]
    v_mfma_f32_16x16x32_bf16 v[168:171], v[216:219], a[232:235], v[168:171]
    ds_read_b64_tr_b16 v[212:213], v9 offset:9280
    v_mfma_f32_16x16x32_bf16 v[168:171], v[220:223], a[248:251], v[168:171]
    ds_read_b64_tr_b16 v[214:215], v9 offset:13888
    v_mfma_f32_16x16x32_bf16 v[204:207], v[220:223], a[252:255], v[204:207]
    buffer_load_dwordx4 a[20:23], v7, s[36:39], s51 offen offset:1024 sc1
    v_mfma_f32_16x16x32_bf16 v[204:207], v[216:219], a[236:239], v[204:207]
    s_waitcnt vmcnt(10) lgkmcnt(8)
    v_mfma_f32_16x16x32_bf16 v[64:67], v[224:227], a[128:131], v[64:67]
    ds_read_b64_tr_b16 v[216:217], v9 offset:96
    s_waitcnt vmcnt(6)
    v_mfma_f32_16x16x32_bf16 v[64:67], v[228:231], a[144:147], v[64:67]
    ds_read_b64_tr_b16 v[218:219], v9 offset:4704
    v_mfma_f32_16x16x32_bf16 v[100:103], v[228:231], a[148:151], v[100:103]
    buffer_load_dword v244, v62, s[68:71], 0 offen sc1
    v_mfma_f32_16x16x32_bf16 v[100:103], v[224:227], a[132:135], v[100:103]
    v_mfma_f32_16x16x32_bf16 v[136:139], v[224:227], a[136:139], v[136:139]
    ds_read_b64_tr_b16 v[220:221], v9 offset:9312
    v_mfma_f32_16x16x32_bf16 v[136:139], v[228:231], a[152:155], v[136:139]
    ds_read_b64_tr_b16 v[222:223], v9 offset:13920
    v_mfma_f32_16x16x32_bf16 v[172:175], v[228:231], a[156:159], v[172:175]
    buffer_load_dwordx4 a[24:27], v7, s[36:39], s51 offen offset:2048 sc1
    v_mfma_f32_16x16x32_bf16 v[172:175], v[224:227], a[140:143], v[172:175]
    s_waitcnt lgkmcnt(8)
    v_mfma_f32_16x16x32_bf16 v[68:71], v[232:235], a[128:131], v[68:71]
    ds_read_b64_tr_b16 v[224:225], v9 offset:128
    v_mfma_f32_16x16x32_bf16 v[68:71], v[236:239], a[144:147], v[68:71]
    ds_read_b64_tr_b16 v[226:227], v9 offset:4736
    v_mfma_f32_16x16x32_bf16 v[104:107], v[236:239], a[148:151], v[104:107]
    buffer_load_dwordx4 a[28:31], v7, s[36:39], s51 offen offset:3072 sc1
    v_mfma_f32_16x16x32_bf16 v[104:107], v[232:235], a[132:135], v[104:107]
    s_add_u32 s51, s61, 0
    v_mfma_f32_16x16x32_bf16 v[140:143], v[232:235], a[136:139], v[140:143]
    ds_read_b64_tr_b16 v[228:229], v9 offset:9344
    v_mfma_f32_16x16x32_bf16 v[140:143], v[236:239], a[152:155], v[140:143]
    ds_read_b64_tr_b16 v[230:231], v9 offset:13952
    v_mfma_f32_16x16x32_bf16 v[176:179], v[236:239], a[156:159], v[176:179]
    buffer_load_dwordx4 a[64:67], v7, s[36:39], s51 offen offset:0 sc1
    v_mfma_f32_16x16x32_bf16 v[176:179], v[232:235], a[140:143], v[176:179]
    s_waitcnt lgkmcnt(8)
    v_mfma_f32_16x16x32_bf16 v[72:75], v[208:211], a[128:131], v[72:75]
    ds_read_b64_tr_b16 v[232:233], v9 offset:160
    v_mfma_f32_16x16x32_bf16 v[72:75], v[212:215], a[144:147], v[72:75]
    ds_read_b64_tr_b16 v[234:235], v9 offset:4768
    v_mfma_f32_16x16x32_bf16 v[108:111], v[212:215], a[148:151], v[108:111]
    v_mfma_f32_16x16x32_bf16 v[108:111], v[208:211], a[132:135], v[108:111]
    v_mfma_f32_16x16x32_bf16 v[144:147], v[208:211], a[136:139], v[144:147]
    ds_read_b64_tr_b16 v[236:237], v9 offset:9376
    v_mfma_f32_16x16x32_bf16 v[144:147], v[212:215], a[152:155], v[144:147]
    ds_read_b64_tr_b16 v[238:239], v9 offset:13984
    v_mfma_f32_16x16x32_bf16 v[180:183], v[212:215], a[156:159], v[180:183]
    buffer_load_dwordx4 a[68:71], v7, s[36:39], s51 offen offset:1024 sc1
    v_mfma_f32_16x16x32_bf16 v[180:183], v[208:211], a[140:143], v[180:183]
    s_waitcnt lgkmcnt(8)
    v_mfma_f32_16x16x32_bf16 v[76:79], v[216:219], a[128:131], v[76:79]
    ds_read_b64_tr_b16 v[208:209], v9 offset:192
    v_mfma_f32_16x16x32_bf16 v[76:79], v[220:223], a[144:147], v[76:79]
    ds_read_b64_tr_b16 v[210:211], v9 offset:4800
    v_mfma_f32_16x16x32_bf16 v[112:115], v[220:223], a[148:151], v[112:115]
    buffer_load_dwordx4 a[72:75], v7, s[36:39], s51 offen offset:2048 sc1
    v_mfma_f32_16x16x32_bf16 v[112:115], v[216:219], a[132:135], v[112:115]
    v_mfma_f32_16x16x32_bf16 v[148:151], v[216:219], a[136:139], v[148:151]
    ds_read_b64_tr_b16 v[212:213], v9 offset:9408
    v_mfma_f32_16x16x32_bf16 v[148:151], v[220:223], a[152:155], v[148:151]
    ds_read_b64_tr_b16 v[214:215], v9 offset:14016
    v_mfma_f32_16x16x32_bf16 v[184:187], v[220:223], a[156:159], v[184:187]
    buffer_load_dwordx4 a[76:79], v7, s[36:39], s51 offen offset:3072 sc1
    v_mfma_f32_16x16x32_bf16 v[184:187], v[216:219], a[140:143], v[184:187]
    s_add_u32 s51, s61, 4096
    s_waitcnt lgkmcnt(8)
    v_mfma_f32_16x16x32_bf16 v[80:83], v[224:227], a[128:131], v[80:83]
    ds_read_b64_tr_b16 v[216:217], v9 offset:224
    v_mfma_f32_16x16x32_bf16 v[80:83], v[228:231], a[144:147], v[80:83]
    ds_read_b64_tr_b16 v[218:219], v9 offset:4832
    v_mfma_f32_16x16x32_bf16 v[116:119], v[228:231], a[148:151], v[116:119]
    buffer_load_dwordx4 a[80:83], v7, s[36:39], s51 offen offset:0 sc1
    v_mfma_f32_16x16x32_bf16 v[116:119], v[224:227], a[132:135], v[116:119]
    v_mfma_f32_16x16x32_bf16 v[152:155], v[224:227], a[136:139], v[152:155]
    ds_read_b64_tr_b16 v[220:221], v9 offset:9440
    v_mfma_f32_16x16x32_bf16 v[152:155], v[228:231], a[152:155], v[152:155]
    ds_read_b64_tr_b16 v[222:223], v9 offset:14048
    v_mfma_f32_16x16x32_bf16 v[188:191], v[228:231], a[156:159], v[188:191]
    buffer_load_dwordx4 a[84:87], v7, s[36:39], s51 offen offset:1024 sc1
    v_mfma_f32_16x16x32_bf16 v[188:191], v[224:227], a[140:143], v[188:191]
    s_waitcnt lgkmcnt(8)
    v_mfma_f32_16x16x32_bf16 v[84:87], v[232:235], a[128:131], v[84:87]
    ds_read_b64_tr_b16 v[224:225], v9 offset:256
    v_mfma_f32_16x16x32_bf16 v[84:87], v[236:239], a[144:147], v[84:87]
    ds_read_b64_tr_b16 v[226:227], v9 offset:4864
    v_mfma_f32_16x16x32_bf16 v[120:123], v[236:239], a[148:151], v[120:123]
    buffer_load_dwordx4 a[88:91], v7, s[36:39], s51 offen offset:2048 sc1
    v_mfma_f32_16x16x32_bf16 v[120:123], v[232:235], a[132:135], v[120:123]
    v_mfma_f32_16x16x32_bf16 v[156:159], v[232:235], a[136:139], v[156:159]
    ds_read_b64_tr_b16 v[228:229], v9 offset:9472
    v_mfma_f32_16x16x32_bf16 v[156:159], v[236:239], a[152:155], v[156:159]
    ds_read_b64_tr_b16 v[230:231], v9 offset:14080
    v_mfma_f32_16x16x32_bf16 v[192:195], v[236:239], a[156:159], v[192:195]
    buffer_load_dwordx4 a[92:95], v7, s[36:39], s51 offen offset:3072 sc1
    v_mfma_f32_16x16x32_bf16 v[192:195], v[232:235], a[140:143], v[192:195]
    s_waitcnt vmcnt(10)
    v_cmp_eq_u32 vcc, 0, v244
    s_cbranch_vccz L_k2_pollO1_ok
    s_mov_b32 s3, 0
L_k2_pollO1:
    buffer_load_dword v244, v62, s[68:71], 0 offen sc1
    s_add_u32 s3, s3, 1
    s_waitcnt vmcnt(0)
    v_cmp_eq_u32 vcc, 0, v244
    s_cbranch_vccz L_k2_pollO1_ok
    s_sleep 4
    s_cmp_lt_u32 s3, 0x40000
    s_cbranch_scc1 L_k2_pollO1
L_k2_pollO1_ok:
    s_waitcnt lgkmcnt(8)
    v_mfma_f32_16x16x32_bf16 v[88:91], v[208:211], a[128:131], v[88:91]
    v_mfma_f32_16x16x32_bf16 v[88:91], v[212:215], a[144:147], v[88:91]
    v_mfma_f32_16x16x32_bf16 v[124:127], v[212:215], a[148:151], v[124:127]
    v_mfma_f32_16x16x32_bf16 v[124:127], v[208:211], a[132:135], v[124:127]
    s_add_u32 s51, s59, 8192
    s_add_u32 s68, s68, 512
    s_addc_u32 s69, s69, 0
    v_mfma_f32_16x16x32_bf16 v[160:163], v[208:211], a[136:139], v[160:163]
    v_mfma_f32_16x16x32_bf16 v[160:163], v[212:215], a[152:155], v[160:163]
    v_mfma_f32_16x16x32_bf16 v[196:199], v[212:215], a[156:159], v[196:199]
    buffer_load_dwordx4 a[160:163], v7, s[36:39], s51 offen offset:0 sc1
    v_mfma_f32_16x16x32_bf16 v[196:199], v[208:211], a[140:143], v[196:199]
    s_waitcnt lgkmcnt(0)
    s_barrier
    v_mfma_f32_16x16x32_bf16 v[92:95], v[216:219], a[128:131], v[92:95]
    ds_read_b64_tr_b16 v[232:233], v10 offset:0
    ds_read_b64_tr_b16 v[234:235], v10 offset:4608
    v_mfma_f32_16x16x32_bf16 v[92:95], v[220:223], a[144:147], v[92:95]
    ds_read_b64_tr_b16 v[236:237], v10 offset:9216
    ds_read_b64_tr_b16 v[238:239], v10 offset:13824
    v_mfma_f32_16x16x32_bf16 v[128:131], v[220:223], a[148:151], v[128:131]
    ds_read_b64_tr_b16 v[208:209], v10 offset:32
    ds_read_b64_tr_b16 v[210:211], v10 offset:4640
    v_mfma_f32_16x16x32_bf16 v[128:131], v[216:219], a[132:135], v[128:131]
    v_mfma_f32_16x16x32_bf16 v[164:167], v[216:219], a[136:139], v[164:167]
    ds_read_b64_tr_b16 v[212:213], v10 offset:9248
    v_mfma_f32_16x16x32_bf16 v[164:167], v[220:223], a[152:155], v[164:167]
    ds_read_b64_tr_b16 v[214:215], v10 offset:13856
    v_mfma_f32_16x16x32_bf16 v[200:203], v[220:223], a[156:159], v[200:203]
    buffer_load_dwordx4 a[164:167], v7, s[36:39], s51 offen offset:1024 sc1
    v_mfma_f32_16x16x32_bf16 v[200:203], v[216:219], a[140:143], v[200:203]
    v_mfma_f32_16x16x32_bf16 v[96:99], v[224:227], a[128:131], v[96:99]
    ds_read_b64_tr_b16 v[216:217], v10 offset:64
    v_mfma_f32_16x16x32_bf16 v[96:99], v[228:231], a[144:147], v[96:99]
    ds_read_b64_tr_b16 v[218:219], v10 offset:4672
    v_mfma_f32_16x16x32_bf16 v[132:135], v[228:231], a[148:151], v[132:135]
    buffer_load_dwordx4 a[168:171], v7, s[36:39], s51 offen offset:2048 sc1
    v_mfma_f32_16x16x32_bf16 v[132:135], v[224:227], a[132:135], v[132:135]
    v_mfma_f32_16x16x32_bf16 v[168:171], v[224:227], a[136:139], v[168:171]
    ds_read_b64_tr_b16 v[220:221], v10 offset:9280
    v_mfma_f32_16x16x32_bf16 v[168:171], v[228:231], a[152:155], v[168:171]
    ds_read_b64_tr_b16 v[222:223], v10 offset:13888
    v_mfma_f32_16x16x32_bf16 v[204:207], v[228:231], a[156:159], v[204:207]
    buffer_load_dwordx4 a[172:175], v7, s[36:39], s51 offen offset:3072 sc1
    v_mfma_f32_16x16x32_bf16 v[204:207], v[224:227], a[140:143], v[204:207]
    s_add_u32 s51, s59, 12288
    s_waitcnt lgkmcnt(8)
    v_mfma_f32_16x16x32_bf16 v[64:67], v[232:235], a[0:3], v[64:67]
    ds_read_b64_tr_b16 v[224:225], v10 offset:96
    s_waitcnt vmcnt(12)
    v_mfma_f32_16x16x32_bf16 v[64:67], v[236:239], a[16:19], v[64:67]
    ds_read_b64_tr_b16 v[226:227], v10 offset:4704
    v_mfma_f32_16x16x32_bf16 v[100:103], v[236:239], a[20:23], v[100:103]
    buffer_load_dwordx4 a[176:179], v7, s[36:39], s51 offen offset:0 sc1
    v_mfma_f32_16x16x32_bf16 v[100:103], v[232:235], a[4:7], v[100:103]
    v_mfma_f32_16x16x32_bf16 v[136:139], v[232:235], a[8:11], v[136:139]
    ds_read_b64_tr_b16 v[228:229], v10 offset:9312
    v_mfma_f32_16x16x32_bf16 v[136:139], v[236:239], a[24:27], v[136:139]
    ds_read_b64_tr_b16 v[230:231], v10 offset:13920
    v_mfma_f32_16x16x32_bf16 v[172:175], v[236:239], a[28:31], v[172:175]
    buffer_load_dwordx4 a[180:183], v7, s[36:39], s51 offen offset:1024 sc1
    v_mfma_f32_16x16x32_bf16 v[172:175], v[232:235], a[12:15], v[172:175]
    s_waitcnt lgkmcnt(8)
    v_mfma_f32_16x16x32_bf16 v[68:71], v[208:211], a[0:3], v[68:71]
    ds_read_b64_tr_b16 v[232:233], v10 offset:128
    v_mfma_f32_16x16x32_bf16 v[68:71], v[212:215], a[16:19], v[68:71]
    ds_read_b64_tr_b16 v[234:235], v10 offset:4736
    v_mfma_f32_16x16x32_bf16 v[104:107], v[212:215], a[20:23], v[104:107]
    buffer_load_dwordx4 a[184:187], v7, s[36:39], s51 offen offset:2048 sc1
    v_mfma_f32_16x16x32_bf16 v[104:107], v[208:211], a[4:7], v[104:107]
    v_mfma_f32_16x16x32_bf16 v[140:143], v[208:211], a[8:11], v[140:143]
    ds_read_b64_tr_b16 v[236:237], v10 offset:9344
    v_mfma_f32_16x16x32_bf16 v[140:143], v[212:215], a[24:27], v[140:143]
    ds_read_b64_tr_b16 v[238:239], v10 offset:13952
    v_mfma_f32_16x16x32_bf16 v[176:179], v[212:215], a[28:31], v[176:179]
    buffer_load_dwordx4 a[188:191], v7, s[36:39], s51 offen offset:3072 sc1
    v_mfma_f32_16x16x32_bf16 v[176:179], v[208:211], a[12:15], v[176:179]
    s_waitcnt lgkmcnt(8)
    v_mfma_f32_16x16x32_bf16 v[72:75], v[216:219], a[0:3], v[72:75]
    ds_read_b64_tr_b16 v[208:209], v10 offset:160
    v_mfma_f32_16x16x32_bf16 v[72:75], v[220:223], a[16:19], v[72:75]
    ds_read_b64_tr_b16 v[210:211], v10 offset:4768
    v_mfma_f32_16x16x32_bf16 v[108:111], v[220:223], a[20:23], v[108:111]
    v_mfma_f32_16x16x32_bf16 v[108:111], v[216:219], a[4:7], v[108:111]
    s_add_u32 s51, s60, 8192
    v_mfma_f32_16x16x32_bf16 v[144:147], v[216:219], a[8:11], v[144:147]
    ds_read_b64_tr_b16 v[212:213], v10 offset:9376
    v_mfma_f32_16x16x32_bf16 v[144:147], v[220:223], a[24:27], v[144:147]
    ds_read_b64_tr_b16 v[214:215], v10 offset:13984
    v_mfma_f32_16x16x32_bf16 v[180:183], v[220:223], a[28:31], v[180:183]
    buffer_load_dwordx4 a[32:35], v7, s[36:39], s51 offen offset:0 sc1
    v_mfma_f32_16x16x32_bf16 v[180:183], v[216:219], a[12:15], v[180:183]
    s_waitcnt lgkmcnt(8)
    v_mfma_f32_16x16x32_bf16 v[76:79], v[224:227], a[0:3], v[76:79]
    ds_read_b64_tr_b16 v[216:217], v10 offset:192
    v_mfma_f32_16x16x32_bf16 v[76:79], v[228:231], a[16:19], v[76:79]
    ds_read_b64_tr_b16 v[218:219], v10 offset:4800
    v_mfma_f32_16x16x32_bf16 v[112:115], v[228:231], a[20:23], v[112:115]
    buffer_load_dwordx4 a[36:39], v7, s[36:39], s51 offen offset:1024 sc1
    v_mfma_f32_16x16x32_bf16 v[112:115], v[224:227], a[4:7], v[112:115]
    v_mfma_f32_16x16x32_bf16 v[148:151], v[224:227], a[8:11], v[148:151]
    ds_read_b64_tr_b16 v[220:221], v10 offset:9408
    v_mfma_f32_16x16x32_bf16 v[148:151], v[228:231], a[24:27], v[148:151]
    ds_read_b64_tr_b16 v[222:223], v10 offset:14016
    v_mfma_f32_16x16x32_bf16 v[184:187], v[228:231], a[28:31], v[184:187]
    buffer_load_dwordx4 a[40:43], v7, s[36:39], s51 offen offset:2048 sc1
    v_mfma_f32_16x16x32_bf16 v[184:187], v[224:227], a[12:15], v[184:187]
    s_waitcnt lgkmcnt(8)
    v_mfma_f32_16x16x32_bf16 v[80:83], v[232:235], a[0:3], v[80:83]
    ds_read_b64_tr_b16 v[224:225], v10 offset:224
    v_mfma_f32_16x16x32_bf16 v[80:83], v[236:239], a[16:19], v[80:83]
    ds_read_b64_tr_b16 v[226:227], v10 offset:4832
    v_mfma_f32_16x16x32_bf16 v[116:119], v[236:239], a[20:23], v[116:119]
    buffer_load_dwordx4 a[44:47], v7, s[36:39], s51 offen offset:3072 sc1
    v_mfma_f32_16x16x32_bf16 v[116:119], v[232:235], a[4:7], v[116:119]
    s_add_u32 s51, s60, 12288
    v_mfma_f32_16x16x32_bf16 v[152:155], v[232:235], a[8:11], v[152:155]
    ds_read_b64_tr_b16 v[228:229], v10 offset:9440
    v_mfma_f32_16x16x32_bf16 v[152:155], v[236:239], a[24:27], v[152:155]
    ds_read_b64_tr_b16 v[230:231], v10 offset:14048
    v_mfma_f32_16x16x32_bf16 v[188:191], v[236:239], a[28:31], v[188:191]
    buffer_load_dwordx4 a[48:51], v7, s[36:39], s51 offen offset:0 sc1
    v_mfma_f32_16x16x32_bf16 v[188:191], v[232:235], a[12:15], v[188:191]
    s_waitcnt lgkmcnt(8)
    v_mfma_f32_16x16x32_bf16 v[84:87], v[208:211], a[0:3], v[84:87]
    ds_read_b64_tr_b16 v[232:233], v10 offset:256
    v_mfma_f32_16x16x32_bf16 v[84:87], v[212:215], a[16:19], v[84:87]
    ds_read_b64_tr_b16 v[234:235], v10 offset:4864
    v_mfma_f32_16x16x32_bf16 v[120:123], v[212:215], a[20:23], v[120:123]
    buffer_load_dwordx4 a[52:55], v7, s[36:39], s51 offen offset:1024 sc1
    v_mfma_f32_16x16x32_bf16 v[120:123], v[208:211], a[4:7], v[120:123]
    v_mfma_f32_16x16x32_bf16 v[156:159], v[208:211], a[8:11], v[156:159]
    ds_read_b64_tr_b16 v[236:237], v10 offset:9472
    v_mfma_f32_16x16x32_bf16 v[156:159], v[212:215], a[24:27], v[156:159]
    ds_read_b64_tr_b16 v[238:239], v10 offset:14080
    v_mfma_f32_16x16x32_bf16 v[192:195], v[212:215], a[28:31], v[192:195]
    buffer_load_dwordx4 a[56:59], v7, s[36:39], s51 offen offset:2048 sc1
    v_mfma_f32_16x16x32_bf16 v[192:195], v[208:211], a[12:15], v[192:195]
    s_waitcnt lgkmcnt(8)
    v_mfma_f32_16x16x32_bf16 v[88:91], v[216:219], a[0:3], v[88:91]
    v_mfma_f32_16x16x32_bf16 v[88:91], v[220:223], a[16:19], v[88:91]
    v_mfma_f32_16x16x32_bf16 v[124:127], v[220:223], a[20:23], v[124:127]
    v_mfma_f32_16x16x32_bf16 v[124:127], v[216:219], a[4:7], v[124:127]
    v_mfma_f32_16x16x32_bf16 v[160:163], v[216:219], a[8:11], v[160:163]
    v_mfma_f32_16x16x32_bf16 v[160:163], v[220:223], a[24:27], v[160:163]
    v_mfma_f32_16x16x32_bf16 v[196:199], v[220:223], a[28:31], v[196:199]
    buffer_load_dwordx4 a[60:63], v7, s[36:39], s51 offen offset:3072 sc1
    v_mfma_f32_16x16x32_bf16 v[196:199], v[216:219], a[12:15], v[196:199]
    s_waitcnt lgkmcnt(0)
    s_barrier
    v_mfma_f32_16x16x32_bf16 v[92:95], v[224:227], a[0:3], v[92:95]
    ds_read_b64_tr_b16 v[208:209], v11 offset:0
    ds_read_b64_tr_b16 v[210:211], v11 offset:4608
    v_mfma_f32_16x16x32_bf16 v[92:95], v[228:231], a[16:19], v[92:95]
    ds_read_b64_tr_b16 v[212:213], v11 offset:9216
    ds_read_b64_tr_b16 v[214:215], v11 offset:13824
    v_mfma_f32_16x16x32_bf16 v[128:131], v[228:231], a[20:23], v[128:131]
    ds_read_b64_tr_b16 v[216:217], v11 offset:32
    ds_read_b64_tr_b16 v[218:219], v11 offset:4640
    v_mfma_f32_16x16x32_bf16 v[128:131], v[224:227], a[4:7], v[128:131]
    s_add_u32 s51, s61, 8192
    v_mfma_f32_16x16x32_bf16 v[164:167], v[224:227], a[8:11], v[164:167]
    ds_read_b64_tr_b16 v[220:221], v11 offset:9248
    v_mfma_f32_16x16x32_bf16 v[164:167], v[228:231], a[24:27], v[164:167]
    ds_read_b64_tr_b16 v[222:223], v11 offset:13856
    v_mfma_f32_16x16x32_bf16 v[200:203], v[228:231], a[28:31], v[200:203]
    buffer_load_dwordx4 a[96:99], v7, s[36:39], s51 offen offset:0 sc1
    v_mfma_f32_16x16x32_bf16 v[200:203], v[224:227], a[12:15], v[200:203]
    v_mfma_f32_16x16x32_bf16 v[96:99], v[232:235], a[0:3], v[96:99]
    ds_read_b64_tr_b16 v[224:225], v11 offset:64
    v_mfma_f32_16x16x32_bf16 v[96:99], v[236:239], a[16:19], v[96:99]
    ds_read_b64_tr_b16 v[226:227], v11 offset:4672
    v_mfma_f32_16x16x32_bf16 v[132:135], v[236:239], a[20:23], v[132:135]
    buffer_load_dwordx4 a[100:103], v7, s[36:39], s51 offen offset:1024 sc1
    v_mfma_f32_16x16x32_bf16 v[132:135], v[232:235], a[4:7], v[132:135]
    v_mfma_f32_16x16x32_bf16 v[168:171], v[232:235], a[8:11], v[168:171]
    ds_read_b64_tr_b16 v[228:229], v11 offset:9280
    v_mfma_f32_16x16x32_bf16 v[168:171], v[236:239], a[24:27], v[168:171]
    ds_read_b64_tr_b16 v[230:231], v11 offset:13888
    v_mfma_f32_16x16x32_bf16 v[204:207], v[236:239], a[28:31], v[204:207]
    buffer_load_dwordx4 a[104:107], v7, s[36:39], s51 offen offset:2048 sc1
    v_mfma_f32_16x16x32_bf16 v[204:207], v[232:235], a[12:15], v[204:207]
    s_waitcnt vmcnt(23) lgkmcnt(8)
    v_mfma_f32_16x16x32_bf16 v[64:67], v[208:211], a[64:67], v[64:67]
    ds_read_b64_tr_b16 v[232:233], v11 offset:96
    s_waitcnt vmcnt(19)
    v_mfma_f32_16x16x32_bf16 v[64:67], v[212:215], a[80:83], v[64:67]
    ds_read_b64_tr_b16 v[234:235], v11 offset:4704
    v_mfma_f32_16x16x32_bf16 v[100:103], v[212:215], a[84:87], v[100:103]
    buffer_load_dwordx4 a[108:111], v7, s[36:39], s51 offen offset:3072 sc1
    v_mfma_f32_16x16x32_bf16 v[100:103], v[208:211], a[68:71], v[100:103]
    s_add_u32 s51, s61, 12288
    v_mfma_f32_16x16x32_bf16 v[136:139], v[208:211], a[72:75], v[136:139]
    ds_read_b64_tr_b16 v[236:237], v11 offset:9312
    v_mfma_f32_16x16x32_bf16 v[136:139], v[212:215], a[88:91], v[136:139]
    ds_read_b64_tr_b16 v[238:239], v11 offset:13920
    v_mfma_f32_16x16x32_bf16 v[172:175], v[212:215], a[92:95], v[172:175]
    buffer_load_dwordx4 a[112:115], v7, s[36:39], s51 offen offset:0 sc1
    v_mfma_f32_16x16x32_bf16 v[172:175], v[208:211], a[76:79], v[172:175]
    s_waitcnt lgkmcnt(8)
    v_mfma_f32_16x16x32_bf16 v[68:71], v[216:219], a[64:67], v[68:71]
    ds_read_b64_tr_b16 v[208:209], v11 offset:128
    v_mfma_f32_16x16x32_bf16 v[68:71], v[220:223], a[80:83], v[68:71]
    ds_read_b64_tr_b16 v[210:211], v11 offset:4736
    v_mfma_f32_16x16x32_bf16 v[104:107], v[220:223], a[84:87], v[104:107]
    buffer_load_dwordx4 a[116:119], v7, s[36:39], s51 offen offset:1024 sc1
    v_mfma_f32_16x16x32_bf16 v[104:107], v[216:219], a[68:71], v[104:107]
    v_mfma_f32_16x16x32_bf16 v[140:143], v[216:219], a[72:75], v[140:143]
    ds_read_b64_tr_b16 v[212:213], v11 offset:9344
    v_mfma_f32_16x16x32_bf16 v[140:143], v[220:223], a[88:91], v[140:143]
    ds_read_b64_tr_b16 v[214:215], v11 offset:13952
    v_mfma_f32_16x16x32_bf16 v[176:179], v[220:223], a[92:95], v[176:179]
    buffer_load_dwordx4 a[120:123], v7, s[36:39], s51 offen offset:2048 sc1
    v_mfma_f32_16x16x32_bf16 v[176:179], v[216:219], a[76:79], v[176:179]
    s_waitcnt lgkmcnt(8)
    v_mfma_f32_16x16x32_bf16 v[72:75], v[224:227], a[64:67], v[72:75]
    ds_read_b64_tr_b16 v[216:217], v11 offset:160
    v_mfma_f32_16x16x32_bf16 v[72:75], v[228:231], a[80:83], v[72:75]
    ds_read_b64_tr_b16 v[218:219], v11 offset:4768
    v_mfma_f32_16x16x32_bf16 v[108:111], v[228:231], a[84:87], v[108:111]
    v_mfma_f32_16x16x32_bf16 v[108:111], v[224:227], a[68:71], v[108:111]
    v_mfma_f32_16x16x32_bf16 v[144:147], v[224:227], a[72:75], v[144:147]
    ds_read_b64_tr_b16 v[220:221], v11 offset:9376
    v_mfma_f32_16x16x32_bf16 v[144:147], v[228:231], a[88:91], v[144:147]
    ds_read_b64_tr_b16 v[222:223], v11 offset:13984
    v_mfma_f32_16x16x32_bf16 v[180:183], v[228:231], a[92:95], v[180:183]
    buffer_load_dwordx4 a[124:127], v7, s[36:39], s51 offen offset:3072 sc1
    v_mfma_f32_16x16x32_bf16 v[180:183], v[224:227], a[76:79], v[180:183]
    s_add_u32 m0, s49, 0
    s_waitcnt lgkmcnt(8)
    v_mfma_f32_16x16x32_bf16 v[76:79], v[232:235], a[64:67], v[76:79]
    ds_read_b64_tr_b16 v[224:225], v11 offset:192
    v_mfma_f32_16x16x32_bf16 v[76:79], v[236:239], a[80:83], v[76:79]
    ds_read_b64_tr_b16 v[226:227], v11 offset:4800
    v_mfma_f32_16x16x32_bf16 v[112:115], v[236:239], a[84:87], v[112:115]
    buffer_load_dwordx4 v52, s[8:11], s52 offen lds
    v_mfma_f32_16x16x32_bf16 v[112:115], v[232:235], a[68:71], v[112:115]
    s_add_u32 m0, s49, 1024
    v_mfma_f32_16x16x32_bf16 v[148:151], v[232:235], a[72:75], v[148:151]
    ds_read_b64_tr_b16 v[228:229], v11 offset:9408
    v_mfma_f32_16x16x32_bf16 v[148:151], v[236:239], a[88:91], v[148:151]
    ds_read_b64_tr_b16 v[230:231], v11 offset:14016
    v_mfma_f32_16x16x32_bf16 v[184:187], v[236:239], a[92:95], v[184:187]
    buffer_load_dwordx4 v53, s[8:11], s52 offen lds
    v_mfma_f32_16x16x32_bf16 v[184:187], v[232:235], a[76:79], v[184:187]
    s_add_u32 m0, s49, 2048
    s_waitcnt lgkmcnt(8)
    v_mfma_f32_16x16x32_bf16 v[80:83], v[208:211], a[64:67], v[80:83]
    ds_read_b64_tr_b16 v[232:233], v11 offset:224
    v_mfma_f32_16x16x32_bf16 v[80:83], v[212:215], a[80:83], v[80:83]
    ds_read_b64_tr_b16 v[234:235], v11 offset:4832
    v_mfma_f32_16x16x32_bf16 v[116:119], v[212:215], a[84:87], v[116:119]
    buffer_load_dwordx4 v54, s[8:11], s52 offen lds
    v_mfma_f32_16x16x32_bf16 v[116:119], v[208:211], a[68:71], v[116:119]
    s_add_u32 m0, s49, 3072
    v_mfma_f32_16x16x32_bf16 v[152:155], v[208:211], a[72:75], v[152:155]
    ds_read_b64_tr_b16 v[236:237], v11 offset:9440
    v_mfma_f32_16x16x32_bf16 v[152:155], v[212:215], a[88:91], v[152:155]
    ds_read_b64_tr_b16 v[238:239], v11 offset:14048
    v_mfma_f32_16x16x32_bf16 v[188:191], v[212:215], a[92:95], v[188:191]
    buffer_load_dwordx4 v55, s[8:11], s52 offen lds
    v_mfma_f32_16x16x32_bf16 v[188:191], v[208:211], a[76:79], v[188:191]
    s_add_u32 m0, s49, 4096
    s_waitcnt lgkmcnt(8)
    v_mfma_f32_16x16x32_bf16 v[84:87], v[216:219], a[64:67], v[84:87]
    ds_read_b64_tr_b16 v[208:209], v11 offset:256
    v_mfma_f32_16x16x32_bf16 v[84:87], v[220:223], a[80:83], v[84:87]
    ds_read_b64_tr_b16 v[210:211], v11 offset:4864
    v_mfma_f32_16x16x32_bf16 v[120:123], v[220:223], a[84:87], v[120:123]
    buffer_load_dwordx4 v56, s[8:11], s52 offen lds
    v_mfma_f32_16x16x32_bf16 v[120:123], v[216:219], a[68:71], v[120:123]
    s_add_u32 m0, s49, 5120
    v_mfma_f32_16x16x32_bf16 v[156:159], v[216:219], a[72:75], v[156:159]
    ds_read_b64_tr_b16 v[212:213], v11 offset:9472
    v_mfma_f32_16x16x32_bf16 v[156:159], v[220:223], a[88:91], v[156:159]
    ds_read_b64_tr_b16 v[214:215], v11 offset:14080
    v_mfma_f32_16x16x32_bf16 v[192:195], v[220:223], a[92:95], v[192:195]
    buffer_load_dwordx4 v57, s[8:11], s52 offen lds
    v_mfma_f32_16x16x32_bf16 v[192:195], v[216:219], a[76:79], v[192:195]
    s_waitcnt lgkmcnt(8)
    v_mfma_f32_16x16x32_bf16 v[88:91], v[224:227], a[64:67], v[88:91]
    ds_read_b64_tr_b16 v[216:217], v9 offset:18432
    v_mfma_f32_16x16x32_bf16 v[88:91], v[228:231], a[80:83], v[88:91]
    ds_read_b64_tr_b16 v[218:219], v9 offset:23040
    v_mfma_f32_16x16x32_bf16 v[124:127], v[228:231], a[84:87], v[124:127]
    v_mfma_f32_16x16x32_bf16 v[124:127], v[224:227], a[68:71], v[124:127]
    s_add_u32 m0, s49, 6144
    v_mfma_f32_16x16x32_bf16 v[160:163], v[224:227], a[72:75], v[160:163]
    ds_read_b64_tr_b16 v[220:221], v9 offset:27648
    v_mfma_f32_16x16x32_bf16 v[160:163], v[228:231], a[88:91], v[160:163]
    ds_read_b64_tr_b16 v[222:223], v9 offset:32256
    v_mfma_f32_16x16x32_bf16 v[196:199], v[228:231], a[92:95], v[196:199]
    buffer_load_dwordx4 v58, s[8:11], s52 offen lds
    v_mfma_f32_16x16x32_bf16 v[196:199], v[224:227], a[76:79], v[196:199]
    s_add_u32 m0, s49, 7168
    s_waitcnt lgkmcnt(8)
    v_mfma_f32_16x16x32_bf16 v[92:95], v[232:235], a[64:67], v[92:95]
    ds_read_b64_tr_b16 v[224:225], v9 offset:18464
    v_mfma_f32_16x16x32_bf16 v[92:95], v[236:239], a[80:83], v[92:95]
    ds_read_b64_tr_b16 v[226:227], v9 offset:23072
    v_mfma_f32_16x16x32_bf16 v[128:131], v[236:239], a[84:87], v[128:131]
    buffer_load_dwordx4 v59, s[8:11], s52 offen lds
    v_mfma_f32_16x16x32_bf16 v[128:131], v[232:235], a[68:71], v[128:131]
    s_add_u32 m0, s49, 8192
    v_mfma_f32_16x16x32_bf16 v[164:167], v[232:235], a[72:75], v[164:167]
    ds_read_b64_tr_b16 v[228:229], v9 offset:27680
    v_mfma_f32_16x16x32_bf16 v[164:167], v[236:239], a[88:91], v[164:167]
    ds_read_b64_tr_b16 v[230:231], v9 offset:32288
    v_mfma_f32_16x16x32_bf16 v[200:203], v[236:239], a[92:95], v[200:203]
    buffer_load_dwordx4 v60, s[8:11], s52 offen lds
    v_mfma_f32_16x16x32_bf16 v[200:203], v[232:235], a[76:79], v[200:203]
    s_waitcnt lgkmcnt(8)
    v_mfma_f32_16x16x32_bf16 v[96:99], v[208:211], a[64:67], v[96:99]
    ds_read_b64_tr_b16 v[232:233], v9 offset:18496
    v_mfma_f32_16x16x32_bf16 v[96:99], v[212:215], a[80:83], v[96:99]
    ds_read_b64_tr_b16 v[234:235], v9 offset:23104
    v_mfma_f32_16x16x32_bf16 v[132:135], v[212:215], a[84:87], v[132:135]
    v_mfma_f32_16x16x32_bf16 v[132:135], v[208:211], a[68:71], v[132:135]
    v_mfma_f32_16x16x32_bf16 v[168:171], v[208:211], a[72:75], v[168:171]
    ds_read_b64_tr_b16 v[236:237], v9 offset:27712
    v_mfma_f32_16x16x32_bf16 v[168:171], v[212:215], a[88:91], v[168:171]
    ds_read_b64_tr_b16 v[238:239], v9 offset:32320
    v_mfma_f32_16x16x32_bf16 v[204:207], v[212:215], a[92:95], v[204:207]
    v_mfma_f32_16x16x32_bf16 v[204:207], v[208:211], a[76:79], v[204:207]
    s_waitcnt vmcnt(29) lgkmcnt(8)
    v_mfma_f32_16x16x32_bf16 v[64:67], v[216:219], a[160:163], v[64:67]
    ds_read_b64_tr_b16 v[208:209], v9 offset:18528
    s_waitcnt vmcnt(25)
    v_mfma_f32_16x16x32_bf16 v[64:67], v[220:223], a[176:179], v[64:67]
    ds_read_b64_tr_b16 v[210:211], v9 offset:23136
    v_mfma_f32_16x16x32_bf16 v[100:103], v[220:223], a[180:183], v[100:103]
    v_mfma_f32_16x16x32_bf16 v[100:103], v[216:219], a[164:167], v[100:103]
    v_mfma_f32_16x16x32_bf16 v[136:139], v[216:219], a[168:171], v[136:139]
    ds_read_b64_tr_b16 v[212:213], v9 offset:27744
    v_mfma_f32_16x16x32_bf16 v[136:139], v[220:223], a[184:187], v[136:139]
    ds_read_b64_tr_b16 v[214:215], v9 offset:32352
    v_mfma_f32_16x16x32_bf16 v[172:175], v[220:223], a[188:191], v[172:175]
    v_mfma_f32_16x16x32_bf16 v[172:175], v[216:219], a[172:175], v[172:175]
    s_waitcnt lgkmcnt(8)
    v_mfma_f32_16x16x32_bf16 v[68:71], v[224:227], a[160:163], v[68:71]
    ds_read_b64_tr_b16 v[216:217], v9 offset:18560
    v_mfma_f32_16x16x32_bf16 v[68:71], v[228:231], a[176:179], v[68:71]
    ds_read_b64_tr_b16 v[218:219], v9 offset:23168
    v_mfma_f32_16x16x32_bf16 v[104:107], v[228:231], a[180:183], v[104:107]
    v_mfma_f32_16x16x32_bf16 v[104:107], v[224:227], a[164:167], v[104:107]
    v_mfma_f32_16x16x32_bf16 v[140:143], v[224:227], a[168:171], v[140:143]
    ds_read_b64_tr_b16 v[220:221], v9 offset:27776
    v_mfma_f32_16x16x32_bf16 v[140:143], v[228:231], a[184:187], v[140:143]
    ds_read_b64_tr_b16 v[222:223], v9 offset:32384
    v_mfma_f32_16x16x32_bf16 v[176:179], v[228:231], a[188:191], v[176:179]
    v_mfma_f32_16x16x32_bf16 v[176:179], v[224:227], a[172:175], v[176:179]
    s_waitcnt lgkmcnt(8)
    v_mfma_f32_16x16x32_bf16 v[72:75], v[232:235], a[160:163], v[72:75]
    ds_read_b64_tr_b16 v[224:225], v9 offset:18592
    v_mfma_f32_16x16x32_bf16 v[72:75], v[236:239], a[176:179], v[72:75]
    ds_read_b64_tr_b16 v[226:227], v9 offset:23200
    v_mfma_f32_16x16x32_bf16 v[108:111], v[236:239], a[180:183], v[108:111]
    v_mfma_f32_16x16x32_bf16 v[108:111], v[232:235], a[164:167], v[108:111]
    v_mfma_f32_16x16x32_bf16 v[144:147], v[232:235], a[168:171], v[144:147]
    ds_read_b64_tr_b16 v[228:229], v9 offset:27808
    v_mfma_f32_16x16x32_bf16 v[144:147], v[236:239], a[184:187], v[144:147]
    ds_read_b64_tr_b16 v[230:231], v9 offset:32416
    v_mfma_f32_16x16x32_bf16 v[180:183], v[236:239], a[188:191], v[180:183]
    v_mfma_f32_16x16x32_bf16 v[180:183], v[232:235], a[172:175], v[180:183]
    s_waitcnt lgkmcnt(8)
    v_mfma_f32_16x16x32_bf16 v[76:79], v[208:211], a[160:163], v[76:79]
    ds_read_b64_tr_b16 v[232:233], v9 offset:18624
    v_mfma_f32_16x16x32_bf16 v[76:79], v[212:215], a[176:179], v[76:79]
    ds_read_b64_tr_b16 v[234:235], v9 offset:23232
    v_mfma_f32_16x16x32_bf16 v[112:115], v[212:215], a[180:183], v[112:115]
    v_mfma_f32_16x16x32_bf16 v[112:115], v[208:211], a[164:167], v[112:115]
    v_mfma_f32_16x16x32_bf16 v[148:151], v[208:211], a[168:171], v[148:151]
    ds_read_b64_tr_b16 v[236:237], v9 offset:27840
    v_mfma_f32_16x16x32_bf16 v[148:151], v[212:215], a[184:187], v[148:151]
    ds_read_b64_tr_b16 v[238:239], v9 offset:32448
    v_mfma_f32_16x16x32_bf16 v[184:187], v[212:215], a[188:191], v[184:187]
    v_mfma_f32_16x16x32_bf16 v[184:187], v[208:211], a[172:175], v[184:187]
    s_waitcnt lgkmcnt(8)
    v_mfma_f32_16x16x32_bf16 v[80:83], v[216:219], a[160:163], v[80:83]
    ds_read_b64_tr_b16 v[208:209], v9 offset:18656
    v_mfma_f32_16x16x32_bf16 v[80:83], v[220:223], a[176:179], v[80:83]
    ds_read_b64_tr_b16 v[210:211], v9 offset:23264
    v_mfma_f32_16x16x32_bf16 v[116:119], v[220:223], a[180:183], v[116:119]
    v_mfma_f32_16x16x32_bf16 v[116:119], v[216:219], a[164:167], v[116:119]
    v_mfma_f32_16x16x32_bf16 v[152:155], v[216:219], a[168:171], v[152:155]
    ds_read_b64_tr_b16 v[212:213], v9 offset:27872
    v_mfma_f32_16x16x32_bf16 v[152:155], v[220:223], a[184:187], v[152:155]
    ds_read_b64_tr_b16 v[214:215], v9 offset:32480
    v_mfma_f32_16x16x32_bf16 v[188:191], v[220:223], a[188:191], v[188:191]
    v_mfma_f32_16x16x32_bf16 v[188:191], v[216:219], a[172:175], v[188:191]
    s_waitcnt lgkmcnt(8)
    v_mfma_f32_16x16x32_bf16 v[84:87], v[224:227], a[160:163], v[84:87]
    ds_read_b64_tr_b16 v[216:217], v9 offset:18688
    v_mfma_f32_16x16x32_bf16 v[84:87], v[228:231], a[176:179], v[84:87]
    ds_read_b64_tr_b16 v[218:219], v9 offset:23296
    v_mfma_f32_16x16x32_bf16 v[120:123], v[228:231], a[180:183], v[120:123]
    buffer_load_dword v247, v246, s[24:27], 0 offen
    v_mfma_f32_16x16x32_bf16 v[120:123], v[224:227], a[164:167], v[120:123]
    v_mfma_f32_16x16x32_bf16 v[156:159], v[224:227], a[168:171], v[156:159]
    ds_read_b64_tr_b16 v[220:221], v9 offset:27904
    v_mfma_f32_16x16x32_bf16 v[156:159], v[228:231], a[184:187], v[156:159]
    ds_read_b64_tr_b16 v[222:223], v9 offset:32512
    v_mfma_f32_16x16x32_bf16 v[192:195], v[228:231], a[188:191], v[192:195]
    v_mfma_f32_16x16x32_bf16 v[192:195], v[224:227], a[172:175], v[192:195]
    s_waitcnt lgkmcnt(8)
    v_mfma_f32_16x16x32_bf16 v[88:91], v[232:235], a[160:163], v[88:91]
    v_mfma_f32_16x16x32_bf16 v[88:91], v[236:239], a[176:179], v[88:91]
    v_mfma_f32_16x16x32_bf16 v[124:127], v[236:239], a[180:183], v[124:127]
    v_mfma_f32_16x16x32_bf16 v[124:127], v[232:235], a[164:167], v[124:127]
    v_mfma_f32_16x16x32_bf16 v[160:163], v[232:235], a[168:171], v[160:163]
    v_mfma_f32_16x16x32_bf16 v[160:163], v[236:239], a[184:187], v[160:163]
    v_mfma_f32_16x16x32_bf16 v[196:199], v[236:239], a[188:191], v[196:199]
    v_mfma_f32_16x16x32_bf16 v[196:199], v[232:235], a[172:175], v[196:199]
    s_waitcnt lgkmcnt(0)
    s_barrier
    v_mfma_f32_16x16x32_bf16 v[92:95], v[208:211], a[160:163], v[92:95]
    ds_read_b64_tr_b16 v[224:225], v10 offset:18432
    ds_read_b64_tr_b16 v[226:227], v10 offset:23040
    v_mfma_f32_16x16x32_bf16 v[92:95], v[212:215], a[176:179], v[92:95]
    ds_read_b64_tr_b16 v[228:229], v10 offset:27648
    ds_read_b64_tr_b16 v[230:231], v10 offset:32256
    v_mfma_f32_16x16x32_bf16 v[128:131], v[212:215], a[180:183], v[128:131]
    ds_read_b64_tr_b16 v[232:233], v10 offset:18464
    ds_read_b64_tr_b16 v[234:235], v10 offset:23072
    v_mfma_f32_16x16x32_bf16 v[128:131], v[208:211], a[164:167], v[128:131]
    s_add_u32 s50, s52, 147456
    s_add_u32 m0, s49, 36864
    v_mfma_f32_16x16x32_bf16 v[164:167], v[208:211], a[168:171], v[164:167]
    ds_read_b64_tr_b16 v[236:237], v10 offset:27680
    v_mfma_f32_16x16x32_bf16 v[164:167], v[212:215], a[184:187], v[164:167]
    ds_read_b64_tr_b16 v[238:239], v10 offset:32288
    v_mfma_f32_16x16x32_bf16 v[200:203], v[212:215], a[188:191], v[200:203]
    buffer_load_dwordx4 v52, s[8:11], s50 offen lds
    v_mfma_f32_16x16x32_bf16 v[200:203], v[208:211], a[172:175], v[200:203]
    s_add_u32 m0, s49, 37888
    v_mfma_f32_16x16x32_bf16 v[96:99], v[216:219], a[160:163], v[96:99]
    ds_read_b64_tr_b16 v[208:209], v10 offset:18496
    v_mfma_f32_16x16x32_bf16 v[96:99], v[220:223], a[176:179], v[96:99]
    ds_read_b64_tr_b16 v[210:211], v10 offset:23104
    v_mfma_f32_16x16x32_bf16 v[132:135], v[220:223], a[180:183], v[132:135]
    buffer_load_dwordx4 v53, s[8:11], s50 offen lds
    v_mfma_f32_16x16x32_bf16 v[132:135], v[216:219], a[164:167], v[132:135]
    s_add_u32 m0, s49, 38912
    v_mfma_f32_16x16x32_bf16 v[168:171], v[216:219], a[168:171], v[168:171]
    ds_read_b64_tr_b16 v[212:213], v10 offset:27712
    v_mfma_f32_16x16x32_bf16 v[168:171], v[220:223], a[184:187], v[168:171]
    ds_read_b64_tr_b16 v[214:215], v10 offset:32320
    v_mfma_f32_16x16x32_bf16 v[204:207], v[220:223], a[188:191], v[204:207]
    buffer_load_dwordx4 v54, s[8:11], s50 offen lds
    v_mfma_f32_16x16x32_bf16 v[204:207], v[216:219], a[172:175], v[204:207]
    s_waitcnt vmcnt(25) lgkmcnt(8)
    v_mfma_f32_16x16x32_bf16 v[64:67], v[224:227], a[32:35], v[64:67]
    ds_read_b64_tr_b16 v[216:217], v10 offset:18528
    s_waitcnt vmcnt(21)
    v_mfma_f32_16x16x32_bf16 v[64:67], v[228:231], a[48:51], v[64:67]
    ds_read_b64_tr_b16 v[218:219], v10 offset:23136
    v_mfma_f32_16x16x32_bf16 v[100:103], v[228:231], a[52:55], v[100:103]
    buffer_load_dword v244, v62, s[68:71], 0 offen sc1
    v_mfma_f32_16x16x32_bf16 v[100:103], v[224:227], a[36:39], v[100:103]
    s_add_u32 m0, s49, 39936
    v_mfma_f32_16x16x32_bf16 v[136:139], v[224:227], a[40:43], v[136:139]
    ds_read_b64_tr_b16 v[220:221], v10 offset:27744
    v_mfma_f32_16x16x32_bf16 v[136:139], v[228:231], a[56:59], v[136:139]
    ds_read_b64_tr_b16 v[222:223], v10 offset:32352
    v_mfma_f32_16x16x32_bf16 v[172:175], v[228:231], a[60:63], v[172:175]
    buffer_load_dwordx4 v55, s[8:11], s50 offen lds
    v_mfma_f32_16x16x32_bf16 v[172:175], v[224:227], a[44:47], v[172:175]
    s_add_u32 m0, s49, 40960
    s_waitcnt lgkmcnt(8)
    v_mfma_f32_16x16x32_bf16 v[68:71], v[232:235], a[32:35], v[68:71]
    ds_read_b64_tr_b16 v[224:225], v10 offset:18560
    v_mfma_f32_16x16x32_bf16 v[68:71], v[236:239], a[48:51], v[68:71]
    ds_read_b64_tr_b16 v[226:227], v10 offset:23168
    v_mfma_f32_16x16x32_bf16 v[104:107], v[236:239], a[52:55], v[104:107]
    buffer_load_dwordx4 v56, s[8:11], s50 offen lds
    v_mfma_f32_16x16x32_bf16 v[104:107], v[232:235], a[36:39], v[104:107]
    s_add_u32 m0, s49, 41984
    v_mfma_f32_16x16x32_bf16 v[140:143], v[232:235], a[40:43], v[140:143]
    ds_read_b64_tr_b16 v[228:229], v10 offset:27776
    v_mfma_f32_16x16x32_bf16 v[140:143], v[236:239], a[56:59], v[140:143]
    ds_read_b64_tr_b16 v[230:231], v10 offset:32384
    v_mfma_f32_16x16x32_bf16 v[176:179], v[236:239], a[60:63], v[176:179]
    buffer_load_dwordx4 v57, s[8:11], s50 offen lds
    v_mfma_f32_16x16x32_bf16 v[176:179], v[232:235], a[44:47], v[176:179]
    s_waitcnt lgkmcnt(8)
    v_mfma_f32_16x16x32_bf16 v[72:75], v[208:211], a[32:35], v[72:75]
    ds_read_b64_tr_b16 v[232:233], v10 offset:18592
    v_mfma_f32_16x16x32_bf16 v[72:75], v[212:215], a[48:51], v[72:75]
    ds_read_b64_tr_b16 v[234:235], v10 offset:23200
    v_mfma_f32_16x16x32_bf16 v[108:111], v[212:215], a[52:55], v[108:111]
    v_mfma_f32_16x16x32_bf16 v[108:111], v[208:211], a[36:39], v[108:111]
    s_add_u32 m0, s49, 43008
    v_mfma_f32_16x16x32_bf16 v[144:147], v[208:211], a[40:43], v[144:147]
    ds_read_b64_tr_b16 v[236:237], v10 offset:27808
    v_mfma_f32_16x16x32_bf16 v[144:147], v[212:215], a[56:59], v[144:147]
    ds_read_b64_tr_b16 v[238:239], v10 offset:32416
    v_mfma_f32_16x16x32_bf16 v[180:183], v[212:215], a[60:63], v[180:183]
    buffer_load_dwordx4 v58, s[8:11], s50 offen lds
    v_mfma_f32_16x16x32_bf16 v[180:183], v[208:211], a[44:47], v[180:183]
    s_add_u32 m0, s49, 44032
    s_waitcnt lgkmcnt(8)
    v_mfma_f32_16x16x32_bf16 v[76:79], v[216:219], a[32:35], v[76:79]
    ds_read_b64_tr_b16 v[208:209], v10 offset:18624
    v_mfma_f32_16x16x32_bf16 v[76:79], v[220:223], a[48:51], v[76:79]
    ds_read_b64_tr_b16 v[210:211], v10 offset:23232
    v_mfma_f32_16x16x32_bf16 v[112:115], v[220:223], a[52:55], v[112:115]
    buffer_load_dwordx4 v59, s[8:11], s50 offen lds
    v_mfma_f32_16x16x32_bf16 v[112:115], v[216:219], a[36:39], v[112:115]
    s_add_u32 m0, s49, 45056
    v_mfma_f32_16x16x32_bf16 v[148:151], v[216:219], a[40:43], v[148:151]
    ds_read_b64_tr_b16 v[212:213], v10 offset:27840
    v_mfma_f32_16x16x32_bf16 v[148:151], v[220:223], a[56:59], v[148:151]
    ds_read_b64_tr_b16 v[214:215], v10 offset:32448
    v_mfma_f32_16x16x32_bf16 v[184:187], v[220:223], a[60:63], v[184:187]
    buffer_load_dwordx4 v60, s[8:11], s50 offen lds
    v_mfma_f32_16x16x32_bf16 v[184:187], v[216:219], a[44:47], v[184:187]
    s_waitcnt lgkmcnt(8)
    v_mfma_f32_16x16x32_bf16 v[80:83], v[224:227], a[32:35], v[80:83]
    ds_read_b64_tr_b16 v[216:217], v10 offset:18656
    v_mfma_f32_16x16x32_bf16 v[80:83], v[228:231], a[48:51], v[80:83]
    ds_read_b64_tr_b16 v[218:219], v10 offset:23264
    v_mfma_f32_16x16x32_bf16 v[116:119], v[228:231], a[52:55], v[116:119]
    v_mfma_f32_16x16x32_bf16 v[116:119], v[224:227], a[36:39], v[116:119]
    v_mfma_f32_16x16x32_bf16 v[152:155], v[224:227], a[40:43], v[152:155]
    ds_read_b64_tr_b16 v[220:221], v10 offset:27872
    v_mfma_f32_16x16x32_bf16 v[152:155], v[228:231], a[56:59], v[152:155]
    ds_read_b64_tr_b16 v[222:223], v10 offset:32480
    v_mfma_f32_16x16x32_bf16 v[188:191], v[228:231], a[60:63], v[188:191]
    v_mfma_f32_16x16x32_bf16 v[188:191], v[224:227], a[44:47], v[188:191]
    s_waitcnt lgkmcnt(8)
    v_mfma_f32_16x16x32_bf16 v[84:87], v[232:235], a[32:35], v[84:87]
    ds_read_b64_tr_b16 v[224:225], v10 offset:18688
    v_mfma_f32_16x16x32_bf16 v[84:87], v[236:239], a[48:51], v[84:87]
    ds_read_b64_tr_b16 v[226:227], v10 offset:23296
    v_mfma_f32_16x16x32_bf16 v[120:123], v[236:239], a[52:55], v[120:123]
    v_mfma_f32_16x16x32_bf16 v[120:123], v[232:235], a[36:39], v[120:123]
    v_mfma_f32_16x16x32_bf16 v[156:159], v[232:235], a[40:43], v[156:159]
    ds_read_b64_tr_b16 v[228:229], v10 offset:27904
    v_mfma_f32_16x16x32_bf16 v[156:159], v[236:239], a[56:59], v[156:159]
    ds_read_b64_tr_b16 v[230:231], v10 offset:32512
    v_mfma_f32_16x16x32_bf16 v[192:195], v[236:239], a[60:63], v[192:195]
    v_mfma_f32_16x16x32_bf16 v[192:195], v[232:235], a[44:47], v[192:195]
    s_add_u32 s51, s62, 0
    s_waitcnt vmcnt(6)
    v_cmp_eq_u32 vcc, 0, v244
    s_cbranch_vccz L_k2_pollO2_ok
    s_mov_b32 s3, 0
L_k2_pollO2:
    buffer_load_dword v244, v62, s[68:71], 0 offen sc1
    s_add_u32 s3, s3, 1
    s_waitcnt vmcnt(0)
    v_cmp_eq_u32 vcc, 0, v244
    s_cbranch_vccz L_k2_pollO2_ok
    s_sleep 4
    s_cmp_lt_u32 s3, 0x40000
    s_cbranch_scc1 L_k2_pollO2
L_k2_pollO2_ok:
    s_waitcnt lgkmcnt(8)
    v_mfma_f32_16x16x32_bf16 v[88:91], v[208:211], a[32:35], v[88:91]
    ds_read_b64_tr_b16 v[232:233], v11 offset:18432
    v_mfma_f32_16x16x32_bf16 v[88:91], v[212:215], a[48:51], v[88:91]
    ds_read_b64_tr_b16 v[234:235], v11 offset:23040
    v_mfma_f32_16x16x32_bf16 v[124:127], v[212:215], a[52:55], v[124:127]
    buffer_load_dwordx4 a[192:195], v7, s[36:39], s51 offen offset:0 sc1
    v_mfma_f32_16x16x32_bf16 v[124:127], v[208:211], a[36:39], v[124:127]
    v_mfma_f32_16x16x32_bf16 v[160:163], v[208:211], a[40:43], v[160:163]
    ds_read_b64_tr_b16 v[236:237], v11 offset:27648
    v_mfma_f32_16x16x32_bf16 v[160:163], v[212:215], a[56:59], v[160:163]
    ds_read_b64_tr_b16 v[238:239], v11 offset:32256
    v_mfma_f32_16x16x32_bf16 v[196:199], v[212:215], a[60:63], v[196:199]
    buffer_load_dwordx4 a[196:199], v7, s[36:39], s51 offen offset:1024 sc1
    v_mfma_f32_16x16x32_bf16 v[196:199], v[208:211], a[44:47], v[196:199]
    s_waitcnt lgkmcnt(8)
    v_mfma_f32_16x16x32_bf16 v[92:95], v[216:219], a[32:35], v[92:95]
    ds_read_b64_tr_b16 v[208:209], v11 offset:18464
    v_and_b32 v62, 28, v0
    v_mfma_f32_16x16x32_bf16 v[92:95], v[220:223], a[48:51], v[92:95]
    ds_read_b64_tr_b16 v[210:211], v11 offset:23072
    v_and_b32 v2, 15, v1
    v_mfma_f32_16x16x32_bf16 v[128:131], v[220:223], a[52:55], v[128:131]
    buffer_load_dwordx4 a[200:203], v7, s[36:39], s51 offen offset:2048 sc1
    v_mfma_f32_16x16x32_bf16 v[128:131], v[216:219], a[36:39], v[128:131]
    s_add_u32 s68, s66, s7
    s_addc_u32 s69, s67, 0
    v_mul_u32_u24 v2, 1152, v2
    v_lshrrev_b32 v3, 4, v1
    v_mfma_f32_16x16x32_bf16 v[164:167], v[216:219], a[40:43], v[164:167]
    ds_read_b64_tr_b16 v[212:213], v11 offset:27680
    v_lshl_add_u32 v2, v3, 3, v2
    v_mfma_f32_16x16x32_bf16 v[164:167], v[220:223], a[56:59], v[164:167]
    ds_read_b64_tr_b16 v[214:215], v11 offset:32288
    v_add_u32 v3, 18432, v2
    v_mfma_f32_16x16x32_bf16 v[200:203], v[220:223], a[60:63], v[200:203]
    buffer_load_dwordx4 a[204:207], v7, s[36:39], s51 offen offset:3072 sc1
    v_mfma_f32_16x16x32_bf16 v[200:203], v[216:219], a[44:47], v[200:203]
    s_add_u32 s51, s62, 4096
    s_lshl_b32 s3, s43, 2
    s_add_u32 s7, s7, s3
    s_waitcnt lgkmcnt(8)
    v_mfma_f32_16x16x32_bf16 v[96:99], v[224:227], a[32:35], v[96:99]
    ds_read_b64_tr_b16 v[216:217], v11 offset:18496
    v_mfma_f32_16x16x32_bf16 v[96:99], v[228:231], a[48:51], v[96:99]
    ds_read_b64_tr_b16 v[218:219], v11 offset:23104
    v_mfma_f32_16x16x32_bf16 v[132:135], v[228:231], a[52:55], v[132:135]
    buffer_load_dwordx4 a[208:211], v7, s[36:39], s51 offen offset:0 sc1
    v_mfma_f32_16x16x32_bf16 v[132:135], v[224:227], a[36:39], v[132:135]
    s_add_u32 s20, s66, s7
    s_addc_u32 s21, s67, 0
    v_mfma_f32_16x16x32_bf16 v[168:171], v[224:227], a[40:43], v[168:171]
    ds_read_b64_tr_b16 v[220:221], v11 offset:27712
    v_mfma_f32_16x16x32_bf16 v[168:171], v[228:231], a[56:59], v[168:171]
    ds_read_b64_tr_b16 v[222:223], v11 offset:32320
    v_mfma_f32_16x16x32_bf16 v[204:207], v[228:231], a[60:63], v[204:207]
    buffer_load_dwordx4 a[212:215], v7, s[36:39], s51 offen offset:1024 sc1
    v_mfma_f32_16x16x32_bf16 v[204:207], v[224:227], a[44:47], v[204:207]
    s_waitcnt lgkmcnt(8)
    v_mfma_f32_16x16x32_bf16 v[64:67], v[232:235], a[96:99], v[64:67]
    ds_read_b64_tr_b16 v[224:225], v11 offset:18528
    v_mfma_f32_16x16x32_bf16 v[64:67], v[236:239], a[112:115], v[64:67]
    ds_read_b64_tr_b16 v[226:227], v11 offset:23136
    v_mfma_f32_16x16x32_bf16 v[100:103], v[236:239], a[116:119], v[100:103]
    buffer_load_dwordx4 a[216:219], v7, s[36:39], s51 offen offset:2048 sc1
    v_mfma_f32_16x16x32_bf16 v[100:103], v[232:235], a[100:103], v[100:103]
    v_mfma_f32_16x16x32_bf16 v[136:139], v[232:235], a[104:107], v[136:139]
    ds_read_b64_tr_b16 v[228:229], v11 offset:27744
    v_mfma_f32_16x16x32_bf16 v[136:139], v[236:239], a[120:123], v[136:139]
    ds_read_b64_tr_b16 v[230:231], v11 offset:32352
    v_mfma_f32_16x16x32_bf16 v[172:175], v[236:239], a[124:127], v[172:175]
    v_mfma_f32_16x16x32_bf16 v[172:175], v[232:235], a[108:111], v[172:175]
    s_waitcnt lgkmcnt(8)
    v_mfma_f32_16x16x32_bf16 v[68:71], v[208:211], a[96:99], v[68:71]
    ds_read_b64_tr_b16 v[232:233], v11 offset:18560
    v_mfma_f32_16x16x32_bf16 v[68:71], v[212:215], a[112:115], v[68:71]
    ds_read_b64_tr_b16 v[234:235], v11 offset:23168
    v_mfma_f32_16x16x32_bf16 v[104:107], v[212:215], a[116:119], v[104:107]
    buffer_load_dwordx4 a[220:223], v7, s[36:39], s51 offen offset:3072 sc1
    v_mfma_f32_16x16x32_bf16 v[104:107], v[208:211], a[100:103], v[104:107]
    s_add_u32 s51, s62, 8192
    v_mfma_f32_16x16x32_bf16 v[140:143], v[208:211], a[104:107], v[140:143]
    ds_read_b64_tr_b16 v[236:237], v11 offset:27776
    v_mfma_f32_16x16x32_bf16 v[140:143], v[212:215], a[120:123], v[140:143]
    ds_read_b64_tr_b16 v[238:239], v11 offset:32384
    v_mfma_f32_16x16x32_bf16 v[176:179], v[212:215], a[124:127], v[176:179]
    buffer_load_dwordx4 a[224:227], v7, s[36:39], s51 offen offset:0 sc1
    v_mfma_f32_16x16x32_bf16 v[176:179], v[208:211], a[108:111], v[176:179]
    s_waitcnt lgkmcnt(8)
    v_mfma_f32_16x16x32_bf16 v[72:75], v[216:219], a[96:99], v[72:75]
    ds_read_b64_tr_b16 v[208:209], v11 offset:18592
    v_mfma_f32_16x16x32_bf16 v[72:75], v[220:223], a[112:115], v[72:75]
    ds_read_b64_tr_b16 v[210:211], v11 offset:23200
    v_mfma_f32_16x16x32_bf16 v[108:111], v[220:223], a[116:119], v[108:111]
    buffer_load_dwordx4 a[228:231], v7, s[36:39], s51 offen offset:1024 sc1
    v_mfma_f32_16x16x32_bf16 v[108:111], v[216:219], a[100:103], v[108:111]
    v_mfma_f32_16x16x32_bf16 v[144:147], v[216:219], a[104:107], v[144:147]
    ds_read_b64_tr_b16 v[212:213], v11 offset:27808
    v_mfma_f32_16x16x32_bf16 v[144:147], v[220:223], a[120:123], v[144:147]
    ds_read_b64_tr_b16 v[214:215], v11 offset:32416
    v_mfma_f32_16x16x32_bf16 v[180:183], v[220:223], a[124:127], v[180:183]
    buffer_load_dwordx4 a[232:235], v7, s[36:39], s51 offen offset:2048 sc1
    v_mfma_f32_16x16x32_bf16 v[180:183], v[216:219], a[108:111], v[180:183]
    s_waitcnt lgkmcnt(8)
    v_mfma_f32_16x16x32_bf16 v[76:79], v[224:227], a[96:99], v[76:79]
    ds_read_b64_tr_b16 v[216:217], v11 offset:18624
    v_mfma_f32_16x16x32_bf16 v[76:79], v[228:231], a[112:115], v[76:79]
    ds_read_b64_tr_b16 v[218:219], v11 offset:23232
    v_mfma_f32_16x16x32_bf16 v[112:115], v[228:231], a[116:119], v[112:115]
    buffer_load_dwordx4 a[236:239], v7, s[36:39], s51 offen offset:3072 sc1
    v_mfma_f32_16x16x32_bf16 v[112:115], v[224:227], a[100:103], v[112:115]
    s_add_u32 s51, s62, 12288
    v_mfma_f32_16x16x32_bf16 v[148:151], v[224:227], a[104:107], v[148:151]
    ds_read_b64_tr_b16 v[220:221], v11 offset:27840
    v_mfma_f32_16x16x32_bf16 v[148:151], v[228:231], a[120:123], v[148:151]
    ds_read_b64_tr_b16 v[222:223], v11 offset:32448
    v_mfma_f32_16x16x32_bf16 v[184:187], v[228:231], a[124:127], v[184:187]
    buffer_load_dwordx4 a[240:243], v7, s[36:39], s51 offen offset:0 sc1
    v_mfma_f32_16x16x32_bf16 v[184:187], v[224:227], a[108:111], v[184:187]
    s_waitcnt lgkmcnt(8)
    v_mfma_f32_16x16x32_bf16 v[80:83], v[232:235], a[96:99], v[80:83]
    ds_read_b64_tr_b16 v[224:225], v11 offset:18656
    v_mfma_f32_16x16x32_bf16 v[80:83], v[236:239], a[112:115], v[80:83]
    ds_read_b64_tr_b16 v[226:227], v11 offset:23264
    v_mfma_f32_16x16x32_bf16 v[116:119], v[236:239], a[116:119], v[116:119]
    buffer_load_dwordx4 a[244:247], v7, s[36:39], s51 offen offset:1024 sc1
    v_mfma_f32_16x16x32_bf16 v[116:119], v[232:235], a[100:103], v[116:119]
    v_mfma_f32_16x16x32_bf16 v[152:155], v[232:235], a[104:107], v[152:155]
    ds_read_b64_tr_b16 v[228:229], v11 offset:27872
    v_mfma_f32_16x16x32_bf16 v[152:155], v[236:239], a[120:123], v[152:155]
    ds_read_b64_tr_b16 v[230:231], v11 offset:32480
    v_mfma_f32_16x16x32_bf16 v[188:191], v[236:239], a[124:127], v[188:191]
    v_mfma_f32_16x16x32_bf16 v[188:191], v[232:235], a[108:111], v[188:191]
    s_waitcnt lgkmcnt(8)
    v_mfma_f32_16x16x32_bf16 v[84:87], v[208:211], a[96:99], v[84:87]
    ds_read_b64_tr_b16 v[232:233], v11 offset:18688
    v_mfma_f32_16x16x32_bf16 v[84:87], v[212:215], a[112:115], v[84:87]
    ds_read_b64_tr_b16 v[234:235], v11 offset:23296
    v_mfma_f32_16x16x32_bf16 v[120:123], v[212:215], a[116:119], v[120:123]
    buffer_load_dwordx4 a[248:251], v7, s[36:39], s51 offen offset:2048 sc1
    v_mfma_f32_16x16x32_bf16 v[120:123], v[208:211], a[100:103], v[120:123]
    v_mfma_f32_16x16x32_bf16 v[156:159], v[208:211], a[104:107], v[156:159]
    ds_read_b64_tr_b16 v[236:237], v11 offset:27904
    v_mfma_f32_16x16x32_bf16 v[156:159], v[212:215], a[120:123], v[156:159]
    ds_read_b64_tr_b16 v[238:239], v11 offset:32512
    v_mfma_f32_16x16x32_bf16 v[192:195], v[212:215], a[124:127], v[192:195]
    buffer_load_dwordx4 a[252:255], v7, s[36:39], s51 offen offset:3072 sc1
    v_mfma_f32_16x16x32_bf16 v[192:195], v[208:211], a[108:111], v[192:195]
    s_add_u32 s51, s62, 16384
    s_waitcnt lgkmcnt(8)
    v_mfma_f32_16x16x32_bf16 v[88:91], v[216:219], a[96:99], v[88:91]
    v_mfma_f32_16x16x32_bf16 v[88:91], v[220:223], a[112:115], v[88:91]
    v_mfma_f32_16x16x32_bf16 v[124:127], v[220:223], a[116:119], v[124:127]
    buffer_load_dwordx4 a[128:131], v7, s[36:39], s51 offen offset:0 sc1
    v_mfma_f32_16x16x32_bf16 v[124:127], v[216:219], a[100:103], v[124:127]
    v_mfma_f32_16x16x32_bf16 v[160:163], v[216:219], a[104:107], v[160:163]
    v_mfma_f32_16x16x32_bf16 v[160:163], v[220:223], a[120:123], v[160:163]
    v_mfma_f32_16x16x32_bf16 v[196:199], v[220:223], a[124:127], v[196:199]
    buffer_load_dwordx4 a[132:135], v7, s[36:39], s51 offen offset:1024 sc1
    v_mfma_f32_16x16x32_bf16 v[196:199], v[216:219], a[108:111], v[196:199]
    s_waitcnt lgkmcnt(0)
    s_barrier
    v_mfma_f32_16x16x32_bf16 v[92:95], v[224:227], a[96:99], v[92:95]
    ds_read_b64_tr_b16 v[208:209], v8 offset:0
    ds_read_b64_tr_b16 v[210:211], v8 offset:4608
    v_mfma_f32_16x16x32_bf16 v[92:95], v[228:231], a[112:115], v[92:95]
    ds_read_b64_tr_b16 v[212:213], v8 offset:9216
    ds_read_b64_tr_b16 v[214:215], v8 offset:13824
    v_mfma_f32_16x16x32_bf16 v[128:131], v[228:231], a[116:119], v[128:131]
    ds_read_b64_tr_b16 v[216:217], v8 offset:32
    ds_read_b64_tr_b16 v[218:219], v8 offset:4640
    v_mfma_f32_16x16x32_bf16 v[128:131], v[224:227], a[100:103], v[128:131]
    v_mfma_f32_16x16x32_bf16 v[164:167], v[224:227], a[104:107], v[164:167]
    ds_read_b64_tr_b16 v[220:221], v8 offset:9248
    v_mfma_f32_16x16x32_bf16 v[164:167], v[228:231], a[120:123], v[164:167]
    ds_read_b64_tr_b16 v[222:223], v8 offset:13856
    v_mfma_f32_16x16x32_bf16 v[200:203], v[228:231], a[124:127], v[200:203]
    buffer_load_dwordx4 a[136:139], v7, s[36:39], s51 offen offset:2048 sc1
    v_mfma_f32_16x16x32_bf16 v[200:203], v[224:227], a[108:111], v[200:203]
    v_mfma_f32_16x16x32_bf16 v[96:99], v[232:235], a[96:99], v[96:99]
    ds_read_b64_tr_b16 v[224:225], v8 offset:64
    v_mfma_f32_16x16x32_bf16 v[96:99], v[236:239], a[112:115], v[96:99]
    ds_read_b64_tr_b16 v[226:227], v8 offset:4672
    v_mfma_f32_16x16x32_bf16 v[132:135], v[236:239], a[116:119], v[132:135]
    buffer_load_dwordx4 a[140:143], v7, s[36:39], s51 offen offset:3072 sc1
    v_mfma_f32_16x16x32_bf16 v[132:135], v[232:235], a[100:103], v[132:135]
    s_add_u32 s51, s62, 20480
    v_mfma_f32_16x16x32_bf16 v[168:171], v[232:235], a[104:107], v[168:171]
    ds_read_b64_tr_b16 v[228:229], v8 offset:9280
    v_mfma_f32_16x16x32_bf16 v[168:171], v[236:239], a[120:123], v[168:171]
    ds_read_b64_tr_b16 v[230:231], v8 offset:13888
    v_mfma_f32_16x16x32_bf16 v[204:207], v[236:239], a[124:127], v[204:207]
    buffer_load_dwordx4 a[144:147], v7, s[36:39], s51 offen offset:0 sc1
    v_mfma_f32_16x16x32_bf16 v[204:207], v[232:235], a[108:111], v[204:207]
    s_waitcnt vmcnt(17) lgkmcnt(8)
    v_mfma_f32_16x16x32_bf16 v[64:67], v[208:211], a[192:195], v[64:67]
    ds_read_b64_tr_b16 v[232:233], v8 offset:96
    s_waitcnt vmcnt(13)
    v_mfma_f32_16x16x32_bf16 v[64:67], v[212:215], a[208:211], v[64:67]
    ds_read_b64_tr_b16 v[234:235], v8 offset:4704
    v_mfma_f32_16x16x32_bf16 v[100:103], v[212:215], a[212:215], v[100:103]
    buffer_load_dwordx4 a[148:151], v7, s[36:39], s51 offen offset:1024 sc1
    v_mfma_f32_16x16x32_bf16 v[100:103], v[208:211], a[196:199], v[100:103]
    v_mfma_f32_16x16x32_bf16 v[136:139], v[208:211], a[200:203], v[136:139]
    ds_read_b64_tr_b16 v[236:237], v8 offset:9312
    v_mfma_f32_16x16x32_bf16 v[136:139], v[212:215], a[216:219], v[136:139]
    ds_read_b64_tr_b16 v[238:239], v8 offset:13920
    v_mfma_f32_16x16x32_bf16 v[172:175], v[212:215], a[220:223], v[172:175]
    buffer_load_dwordx4 a[152:155], v7, s[36:39], s51 offen offset:2048 sc1
    v_mfma_f32_16x16x32_bf16 v[172:175], v[208:211], a[204:207], v[172:175]
    s_waitcnt lgkmcnt(8)
    v_mfma_f32_16x16x32_bf16 v[68:71], v[216:219], a[192:195], v[68:71]
    ds_read_b64_tr_b16 v[208:209], v8 offset:128
    v_mfma_f32_16x16x32_bf16 v[68:71], v[220:223], a[208:211], v[68:71]
    ds_read_b64_tr_b16 v[210:211], v8 offset:4736
    v_mfma_f32_16x16x32_bf16 v[104:107], v[220:223], a[212:215], v[104:107]
    buffer_load_dwordx4 a[156:159], v7, s[36:39], s51 offen offset:3072 sc1
    v_mfma_f32_16x16x32_bf16 v[104:107], v[216:219], a[196:199], v[104:107]
    s_add_u32 s51, s62, 24576
    v_mfma_f32_16x16x32_bf16 v[140:143], v[216:219], a[200:203], v[140:143]
    ds_read_b64_tr_b16 v[212:213], v8 offset:9344
    v_mfma_f32_16x16x32_bf16 v[140:143], v[220:223], a[216:219], v[140:143]
    ds_read_b64_tr_b16 v[214:215], v8 offset:13952
    v_mfma_f32_16x16x32_bf16 v[176:179], v[220:223], a[220:223], v[176:179]
    buffer_load_dwordx4 a[160:163], v7, s[36:39], s51 offen offset:0 sc1
    v_mfma_f32_16x16x32_bf16 v[176:179], v[216:219], a[204:207], v[176:179]
    s_waitcnt lgkmcnt(8)
    v_mfma_f32_16x16x32_bf16 v[72:75], v[224:227], a[192:195], v[72:75]
    ds_read_b64_tr_b16 v[216:217], v8 offset:160
    v_mfma_f32_16x16x32_bf16 v[72:75], v[228:231], a[208:211], v[72:75]
    ds_read_b64_tr_b16 v[218:219], v8 offset:4768
    v_mfma_f32_16x16x32_bf16 v[108:111], v[228:231], a[212:215], v[108:111]
    v_mfma_f32_16x16x32_bf16 v[108:111], v[224:227], a[196:199], v[108:111]
    v_mfma_f32_16x16x32_bf16 v[144:147], v[224:227], a[200:203], v[144:147]
    ds_read_b64_tr_b16 v[220:221], v8 offset:9376
    v_mfma_f32_16x16x32_bf16 v[144:147], v[228:231], a[216:219], v[144:147]
    ds_read_b64_tr_b16 v[222:223], v8 offset:13984
    v_mfma_f32_16x16x32_bf16 v[180:183], v[228:231], a[220:223], v[180:183]
    buffer_load_dwordx4 a[164:167], v7, s[36:39], s51 offen offset:1024 sc1
    v_mfma_f32_16x16x32_bf16 v[180:183], v[224:227], a[204:207], v[180:183]
    s_waitcnt lgkmcnt(8)
    v_mfma_f32_16x16x32_bf16 v[76:79], v[232:235], a[192:195], v[76:79]
    ds_read_b64_tr_b16 v[224:225], v8 offset:192
    v_mfma_f32_16x16x32_bf16 v[76:79], v[236:239], a[208:211], v[76:79]
    ds_read_b64_tr_b16 v[226:227], v8 offset:4800
    v_mfma_f32_16x16x32_bf16 v[112:115], v[236:239], a[212:215], v[112:115]
    buffer_load_dwordx4 a[168:171], v7, s[36:39], s51 offen offset:2048 sc1
    v_mfma_f32_16x16x32_bf16 v[112:115], v[232:235], a[196:199], v[112:115]
    v_mfma_f32_16x16x32_bf16 v[148:151], v[232:235], a[200:203], v[148:151]
    ds_read_b64_tr_b16 v[228:229], v8 offset:9408
    v_mfma_f32_16x16x32_bf16 v[148:151], v[236:239], a[216:219], v[148:151]
    ds_read_b64_tr_b16 v[230:231], v8 offset:14016
    v_mfma_f32_16x16x32_bf16 v[184:187], v[236:239], a[220:223], v[184:187]
    buffer_load_dwordx4 a[172:175], v7, s[36:39], s51 offen offset:3072 sc1
    v_mfma_f32_16x16x32_bf16 v[184:187], v[232:235], a[204:207], v[184:187]
    s_add_u32 s51, s62, 28672
    s_waitcnt lgkmcnt(8)
    v_mfma_f32_16x16x32_bf16 v[80:83], v[208:211], a[192:195], v[80:83]
    ds_read_b64_tr_b16 v[232:233], v8 offset:224
    v_mfma_f32_16x16x32_bf16 v[80:83], v[212:215], a[208:211], v[80:83]
    ds_read_b64_tr_b16 v[234:235], v8 offset:4832
    v_mfma_f32_16x16x32_bf16 v[116:119], v[212:215], a[212:215], v[116:119]
    buffer_load_dwordx4 a[176:179], v7, s[36:39], s51 offen offset:0 sc1
    v_mfma_f32_16x16x32_bf16 v[116:119], v[208:211], a[196:199], v[116:119]
    v_mfma_f32_16x16x32_bf16 v[152:155], v[208:211], a[200:203], v[152:155]
    ds_read_b64_tr_b16 v[236:237], v8 offset:9440
    v_mfma_f32_16x16x32_bf16 v[152:155], v[212:215], a[216:219], v[152:155]
    ds_read_b64_tr_b16 v[238:239], v8 offset:14048
    v_mfma_f32_16x16x32_bf16 v[188:191], v[212:215], a[220:223], v[188:191]
    buffer_load_dwordx4 a[180:183], v7, s[36:39], s51 offen offset:1024 sc1
    v_mfma_f32_16x16x32_bf16 v[188:191], v[208:211], a[204:207], v[188:191]
    s_waitcnt lgkmcnt(8)
    v_mfma_f32_16x16x32_bf16 v[84:87], v[216:219], a[192:195], v[84:87]
    ds_read_b64_tr_b16 v[208:209], v8 offset:256
    v_mfma_f32_16x16x32_bf16 v[84:87], v[220:223], a[208:211], v[84:87]
    ds_read_b64_tr_b16 v[210:211], v8 offset:4864
    v_mfma_f32_16x16x32_bf16 v[120:123], v[220:223], a[212:215], v[120:123]
    buffer_load_dwordx4 a[184:187], v7, s[36:39], s51 offen offset:2048 sc1
    v_mfma_f32_16x16x32_bf16 v[120:123], v[216:219], a[196:199], v[120:123]
    v_mfma_f32_16x16x32_bf16 v[156:159], v[216:219], a[200:203], v[156:159]
    ds_read_b64_tr_b16 v[212:213], v8 offset:9472
    v_mfma_f32_16x16x32_bf16 v[156:159], v[220:223], a[216:219], v[156:159]
    ds_read_b64_tr_b16 v[214:215], v8 offset:14080
    v_mfma_f32_16x16x32_bf16 v[192:195], v[220:223], a[220:223], v[192:195]
    buffer_load_dwordx4 a[188:191], v7, s[36:39], s51 offen offset:3072 sc1
    v_mfma_f32_16x16x32_bf16 v[192:195], v[216:219], a[204:207], v[192:195]
    s_waitcnt lgkmcnt(8)
    v_mfma_f32_16x16x32_bf16 v[88:91], v[224:227], a[192:195], v[88:91]
    ds_read_b64_tr_b16 v[216:217], v8 offset:18432
    v_mfma_f32_16x16x32_bf16 v[88:91], v[228:231], a[208:211], v[88:91]
    ds_read_b64_tr_b16 v[218:219], v8 offset:23040
    v_mfma_f32_16x16x32_bf16 v[124:127], v[228:231], a[212:215], v[124:127]
    v_mfma_f32_16x16x32_bf16 v[124:127], v[224:227], a[196:199], v[124:127]
    s_add_u32 s50, s52, 294912
    s_add_u32 m0, s49, 73728
    v_mfma_f32_16x16x32_bf16 v[160:163], v[224:227], a[200:203], v[160:163]
    ds_read_b64_tr_b16 v[220:221], v8 offset:27648
    v_mfma_f32_16x16x32_bf16 v[160:163], v[228:231], a[216:219], v[160:163]
    ds_read_b64_tr_b16 v[222:223], v8 offset:32256
    v_mfma_f32_16x16x32_bf16 v[196:199], v[228:231], a[220:223], v[196:199]
    buffer_load_dwordx4 v52, s[8:11], s50 offen lds
    v_mfma_f32_16x16x32_bf16 v[196:199], v[224:227], a[204:207], v[196:199]
    s_add_u32 m0, s49, 74752
    s_waitcnt lgkmcnt(8)
    v_mfma_f32_16x16x32_bf16 v[92:95], v[232:235], a[192:195], v[92:95]
    ds_read_b64_tr_b16 v[224:225], v8 offset:18464
    v_mfma_f32_16x16x32_bf16 v[92:95], v[236:239], a[208:211], v[92:95]
    ds_read_b64_tr_b16 v[226:227], v8 offset:23072
    v_mfma_f32_16x16x32_bf16 v[128:131], v[236:239], a[212:215], v[128:131]
    buffer_load_dwordx4 v53, s[8:11], s50 offen lds
    v_mfma_f32_16x16x32_bf16 v[128:131], v[232:235], a[196:199], v[128:131]
    s_add_u32 m0, s49, 75776
    v_mfma_f32_16x16x32_bf16 v[164:167], v[232:235], a[200:203], v[164:167]
    ds_read_b64_tr_b16 v[228:229], v8 offset:27680
    v_mfma_f32_16x16x32_bf16 v[164:167], v[236:239], a[216:219], v[164:167]
    ds_read_b64_tr_b16 v[230:231], v8 offset:32288
    v_mfma_f32_16x16x32_bf16 v[200:203], v[236:239], a[220:223], v[200:203]
    buffer_load_dwordx4 v54, s[8:11], s50 offen lds
    v_mfma_f32_16x16x32_bf16 v[200:203], v[232:235], a[204:207], v[200:203]
    s_add_u32 m0, s49, 76800
    s_waitcnt lgkmcnt(8)
    v_mfma_f32_16x16x32_bf16 v[96:99], v[208:211], a[192:195], v[96:99]
    ds_read_b64_tr_b16 v[232:233], v8 offset:18496
    v_mfma_f32_16x16x32_bf16 v[96:99], v[212:215], a[208:211], v[96:99]
    ds_read_b64_tr_b16 v[234:235], v8 offset:23104
    v_mfma_f32_16x16x32_bf16 v[132:135], v[212:215], a[212:215], v[132:135]
    buffer_load_dwordx4 v55, s[8:11], s50 offen lds
    v_mfma_f32_16x16x32_bf16 v[132:135], v[208:211], a[196:199], v[132:135]
    s_add_u32 m0, s49, 77824
    v_mfma_f32_16x16x32_bf16 v[168:171], v[208:211], a[200:203], v[168:171]
    ds_read_b64_tr_b16 v[236:237], v8 offset:27712
    v_mfma_f32_16x16x32_bf16 v[168:171], v[212:215], a[216:219], v[168:171]
    ds_read_b64_tr_b16 v[238:239], v8 offset:32320
    v_mfma_f32_16x16x32_bf16 v[204:207], v[212:215], a[220:223], v[204:207]
    buffer_load_dwordx4 v56, s[8:11], s50 offen lds
    v_mfma_f32_16x16x32_bf16 v[204:207], v[208:211], a[204:207], v[204:207]
    s_add_u32 m0, s49, 78848
    s_waitcnt vmcnt(25) lgkmcnt(8)
    v_mfma_f32_16x16x32_bf16 v[64:67], v[216:219], a[224:227], v[64:67]
    ds_read_b64_tr_b16 v[208:209], v8 offset:18528
    s_waitcnt vmcnt(21)
    v_mfma_f32_16x16x32_bf16 v[64:67], v[220:223], a[240:243], v[64:67]
    ds_read_b64_tr_b16 v[210:211], v8 offset:23136
    v_mfma_f32_16x16x32_bf16 v[100:103], v[220:223], a[244:247], v[100:103]
    buffer_load_dwordx4 v57, s[8:11], s50 offen lds
    v_mfma_f32_16x16x32_bf16 v[100:103], v[216:219], a[228:231], v[100:103]
    s_add_u32 m0, s49, 79872
    v_mfma_f32_16x16x32_bf16 v[136:139], v[216:219], a[232:235], v[136:139]
    ds_read_b64_tr_b16 v[212:213], v8 offset:27744
    v_mfma_f32_16x16x32_bf16 v[136:139], v[220:223], a[248:251], v[136:139]
    ds_read_b64_tr_b16 v[214:215], v8 offset:32352
    v_mfma_f32_16x16x32_bf16 v[172:175], v[220:223], a[252:255], v[172:175]
    buffer_load_dwordx4 v58, s[8:11], s50 offen lds
    v_mfma_f32_16x16x32_bf16 v[172:175], v[216:219], a[236:239], v[172:175]
    s_waitcnt lgkmcnt(8)
    v_mfma_f32_16x16x32_bf16 v[68:71], v[224:227], a[224:227], v[68:71]
    ds_read_b64_tr_b16 v[216:217], v8 offset:18560
    v_mfma_f32_16x16x32_bf16 v[68:71], v[228:231], a[240:243], v[68:71]
    ds_read_b64_tr_b16 v[218:219], v8 offset:23168
    v_mfma_f32_16x16x32_bf16 v[104:107], v[228:231], a[244:247], v[104:107]
    v_mfma_f32_16x16x32_bf16 v[104:107], v[224:227], a[228:231], v[104:107]
    s_add_u32 m0, s49, 80896
    v_mfma_f32_16x16x32_bf16 v[140:143], v[224:227], a[232:235], v[140:143]
    ds_read_b64_tr_b16 v[220:221], v8 offset:27776
    v_mfma_f32_16x16x32_bf16 v[140:143], v[228:231], a[248:251], v[140:143]
    ds_read_b64_tr_b16 v[222:223], v8 offset:32384
    v_mfma_f32_16x16x32_bf16 v[176:179], v[228:231], a[252:255], v[176:179]
    buffer_load_dwordx4 v59, s[8:11], s50 offen lds
    v_mfma_f32_16x16x32_bf16 v[176:179], v[224:227], a[236:239], v[176:179]
    s_add_u32 m0, s49, 81920
    s_waitcnt lgkmcnt(8)
    v_mfma_f32_16x16x32_bf16 v[72:75], v[232:235], a[224:227], v[72:75]
    ds_read_b64_tr_b16 v[224:225], v8 offset:18592
    v_mfma_f32_16x16x32_bf16 v[72:75], v[236:239], a[240:243], v[72:75]
    ds_read_b64_tr_b16 v[226:227], v8 offset:23200
    v_mfma_f32_16x16x32_bf16 v[108:111], v[236:239], a[244:247], v[108:111]
    buffer_load_dwordx4 v60, s[8:11], s50 offen lds
    v_mfma_f32_16x16x32_bf16 v[108:111], v[232:235], a[228:231], v[108:111]
    s_add_u32 s51, s62, 32768
    v_mfma_f32_16x16x32_bf16 v[144:147], v[232:235], a[232:235], v[144:147]
    ds_read_b64_tr_b16 v[228:229], v8 offset:27808
    v_mfma_f32_16x16x32_bf16 v[144:147], v[236:239], a[248:251], v[144:147]
    ds_read_b64_tr_b16 v[230:231], v8 offset:32416
    v_mfma_f32_16x16x32_bf16 v[180:183], v[236:239], a[252:255], v[180:183]
    buffer_load_dwordx4 a[0:3], v7, s[36:39], s51 offen offset:0 sc1
    v_mfma_f32_16x16x32_bf16 v[180:183], v[232:235], a[236:239], v[180:183]
    s_waitcnt lgkmcnt(8)
    v_mfma_f32_16x16x32_bf16 v[76:79], v[208:211], a[224:227], v[76:79]
    ds_read_b64_tr_b16 v[232:233], v8 offset:18624
    v_mfma_f32_16x16x32_bf16 v[76:79], v[212:215], a[240:243], v[76:79]
    ds_read_b64_tr_b16 v[234:235], v8 offset:23232
    v_mfma_f32_16x16x32_bf16 v[112:115], v[212:215], a[244:247], v[112:115]
    buffer_load_dwordx4 a[4:7], v7, s[36:39], s51 offen offset:1024 sc1
    v_mfma_f32_16x16x32_bf16 v[112:115], v[208:211], a[228:231], v[112:115]
    v_mfma_f32_16x16x32_bf16 v[148:151], v[208:211], a[232:235], v[148:151]
    ds_read_b64_tr_b16 v[236:237], v8 offset:27840
    v_mfma_f32_16x16x32_bf16 v[148:151], v[212:215], a[248:251], v[148:151]
    ds_read_b64_tr_b16 v[238:239], v8 offset:32448
    v_mfma_f32_16x16x32_bf16 v[184:187], v[212:215], a[252:255], v[184:187]
    buffer_load_dwordx4 a[8:11], v7, s[36:39], s51 offen offset:2048 sc1
    v_mfma_f32_16x16x32_bf16 v[184:187], v[208:211], a[236:239], v[184:187]
    s_waitcnt lgkmcnt(8)
    v_mfma_f32_16x16x32_bf16 v[80:83], v[216:219], a[224:227], v[80:83]
    ds_read_b64_tr_b16 v[208:209], v8 offset:18656
    v_mfma_f32_16x16x32_bf16 v[80:83], v[220:223], a[240:243], v[80:83]
    ds_read_b64_tr_b16 v[210:211], v8 offset:23264
    v_mfma_f32_16x16x32_bf16 v[116:119], v[220:223], a[244:247], v[116:119]
    buffer_load_dwordx4 a[12:15], v7, s[36:39], s51 offen offset:3072 sc1
    v_mfma_f32_16x16x32_bf16 v[116:119], v[216:219], a[228:231], v[116:119]
    s_add_u32 s51, s62, 36864
    v_mfma_f32_16x16x32_bf16 v[152:155], v[216:219], a[232:235], v[152:155]
    ds_read_b64_tr_b16 v[212:213], v8 offset:27872
    v_mfma_f32_16x16x32_bf16 v[152:155], v[220:223], a[248:251], v[152:155]
    ds_read_b64_tr_b16 v[214:215], v8 offset:32480
    v_mfma_f32_16x16x32_bf16 v[188:191], v[220:223], a[252:255], v[188:191]
    buffer_load_dwordx4 a[16:19], v7, s[36:39], s51 offen offset:0 sc1
    v_mfma_f32_16x16x32_bf16 v[188:191], v[216:219], a[236:239], v[188:191]
    s_waitcnt lgkmcnt(8)
    v_mfma_f32_16x16x32_bf16 v[84:87], v[224:227], a[224:227], v[84:87]
    ds_read_b64_tr_b16 v[216:217], v8 offset:18688
    v_mfma_f32_16x16x32_bf16 v[84:87], v[228:231], a[240:243], v[84:87]
    ds_read_b64_tr_b16 v[218:219], v8 offset:23296
    v_mfma_f32_16x16x32_bf16 v[120:123], v[228:231], a[244:247], v[120:123]
    v_mfma_f32_16x16x32_bf16 v[120:123], v[224:227], a[228:231], v[120:123]
    v_mfma_f32_16x16x32_bf16 v[156:159], v[224:227], a[232:235], v[156:159]
    ds_read_b64_tr_b16 v[220:221], v8 offset:27904
    v_mfma_f32_16x16x32_bf16 v[156:159], v[228:231], a[248:251], v[156:159]
    ds_read_b64_tr_b16 v[222:223], v8 offset:32512
    v_mfma_f32_16x16x32_bf16 v[192:195], v[228:231], a[252:255], v[192:195]
    buffer_load_dwordx4 a[20:23], v7, s[36:39], s51 offen offset:1024 sc1
    v_mfma_f32_16x16x32_bf16 v[192:195], v[224:227], a[236:239], v[192:195]
    s_waitcnt lgkmcnt(8)
    v_mfma_f32_16x16x32_bf16 v[88:91], v[232:235], a[224:227], v[88:91]
    v_mfma_f32_16x16x32_bf16 v[88:91], v[236:239], a[240:243], v[88:91]
    v_mfma_f32_16x16x32_bf16 v[124:127], v[236:239], a[244:247], v[124:127]
    buffer_load_dwordx4 a[24:27], v7, s[36:39], s51 offen offset:2048 sc1
    v_mfma_f32_16x16x32_bf16 v[124:127], v[232:235], a[228:231], v[124:127]
    v_mfma_f32_16x16x32_bf16 v[160:163], v[232:235], a[232:235], v[160:163]
    v_mfma_f32_16x16x32_bf16 v[160:163], v[236:239], a[248:251], v[160:163]
    v_mfma_f32_16x16x32_bf16 v[196:199], v[236:239], a[252:255], v[196:199]
    buffer_load_dwordx4 a[28:31], v7, s[36:39], s51 offen offset:3072 sc1
    v_mfma_f32_16x16x32_bf16 v[196:199], v[232:235], a[236:239], v[196:199]
    s_waitcnt lgkmcnt(0)
    s_barrier
    v_mfma_f32_16x16x32_bf16 v[92:95], v[208:211], a[224:227], v[92:95]
    ds_read_b64_tr_b16 v[224:225], v9 offset:0
    ds_read_b64_tr_b16 v[226:227], v9 offset:4608
    v_mfma_f32_16x16x32_bf16 v[92:95], v[212:215], a[240:243], v[92:95]
    ds_read_b64_tr_b16 v[228:229], v9 offset:9216
    ds_read_b64_tr_b16 v[230:231], v9 offset:13824
    v_mfma_f32_16x16x32_bf16 v[128:131], v[212:215], a[244:247], v[128:131]
    ds_read_b64_tr_b16 v[232:233], v9 offset:32
    ds_read_b64_tr_b16 v[234:235], v9 offset:4640
    v_mfma_f32_16x16x32_bf16 v[128:131], v[208:211], a[228:231], v[128:131]
    s_add_u32 s50, s52, 442368
    s_add_u32 m0, s49, 110592
    v_mfma_f32_16x16x32_bf16 v[164:167], v[208:211], a[232:235], v[164:167]
    ds_read_b64_tr_b16 v[236:237], v9 offset:9248
    v_mfma_f32_16x16x32_bf16 v[164:167], v[212:215], a[248:251], v[164:167]
    ds_read_b64_tr_b16 v[238:239], v9 offset:13856
    v_mfma_f32_16x16x32_bf16 v[200:203], v[212:215], a[252:255], v[200:203]
    buffer_load_dwordx4 v52, s[8:11], s50 offen lds
    v_mfma_f32_16x16x32_bf16 v[200:203], v[208:211], a[236:239], v[200:203]
    s_add_u32 m0, s49, 111616
    v_mfma_f32_16x16x32_bf16 v[96:99], v[216:219], a[224:227], v[96:99]
    ds_read_b64_tr_b16 v[208:209], v9 offset:64
    v_mfma_f32_16x16x32_bf16 v[96:99], v[220:223], a[240:243], v[96:99]
    ds_read_b64_tr_b16 v[210:211], v9 offset:4672
    v_mfma_f32_16x16x32_bf16 v[132:135], v[220:223], a[244:247], v[132:135]
    buffer_load_dwordx4 v53, s[8:11], s50 offen lds
    v_mfma_f32_16x16x32_bf16 v[132:135], v[216:219], a[228:231], v[132:135]
    s_add_u32 m0, s49, 112640
    v_mfma_f32_16x16x32_bf16 v[168:171], v[216:219], a[232:235], v[168:171]
    ds_read_b64_tr_b16 v[212:213], v9 offset:9280
    v_mfma_f32_16x16x32_bf16 v[168:171], v[220:223], a[248:251], v[168:171]
    ds_read_b64_tr_b16 v[214:215], v9 offset:13888
    v_mfma_f32_16x16x32_bf16 v[204:207], v[220:223], a[252:255], v[204:207]
    buffer_load_dwordx4 v54, s[8:11], s50 offen lds
    v_mfma_f32_16x16x32_bf16 v[204:207], v[216:219], a[236:239], v[204:207]
    s_add_u32 m0, s49, 113664
    s_waitcnt vmcnt(32) lgkmcnt(8)
    v_mfma_f32_16x16x32_bf16 v[64:67], v[224:227], a[128:131], v[64:67]
    ds_read_b64_tr_b16 v[216:217], v9 offset:96
    s_waitcnt vmcnt(28)
    v_mfma_f32_16x16x32_bf16 v[64:67], v[228:231], a[144:147], v[64:67]
    ds_read_b64_tr_b16 v[218:219], v9 offset:4704
    v_mfma_f32_16x16x32_bf16 v[100:103], v[228:231], a[148:151], v[100:103]
    buffer_load_dwordx4 v55, s[8:11], s50 offen lds
    v_mfma_f32_16x16x32_bf16 v[100:103], v[224:227], a[132:135], v[100:103]
    s_add_u32 m0, s49, 114688
    v_mfma_f32_16x16x32_bf16 v[136:139], v[224:227], a[136:139], v[136:139]
    ds_read_b64_tr_b16 v[220:221], v9 offset:9312
    v_mfma_f32_16x16x32_bf16 v[136:139], v[228:231], a[152:155], v[136:139]
    ds_read_b64_tr_b16 v[222:223], v9 offset:13920
    v_mfma_f32_16x16x32_bf16 v[172:175], v[228:231], a[156:159], v[172:175]
    buffer_load_dwordx4 v56, s[8:11], s50 offen lds
    v_mfma_f32_16x16x32_bf16 v[172:175], v[224:227], a[140:143], v[172:175]
    s_add_u32 m0, s49, 115712
    s_waitcnt lgkmcnt(8)
    v_mfma_f32_16x16x32_bf16 v[68:71], v[232:235], a[128:131], v[68:71]
    ds_read_b64_tr_b16 v[224:225], v9 offset:128
    v_mfma_f32_16x16x32_bf16 v[68:71], v[236:239], a[144:147], v[68:71]
    ds_read_b64_tr_b16 v[226:227], v9 offset:4736
    v_mfma_f32_16x16x32_bf16 v[104:107], v[236:239], a[148:151], v[104:107]
    buffer_load_dwordx4 v57, s[8:11], s50 offen lds
    v_mfma_f32_16x16x32_bf16 v[104:107], v[232:235], a[132:135], v[104:107]
    s_add_u32 m0, s49, 116736
    v_mfma_f32_16x16x32_bf16 v[140:143], v[232:235], a[136:139], v[140:143]
    ds_read_b64_tr_b16 v[228:229], v9 offset:9344
    v_mfma_f32_16x16x32_bf16 v[140:143], v[236:239], a[152:155], v[140:143]
    ds_read_b64_tr_b16 v[230:231], v9 offset:13952
    v_mfma_f32_16x16x32_bf16 v[176:179], v[236:239], a[156:159], v[176:179]
    buffer_load_dwordx4 v58, s[8:11], s50 offen lds
    v_mfma_f32_16x16x32_bf16 v[176:179], v[232:235], a[140:143], v[176:179]
    s_waitcnt lgkmcnt(8)
    v_mfma_f32_16x16x32_bf16 v[72:75], v[208:211], a[128:131], v[72:75]
    ds_read_b64_tr_b16 v[232:233], v9 offset:160
    v_mfma_f32_16x16x32_bf16 v[72:75], v[212:215], a[144:147], v[72:75]
    ds_read_b64_tr_b16 v[234:235], v9 offset:4768
    v_mfma_f32_16x16x32_bf16 v[108:111], v[212:215], a[148:151], v[108:111]
    v_mfma_f32_16x16x32_bf16 v[108:111], v[208:211], a[132:135], v[108:111]
    s_add_u32 m0, s49, 117760
    v_mfma_f32_16x16x32_bf16 v[144:147], v[208:211], a[136:139], v[144:147]
    ds_read_b64_tr_b16 v[236:237], v9 offset:9376
    v_mfma_f32_16x16x32_bf16 v[144:147], v[212:215], a[152:155], v[144:147]
    ds_read_b64_tr_b16 v[238:239], v9 offset:13984
    v_mfma_f32_16x16x32_bf16 v[180:183], v[212:215], a[156:159], v[180:183]
    buffer_load_dwordx4 v59, s[8:11], s50 offen lds
    v_mfma_f32_16x16x32_bf16 v[180:183], v[208:211], a[140:143], v[180:183]
    s_add_u32 m0, s49, 118784
    s_waitcnt lgkmcnt(8)
    v_mfma_f32_16x16x32_bf16 v[76:79], v[216:219], a[128:131], v[76:79]
    ds_read_b64_tr_b16 v[208:209], v9 offset:192
    v_mfma_f32_16x16x32_bf16 v[76:79], v[220:223], a[144:147], v[76:79]
    ds_read_b64_tr_b16 v[210:211], v9 offset:4800
    v_mfma_f32_16x16x32_bf16 v[112:115], v[220:223], a[148:151], v[112:115]
    buffer_load_dwordx4 v60, s[8:11], s50 offen lds
    v_mfma_f32_16x16x32_bf16 v[112:115], v[216:219], a[132:135], v[112:115]
    s_add_u32 s51, s62, 40960
    v_mfma_f32_16x16x32_bf16 v[148:151], v[216:219], a[136:139], v[148:151]
    ds_read_b64_tr_b16 v[212:213], v9 offset:9408
    v_mfma_f32_16x16x32_bf16 v[148:151], v[220:223], a[152:155], v[148:151]
    ds_read_b64_tr_b16 v[214:215], v9 offset:14016
    v_mfma_f32_16x16x32_bf16 v[184:187], v[220:223], a[156:159], v[184:187]
    buffer_load_dwordx4 a[32:35], v7, s[36:39], s51 offen offset:0 sc1
    v_mfma_f32_16x16x32_bf16 v[184:187], v[216:219], a[140:143], v[184:187]
    s_waitcnt lgkmcnt(8)
    v_mfma_f32_16x16x32_bf16 v[80:83], v[224:227], a[128:131], v[80:83]
    ds_read_b64_tr_b16 v[216:217], v9 offset:224
    v_mfma_f32_16x16x32_bf16 v[80:83], v[228:231], a[144:147], v[80:83]
    ds_read_b64_tr_b16 v[218:219], v9 offset:4832
    v_mfma_f32_16x16x32_bf16 v[116:119], v[228:231], a[148:151], v[116:119]
    buffer_load_dwordx4 a[36:39], v7, s[36:39], s51 offen offset:1024 sc1
    v_mfma_f32_16x16x32_bf16 v[116:119], v[224:227], a[132:135], v[116:119]
    v_mfma_f32_16x16x32_bf16 v[152:155], v[224:227], a[136:139], v[152:155]
    ds_read_b64_tr_b16 v[220:221], v9 offset:9440
    v_mfma_f32_16x16x32_bf16 v[152:155], v[228:231], a[152:155], v[152:155]
    ds_read_b64_tr_b16 v[222:223], v9 offset:14048
    v_mfma_f32_16x16x32_bf16 v[188:191], v[228:231], a[156:159], v[188:191]
    buffer_load_dwordx4 a[40:43], v7, s[36:39], s51 offen offset:2048 sc1
    v_mfma_f32_16x16x32_bf16 v[188:191], v[224:227], a[140:143], v[188:191]
    s_waitcnt lgkmcnt(8)
    v_mfma_f32_16x16x32_bf16 v[84:87], v[232:235], a[128:131], v[84:87]
    ds_read_b64_tr_b16 v[224:225], v9 offset:256
    v_mfma_f32_16x16x32_bf16 v[84:87], v[236:239], a[144:147], v[84:87]
    ds_read_b64_tr_b16 v[226:227], v9 offset:4864
    v_mfma_f32_16x16x32_bf16 v[120:123], v[236:239], a[148:151], v[120:123]
    buffer_load_dword v247, v246, s[24:27], 0 offen
    v_mfma_f32_16x16x32_bf16 v[120:123], v[232:235], a[132:135], v[120:123]
    v_mfma_f32_16x16x32_bf16 v[156:159], v[232:235], a[136:139], v[156:159]
    ds_read_b64_tr_b16 v[228:229], v9 offset:9472
    v_mfma_f32_16x16x32_bf16 v[156:159], v[236:239], a[152:155], v[156:159]
    ds_read_b64_tr_b16 v[230:231], v9 offset:14080
    v_mfma_f32_16x16x32_bf16 v[192:195], v[236:239], a[156:159], v[192:195]
    buffer_load_dwordx4 a[44:47], v7, s[36:39], s51 offen offset:3072 sc1
    v_mfma_f32_16x16x32_bf16 v[192:195], v[232:235], a[140:143], v[192:195]
    s_waitcnt lgkmcnt(8)
    v_mfma_f32_16x16x32_bf16 v[88:91], v[208:211], a[128:131], v[88:91]
    ds_read_b64_tr_b16 v[232:233], v9 offset:18432
    v_mfma_f32_16x16x32_bf16 v[88:91], v[212:215], a[144:147], v[88:91]
    ds_read_b64_tr_b16 v[234:235], v9 offset:23040
    v_mfma_f32_16x16x32_bf16 v[124:127], v[212:215], a[148:151], v[124:127]
    v_mfma_f32_16x16x32_bf16 v[124:127], v[208:211], a[132:135], v[124:127]
    s_add_u32 s51, s62, 45056
    v_mfma_f32_16x16x32_bf16 v[160:163], v[208:211], a[136:139], v[160:163]
    ds_read_b64_tr_b16 v[236:237], v9 offset:27648
    v_mfma_f32_16x16x32_bf16 v[160:163], v[212:215], a[152:155], v[160:163]
    ds_read_b64_tr_b16 v[238:239], v9 offset:32256
    v_mfma_f32_16x16x32_bf16 v[196:199], v[212:215], a[156:159], v[196:199]
    buffer_load_dwordx4 a[48:51], v7, s[36:39], s51 offen offset:0 sc1
    v_mfma_f32_16x16x32_bf16 v[196:199], v[208:211], a[140:143], v[196:199]
    s_waitcnt lgkmcnt(8)
    v_mfma_f32_16x16x32_bf16 v[92:95], v[216:219], a[128:131], v[92:95]
    ds_read_b64_tr_b16 v[208:209], v9 offset:18464
    v_mfma_f32_16x16x32_bf16 v[92:95], v[220:223], a[144:147], v[92:95]
    ds_read_b64_tr_b16 v[210:211], v9 offset:23072
    v_mfma_f32_16x16x32_bf16 v[128:131], v[220:223], a[148:151], v[128:131]
    buffer_load_dwordx4 a[52:55], v7, s[36:39], s51 offen offset:1024 sc1
    v_mfma_f32_16x16x32_bf16 v[128:131], v[216:219], a[132:135], v[128:131]
    v_mfma_f32_16x16x32_bf16 v[164:167], v[216:219], a[136:139], v[164:167]
    ds_read_b64_tr_b16 v[212:213], v9 offset:27680
    v_mfma_f32_16x16x32_bf16 v[164:167], v[220:223], a[152:155], v[164:167]
    ds_read_b64_tr_b16 v[214:215], v9 offset:32288
    v_mfma_f32_16x16x32_bf16 v[200:203], v[220:223], a[156:159], v[200:203]
    buffer_load_dwordx4 a[56:59], v7, s[36:39], s51 offen offset:2048 sc1
    v_mfma_f32_16x16x32_bf16 v[200:203], v[216:219], a[140:143], v[200:203]
    s_waitcnt lgkmcnt(8)
    v_mfma_f32_16x16x32_bf16 v[96:99], v[224:227], a[128:131], v[96:99]
    ds_read_b64_tr_b16 v[216:217], v9 offset:18496
    v_mfma_f32_16x16x32_bf16 v[96:99], v[228:231], a[144:147], v[96:99]
    ds_read_b64_tr_b16 v[218:219], v9 offset:23104
    v_mfma_f32_16x16x32_bf16 v[132:135], v[228:231], a[148:151], v[132:135]
    buffer_load_dwordx4 a[60:63], v7, s[36:39], s51 offen offset:3072 sc1
    v_mfma_f32_16x16x32_bf16 v[132:135], v[224:227], a[132:135], v[132:135]
    s_add_u32 s51, s62, 49152
    v_mfma_f32_16x16x32_bf16 v[168:171], v[224:227], a[136:139], v[168:171]
    ds_read_b64_tr_b16 v[220:221], v9 offset:27712
    v_mfma_f32_16x16x32_bf16 v[168:171], v[228:231], a[152:155], v[168:171]
    ds_read_b64_tr_b16 v[222:223], v9 offset:32320
    v_mfma_f32_16x16x32_bf16 v[204:207], v[228:231], a[156:159], v[204:207]
    buffer_load_dwordx4 a[64:67], v7, s[36:39], s51 offen offset:0 sc1
    v_mfma_f32_16x16x32_bf16 v[204:207], v[224:227], a[140:143], v[204:207]
    s_waitcnt vmcnt(40) lgkmcnt(8)
    v_mfma_f32_16x16x32_bf16 v[64:67], v[232:235], a[160:163], v[64:67]
    ds_read_b64_tr_b16 v[224:225], v9 offset:18528
    s_waitcnt vmcnt(36)
    v_mfma_f32_16x16x32_bf16 v[64:67], v[236:239], a[176:179], v[64:67]
    ds_read_b64_tr_b16 v[226:227], v9 offset:23136
    v_mfma_f32_16x16x32_bf16 v[100:103], v[236:239], a[180:183], v[100:103]
    buffer_load_dwordx4 a[68:71], v7, s[36:39], s51 offen offset:1024 sc1
    v_mfma_f32_16x16x32_bf16 v[100:103], v[232:235], a[164:167], v[100:103]
    v_mfma_f32_16x16x32_bf16 v[136:139], v[232:235], a[168:171], v[136:139]
    ds_read_b64_tr_b16 v[228:229], v9 offset:27744
    v_mfma_f32_16x16x32_bf16 v[136:139], v[236:239], a[184:187], v[136:139]
    ds_read_b64_tr_b16 v[230:231], v9 offset:32352
    v_mfma_f32_16x16x32_bf16 v[172:175], v[236:239], a[188:191], v[172:175]
    buffer_load_dwordx4 a[72:75], v7, s[36:39], s51 offen offset:2048 sc1
    v_mfma_f32_16x16x32_bf16 v[172:175], v[232:235], a[172:175], v[172:175]
    s_waitcnt lgkmcnt(8)
    v_mfma_f32_16x16x32_bf16 v[68:71], v[208:211], a[160:163], v[68:71]
    ds_read_b64_tr_b16 v[232:233], v9 offset:18560
    v_mfma_f32_16x16x32_bf16 v[68:71], v[212:215], a[176:179], v[68:71]
    ds_read_b64_tr_b16 v[234:235], v9 offset:23168
    v_mfma_f32_16x16x32_bf16 v[104:107], v[212:215], a[180:183], v[104:107]
    v_mfma_f32_16x16x32_bf16 v[104:107], v[208:211], a[164:167], v[104:107]
    v_mfma_f32_16x16x32_bf16 v[140:143], v[208:211], a[168:171], v[140:143]
    ds_read_b64_tr_b16 v[236:237], v9 offset:27776
    v_mfma_f32_16x16x32_bf16 v[140:143], v[212:215], a[184:187], v[140:143]
    ds_read_b64_tr_b16 v[238:239], v9 offset:32384
    v_mfma_f32_16x16x32_bf16 v[176:179], v[212:215], a[188:191], v[176:179]
    buffer_load_dwordx4 a[76:79], v7, s[36:39], s51 offen offset:3072 sc1
    v_mfma_f32_16x16x32_bf16 v[176:179], v[208:211], a[172:175], v[176:179]
    s_add_u32 s51, s62, 53248
    s_waitcnt lgkmcnt(8)
    v_mfma_f32_16x16x32_bf16 v[72:75], v[216:219], a[160:163], v[72:75]
    ds_read_b64_tr_b16 v[208:209], v9 offset:18592
    v_mfma_f32_16x16x32_bf16 v[72:75], v[220:223], a[176:179], v[72:75]
    ds_read_b64_tr_b16 v[210:211], v9 offset:23200
    v_mfma_f32_16x16x32_bf16 v[108:111], v[220:223], a[180:183], v[108:111]
    buffer_load_dwordx4 a[80:83], v7, s[36:39], s51 offen offset:0 sc1
    v_mfma_f32_16x16x32_bf16 v[108:111], v[216:219], a[164:167], v[108:111]
    v_mfma_f32_16x16x32_bf16 v[144:147], v[216:219], a[168:171], v[144:147]
    ds_read_b64_tr_b16 v[212:213], v9 offset:27808
    v_mfma_f32_16x16x32_bf16 v[144:147], v[220:223], a[184:187], v[144:147]
    ds_read_b64_tr_b16 v[214:215], v9 offset:32416
    v_mfma_f32_16x16x32_bf16 v[180:183], v[220:223], a[188:191], v[180:183]
    buffer_load_dwordx4 a[84:87], v7, s[36:39], s51 offen offset:1024 sc1
    v_mfma_f32_16x16x32_bf16 v[180:183], v[216:219], a[172:175], v[180:183]
    s_waitcnt lgkmcnt(8)
    v_mfma_f32_16x16x32_bf16 v[76:79], v[224:227], a[160:163], v[76:79]
    ds_read_b64_tr_b16 v[216:217], v9 offset:18624
    v_mfma_f32_16x16x32_bf16 v[76:79], v[228:231], a[176:179], v[76:79]
    ds_read_b64_tr_b16 v[218:219], v9 offset:23232
    v_mfma_f32_16x16x32_bf16 v[112:115], v[228:231], a[180:183], v[112:115]
    buffer_load_dwordx4 a[88:91], v7, s[36:39], s51 offen offset:2048 sc1
    v_mfma_f32_16x16x32_bf16 v[112:115], v[224:227], a[164:167], v[112:115]
    v_mfma_f32_16x16x32_bf16 v[148:151], v[224:227], a[168:171], v[148:151]
    ds_read_b64_tr_b16 v[220:221], v9 offset:27840
    v_mfma_f32_16x16x32_bf16 v[148:151], v[228:231], a[184:187], v[148:151]
    ds_read_b64_tr_b16 v[222:223], v9 offset:32448
    v_mfma_f32_16x16x32_bf16 v[184:187], v[228:231], a[188:191], v[184:187]
    buffer_load_dwordx4 a[92:95], v7, s[36:39], s51 offen offset:3072 sc1
    v_mfma_f32_16x16x32_bf16 v[184:187], v[224:227], a[172:175], v[184:187]
    s_add_u32 s51, s62, 57344
    s_waitcnt lgkmcnt(8)
    v_mfma_f32_16x16x32_bf16 v[80:83], v[232:235], a[160:163], v[80:83]
    ds_read_b64_tr_b16 v[224:225], v9 offset:18656
    v_mfma_f32_16x16x32_bf16 v[80:83], v[236:239], a[176:179], v[80:83]
    ds_read_b64_tr_b16 v[226:227], v9 offset:23264
    v_mfma_f32_16x16x32_bf16 v[116:119], v[236:239], a[180:183], v[116:119]
    buffer_load_dwordx4 a[96:99], v7, s[36:39], s51 offen offset:0 sc1
    v_mfma_f32_16x16x32_bf16 v[116:119], v[232:235], a[164:167], v[116:119]
    v_mfma_f32_16x16x32_bf16 v[152:155], v[232:235], a[168:171], v[152:155]
    ds_read_b64_tr_b16 v[228:229], v9 offset:27872
    v_mfma_f32_16x16x32_bf16 v[152:155], v[236:239], a[184:187], v[152:155]
    ds_read_b64_tr_b16 v[230:231], v9 offset:32480
    v_mfma_f32_16x16x32_bf16 v[188:191], v[236:239], a[188:191], v[188:191]
    buffer_load_dwordx4 a[100:103], v7, s[36:39], s51 offen offset:1024 sc1
    v_mfma_f32_16x16x32_bf16 v[188:191], v[232:235], a[172:175], v[188:191]
    s_waitcnt lgkmcnt(8)
    v_mfma_f32_16x16x32_bf16 v[84:87], v[208:211], a[160:163], v[84:87]
    ds_read_b64_tr_b16 v[232:233], v9 offset:18688
    v_mfma_f32_16x16x32_bf16 v[84:87], v[212:215], a[176:179], v[84:87]
    ds_read_b64_tr_b16 v[234:235], v9 offset:23296
    v_mfma_f32_16x16x32_bf16 v[120:123], v[212:215], a[180:183], v[120:123]
    v_mfma_f32_16x16x32_bf16 v[120:123], v[208:211], a[164:167], v[120:123]
    v_mfma_f32_16x16x32_bf16 v[156:159], v[208:211], a[168:171], v[156:159]
    ds_read_b64_tr_b16 v[236:237], v9 offset:27904
    v_mfma_f32_16x16x32_bf16 v[156:159], v[212:215], a[184:187], v[156:159]
    ds_read_b64_tr_b16 v[238:239], v9 offset:32512
    v_mfma_f32_16x16x32_bf16 v[192:195], v[212:215], a[188:191], v[192:195]
    buffer_load_dwordx4 a[104:107], v7, s[36:39], s51 offen offset:2048 sc1
    v_mfma_f32_16x16x32_bf16 v[192:195], v[208:211], a[172:175], v[192:195]
    s_waitcnt lgkmcnt(8)
    v_mfma_f32_16x16x32_bf16 v[88:91], v[216:219], a[160:163], v[88:91]
    v_mfma_f32_16x16x32_bf16 v[88:91], v[220:223], a[176:179], v[88:91]
    v_mfma_f32_16x16x32_bf16 v[124:127], v[220:223], a[180:183], v[124:127]
    buffer_load_dwordx4 a[108:111], v7, s[36:39], s51 offen offset:3072 sc1
    v_mfma_f32_16x16x32_bf16 v[124:127], v[216:219], a[164:167], v[124:127]
    s_add_u32 s51, s62, 61440
    v_mfma_f32_16x16x32_bf16 v[160:163], v[216:219], a[168:171], v[160:163]
    v_mfma_f32_16x16x32_bf16 v[160:163], v[220:223], a[184:187], v[160:163]
    v_mfma_f32_16x16x32_bf16 v[196:199], v[220:223], a[188:191], v[196:199]
    buffer_load_dwordx4 a[112:115], v7, s[36:39], s51 offen offset:0 sc1
    v_mfma_f32_16x16x32_bf16 v[196:199], v[216:219], a[172:175], v[196:199]
    s_waitcnt vmcnt(39) lgkmcnt(0)
    s_barrier
    v_mfma_f32_16x16x32_bf16 v[92:95], v[224:227], a[160:163], v[92:95]
    ds_read_b64_tr_b16 v[208:209], v10 offset:0
    ds_read_b64_tr_b16 v[210:211], v10 offset:4608
    v_mfma_f32_16x16x32_bf16 v[92:95], v[228:231], a[176:179], v[92:95]
    ds_read_b64_tr_b16 v[212:213], v10 offset:9216
    ds_read_b64_tr_b16 v[214:215], v10 offset:13824
    v_mfma_f32_16x16x32_bf16 v[128:131], v[228:231], a[180:183], v[128:131]
    ds_read_b64_tr_b16 v[216:217], v10 offset:32
    ds_read_b64_tr_b16 v[218:219], v10 offset:4640
    v_mfma_f32_16x16x32_bf16 v[128:131], v[224:227], a[164:167], v[128:131]
    v_mfma_f32_16x16x32_bf16 v[164:167], v[224:227], a[168:171], v[164:167]
    ds_read_b64_tr_b16 v[220:221], v10 offset:9248
    v_mfma_f32_16x16x32_bf16 v[164:167], v[228:231], a[184:187], v[164:167]
    ds_read_b64_tr_b16 v[222:223], v10 offset:13856
    v_mfma_f32_16x16x32_bf16 v[200:203], v[228:231], a[188:191], v[200:203]
    buffer_load_dwordx4 a[116:119], v7, s[36:39], s51 offen offset:1024 sc1
    v_mfma_f32_16x16x32_bf16 v[200:203], v[224:227], a[172:175], v[200:203]
    v_mfma_f32_16x16x32_bf16 v[96:99], v[232:235], a[160:163], v[96:99]
    ds_read_b64_tr_b16 v[224:225], v10 offset:64
    v_mfma_f32_16x16x32_bf16 v[96:99], v[236:239], a[176:179], v[96:99]
    ds_read_b64_tr_b16 v[226:227], v10 offset:4672
    v_mfma_f32_16x16x32_bf16 v[132:135], v[236:239], a[180:183], v[132:135]
    buffer_load_dwordx4 a[120:123], v7, s[36:39], s51 offen offset:2048 sc1
    v_mfma_f32_16x16x32_bf16 v[132:135], v[232:235], a[164:167], v[132:135]
    v_mfma_f32_16x16x32_bf16 v[168:171], v[232:235], a[168:171], v[168:171]
    ds_read_b64_tr_b16 v[228:229], v10 offset:9280
    v_mfma_f32_16x16x32_bf16 v[168:171], v[236:239], a[184:187], v[168:171]
    ds_read_b64_tr_b16 v[230:231], v10 offset:13888
    v_mfma_f32_16x16x32_bf16 v[204:207], v[236:239], a[188:191], v[204:207]
    buffer_load_dwordx4 a[124:127], v7, s[36:39], s51 offen offset:3072 sc1
    v_mfma_f32_16x16x32_bf16 v[204:207], v[232:235], a[172:175], v[204:207]
    s_waitcnt vmcnt(38) lgkmcnt(8)
    v_mfma_f32_16x16x32_bf16 v[64:67], v[208:211], a[0:3], v[64:67]
    ds_read_b64_tr_b16 v[232:233], v10 offset:96
    s_waitcnt vmcnt(34)
    v_mfma_f32_16x16x32_bf16 v[64:67], v[212:215], a[16:19], v[64:67]
    ds_read_b64_tr_b16 v[234:235], v10 offset:4704
    v_mfma_f32_16x16x32_bf16 v[100:103], v[212:215], a[20:23], v[100:103]
    v_mfma_f32_16x16x32_bf16 v[100:103], v[208:211], a[4:7], v[100:103]
    v_mfma_f32_16x16x32_bf16 v[136:139], v[208:211], a[8:11], v[136:139]
    ds_read_b64_tr_b16 v[236:237], v10 offset:9312
    v_mfma_f32_16x16x32_bf16 v[136:139], v[212:215], a[24:27], v[136:139]
    ds_read_b64_tr_b16 v[238:239], v10 offset:13920
    v_mfma_f32_16x16x32_bf16 v[172:175], v[212:215], a[28:31], v[172:175]
    v_mfma_f32_16x16x32_bf16 v[172:175], v[208:211], a[12:15], v[172:175]
    s_waitcnt lgkmcnt(8)
    v_mfma_f32_16x16x32_bf16 v[68:71], v[216:219], a[0:3], v[68:71]
    ds_read_b64_tr_b16 v[208:209], v10 offset:128
    v_mfma_f32_16x16x32_bf16 v[68:71], v[220:223], a[16:19], v[68:71]
    ds_read_b64_tr_b16 v[210:211], v10 offset:4736
    v_mfma_f32_16x16x32_bf16 v[104:107], v[220:223], a[20:23], v[104:107]
    v_mfma_f32_16x16x32_bf16 v[104:107], v[216:219], a[4:7], v[104:107]
    v_mfma_f32_16x16x32_bf16 v[140:143], v[216:219], a[8:11], v[140:143]
    ds_read_b64_tr_b16 v[212:213], v10 offset:9344
    v_mfma_f32_16x16x32_bf16 v[140:143], v[220:223], a[24:27], v[140:143]
    ds_read_b64_tr_b16 v[214:215], v10 offset:13952
    v_mfma_f32_16x16x32_bf16 v[176:179], v[220:223], a[28:31], v[176:179]
    v_mfma_f32_16x16x32_bf16 v[176:179], v[216:219], a[12:15], v[176:179]
    s_waitcnt lgkmcnt(8)
    v_mfma_f32_16x16x32_bf16 v[72:75], v[224:227], a[0:3], v[72:75]
    ds_read_b64_tr_b16 v[216:217], v10 offset:160
    v_mfma_f32_16x16x32_bf16 v[72:75], v[228:231], a[16:19], v[72:75]
    ds_read_b64_tr_b16 v[218:219], v10 offset:4768
    v_mfma_f32_16x16x32_bf16 v[108:111], v[228:231], a[20:23], v[108:111]
    v_mfma_f32_16x16x32_bf16 v[108:111], v[224:227], a[4:7], v[108:111]
    v_mfma_f32_16x16x32_bf16 v[144:147], v[224:227], a[8:11], v[144:147]
    ds_read_b64_tr_b16 v[220:221], v10 offset:9376
    v_mfma_f32_16x16x32_bf16 v[144:147], v[228:231], a[24:27], v[144:147]
    ds_read_b64_tr_b16 v[222:223], v10 offset:13984
    v_mfma_f32_16x16x32_bf16 v[180:183], v[228:231], a[28:31], v[180:183]
    v_mfma_f32_16x16x32_bf16 v[180:183], v[224:227], a[12:15], v[180:183]
    s_waitcnt lgkmcnt(8)
    v_mfma_f32_16x16x32_bf16 v[76:79], v[232:235], a[0:3], v[76:79]
    ds_read_b64_tr_b16 v[224:225], v10 offset:192
    v_mfma_f32_16x16x32_bf16 v[76:79], v[236:239], a[16:19], v[76:79]
    ds_read_b64_tr_b16 v[226:227], v10 offset:4800
    v_mfma_f32_16x16x32_bf16 v[112:115], v[236:239], a[20:23], v[112:115]
    v_mfma_f32_16x16x32_bf16 v[112:115], v[232:235], a[4:7], v[112:115]
    v_mfma_f32_16x16x32_bf16 v[148:151], v[232:235], a[8:11], v[148:151]
    ds_read_b64_tr_b16 v[228:229], v10 offset:9408
    v_mfma_f32_16x16x32_bf16 v[148:151], v[236:239], a[24:27], v[148:151]
    ds_read_b64_tr_b16 v[230:231], v10 offset:14016
    v_mfma_f32_16x16x32_bf16 v[184:187], v[236:239], a[28:31], v[184:187]
    v_mfma_f32_16x16x32_bf16 v[184:187], v[232:235], a[12:15], v[184:187]
    s_waitcnt lgkmcnt(8)
    v_mfma_f32_16x16x32_bf16 v[80:83], v[208:211], a[0:3], v[80:83]
    ds_read_b64_tr_b16 v[232:233], v10 offset:224
    v_mfma_f32_16x16x32_bf16 v[80:83], v[212:215], a[16:19], v[80:83]
    ds_read_b64_tr_b16 v[234:235], v10 offset:4832
    v_mfma_f32_16x16x32_bf16 v[116:119], v[212:215], a[20:23], v[116:119]
    v_mfma_f32_16x16x32_bf16 v[116:119], v[208:211], a[4:7], v[116:119]
    v_mfma_f32_16x16x32_bf16 v[152:155], v[208:211], a[8:11], v[152:155]
    ds_read_b64_tr_b16 v[236:237], v10 offset:9440
    v_mfma_f32_16x16x32_bf16 v[152:155], v[212:215], a[24:27], v[152:155]
    ds_read_b64_tr_b16 v[238:239], v10 offset:14048
    v_mfma_f32_16x16x32_bf16 v[188:191], v[212:215], a[28:31], v[188:191]
    v_mfma_f32_16x16x32_bf16 v[188:191], v[208:211], a[12:15], v[188:191]
    s_waitcnt lgkmcnt(8)
    v_mfma_f32_16x16x32_bf16 v[84:87], v[216:219], a[0:3], v[84:87]
    ds_read_b64_tr_b16 v[208:209], v10 offset:256
    v_mfma_f32_16x16x32_bf16 v[84:87], v[220:223], a[16:19], v[84:87]
    ds_read_b64_tr_b16 v[210:211], v10 offset:4864
    v_mfma_f32_16x16x32_bf16 v[120:123], v[220:223], a[20:23], v[120:123]
    v_mfma_f32_16x16x32_bf16 v[120:123], v[216:219], a[4:7], v[120:123]
    v_mfma_f32_16x16x32_bf16 v[156:159], v[216:219], a[8:11], v[156:159]
    ds_read_b64_tr_b16 v[212:213], v10 offset:9472
    v_mfma_f32_16x16x32_bf16 v[156:159], v[220:223], a[24:27], v[156:159]
    ds_read_b64_tr_b16 v[214:215], v10 offset:14080
    v_mfma_f32_16x16x32_bf16 v[192:195], v[220:223], a[28:31], v[192:195]
    v_mfma_f32_16x16x32_bf16 v[192:195], v[216:219], a[12:15], v[192:195]
    s_waitcnt lgkmcnt(8)
    v_mfma_f32_16x16x32_bf16 v[88:91], v[224:227], a[0:3], v[88:91]
    ds_read_b64_tr_b16 v[216:217], v10 offset:18432
    v_mfma_f32_16x16x32_bf16 v[88:91], v[228:231], a[16:19], v[88:91]
    ds_read_b64_tr_b16 v[218:219], v10 offset:23040
    v_mfma_f32_16x16x32_bf16 v[124:127], v[228:231], a[20:23], v[124:127]
    buffer_load_dword v247, v246, s[24:27], 0 offen
    v_mfma_f32_16x16x32_bf16 v[124:127], v[224:227], a[4:7], v[124:127]
    v_mfma_f32_16x16x32_bf16 v[160:163], v[224:227], a[8:11], v[160:163]
    ds_read_b64_tr_b16 v[220:221], v10 offset:27648
    v_mfma_f32_16x16x32_bf16 v[160:163], v[228:231], a[24:27], v[160:163]
    ds_read_b64_tr_b16 v[222:223], v10 offset:32256
    v_mfma_f32_16x16x32_bf16 v[196:199], v[228:231], a[28:31], v[196:199]
    v_mfma_f32_16x16x32_bf16 v[196:199], v[224:227], a[12:15], v[196:199]
    s_waitcnt lgkmcnt(8)
    v_mfma_f32_16x16x32_bf16 v[92:95], v[232:235], a[0:3], v[92:95]
    v_mfma_f32_16x16x32_bf16 v[92:95], v[236:239], a[16:19], v[92:95]
    v_mfma_f32_16x16x32_bf16 v[128:131], v[236:239], a[20:23], v[128:131]
    v_mfma_f32_16x16x32_bf16 v[128:131], v[232:235], a[4:7], v[128:131]
    v_mfma_f32_16x16x32_bf16 v[164:167], v[232:235], a[8:11], v[164:167]
    v_mfma_f32_16x16x32_bf16 v[164:167], v[236:239], a[24:27], v[164:167]
    v_mfma_f32_16x16x32_bf16 v[200:203], v[236:239], a[28:31], v[200:203]
    v_mfma_f32_16x16x32_bf16 v[200:203], v[232:235], a[12:15], v[200:203]
    s_waitcnt vmcnt(26) lgkmcnt(0)
    s_barrier
    v_mfma_f32_16x16x32_bf16 v[96:99], v[208:211], a[0:3], v[96:99]
    ds_read_b64_tr_b16 v[224:225], v11 offset:0
    ds_read_b64_tr_b16 v[226:227], v11 offset:4608
    v_mfma_f32_16x16x32_bf16 v[96:99], v[212:215], a[16:19], v[96:99]
    ds_read_b64_tr_b16 v[228:229], v11 offset:9216
    ds_read_b64_tr_b16 v[230:231], v11 offset:13824
    v_mfma_f32_16x16x32_bf16 v[132:135], v[212:215], a[20:23], v[132:135]
    ds_read_b64_tr_b16 v[232:233], v11 offset:18432
    ds_read_b64_tr_b16 v[234:235], v11 offset:23040
    v_mfma_f32_16x16x32_bf16 v[132:135], v[208:211], a[4:7], v[132:135]
    v_mfma_f32_16x16x32_bf16 v[168:171], v[208:211], a[8:11], v[168:171]
    ds_read_b64_tr_b16 v[236:237], v11 offset:27648
    v_mfma_f32_16x16x32_bf16 v[168:171], v[212:215], a[24:27], v[168:171]
    ds_read_b64_tr_b16 v[238:239], v11 offset:32256
    v_mfma_f32_16x16x32_bf16 v[204:207], v[212:215], a[28:31], v[204:207]
    v_mfma_f32_16x16x32_bf16 v[204:207], v[208:211], a[12:15], v[204:207]
    s_waitcnt vmcnt(21)
    v_mfma_f32_16x16x32_bf16 v[64:67], v[216:219], a[32:35], v[64:67]
    ds_read_b64_tr_b16 v[208:209], v10 offset:18464
    s_waitcnt vmcnt(17)
    v_mfma_f32_16x16x32_bf16 v[64:67], v[220:223], a[48:51], v[64:67]
    ds_read_b64_tr_b16 v[210:211], v10 offset:23072
    v_mfma_f32_16x16x32_bf16 v[100:103], v[220:223], a[52:55], v[100:103]
    v_mfma_f32_16x16x32_bf16 v[100:103], v[216:219], a[36:39], v[100:103]
    v_mfma_f32_16x16x32_bf16 v[136:139], v[216:219], a[40:43], v[136:139]
    ds_read_b64_tr_b16 v[212:213], v10 offset:27680
    v_mfma_f32_16x16x32_bf16 v[136:139], v[220:223], a[56:59], v[136:139]
    ds_read_b64_tr_b16 v[214:215], v10 offset:32288
    v_mfma_f32_16x16x32_bf16 v[172:175], v[220:223], a[60:63], v[172:175]
    v_mfma_f32_16x16x32_bf16 v[172:175], v[216:219], a[44:47], v[172:175]
    s_waitcnt vmcnt(13) lgkmcnt(8)
    v_mfma_f32_16x16x32_bf16 v[64:67], v[224:227], a[64:67], v[64:67]
    ds_read_b64_tr_b16 v[216:217], v11 offset:32
    s_waitcnt vmcnt(9)
    v_mfma_f32_16x16x32_bf16 v[64:67], v[228:231], a[80:83], v[64:67]
    ds_read_b64_tr_b16 v[218:219], v11 offset:4640
    v_mfma_f32_16x16x32_bf16 v[100:103], v[228:231], a[84:87], v[100:103]
    v_mfma_f32_16x16x32_bf16 v[100:103], v[224:227], a[68:71], v[100:103]
    v_mfma_f32_16x16x32_bf16 v[136:139], v[224:227], a[72:75], v[136:139]
    ds_read_b64_tr_b16 v[220:221], v11 offset:9248
    v_mfma_f32_16x16x32_bf16 v[136:139], v[228:231], a[88:91], v[136:139]
    ds_read_b64_tr_b16 v[222:223], v11 offset:13856
    v_mfma_f32_16x16x32_bf16 v[172:175], v[228:231], a[92:95], v[172:175]
    v_mfma_f32_16x16x32_bf16 v[172:175], v[224:227], a[76:79], v[172:175]
    s_waitcnt vmcnt(5) lgkmcnt(8)
    v_mfma_f32_16x16x32_bf16 v[64:67], v[232:235], a[96:99], v[64:67]
    ds_read_b64_tr_b16 v[224:225], v11 offset:18464
    s_waitcnt vmcnt(1)
    v_mfma_f32_16x16x32_bf16 v[64:67], v[236:239], a[112:115], v[64:67]
    ds_read_b64_tr_b16 v[226:227], v11 offset:23072
    v_mfma_f32_16x16x32_bf16 v[100:103], v[236:239], a[116:119], v[100:103]
    v_mfma_f32_16x16x32_bf16 v[100:103], v[232:235], a[100:103], v[100:103]
    v_mfma_f32_16x16x32_bf16 v[136:139], v[232:235], a[104:107], v[136:139]
    ds_read_b64_tr_b16 v[228:229], v11 offset:27680
    v_mfma_f32_16x16x32_bf16 v[136:139], v[236:239], a[120:123], v[136:139]
    ds_read_b64_tr_b16 v[230:231], v11 offset:32288
    v_mfma_f32_16x16x32_bf16 v[172:175], v[236:239], a[124:127], v[172:175]
    v_mfma_f32_16x16x32_bf16 v[172:175], v[232:235], a[108:111], v[172:175]
    s_waitcnt lgkmcnt(8)
    v_mfma_f32_16x16x32_bf16 v[68:71], v[208:211], a[32:35], v[68:71]
    ds_read_b64_tr_b16 v[232:233], v10 offset:18496
    v_mfma_f32_16x16x32_bf16 v[68:71], v[212:215], a[48:51], v[68:71]
    ds_read_b64_tr_b16 v[234:235], v10 offset:23104
    v_mfma_f32_16x16x32_bf16 v[104:107], v[212:215], a[52:55], v[104:107]
    v_mfma_f32_16x16x32_bf16 v[104:107], v[208:211], a[36:39], v[104:107]
    v_mfma_f32_16x16x32_bf16 v[140:143], v[208:211], a[40:43], v[140:143]
    ds_read_b64_tr_b16 v[236:237], v10 offset:27712
    v_cvt_pk_bf16_f32 v12, v64, v65
    v_mfma_f32_16x16x32_bf16 v[140:143], v[212:215], a[56:59], v[140:143]
    ds_read_b64_tr_b16 v[238:239], v10 offset:32320
    v_cvt_pk_bf16_f32 v13, v66, v67
    v_mfma_f32_16x16x32_bf16 v[176:179], v[212:215], a[60:63], v[176:179]
    v_mfma_f32_16x16x32_bf16 v[176:179], v[208:211], a[44:47], v[176:179]
    s_add_u32 s6, s63, 0
    v_cvt_pk_bf16_f32 v14, v100, v101
    v_cvt_pk_bf16_f32 v15, v102, v103
    s_waitcnt lgkmcnt(8)
    v_mfma_f32_16x16x32_bf16 v[68:71], v[216:219], a[64:67], v[68:71]
    ds_read_b64_tr_b16 v[208:209], v11 offset:64
    v_cvt_pk_bf16_f32 v16, v136, v137
    v_mfma_f32_16x16x32_bf16 v[68:71], v[220:223], a[80:83], v[68:71]
    ds_read_b64_tr_b16 v[210:211], v11 offset:4672
    v_cvt_pk_bf16_f32 v17, v138, v139
    v_mfma_f32_16x16x32_bf16 v[104:107], v[220:223], a[84:87], v[104:107]
    buffer_store_dwordx4 v[12:15], v7, s[28:31], s6 offen sc1
    v_mfma_f32_16x16x32_bf16 v[104:107], v[216:219], a[68:71], v[104:107]
    v_cvt_pk_bf16_f32 v18, v172, v173
    v_cvt_pk_bf16_f32 v19, v174, v175
    v_mfma_f32_16x16x32_bf16 v[140:143], v[216:219], a[72:75], v[140:143]
    ds_read_b64_tr_b16 v[212:213], v11 offset:9280
    v_mfma_f32_16x16x32_bf16 v[140:143], v[220:223], a[88:91], v[140:143]
    ds_read_b64_tr_b16 v[214:215], v11 offset:13888
    v_mfma_f32_16x16x32_bf16 v[176:179], v[220:223], a[92:95], v[176:179]
    v_mfma_f32_16x16x32_bf16 v[176:179], v[216:219], a[76:79], v[176:179]
    s_waitcnt lgkmcnt(8)
    v_mfma_f32_16x16x32_bf16 v[68:71], v[224:227], a[96:99], v[68:71]
    ds_read_b64_tr_b16 v[216:217], v11 offset:18496
    v_mfma_f32_16x16x32_bf16 v[68:71], v[228:231], a[112:115], v[68:71]
    ds_read_b64_tr_b16 v[218:219], v11 offset:23104
    v_mfma_f32_16x16x32_bf16 v[104:107], v[228:231], a[116:119], v[104:107]
    v_mfma_f32_16x16x32_bf16 v[104:107], v[224:227], a[100:103], v[104:107]
    s_add_u32 s6, s63, 9216
    v_mfma_f32_16x16x32_bf16 v[140:143], v[224:227], a[104:107], v[140:143]
    ds_read_b64_tr_b16 v[220:221], v11 offset:27712
    v_mfma_f32_16x16x32_bf16 v[140:143], v[228:231], a[120:123], v[140:143]
    ds_read_b64_tr_b16 v[222:223], v11 offset:32320
    v_mfma_f32_16x16x32_bf16 v[176:179], v[228:231], a[124:127], v[176:179]
    buffer_store_dwordx4 v[16:19], v7, s[28:31], s6 offen sc1
    v_mfma_f32_16x16x32_bf16 v[176:179], v[224:227], a[108:111], v[176:179]
    s_waitcnt lgkmcnt(8)
    v_mfma_f32_16x16x32_bf16 v[72:75], v[232:235], a[32:35], v[72:75]
    ds_read_b64_tr_b16 v[224:225], v10 offset:18528
    v_mfma_f32_16x16x32_bf16 v[72:75], v[236:239], a[48:51], v[72:75]
    ds_read_b64_tr_b16 v[226:227], v10 offset:23136
    v_mfma_f32_16x16x32_bf16 v[108:111], v[236:239], a[52:55], v[108:111]
    v_mfma_f32_16x16x32_bf16 v[108:111], v[232:235], a[36:39], v[108:111]
    v_mfma_f32_16x16x32_bf16 v[144:147], v[232:235], a[40:43], v[144:147]
    ds_read_b64_tr_b16 v[228:229], v10 offset:27744
    v_cvt_pk_bf16_f32 v20, v68, v69
    v_mfma_f32_16x16x32_bf16 v[144:147], v[236:239], a[56:59], v[144:147]
    ds_read_b64_tr_b16 v[230:231], v10 offset:32352
    v_cvt_pk_bf16_f32 v21, v70, v71
    v_mfma_f32_16x16x32_bf16 v[180:183], v[236:239], a[60:63], v[180:183]
    v_mfma_f32_16x16x32_bf16 v[180:183], v[232:235], a[44:47], v[180:183]
    s_add_u32 s6, s63, 1024
    v_cvt_pk_bf16_f32 v22, v104, v105
    v_cvt_pk_bf16_f32 v23, v106, v107
    s_waitcnt lgkmcnt(8)
    v_mfma_f32_16x16x32_bf16 v[72:75], v[208:211], a[64:67], v[72:75]
    ds_read_b64_tr_b16 v[232:233], v11 offset:96
    v_cvt_pk_bf16_f32 v24, v140, v141
    v_mfma_f32_16x16x32_bf16 v[72:75], v[212:215], a[80:83], v[72:75]
    ds_read_b64_tr_b16 v[234:235], v11 offset:4704
    v_cvt_pk_bf16_f32 v25, v142, v143
    v_mfma_f32_16x16x32_bf16 v[108:111], v[212:215], a[84:87], v[108:111]
    buffer_store_dwordx4 v[20:23], v7, s[28:31], s6 offen sc1
    v_mfma_f32_16x16x32_bf16 v[108:111], v[208:211], a[68:71], v[108:111]
    v_cvt_pk_bf16_f32 v26, v176, v177
    v_cvt_pk_bf16_f32 v27, v178, v179
    v_mfma_f32_16x16x32_bf16 v[144:147], v[208:211], a[72:75], v[144:147]
    ds_read_b64_tr_b16 v[236:237], v11 offset:9312
    v_mfma_f32_16x16x32_bf16 v[144:147], v[212:215], a[88:91], v[144:147]
    ds_read_b64_tr_b16 v[238:239], v11 offset:13920
    v_mfma_f32_16x16x32_bf16 v[180:183], v[212:215], a[92:95], v[180:183]
    v_mfma_f32_16x16x32_bf16 v[180:183], v[208:211], a[76:79], v[180:183]
    s_waitcnt lgkmcnt(8)
    v_mfma_f32_16x16x32_bf16 v[72:75], v[216:219], a[96:99], v[72:75]
    ds_read_b64_tr_b16 v[208:209], v11 offset:18528
    v_mfma_f32_16x16x32_bf16 v[72:75], v[220:223], a[112:115], v[72:75]
    ds_read_b64_tr_b16 v[210:211], v11 offset:23136
    v_mfma_f32_16x16x32_bf16 v[108:111], v[220:223], a[116:119], v[108:111]
    v_mfma_f32_16x16x32_bf16 v[108:111], v[216:219], a[100:103], v[108:111]
    s_add_u32 s6, s63, 10240
    v_mfma_f32_16x16x32_bf16 v[144:147], v[216:219], a[104:107], v[144:147]
    ds_read_b64_tr_b16 v[212:213], v11 offset:27744
    v_mfma_f32_16x16x32_bf16 v[144:147], v[220:223], a[120:123], v[144:147]
    ds_read_b64_tr_b16 v[214:215], v11 offset:32352
    v_mfma_f32_16x16x32_bf16 v[180:183], v[220:223], a[124:127], v[180:183]
    buffer_store_dwordx4 v[24:27], v7, s[28:31], s6 offen sc1
    v_mfma_f32_16x16x32_bf16 v[180:183], v[216:219], a[108:111], v[180:183]
    s_waitcnt lgkmcnt(8)
    v_mfma_f32_16x16x32_bf16 v[76:79], v[224:227], a[32:35], v[76:79]
    ds_read_b64_tr_b16 v[216:217], v10 offset:18560
    v_mfma_f32_16x16x32_bf16 v[76:79], v[228:231], a[48:51], v[76:79]
    ds_read_b64_tr_b16 v[218:219], v10 offset:23168
    v_mfma_f32_16x16x32_bf16 v[112:115], v[228:231], a[52:55], v[112:115]
    v_mfma_f32_16x16x32_bf16 v[112:115], v[224:227], a[36:39], v[112:115]
    v_mfma_f32_16x16x32_bf16 v[148:151], v[224:227], a[40:43], v[148:151]
    ds_read_b64_tr_b16 v[220:221], v10 offset:27776
    v_cvt_pk_bf16_f32 v28, v72, v73
    v_mfma_f32_16x16x32_bf16 v[148:151], v[228:231], a[56:59], v[148:151]
    ds_read_b64_tr_b16 v[222:223], v10 offset:32384
    v_cvt_pk_bf16_f32 v29, v74, v75
    v_mfma_f32_16x16x32_bf16 v[184:187], v[228:231], a[60:63], v[184:187]
    v_mfma_f32_16x16x32_bf16 v[184:187], v[224:227], a[44:47], v[184:187]
    s_add_u32 s6, s63, 2048
    v_cvt_pk_bf16_f32 v30, v108, v109
    v_cvt_pk_bf16_f32 v31, v110, v111
    s_waitcnt lgkmcnt(8)
    v_mfma_f32_16x16x32_bf16 v[76:79], v[232:235], a[64:67], v[76:79]
    ds_read_b64_tr_b16 v[224:225], v11 offset:128
    v_cvt_pk_bf16_f32 v32, v144, v145
    v_mfma_f32_16x16x32_bf16 v[76:79], v[236:239], a[80:83], v[76:79]
    ds_read_b64_tr_b16 v[226:227], v11 offset:4736
    v_cvt_pk_bf16_f32 v33, v146, v147
    v_mfma_f32_16x16x32_bf16 v[112:115], v[236:239], a[84:87], v[112:115]
    buffer_store_dwordx4 v[28:31], v7, s[28:31], s6 offen sc1
    v_mfma_f32_16x16x32_bf16 v[112:115], v[232:235], a[68:71], v[112:115]
    v_cvt_pk_bf16_f32 v34, v180, v181
    v_cvt_pk_bf16_f32 v35, v182, v183
    v_mfma_f32_16x16x32_bf16 v[148:151], v[232:235], a[72:75], v[148:151]
    ds_read_b64_tr_b16 v[228:229], v11 offset:9344
    v_mfma_f32_16x16x32_bf16 v[148:151], v[236:239], a[88:91], v[148:151]
    ds_read_b64_tr_b16 v[230:231], v11 offset:13952
    v_mfma_f32_16x16x32_bf16 v[184:187], v[236:239], a[92:95], v[184:187]
    v_mfma_f32_16x16x32_bf16 v[184:187], v[232:235], a[76:79], v[184:187]
    s_waitcnt lgkmcnt(8)
    v_mfma_f32_16x16x32_bf16 v[76:79], v[208:211], a[96:99], v[76:79]
    ds_read_b64_tr_b16 v[232:233], v11 offset:18560
    v_mfma_f32_16x16x32_bf16 v[76:79], v[212:215], a[112:115], v[76:79]
    ds_read_b64_tr_b16 v[234:235], v11 offset:23168
    v_mfma_f32_16x16x32_bf16 v[112:115], v[212:215], a[116:119], v[112:115]
    v_mfma_f32_16x16x32_bf16 v[112:115], v[208:211], a[100:103], v[112:115]
    s_add_u32 s6, s63, 11264
    v_mfma_f32_16x16x32_bf16 v[148:151], v[208:211], a[104:107], v[148:151]
    ds_read_b64_tr_b16 v[236:237], v11 offset:27776
    v_mfma_f32_16x16x32_bf16 v[148:151], v[212:215], a[120:123], v[148:151]
    ds_read_b64_tr_b16 v[238:239], v11 offset:32384
    v_mfma_f32_16x16x32_bf16 v[184:187], v[212:215], a[124:127], v[184:187]
    buffer_store_dwordx4 v[32:35], v7, s[28:31], s6 offen sc1
    v_mfma_f32_16x16x32_bf16 v[184:187], v[208:211], a[108:111], v[184:187]
    s_waitcnt lgkmcnt(8)
    v_mfma_f32_16x16x32_bf16 v[80:83], v[216:219], a[32:35], v[80:83]
    ds_read_b64_tr_b16 v[208:209], v10 offset:18592
    v_mfma_f32_16x16x32_bf16 v[80:83], v[220:223], a[48:51], v[80:83]
    ds_read_b64_tr_b16 v[210:211], v10 offset:23200
    v_mfma_f32_16x16x32_bf16 v[116:119], v[220:223], a[52:55], v[116:119]
    v_mfma_f32_16x16x32_bf16 v[116:119], v[216:219], a[36:39], v[116:119]
    v_mfma_f32_16x16x32_bf16 v[152:155], v[216:219], a[40:43], v[152:155]
    ds_read_b64_tr_b16 v[212:213], v10 offset:27808
    v_cvt_pk_bf16_f32 v36, v76, v77
    v_mfma_f32_16x16x32_bf16 v[152:155], v[220:223], a[56:59], v[152:155]
    ds_read_b64_tr_b16 v[214:215], v10 offset:32416
    v_cvt_pk_bf16_f32 v37, v78, v79
    v_mfma_f32_16x16x32_bf16 v[188:191], v[220:223], a[60:63], v[188:191]
    v_mfma_f32_16x16x32_bf16 v[188:191], v[216:219], a[44:47], v[188:191]
    s_add_u32 s6, s63, 3072
    v_cvt_pk_bf16_f32 v38, v112, v113
    v_cvt_pk_bf16_f32 v39, v114, v115
    s_waitcnt lgkmcnt(8)
    v_mfma_f32_16x16x32_bf16 v[80:83], v[224:227], a[64:67], v[80:83]
    ds_read_b64_tr_b16 v[216:217], v11 offset:160
    v_cvt_pk_bf16_f32 v40, v148, v149
    v_mfma_f32_16x16x32_bf16 v[80:83], v[228:231], a[80:83], v[80:83]
    ds_read_b64_tr_b16 v[218:219], v11 offset:4768
    v_cvt_pk_bf16_f32 v41, v150, v151
    v_mfma_f32_16x16x32_bf16 v[116:119], v[228:231], a[84:87], v[116:119]
    buffer_store_dwordx4 v[36:39], v7, s[28:31], s6 offen sc1
    v_mfma_f32_16x16x32_bf16 v[116:119], v[224:227], a[68:71], v[116:119]
    v_cvt_pk_bf16_f32 v42, v184, v185
    v_cvt_pk_bf16_f32 v43, v186, v187
    v_mfma_f32_16x16x32_bf16 v[152:155], v[224:227], a[72:75], v[152:155]
    ds_read_b64_tr_b16 v[220:221], v11 offset:9376
    v_mfma_f32_16x16x32_bf16 v[152:155], v[228:231], a[88:91], v[152:155]
    ds_read_b64_tr_b16 v[222:223], v11 offset:13984
    v_mfma_f32_16x16x32_bf16 v[188:191], v[228:231], a[92:95], v[188:191]
    v_mfma_f32_16x16x32_bf16 v[188:191], v[224:227], a[76:79], v[188:191]
    s_waitcnt lgkmcnt(8)
    v_mfma_f32_16x16x32_bf16 v[80:83], v[232:235], a[96:99], v[80:83]
    ds_read_b64_tr_b16 v[224:225], v11 offset:18592
    v_mfma_f32_16x16x32_bf16 v[80:83], v[236:239], a[112:115], v[80:83]
    ds_read_b64_tr_b16 v[226:227], v11 offset:23200
    v_mfma_f32_16x16x32_bf16 v[116:119], v[236:239], a[116:119], v[116:119]
    v_mfma_f32_16x16x32_bf16 v[116:119], v[232:235], a[100:103], v[116:119]
    s_add_u32 s6, s63, 12288
    v_mfma_f32_16x16x32_bf16 v[152:155], v[232:235], a[104:107], v[152:155]
    ds_read_b64_tr_b16 v[228:229], v11 offset:27808
    v_mfma_f32_16x16x32_bf16 v[152:155], v[236:239], a[120:123], v[152:155]
    ds_read_b64_tr_b16 v[230:231], v11 offset:32416
    v_mfma_f32_16x16x32_bf16 v[188:191], v[236:239], a[124:127], v[188:191]
    buffer_store_dwordx4 v[40:43], v7, s[28:31], s6 offen sc1
    v_mfma_f32_16x16x32_bf16 v[188:191], v[232:235], a[108:111], v[188:191]
    s_waitcnt lgkmcnt(8)
    v_mfma_f32_16x16x32_bf16 v[84:87], v[208:211], a[32:35], v[84:87]
    ds_read_b64_tr_b16 v[232:233], v10 offset:18624
    v_mfma_f32_16x16x32_bf16 v[84:87], v[212:215], a[48:51], v[84:87]
    ds_read_b64_tr_b16 v[234:235], v10 offset:23232
    v_mfma_f32_16x16x32_bf16 v[120:123], v[212:215], a[52:55], v[120:123]
    v_mfma_f32_16x16x32_bf16 v[120:123], v[208:211], a[36:39], v[120:123]
    v_mfma_f32_16x16x32_bf16 v[156:159], v[208:211], a[40:43], v[156:159]
    ds_read_b64_tr_b16 v[236:237], v10 offset:27840
    v_cvt_pk_bf16_f32 v44, v80, v81
    v_mfma_f32_16x16x32_bf16 v[156:159], v[212:215], a[56:59], v[156:159]
    ds_read_b64_tr_b16 v[238:239], v10 offset:32448
    v_cvt_pk_bf16_f32 v45, v82, v83
    v_mfma_f32_16x16x32_bf16 v[192:195], v[212:215], a[60:63], v[192:195]
    v_mfma_f32_16x16x32_bf16 v[192:195], v[208:211], a[44:47], v[192:195]
    s_add_u32 s6, s63, 4096
    v_cvt_pk_bf16_f32 v46, v116, v117
    v_cvt_pk_bf16_f32 v47, v118, v119
    s_waitcnt lgkmcnt(8)
    v_mfma_f32_16x16x32_bf16 v[84:87], v[216:219], a[64:67], v[84:87]
    ds_read_b64_tr_b16 v[208:209], v11 offset:192
    v_cvt_pk_bf16_f32 v48, v152, v153
    v_mfma_f32_16x16x32_bf16 v[84:87], v[220:223], a[80:83], v[84:87]
    ds_read_b64_tr_b16 v[210:211], v11 offset:4800
    v_cvt_pk_bf16_f32 v49, v154, v155
    v_mfma_f32_16x16x32_bf16 v[120:123], v[220:223], a[84:87], v[120:123]
    buffer_store_dwordx4 v[44:47], v7, s[28:31], s6 offen sc1
    v_mfma_f32_16x16x32_bf16 v[120:123], v[216:219], a[68:71], v[120:123]
    v_cvt_pk_bf16_f32 v50, v188, v189
    v_cvt_pk_bf16_f32 v51, v190, v191
    v_mfma_f32_16x16x32_bf16 v[156:159], v[216:219], a[72:75], v[156:159]
    ds_read_b64_tr_b16 v[212:213], v11 offset:9408
    v_mfma_f32_16x16x32_bf16 v[156:159], v[220:223], a[88:91], v[156:159]
    ds_read_b64_tr_b16 v[214:215], v11 offset:14016
    v_mfma_f32_16x16x32_bf16 v[192:195], v[220:223], a[92:95], v[192:195]
    v_mfma_f32_16x16x32_bf16 v[192:195], v[216:219], a[76:79], v[192:195]
    s_waitcnt lgkmcnt(8)
    v_mfma_f32_16x16x32_bf16 v[84:87], v[224:227], a[96:99], v[84:87]
    ds_read_b64_tr_b16 v[216:217], v11 offset:18624
    v_mfma_f32_16x16x32_bf16 v[84:87], v[228:231], a[112:115], v[84:87]
    ds_read_b64_tr_b16 v[218:219], v11 offset:23232
    v_mfma_f32_16x16x32_bf16 v[120:123], v[228:231], a[116:119], v[120:123]
    v_mfma_f32_16x16x32_bf16 v[120:123], v[224:227], a[100:103], v[120:123]
    s_add_u32 s6, s63, 13312
    v_mfma_f32_16x16x32_bf16 v[156:159], v[224:227], a[104:107], v[156:159]
    ds_read_b64_tr_b16 v[220:221], v11 offset:27840
    v_mfma_f32_16x16x32_bf16 v[156:159], v[228:231], a[120:123], v[156:159]
    ds_read_b64_tr_b16 v[222:223], v11 offset:32448
    v_mfma_f32_16x16x32_bf16 v[192:195], v[228:231], a[124:127], v[192:195]
    buffer_store_dwordx4 v[48:51], v7, s[28:31], s6 offen sc1
    v_mfma_f32_16x16x32_bf16 v[192:195], v[224:227], a[108:111], v[192:195]
    s_waitcnt lgkmcnt(8)
    v_mfma_f32_16x16x32_bf16 v[88:91], v[232:235], a[32:35], v[88:91]
    ds_read_b64_tr_b16 v[224:225], v10 offset:18656
    v_mfma_f32_16x16x32_bf16 v[88:91], v[236:239], a[48:51], v[88:91]
    ds_read_b64_tr_b16 v[226:227], v10 offset:23264
    v_mfma_f32_16x16x32_bf16 v[124:127], v[236:239], a[52:55], v[124:127]
    v_mfma_f32_16x16x32_bf16 v[124:127], v[232:235], a[36:39], v[124:127]
    v_mfma_f32_16x16x32_bf16 v[160:163], v[232:235], a[40:43], v[160:163]
    ds_read_b64_tr_b16 v[228:229], v10 offset:27872
    v_cvt_pk_bf16_f32 v240, v84, v85
    v_mfma_f32_16x16x32_bf16 v[160:163], v[236:239], a[56:59], v[160:163]
    ds_read_b64_tr_b16 v[230:231], v10 offset:32480
    v_cvt_pk_bf16_f32 v241, v86, v87
    v_mfma_f32_16x16x32_bf16 v[196:199], v[236:239], a[60:63], v[196:199]
    v_mfma_f32_16x16x32_bf16 v[196:199], v[232:235], a[44:47], v[196:199]
    s_add_u32 s6, s63, 5120
    v_cvt_pk_bf16_f32 v242, v120, v121
    v_cvt_pk_bf16_f32 v243, v122, v123
    s_waitcnt lgkmcnt(8)
    v_mfma_f32_16x16x32_bf16 v[88:91], v[208:211], a[64:67], v[88:91]
    ds_read_b64_tr_b16 v[232:233], v11 offset:224
    v_cvt_pk_bf16_f32 v248, v156, v157
    v_mfma_f32_16x16x32_bf16 v[88:91], v[212:215], a[80:83], v[88:91]
    ds_read_b64_tr_b16 v[234:235], v11 offset:4832
    v_cvt_pk_bf16_f32 v249, v158, v159
    v_mfma_f32_16x16x32_bf16 v[124:127], v[212:215], a[84:87], v[124:127]
    buffer_store_dwordx4 v[240:243], v7, s[28:31], s6 offen sc1
    v_mfma_f32_16x16x32_bf16 v[124:127], v[208:211], a[68:71], v[124:127]
    v_cvt_pk_bf16_f32 v250, v192, v193
    v_cvt_pk_bf16_f32 v251, v194, v195
    v_mfma_f32_16x16x32_bf16 v[160:163], v[208:211], a[72:75], v[160:163]
    ds_read_b64_tr_b16 v[236:237], v11 offset:9440
    v_mfma_f32_16x16x32_bf16 v[160:163], v[212:215], a[88:91], v[160:163]
    ds_read_b64_tr_b16 v[238:239], v11 offset:14048
    v_mfma_f32_16x16x32_bf16 v[196:199], v[212:215], a[92:95], v[196:199]
    v_mfma_f32_16x16x32_bf16 v[196:199], v[208:211], a[76:79], v[196:199]
    s_waitcnt lgkmcnt(8)
    v_mfma_f32_16x16x32_bf16 v[88:91], v[216:219], a[96:99], v[88:91]
    ds_read_b64_tr_b16 v[208:209], v11 offset:18656
    v_mfma_f32_16x16x32_bf16 v[88:91], v[220:223], a[112:115], v[88:91]
    ds_read_b64_tr_b16 v[210:211], v11 offset:23264
    v_mfma_f32_16x16x32_bf16 v[124:127], v[220:223], a[116:119], v[124:127]
    v_mfma_f32_16x16x32_bf16 v[124:127], v[216:219], a[100:103], v[124:127]
    s_add_u32 s6, s63, 14336
    v_mfma_f32_16x16x32_bf16 v[160:163], v[216:219], a[104:107], v[160:163]
    ds_read_b64_tr_b16 v[212:213], v11 offset:27872
    v_mfma_f32_16x16x32_bf16 v[160:163], v[220:223], a[120:123], v[160:163]
    ds_read_b64_tr_b16 v[214:215], v11 offset:32480
    v_mfma_f32_16x16x32_bf16 v[196:199], v[220:223], a[124:127], v[196:199]
    buffer_store_dwordx4 v[248:251], v7, s[28:31], s6 offen sc1
    v_mfma_f32_16x16x32_bf16 v[196:199], v[216:219], a[108:111], v[196:199]
    s_waitcnt lgkmcnt(8)
    v_mfma_f32_16x16x32_bf16 v[92:95], v[224:227], a[32:35], v[92:95]
    ds_read_b64_tr_b16 v[216:217], v10 offset:18688
    v_mfma_f32_16x16x32_bf16 v[92:95], v[228:231], a[48:51], v[92:95]
    ds_read_b64_tr_b16 v[218:219], v10 offset:23296
    v_mfma_f32_16x16x32_bf16 v[128:131], v[228:231], a[52:55], v[128:131]
    v_mfma_f32_16x16x32_bf16 v[128:131], v[224:227], a[36:39], v[128:131]
    v_mfma_f32_16x16x32_bf16 v[164:167], v[224:227], a[40:43], v[164:167]
    ds_read_b64_tr_b16 v[220:221], v10 offset:27904
    v_cvt_pk_bf16_f32 v252, v88, v89
    v_mfma_f32_16x16x32_bf16 v[164:167], v[228:231], a[56:59], v[164:167]
    ds_read_b64_tr_b16 v[222:223], v10 offset:32512
    v_cvt_pk_bf16_f32 v253, v90, v91
    v_mfma_f32_16x16x32_bf16 v[200:203], v[228:231], a[60:63], v[200:203]
    v_mfma_f32_16x16x32_bf16 v[200:203], v[224:227], a[44:47], v[200:203]
    s_add_u32 s6, s63, 6144
    v_cvt_pk_bf16_f32 v254, v124, v125
    v_cvt_pk_bf16_f32 v255, v126, v127
    s_waitcnt lgkmcnt(8)
    v_mfma_f32_16x16x32_bf16 v[92:95], v[232:235], a[64:67], v[92:95]
    ds_read_b64_tr_b16 v[224:225], v11 offset:256
    v_cvt_pk_bf16_f32 v12, v160, v161
    v_mfma_f32_16x16x32_bf16 v[92:95], v[236:239], a[80:83], v[92:95]
    ds_read_b64_tr_b16 v[226:227], v11 offset:4864
    v_cvt_pk_bf16_f32 v13, v162, v163
    v_mfma_f32_16x16x32_bf16 v[128:131], v[236:239], a[84:87], v[128:131]
    buffer_store_dwordx4 v[252:255], v7, s[28:31], s6 offen sc1
    v_mfma_f32_16x16x32_bf16 v[128:131], v[232:235], a[68:71], v[128:131]
    v_cvt_pk_bf16_f32 v14, v196, v197
    v_cvt_pk_bf16_f32 v15, v198, v199
    v_mfma_f32_16x16x32_bf16 v[164:167], v[232:235], a[72:75], v[164:167]
    ds_read_b64_tr_b16 v[228:229], v11 offset:9472
    v_mfma_f32_16x16x32_bf16 v[164:167], v[236:239], a[88:91], v[164:167]
    ds_read_b64_tr_b16 v[230:231], v11 offset:14080
    v_mfma_f32_16x16x32_bf16 v[200:203], v[236:239], a[92:95], v[200:203]
    v_mfma_f32_16x16x32_bf16 v[200:203], v[232:235], a[76:79], v[200:203]
    s_waitcnt lgkmcnt(8)
    v_mfma_f32_16x16x32_bf16 v[92:95], v[208:211], a[96:99], v[92:95]
    ds_read_b64_tr_b16 v[232:233], v11 offset:18688
    v_mfma_f32_16x16x32_bf16 v[92:95], v[212:215], a[112:115], v[92:95]
    ds_read_b64_tr_b16 v[234:235], v11 offset:23296
    v_mfma_f32_16x16x32_bf16 v[128:131], v[212:215], a[116:119], v[128:131]
    v_mfma_f32_16x16x32_bf16 v[128:131], v[208:211], a[100:103], v[128:131]
    s_add_u32 s6, s63, 15360
    v_mfma_f32_16x16x32_bf16 v[164:167], v[208:211], a[104:107], v[164:167]
    ds_read_b64_tr_b16 v[236:237], v11 offset:27904
    v_mfma_f32_16x16x32_bf16 v[164:167], v[212:215], a[120:123], v[164:167]
    ds_read_b64_tr_b16 v[238:239], v11 offset:32512
    v_mfma_f32_16x16x32_bf16 v[200:203], v[212:215], a[124:127], v[200:203]
    buffer_store_dwordx4 v[12:15], v7, s[28:31], s6 offen sc1
    v_mfma_f32_16x16x32_bf16 v[200:203], v[208:211], a[108:111], v[200:203]
    s_waitcnt lgkmcnt(8)
    v_mfma_f32_16x16x32_bf16 v[96:99], v[216:219], a[32:35], v[96:99]
    v_mfma_f32_16x16x32_bf16 v[96:99], v[220:223], a[48:51], v[96:99]
    v_mfma_f32_16x16x32_bf16 v[132:135], v[220:223], a[52:55], v[132:135]
    v_mfma_f32_16x16x32_bf16 v[132:135], v[216:219], a[36:39], v[132:135]
    v_mfma_f32_16x16x32_bf16 v[168:171], v[216:219], a[40:43], v[168:171]
    v_cvt_pk_bf16_f32 v16, v92, v93
    v_mfma_f32_16x16x32_bf16 v[168:171], v[220:223], a[56:59], v[168:171]
    v_cvt_pk_bf16_f32 v17, v94, v95
    v_mfma_f32_16x16x32_bf16 v[204:207], v[220:223], a[60:63], v[204:207]
    v_mfma_f32_16x16x32_bf16 v[204:207], v[216:219], a[44:47], v[204:207]
    s_add_u32 s6, s63, 7168
    v_cvt_pk_bf16_f32 v18, v128, v129
    v_cvt_pk_bf16_f32 v19, v130, v131
    s_waitcnt lgkmcnt(4)
    v_mfma_f32_16x16x32_bf16 v[96:99], v[224:227], a[64:67], v[96:99]
    v_cvt_pk_bf16_f32 v20, v164, v165
    v_mfma_f32_16x16x32_bf16 v[96:99], v[228:231], a[80:83], v[96:99]
    v_cvt_pk_bf16_f32 v21, v166, v167
    v_mfma_f32_16x16x32_bf16 v[132:135], v[228:231], a[84:87], v[132:135]
    buffer_store_dwordx4 v[16:19], v7, s[28:31], s6 offen sc1
    v_mfma_f32_16x16x32_bf16 v[132:135], v[224:227], a[68:71], v[132:135]
    v_cvt_pk_bf16_f32 v22, v200, v201
    v_cvt_pk_bf16_f32 v23, v202, v203
    v_mfma_f32_16x16x32_bf16 v[168:171], v[224:227], a[72:75], v[168:171]
    v_mfma_f32_16x16x32_bf16 v[168:171], v[228:231], a[88:91], v[168:171]
    v_mfma_f32_16x16x32_bf16 v[204:207], v[228:231], a[92:95], v[204:207]
    v_mfma_f32_16x16x32_bf16 v[204:207], v[224:227], a[76:79], v[204:207]
    s_waitcnt lgkmcnt(0)
    v_mfma_f32_16x16x32_bf16 v[96:99], v[232:235], a[96:99], v[96:99]
    v_mfma_f32_16x16x32_bf16 v[96:99], v[236:239], a[112:115], v[96:99]
    v_mfma_f32_16x16x32_bf16 v[132:135], v[236:239], a[116:119], v[132:135]
    v_mfma_f32_16x16x32_bf16 v[132:135], v[232:235], a[100:103], v[132:135]
    v_mfma_f32_16x16x32_bf16 v[168:171], v[232:235], a[104:107], v[168:171]
    v_mfma_f32_16x16x32_bf16 v[168:171], v[236:239], a[120:123], v[168:171]
    v_mfma_f32_16x16x32_bf16 v[204:207], v[236:239], a[124:127], v[204:207]
    v_mfma_f32_16x16x32_bf16 v[204:207], v[232:235], a[108:111], v[204:207]
    s_load_dwordx2 s[76:77], s[0:1], 0
    s_load_dwordx2 s[78:79], s[0:1], 72
    s_nop 7
    s_add_u32 s6, s63, 16384
    buffer_store_dwordx4 v[20:23], v7, s[28:31], s6 offen sc1
    v_cvt_pk_bf16_f32 v24, v96, v97
    v_cvt_pk_bf16_f32 v25, v98, v99
    v_cvt_pk_bf16_f32 v26, v132, v133
    v_cvt_pk_bf16_f32 v27, v134, v135
    s_add_u32 s6, s63, 8192
    buffer_store_dwordx4 v[24:27], v7, s[28:31], s6 offen sc1
    v_cvt_pk_bf16_f32 v28, v168, v169
    v_cvt_pk_bf16_f32 v29, v170, v171
    v_cvt_pk_bf16_f32 v30, v204, v205
    v_cvt_pk_bf16_f32 v31, v206, v207
    s_add_u32 s6, s63, 17408
    buffer_store_dwordx4 v[28:31], v7, s[28:31], s6 offen sc1
L_k2_join:
    s_lshl_b32 s3, s42, 3
    s_add_u32 s3, s3, s43
    s_mul_i32 s3, s3, 36864
    s_mul_i32 s4, s44, 288
    s_add_u32 s3, s3, s4
    s_lshl_b32 s4, s40, 5
    s_add_u32 s3, s3, s4
    s_sub_u32 s4, 2359296, s3
    s_waitcnt lgkmcnt(0)
    s_add_u32 s32, s76, s3
    s_addc_u32 s33, s77, 0
    s_mov_b32 s34, s4
    s_mov_b32 s35, 0x00020000
    s_add_u32 s24, s78, s3
    s_addc_u32 s25, s79, 0
    s_mov_b32 s26, s4
    s_mov_b32 s27, 0x00020000
    buffer_load_dwordx2 v[208:209], v2, s[32:35], 0 offen offset:0
    buffer_load_dwordx2 v[210:211], v3, s[32:35], 0 offen offset:0
    buffer_load_dwordx2 v[212:213], v2, s[32:35], 0 offen offset:128
    buffer_load_dwordx2 v[214:215], v3, s[32:35], 0 offen offset:128
    s_lshr_b32 s3, s40, 1
    s_mul_i32 s3, s3, 18432
    s_and_b32 s4, s40, 1
    s_lshl_b32 s4, s4, 2
    s_add_u32 s3, s3, s4
    s_lshl_b32 s4, s40, 5
    s_sub_u32 s3, s3, s4
    s_add_u32 s16, s3, 256
    buffer_load_dword v216, v2, s[32:35], s16 offen
    buffer_load_dword v61, v62, s[68:71], 0 offen sc1
    s_mul_i32 s3, s43, 9
    s_lshl_b32 s17, s3, 10
    s_add_u32 s3, s3, s40
    s_lshl_b32 s54, s3, 10
    s_lshl_b32 s3, s40, 2
    s_add_u32 s17, s17, s3
    s_mov_b32 s5, 0
    s_lshl_b32 s18, 1, s43
    s_waitcnt vmcnt(6)
    s_barrier
    buffer_store_dword v63, v0, s[20:23], 0 offen sc1
    s_waitcnt vmcnt(1)
    v_cmp_ne_u32 vcc, 0, v61
    s_nop 1
    s_or_b32 s6, vcc_lo, s18
    s_andn2_b32 s6, s6, s5
    s_and_b32 s6, s6, 0xff
    s_or_b32 s5, s5, s6
    s_bitcmp1_b32 s6, 0
    s_cbranch_scc0 L_k2_ska_0
    s_add_u32 s4, s54, 0
    buffer_load_dwordx4 v[64:67], v7, s[28:31], s4 offen sc1
    s_add_u32 s4, s54, 4096
    buffer_load_dwordx4 v[68:71], v7, s[28:31], s4 offen sc1
    s_add_u32 s4, s17, 8192
    buffer_load_dword v72, v7, s[28:31], s4 offen sc1
L_k2_ska_0:
    s_bitcmp1_b32 s6, 1
    s_cbranch_scc0 L_k2_ska_1
    s_add_u32 s4, s54, 73728
    buffer_load_dwordx4 v[76:79], v7, s[28:31], s4 offen sc1
    s_add_u32 s4, s54, 77824
    buffer_load_dwordx4 v[80:83], v7, s[28:31], s4 offen sc1
    s_add_u32 s4, s17, 81920
    buffer_load_dword v84, v7, s[28:31], s4 offen sc1
L_k2_ska_1:
    s_bitcmp1_b32 s6, 2
    s_cbranch_scc0 L_k2_ska_2
    s_add_u32 s4, s54, 147456
    buffer_load_dwordx4 v[88:91], v7, s[28:31], s4 offen sc1
    s_add_u32 s4, s54, 151552
    buffer_load_dwordx4 v[92:95], v7, s[28:31], s4 offen sc1
    s_add_u32 s4, s17, 155648
    buffer_load_dword v96, v7, s[28:31], s4 offen sc1
L_k2_ska_2:
    s_bitcmp1_b32 s6, 3
    s_cbranch_scc0 L_k2_ska_3
    s_add_u32 s4, s54, 221184
    buffer_load_dwordx4 v[100:103], v7, s[28:31], s4 offen sc1
    s_add_u32 s4, s54, 225280
    buffer_load_dwordx4 v[104:107], v7, s[28:31], s4 offen sc1
    s_add_u32 s4, s17, 229376
    buffer_load_dword v108, v7, s[28:31], s4 offen sc1
L_k2_ska_3:
    s_bitcmp1_b32 s6, 4
    s_cbranch_scc0 L_k2_ska_4
    s_add_u32 s4, s54, 294912
    buffer_load_dwordx4 v[112:115], v7, s[28:31], s4 offen sc1
    s_add_u32 s4, s54, 299008
    buffer_load_dwordx4 v[116:119], v7, s[28:31], s4 offen sc1
    s_add_u32 s4, s17, 303104
    buffer_load_dword v120, v7, s[28:31], s4 offen sc1
L_k2_ska_4:
    s_bitcmp1_b32 s6, 5
    s_cbranch_scc0 L_k2_ska_5
    s_add_u32 s4, s54, 368640
    buffer_load_dwordx4 v[124:127], v7, s[28:31], s4 offen sc1
    s_add_u32 s4, s54, 372736
    buffer_load_dwordx4 v[128:131], v7, s[28:31], s4 offen sc1
    s_add_u32 s4, s17, 376832
    buffer_load_dword v132, v7, s[28:31], s4 offen sc1
L_k2_ska_5:
    s_bitcmp1_b32 s6, 6
    s_cbranch_scc0 L_k2_ska_6
    s_add_u32 s4, s54, 442368
    buffer_load_dwordx4 v[136:139], v7, s[28:31], s4 offen sc1
    s_add_u32 s4, s54, 446464
    buffer_load_dwordx4 v[140:143], v7, s[28:31], s4 offen sc1
    s_add_u32 s4, s17, 450560
    buffer_load_dword v144, v7, s[28:31], s4 offen sc1
L_k2_ska_6:
    s_bitcmp1_b32 s6, 7
    s_cbranch_scc0 L_k2_ska_7
    s_add_u32 s4, s54, 516096
    buffer_load_dwordx4 v[148:151], v7, s[28:31], s4 offen sc1
    s_add_u32 s4, s54, 520192
    buffer_load_dwordx4 v[152:155], v7, s[28:31], s4 offen sc1
    s_add_u32 s4, s17, 524288
    buffer_load_dword v156, v7, s[28:31], s4 offen sc1
L_k2_ska_7:
    v_lshlrev_b32 v224, 16, v208
    v_and_b32 v225, 0xffff0000, v208
    v_lshlrev_b32 v226, 16, v209
    v_and_b32 v227, 0xffff0000, v209
    v_lshlrev_b32 v228, 16, v210
    v_and_b32 v229, 0xffff0000, v210
    v_lshlrev_b32 v230, 16, v211
    v_and_b32 v231, 0xffff0000, v211
    v_lshlrev_b32 v232, 16, v212
    v_and_b32 v233, 0xffff0000, v212
    v_lshlrev_b32 v234, 16, v213
    v_and_b32 v235, 0xffff0000, v213
    v_lshlrev_b32 v236, 16, v214
    v_and_b32 v237, 0xffff0000, v214
    v_lshlrev_b32 v238, 16, v215
    v_and_b32 v239, 0xffff0000, v215
    v_lshlrev_b32 v240, 16, v216
    v_and_b32 v241, 0xffff0000, v216
    s_mov_b32 s3, 0
L_k2_sloop:
    s_cmp_eq_u32 s5, 0xff
    s_cbranch_scc1 L_k2_sall
    buffer_load_dword v61, v62, s[68:71], 0 offen sc1
    s_waitcnt vmcnt(0)
    v_cmp_ne_u32 vcc, 0, v61
    s_nop 1
    s_or_b32 s6, vcc_lo, s18
    s_andn2_b32 s6, s6, s5
    s_and_b32 s6, s6, 0xff
    s_or_b32 s5, s5, s6
    s_bitcmp1_b32 s6, 0
    s_cbranch_scc0 L_k2_skb_0
    s_add_u32 s4, s54, 0
    buffer_load_dwordx4 v[64:67], v7, s[28:31], s4 offen sc1
    s_add_u32 s4, s54, 4096
    buffer_load_dwordx4 v[68:71], v7, s[28:31], s4 offen sc1
    s_add_u32 s4, s17, 8192
    buffer_load_dword v72, v7, s[28:31], s4 offen sc1
L_k2_skb_0:
    s_bitcmp1_b32 s6, 1
    s_cbranch_scc0 L_k2_skb_1
    s_add_u32 s4, s54, 73728
    buffer_load_dwordx4 v[76:79], v7, s[28:31], s4 offen sc1
    s_add_u32 s4, s54, 77824
    buffer_load_dwordx4 v[80:83], v7, s[28:31], s4 offen sc1
    s_add_u32 s4, s17, 81920
    buffer_load_dword v84, v7, s[28:31], s4 offen sc1
L_k2_skb_1:
    s_bitcmp1_b32 s6, 2
    s_cbranch_scc0 L_k2_skb_2
    s_add_u32 s4, s54, 147456
    buffer_load_dwordx4 v[88:91], v7, s[28:31], s4 offen sc1
    s_add_u32 s4, s54, 151552
    buffer_load_dwordx4 v[92:95], v7, s[28:31], s4 offen sc1
    s_add_u32 s4, s17, 155648
    buffer_load_dword v96, v7, s[28:31], s4 offen sc1
L_k2_skb_2:
    s_bitcmp1_b32 s6, 3
    s_cbranch_scc0 L_k2_skb_3
    s_add_u32 s4, s54, 221184
    buffer_load_dwordx4 v[100:103], v7, s[28:31], s4 offen sc1
    s_add_u32 s4, s54, 225280
    buffer_load_dwordx4 v[104:107], v7, s[28:31], s4 offen sc1
    s_add_u32 s4, s17, 229376
    buffer_load_dword v108, v7, s[28:31], s4 offen sc1
L_k2_skb_3:
    s_bitcmp1_b32 s6, 4
    s_cbranch_scc0 L_k2_skb_4
    s_add_u32 s4, s54, 294912
    buffer_load_dwordx4 v[112:115], v7, s[28:31], s4 offen sc1
    s_add_u32 s4, s54, 299008
    buffer_load_dwordx4 v[116:119], v7, s[28:31], s4 offen sc1
    s_add_u32 s4, s17, 303104
    buffer_load_dword v120, v7, s[28:31], s4 offen sc1
L_k2_skb_4:
    s_bitcmp1_b32 s6, 5
    s_cbranch_scc0 L_k2_skb_5
    s_add_u32 s4, s54, 368640
    buffer_load_dwordx4 v[124:127], v7, s[28:31], s4 offen sc1
    s_add_u32 s4, s54, 372736
    buffer_load_dwordx4 v[128:131], v7, s[28:31], s4 offen sc1
    s_add_u32 s4, s17, 376832
    buffer_load_dword v132, v7, s[28:31], s4 offen sc1
L_k2_skb_5:
    s_bitcmp1_b32 s6, 6
    s_cbranch_scc0 L_k2_skb_6
    s_add_u32 s4, s54, 442368
    buffer_load_dwordx4 v[136:139], v7, s[28:31], s4 offen sc1
    s_add_u32 s4, s54, 446464
    buffer_load_dwordx4 v[140:143], v7, s[28:31], s4 offen sc1
    s_add_u32 s4, s17, 450560
    buffer_load_dword v144, v7, s[28:31], s4 offen sc1
L_k2_skb_6:
    s_bitcmp1_b32 s6, 7
    s_cbranch_scc0 L_k2_skb_7
    s_add_u32 s4, s54, 516096
    buffer_load_dwordx4 v[148:151], v7, s[28:31], s4 offen sc1
    s_add_u32 s4, s54, 520192
    buffer_load_dwordx4 v[152:155], v7, s[28:31], s4 offen sc1
    s_add_u32 s4, s17, 524288
    buffer_load_dword v156, v7, s[28:31], s4 offen sc1
L_k2_skb_7:
    s_add_u32 s3, s3, 1
    s_cmp_lt_u32 s3, 0x40000
    s_cbranch_scc1 L_k2_sloop
L_k2_sall:
    s_waitcnt vmcnt(0)
    v_lshlrev_b32 v160, 16, v72
    v_and_b32 v161, 0xffff0000, v72
    v_lshlrev_b32 v184, 16, v84
    v_and_b32 v185, 0xffff0000, v84
    v_pk_add_f32 v[160:161], v[160:161], v[184:185]
    v_lshlrev_b32 v184, 16, v96
    v_and_b32 v185, 0xffff0000, v96
    v_pk_add_f32 v[160:161], v[160:161], v[184:185]
    v_lshlrev_b32 v184, 16, v108
    v_and_b32 v185, 0xffff0000, v108
    v_pk_add_f32 v[160:161], v[160:161], v[184:185]
    v_lshlrev_b32 v168, 16, v120
    v_and_b32 v169, 0xffff0000, v120
    v_lshlrev_b32 v184, 16, v132
    v_and_b32 v185, 0xffff0000, v132
    v_pk_add_f32 v[168:169], v[168:169], v[184:185]
    v_lshlrev_b32 v184, 16, v144
    v_and_b32 v185, 0xffff0000, v144
    v_pk_add_f32 v[168:169], v[168:169], v[184:185]
    v_lshlrev_b32 v184, 16, v156
    v_and_b32 v185, 0xffff0000, v156
    v_pk_add_f32 v[168:169], v[168:169], v[184:185]
    v_mul_f32 v184, 0xbfb8aa3b, v168
    v_mul_f32 v185, 0xbfb8aa3b, v169
    v_exp_f32 v184, v184
    v_exp_f32 v185, v185
    s_nop 0
    v_add_f32 v184, 1.0, v184
    v_add_f32 v185, 1.0, v185
    v_rcp_f32 v184, v184
    v_rcp_f32 v185, v185
    s_nop 0
    v_pk_mul_f32 v[168:169], v[168:169], v[184:185]
    v_pk_fma_f32 v[240:241], v[160:161], v[168:169], v[240:241]
    v_cvt_pk_bf16_f32 v48, v240, v241
    buffer_store_dword v48, v2, s[24:27], s16 offen
    v_lshlrev_b32 v160, 16, v64
    v_and_b32 v161, 0xffff0000, v64
    v_lshlrev_b32 v162, 16, v65
    v_and_b32 v163, 0xffff0000, v65
    v_lshlrev_b32 v164, 16, v66
    v_and_b32 v165, 0xffff0000, v66
    v_lshlrev_b32 v166, 16, v67
    v_and_b32 v167, 0xffff0000, v67
    v_lshlrev_b32 v184, 16, v76
    v_and_b32 v185, 0xffff0000, v76
    v_lshlrev_b32 v186, 16, v77
    v_and_b32 v187, 0xffff0000, v77
    v_lshlrev_b32 v188, 16, v78
    v_and_b32 v189, 0xffff0000, v78
    v_lshlrev_b32 v190, 16, v79
    v_and_b32 v191, 0xffff0000, v79
    v_pk_add_f32 v[160:161], v[160:161], v[184:185]
    v_pk_add_f32 v[162:163], v[162:163], v[186:187]
    v_pk_add_f32 v[164:165], v[164:165], v[188:189]
    v_pk_add_f32 v[166:167], v[166:167], v[190:191]
    v_lshlrev_b32 v184, 16, v88
    v_and_b32 v185, 0xffff0000, v88
    v_lshlrev_b32 v186, 16, v89
    v_and_b32 v187, 0xffff0000, v89
    v_lshlrev_b32 v188, 16, v90
    v_and_b32 v189, 0xffff0000, v90
    v_lshlrev_b32 v190, 16, v91
    v_and_b32 v191, 0xffff0000, v91
    v_pk_add_f32 v[160:161], v[160:161], v[184:185]
    v_pk_add_f32 v[162:163], v[162:163], v[186:187]
    v_pk_add_f32 v[164:165], v[164:165], v[188:189]
    v_pk_add_f32 v[166:167], v[166:167], v[190:191]
    v_lshlrev_b32 v184, 16, v100
    v_and_b32 v185, 0xffff0000, v100
    v_lshlrev_b32 v186, 16, v101
    v_and_b32 v187, 0xffff0000, v101
    v_lshlrev_b32 v188, 16, v102
    v_and_b32 v189, 0xffff0000, v102
    v_lshlrev_b32 v190, 16, v103
    v_and_b32 v191, 0xffff0000, v103
    v_pk_add_f32 v[160:161], v[160:161], v[184:185]
    v_pk_add_f32 v[162:163], v[162:163], v[186:187]
    v_pk_add_f32 v[164:165], v[164:165], v[188:189]
    v_pk_add_f32 v[166:167], v[166:167], v[190:191]
    v_lshlrev_b32 v168, 16, v112
    v_and_b32 v169, 0xffff0000, v112
    v_lshlrev_b32 v170, 16, v113
    v_and_b32 v171, 0xffff0000, v113
    v_lshlrev_b32 v172, 16, v114
    v_and_b32 v173, 0xffff0000, v114
    v_lshlrev_b32 v174, 16, v115
    v_and_b32 v175, 0xffff0000, v115
    v_lshlrev_b32 v184, 16, v124
    v_and_b32 v185, 0xffff0000, v124
    v_lshlrev_b32 v186, 16, v125
    v_and_b32 v187, 0xffff0000, v125
    v_lshlrev_b32 v188, 16, v126
    v_and_b32 v189, 0xffff0000, v126
    v_lshlrev_b32 v190, 16, v127
    v_and_b32 v191, 0xffff0000, v127
    v_pk_add_f32 v[168:169], v[168:169], v[184:185]
    v_pk_add_f32 v[170:171], v[170:171], v[186:187]
    v_pk_add_f32 v[172:173], v[172:173], v[188:189]
    v_pk_add_f32 v[174:175], v[174:175], v[190:191]
    v_lshlrev_b32 v184, 16, v136
    v_and_b32 v185, 0xffff0000, v136
    v_lshlrev_b32 v186, 16, v137
    v_and_b32 v187, 0xffff0000, v137
    v_lshlrev_b32 v188, 16, v138
    v_and_b32 v189, 0xffff0000, v138
    v_lshlrev_b32 v190, 16, v139
    v_and_b32 v191, 0xffff0000, v139
    v_pk_add_f32 v[168:169], v[168:169], v[184:185]
    v_pk_add_f32 v[170:171], v[170:171], v[186:187]
    v_pk_add_f32 v[172:173], v[172:173], v[188:189]
    v_pk_add_f32 v[174:175], v[174:175], v[190:191]
    v_lshlrev_b32 v184, 16, v148
    v_and_b32 v185, 0xffff0000, v148
    v_lshlrev_b32 v186, 16, v149
    v_and_b32 v187, 0xffff0000, v149
    v_lshlrev_b32 v188, 16, v150
    v_and_b32 v189, 0xffff0000, v150
    v_lshlrev_b32 v190, 16, v151
    v_and_b32 v191, 0xffff0000, v151
    v_pk_add_f32 v[168:169], v[168:169], v[184:185]
    v_pk_add_f32 v[170:171], v[170:171], v[186:187]
    v_pk_add_f32 v[172:173], v[172:173], v[188:189]
    v_pk_add_f32 v[174:175], v[174:175], v[190:191]
    v_mul_f32 v184, 0xbfb8aa3b, v168
    v_mul_f32 v185, 0xbfb8aa3b, v169
    v_mul_f32 v186, 0xbfb8aa3b, v170
    v_mul_f32 v187, 0xbfb8aa3b, v171
    v_mul_f32 v188, 0xbfb8aa3b, v172
    v_mul_f32 v189, 0xbfb8aa3b, v173
    v_mul_f32 v190, 0xbfb8aa3b, v174
    v_mul_f32 v191, 0xbfb8aa3b, v175
    v_exp_f32 v184, v184
    v_exp_f32 v185, v185
    v_exp_f32 v186, v186
    v_exp_f32 v187, v187
    v_exp_f32 v188, v188
    v_exp_f32 v189, v189
    v_exp_f32 v190, v190
    v_exp_f32 v191, v191
    v_add_f32 v184, 1.0, v184
    v_add_f32 v185, 1.0, v185
    v_add_f32 v186, 1.0, v186
    v_add_f32 v187, 1.0, v187
    v_add_f32 v188, 1.0, v188
    v_add_f32 v189, 1.0, v189
    v_add_f32 v190, 1.0, v190
    v_add_f32 v191, 1.0, v191
    v_rcp_f32 v184, v184
    v_rcp_f32 v185, v185
    v_rcp_f32 v186, v186
    v_rcp_f32 v187, v187
    v_rcp_f32 v188, v188
    v_rcp_f32 v189, v189
    v_rcp_f32 v190, v190
    v_rcp_f32 v191, v191
    v_pk_mul_f32 v[168:169], v[168:169], v[184:185]
    v_pk_mul_f32 v[170:171], v[170:171], v[186:187]
    v_pk_mul_f32 v[172:173], v[172:173], v[188:189]
    v_pk_mul_f32 v[174:175], v[174:175], v[190:191]
    v_pk_fma_f32 v[224:225], v[160:161], v[168:169], v[224:225]
    v_pk_fma_f32 v[226:227], v[162:163], v[170:171], v[226:227]
    v_pk_fma_f32 v[228:229], v[164:165], v[172:173], v[228:229]
    v_pk_fma_f32 v[230:231], v[166:167], v[174:175], v[230:231]
    v_cvt_pk_bf16_f32 v40, v224, v225
    v_cvt_pk_bf16_f32 v41, v226, v227
    v_cvt_pk_bf16_f32 v42, v228, v229
    v_cvt_pk_bf16_f32 v43, v230, v231
    buffer_store_dwordx2 v[40:41], v2, s[24:27], 0 offen offset:0
    buffer_store_dwordx2 v[42:43], v3, s[24:27], 0 offen offset:0
    v_lshlrev_b32 v160, 16, v68
    v_and_b32 v161, 0xffff0000, v68
    v_lshlrev_b32 v162, 16, v69
    v_and_b32 v163, 0xffff0000, v69
    v_lshlrev_b32 v164, 16, v70
    v_and_b32 v165, 0xffff0000, v70
    v_lshlrev_b32 v166, 16, v71
    v_and_b32 v167, 0xffff0000, v71
    v_lshlrev_b32 v184, 16, v80
    v_and_b32 v185, 0xffff0000, v80
    v_lshlrev_b32 v186, 16, v81
    v_and_b32 v187, 0xffff0000, v81
    v_lshlrev_b32 v188, 16, v82
    v_and_b32 v189, 0xffff0000, v82
    v_lshlrev_b32 v190, 16, v83
    v_and_b32 v191, 0xffff0000, v83
    v_pk_add_f32 v[160:161], v[160:161], v[184:185]
    v_pk_add_f32 v[162:163], v[162:163], v[186:187]
    v_pk_add_f32 v[164:165], v[164:165], v[188:189]
    v_pk_add_f32 v[166:167], v[166:167], v[190:191]
    v_lshlrev_b32 v184, 16, v92
    v_and_b32 v185, 0xffff0000, v92
    v_lshlrev_b32 v186, 16, v93
    v_and_b32 v187, 0xffff0000, v93
    v_lshlrev_b32 v188, 16, v94
    v_and_b32 v189, 0xffff0000, v94
    v_lshlrev_b32 v190, 16, v95
    v_and_b32 v191, 0xffff0000, v95
    v_pk_add_f32 v[160:161], v[160:161], v[184:185]
    v_pk_add_f32 v[162:163], v[162:163], v[186:187]
    v_pk_add_f32 v[164:165], v[164:165], v[188:189]
    v_pk_add_f32 v[166:167], v[166:167], v[190:191]
    v_lshlrev_b32 v184, 16, v104
    v_and_b32 v185, 0xffff0000, v104
    v_lshlrev_b32 v186, 16, v105
    v_and_b32 v187, 0xffff0000, v105
    v_lshlrev_b32 v188, 16, v106
    v_and_b32 v189, 0xffff0000, v106
    v_lshlrev_b32 v190, 16, v107
    v_and_b32 v191, 0xffff0000, v107
    v_pk_add_f32 v[160:161], v[160:161], v[184:185]
    v_pk_add_f32 v[162:163], v[162:163], v[186:187]
    v_pk_add_f32 v[164:165], v[164:165], v[188:189]
    v_pk_add_f32 v[166:167], v[166:167], v[190:191]
    v_lshlrev_b32 v168, 16, v116
    v_and_b32 v169, 0xffff0000, v116
    v_lshlrev_b32 v170, 16, v117
    v_and_b32 v171, 0xffff0000, v117
    v_lshlrev_b32 v172, 16, v118
    v_and_b32 v173, 0xffff0000, v118
    v_lshlrev_b32 v174, 16, v119
    v_and_b32 v175, 0xffff0000, v119
    v_lshlrev_b32 v184, 16, v128
    v_and_b32 v185, 0xffff0000, v128
    v_lshlrev_b32 v186, 16, v129
    v_and_b32 v187, 0xffff0000, v129
    v_lshlrev_b32 v188, 16, v130
    v_and_b32 v189, 0xffff0000, v130
    v_lshlrev_b32 v190, 16, v131
    v_and_b32 v191, 0xffff0000, v131
    v_pk_add_f32 v[168:169], v[168:169], v[184:185]
    v_pk_add_f32 v[170:171], v[170:171], v[186:187]
    v_pk_add_f32 v[172:173], v[172:173], v[188:189]
    v_pk_add_f32 v[174:175], v[174:175], v[190:191]
    v_lshlrev_b32 v184, 16, v140
    v_and_b32 v185, 0xffff0000, v140
    v_lshlrev_b32 v186, 16, v141
    v_and_b32 v187, 0xffff0000, v141
    v_lshlrev_b32 v188, 16, v142
    v_and_b32 v189, 0xffff0000, v142
    v_lshlrev_b32 v190, 16, v143
    v_and_b32 v191, 0xffff0000, v143
    v_pk_add_f32 v[168:169], v[168:169], v[184:185]
    v_pk_add_f32 v[170:171], v[170:171], v[186:187]
    v_pk_add_f32 v[172:173], v[172:173], v[188:189]
    v_pk_add_f32 v[174:175], v[174:175], v[190:191]
    v_lshlrev_b32 v184, 16, v152
    v_and_b32 v185, 0xffff0000, v152
    v_lshlrev_b32 v186, 16, v153
    v_and_b32 v187, 0xffff0000, v153
    v_lshlrev_b32 v188, 16, v154
    v_and_b32 v189, 0xffff0000, v154
    v_lshlrev_b32 v190, 16, v155
    v_and_b32 v191, 0xffff0000, v155
    v_pk_add_f32 v[168:169], v[168:169], v[184:185]
    v_pk_add_f32 v[170:171], v[170:171], v[186:187]
    v_pk_add_f32 v[172:173], v[172:173], v[188:189]
    v_pk_add_f32 v[174:175], v[174:175], v[190:191]
    v_mul_f32 v184, 0xbfb8aa3b, v168
    v_mul_f32 v185, 0xbfb8aa3b, v169
    v_mul_f32 v186, 0xbfb8aa3b, v170
    v_mul_f32 v187, 0xbfb8aa3b, v171
    v_mul_f32 v188, 0xbfb8aa3b, v172
    v_mul_f32 v189, 0xbfb8aa3b, v173
    v_mul_f32 v190, 0xbfb8aa3b, v174
    v_mul_f32 v191, 0xbfb8aa3b, v175
    v_exp_f32 v184, v184
    v_exp_f32 v185, v185
    v_exp_f32 v186, v186
    v_exp_f32 v187, v187
    v_exp_f32 v188, v188
    v_exp_f32 v189, v189
    v_exp_f32 v190, v190
    v_exp_f32 v191, v191
    v_add_f32 v184, 1.0, v184
    v_add_f32 v185, 1.0, v185
    v_add_f32 v186, 1.0, v186
    v_add_f32 v187, 1.0, v187
    v_add_f32 v188, 1.0, v188
    v_add_f32 v189, 1.0, v189
    v_add_f32 v190, 1.0, v190
    v_add_f32 v191, 1.0, v191
    v_rcp_f32 v184, v184
    v_rcp_f32 v185, v185
    v_rcp_f32 v186, v186
    v_rcp_f32 v187, v187
    v_rcp_f32 v188, v188
    v_rcp_f32 v189, v189
    v_rcp_f32 v190, v190
    v_rcp_f32 v191, v191
    v_pk_mul_f32 v[168:169], v[168:169], v[184:185]
    v_pk_mul_f32 v[170:171], v[170:171], v[186:187]
    v_pk_mul_f32 v[172:173], v[172:173], v[188:189]
    v_pk_mul_f32 v[174:175], v[174:175], v[190:191]
    v_pk_fma_f32 v[232:233], v[160:161], v[168:169], v[232:233]
    v_pk_fma_f32 v[234:235], v[162:163], v[170:171], v[234:235]
    v_pk_fma_f32 v[236:237], v[164:165], v[172:173], v[236:237]
    v_pk_fma_f32 v[238:239], v[166:167], v[174:175], v[238:239]
    v_cvt_pk_bf16_f32 v44, v232, v233
    v_cvt_pk_bf16_f32 v45, v234, v235
    v_cvt_pk_bf16_f32 v46, v236, v237
    v_cvt_pk_bf16_f32 v47, v238, v239
    buffer_store_dwordx2 v[44:45], v2, s[24:27], 0 offen offset:128
    buffer_store_dwordx2 v[46:47], v3, s[24:27], 0 offen offset:128
L_k2_fin_done:
L_k2_done:
    s_endpgm
L_k2_fallback:
    v_and_b32 v28, 15, v1
    v_lshrrev_b32 v29, 4, v1
    v_lshlrev_b32 v30, 1, v28
    v_lshl_add_u32 v30, v29, 10, v30
    v_add_u32 v31, 0x1000, v30
    v_lshlrev_b32 v28, 8, v28
    v_lshl_add_u32 v28, v29, 4, v28
    v_add_u32 v29, 0x1000, v28
    v_mov_b32 v224, 0xff800000
    v_mov_b32 v226, 0xff800000
    v_mov_b32 v228, 0xff800000
    v_mov_b32 v230, 0xff800000
    s_mov_b32 s3, 0
L_k2_fb1:
    buffer_load_dwordx4 a[128:131], v28, s[28:31], s3 offen offset:0
    buffer_load_dwordx4 a[132:135], v28, s[28:31], s3 offen offset:64
    buffer_load_dwordx4 a[136:139], v28, s[28:31], s3 offen offset:128
    buffer_load_dwordx4 a[140:143], v28, s[28:31], s3 offen offset:192
    buffer_load_dwordx4 a[144:147], v29, s[28:31], s3 offen offset:0
    buffer_load_dwordx4 a[148:151], v29, s[28:31], s3 offen offset:64
    buffer_load_dwordx4 a[152:155], v29, s[28:31], s3 offen offset:128
    buffer_load_dwordx4 a[156:159], v29, s[28:31], s3 offen offset:192
    s_waitcnt vmcnt(0)
    v_mfma_f32_16x16x32_bf16 v[192:195], a[128:131], v[64:67], 0
    v_mfma_f32_16x16x32_bf16 v[192:195], a[132:135], v[68:71], v[192:195]
    v_mfma_f32_16x16x32_bf16 v[192:195], a[136:139], v[72:75], v[192:195]
    v_mfma_f32_16x16x32_bf16 v[192:195], a[140:143], v[76:79], v[192:195]
    v_mfma_f32_16x16x32_bf16 v[196:199], a[128:131], v[80:83], 0
    v_mfma_f32_16x16x32_bf16 v[196:199], a[132:135], v[84:87], v[196:199]
    v_mfma_f32_16x16x32_bf16 v[196:199], a[136:139], v[88:91], v[196:199]
    v_mfma_f32_16x16x32_bf16 v[196:199], a[140:143], v[92:95], v[196:199]
    v_mfma_f32_16x16x32_bf16 v[200:203], a[128:131], v[96:99], 0
    v_mfma_f32_16x16x32_bf16 v[200:203], a[132:135], v[100:103], v[200:203]
    v_mfma_f32_16x16x32_bf16 v[200:203], a[136:139], v[104:107], v[200:203]
    v_mfma_f32_16x16x32_bf16 v[200:203], a[140:143], v[108:111], v[200:203]
    v_mfma_f32_16x16x32_bf16 v[204:207], a[128:131], v[112:115], 0
    v_mfma_f32_16x16x32_bf16 v[204:207], a[132:135], v[116:119], v[204:207]
    v_mfma_f32_16x16x32_bf16 v[204:207], a[136:139], v[120:123], v[204:207]
    v_mfma_f32_16x16x32_bf16 v[204:207], a[140:143], v[124:127], v[204:207]
    v_mfma_f32_16x16x32_bf16 v[208:211], a[144:147], v[64:67], 0
    v_mfma_f32_16x16x32_bf16 v[208:211], a[148:151], v[68:71], v[208:211]
    v_mfma_f32_16x16x32_bf16 v[208:211], a[152:155], v[72:75], v[208:211]
    v_mfma_f32_16x16x32_bf16 v[208:211], a[156:159], v[76:79], v[208:211]
    v_mfma_f32_16x16x32_bf16 v[212:215], a[144:147], v[80:83], 0
    v_mfma_f32_16x16x32_bf16 v[212:215], a[148:151], v[84:87], v[212:215]
    v_mfma_f32_16x16x32_bf16 v[212:215], a[152:155], v[88:91], v[212:215]
    v_mfma_f32_16x16x32_bf16 v[212:215], a[156:159], v[92:95], v[212:215]
    v_mfma_f32_16x16x32_bf16 v[216:219], a[144:147], v[96:99], 0
    v_mfma_f32_16x16x32_bf16 v[216:219], a[148:151], v[100:103], v[216:219]
    v_mfma_f32_16x16x32_bf16 v[216:219], a[152:155], v[104:107], v[216:219]
    v_mfma_f32_16x16x32_bf16 v[216:219], a[156:159], v[108:111], v[216:219]
    v_mfma_f32_16x16x32_bf16 v[220:223], a[144:147], v[112:115], 0
    v_mfma_f32_16x16x32_bf16 v[220:223], a[148:151], v[116:119], v[220:223]
    v_mfma_f32_16x16x32_bf16 v[220:223], a[152:155], v[120:123], v[220:223]
    v_mfma_f32_16x16x32_bf16 v[220:223], a[156:159], v[124:127], v[220:223]
    s_nop 7
    v_max3_f32 v224, v224, v192, v193
    v_max3_f32 v224, v224, v194, v195
    v_max3_f32 v224, v224, v208, v209
    v_max3_f32 v224, v224, v210, v211
    v_max3_f32 v226, v226, v196, v197
    v_max3_f32 v226, v226, v198, v199
    v_max3_f32 v226, v226, v212, v213
    v_max3_f32 v226, v226, v214, v215
    v_max3_f32 v228, v228, v200, v201
    v_max3_f32 v228, v228, v202, v203
    v_max3_f32 v228, v228, v216, v217
    v_max3_f32 v228, v228, v218, v219
    v_max3_f32 v230, v230, v204, v205
    v_max3_f32 v230, v230, v206, v207
    v_max3_f32 v230, v230, v220, v221
    v_max3_f32 v230, v230, v222, v223
    s_add_u32 s3, s3, 8192
    s_cmp_lt_u32 s3, 524288
    s_cbranch_scc1 L_k2_fb1
    v_mov_b32 v225, v224
    v_mov_b32 v227, v226
    v_mov_b32 v229, v228
    v_mov_b32 v231, v230
    s_nop 1
    v_permlane16_swap_b32 v224, v225
    v_permlane16_swap_b32 v226, v227
    v_permlane16_swap_b32 v228, v229
    v_permlane16_swap_b32 v230, v231
    s_nop 1
    v_max_f32 v224, v224, v225
    v_max_f32 v226, v226, v227
    v_max_f32 v228, v228, v229
    v_max_f32 v230, v230, v231
    v_mov_b32 v225, v224
    v_mov_b32 v227, v226
    v_mov_b32 v229, v228
    v_mov_b32 v231, v230
    s_nop 1
    v_permlane32_swap_b32 v224, v225
    v_permlane32_swap_b32 v226, v227
    v_permlane32_swap_b32 v228, v229
    v_permlane32_swap_b32 v230, v231
    s_nop 1
    v_max_f32 v224, v224, v225
    v_max_f32 v226, v226, v227
    v_max_f32 v228, v228, v229
    v_max_f32 v230, v230, v231
    v_sub_f32 v36, 0, v224
    v_sub_f32 v37, 0, v224
    v_sub_f32 v38, 0, v224
    v_sub_f32 v39, 0, v224
    v_sub_f32 v40, 0, v226
    v_sub_f32 v41, 0, v226
    v_sub_f32 v42, 0, v226
    v_sub_f32 v43, 0, v226
    v_sub_f32 v44, 0, v228
    v_sub_f32 v45, 0, v228
    v_sub_f32 v46, 0, v228
    v_sub_f32 v47, 0, v228
    v_sub_f32 v48, 0, v230
    v_sub_f32 v49, 0, v230
    v_sub_f32 v50, 0, v230
    v_sub_f32 v51, 0, v230
    v_accvgpr_write_b32 a0, 0
    v_accvgpr_write_b32 a1, 0
    v_accvgpr_write_b32 a2, 0
    v_accvgpr_write_b32 a3, 0
    v_accvgpr_write_b32 a4, 0
    v_accvgpr_write_b32 a5, 0
    v_accvgpr_write_b32 a6, 0
    v_accvgpr_write_b32 a7, 0
    v_accvgpr_write_b32 a8, 0
    v_accvgpr_write_b32 a9, 0
    v_accvgpr_write_b32 a10, 0
    v_accvgpr_write_b32 a11, 0
    v_accvgpr_write_b32 a12, 0
    v_accvgpr_write_b32 a13, 0
    v_accvgpr_write_b32 a14, 0
    v_accvgpr_write_b32 a15, 0
    v_accvgpr_write_b32 a16, 0
    v_accvgpr_write_b32 a17, 0
    v_accvgpr_write_b32 a18, 0
    v_accvgpr_write_b32 a19, 0
    v_accvgpr_write_b32 a20, 0
    v_accvgpr_write_b32 a21, 0
    v_accvgpr_write_b32 a22, 0
    v_accvgpr_write_b32 a23, 0
    v_accvgpr_write_b32 a24, 0
    v_accvgpr_write_b32 a25, 0
    v_accvgpr_write_b32 a26, 0
    v_accvgpr_write_b32 a27, 0
    v_accvgpr_write_b32 a28, 0
    v_accvgpr_write_b32 a29, 0
    v_accvgpr_write_b32 a30, 0
    v_accvgpr_write_b32 a31, 0
    v_accvgpr_write_b32 a32, 0
    v_accvgpr_write_b32 a33, 0
    v_accvgpr_write_b32 a34, 0
    v_accvgpr_write_b32 a35, 0
    v_accvgpr_write_b32 a36, 0
    v_accvgpr_write_b32 a37, 0
    v_accvgpr_write_b32 a38, 0
    v_accvgpr_write_b32 a39, 0
    v_accvgpr_write_b32 a40, 0
    v_accvgpr_write_b32 a41, 0
    v_accvgpr_write_b32 a42, 0
    v_accvgpr_write_b32 a43, 0
    v_accvgpr_write_b32 a44, 0
    v_accvgpr_write_b32 a45, 0
    v_accvgpr_write_b32 a46, 0
    v_accvgpr_write_b32 a47, 0
    v_accvgpr_write_b32 a48, 0
    v_accvgpr_write_b32 a49, 0
    v_accvgpr_write_b32 a50, 0
    v_accvgpr_write_b32 a51, 0
    v_accvgpr_write_b32 a52, 0
    v_accvgpr_write_b32 a53, 0
    v_accvgpr_write_b32 a54, 0
    v_accvgpr_write_b32 a55, 0
    v_accvgpr_write_b32 a56, 0
    v_accvgpr_write_b32 a57, 0
    v_accvgpr_write_b32 a58, 0
    v_accvgpr_write_b32 a59, 0
    v_accvgpr_write_b32 a60, 0
    v_accvgpr_write_b32 a61, 0
    v_accvgpr_write_b32 a62, 0
    v_accvgpr_write_b32 a63, 0
    v_accvgpr_write_b32 a64, 0
    v_accvgpr_write_b32 a65, 0
    v_accvgpr_write_b32 a66, 0
    v_accvgpr_write_b32 a67, 0
    v_accvgpr_write_b32 a68, 0
    v_accvgpr_write_b32 a69, 0
    v_accvgpr_write_b32 a70, 0
    v_accvgpr_write_b32 a71, 0
    v_accvgpr_write_b32 a72, 0
    v_accvgpr_write_b32 a73, 0
    v_accvgpr_write_b32 a74, 0
    v_accvgpr_write_b32 a75, 0
    v_accvgpr_write_b32 a76, 0
    v_accvgpr_write_b32 a77, 0
    v_accvgpr_write_b32 a78, 0
    v_accvgpr_write_b32 a79, 0
    v_accvgpr_write_b32 a80, 0
    v_accvgpr_write_b32 a81, 0
    v_accvgpr_write_b32 a82, 0
    v_accvgpr_write_b32 a83, 0
    v_accvgpr_write_b32 a84, 0
    v_accvgpr_write_b32 a85, 0
    v_accvgpr_write_b32 a86, 0
    v_accvgpr_write_b32 a87, 0
    v_accvgpr_write_b32 a88, 0
    v_accvgpr_write_b32 a89, 0
    v_accvgpr_write_b32 a90, 0
    v_accvgpr_write_b32 a91, 0
    v_accvgpr_write_b32 a92, 0
    v_accvgpr_write_b32 a93, 0
    v_accvgpr_write_b32 a94, 0
    v_accvgpr_write_b32 a95, 0
    v_accvgpr_write_b32 a96, 0
    v_accvgpr_write_b32 a97, 0
    v_accvgpr_write_b32 a98, 0
    v_accvgpr_write_b32 a99, 0
    v_accvgpr_write_b32 a100, 0
    v_accvgpr_write_b32 a101, 0
    v_accvgpr_write_b32 a102, 0
    v_accvgpr_write_b32 a103, 0
    v_accvgpr_write_b32 a104, 0
    v_accvgpr_write_b32 a105, 0
    v_accvgpr_write_b32 a106, 0
    v_accvgpr_write_b32 a107, 0
    v_accvgpr_write_b32 a108, 0
    v_accvgpr_write_b32 a109, 0
    v_accvgpr_write_b32 a110, 0
    v_accvgpr_write_b32 a111, 0
    v_accvgpr_write_b32 a112, 0
    v_accvgpr_write_b32 a113, 0
    v_accvgpr_write_b32 a114, 0
    v_accvgpr_write_b32 a115, 0
    v_accvgpr_write_b32 a116, 0
    v_accvgpr_write_b32 a117, 0
    v_accvgpr_write_b32 a118, 0
    v_accvgpr_write_b32 a119, 0
    v_accvgpr_write_b32 a120, 0
    v_accvgpr_write_b32 a121, 0
    v_accvgpr_write_b32 a122, 0
    v_accvgpr_write_b32 a123, 0
    v_accvgpr_write_b32 a124, 0
    v_accvgpr_write_b32 a125, 0
    v_accvgpr_write_b32 a126, 0
    v_accvgpr_write_b32 a127, 0
    v_mov_b32 v240, 0
    v_mov_b32 v241, 0
    v_mov_b32 v242, 0
    v_mov_b32 v243, 0
    v_mov_b32 v244, 0
    v_mov_b32 v245, 0
    v_mov_b32 v246, 0
    v_mov_b32 v247, 0
    v_mov_b32 v248, 0
    v_mov_b32 v249, 0
    v_mov_b32 v250, 0
    v_mov_b32 v251, 0
    v_mov_b32 v252, 0
    v_mov_b32 v253, 0
    v_mov_b32 v254, 0
    v_mov_b32 v255, 0
    s_mov_b32 s3, 0
L_k2_fb2:
    buffer_load_dwordx4 a[128:131], v28, s[28:31], s3 offen offset:0
    buffer_load_dwordx4 a[132:135], v28, s[28:31], s3 offen offset:64
    buffer_load_dwordx4 a[136:139], v28, s[28:31], s3 offen offset:128
    buffer_load_dwordx4 a[140:143], v28, s[28:31], s3 offen offset:192
    buffer_load_dwordx4 a[144:147], v29, s[28:31], s3 offen offset:0
    buffer_load_dwordx4 a[148:151], v29, s[28:31], s3 offen offset:64
    buffer_load_dwordx4 a[152:155], v29, s[28:31], s3 offen offset:128
    buffer_load_dwordx4 a[156:159], v29, s[28:31], s3 offen offset:192
    buffer_load_ushort v128, v30, s[32:35], s3 offen offset:0
    buffer_load_ushort v129, v30, s[32:35], s3 offen offset:256
    buffer_load_ushort v130, v30, s[32:35], s3 offen offset:512
    buffer_load_ushort v131, v30, s[32:35], s3 offen offset:768
    buffer_load_ushort v132, v31, s[32:35], s3 offen offset:0
    buffer_load_ushort v133, v31, s[32:35], s3 offen offset:256
    buffer_load_ushort v134, v31, s[32:35], s3 offen offset:512
    buffer_load_ushort v135, v31, s[32:35], s3 offen offset:768
    buffer_load_ushort v136, v30, s[32:35], s3 offen offset:32
    buffer_load_ushort v137, v30, s[32:35], s3 offen offset:288
    buffer_load_ushort v138, v30, s[32:35], s3 offen offset:544
    buffer_load_ushort v139, v30, s[32:35], s3 offen offset:800
    buffer_load_ushort v140, v31, s[32:35], s3 offen offset:32
    buffer_load_ushort v141, v31, s[32:35], s3 offen offset:288
    buffer_load_ushort v142, v31, s[32:35], s3 offen offset:544
    buffer_load_ushort v143, v31, s[32:35], s3 offen offset:800
    buffer_load_ushort v144, v30, s[32:35], s3 offen offset:64
    buffer_load_ushort v145, v30, s[32:35], s3 offen offset:320
    buffer_load_ushort v146, v30, s[32:35], s3 offen offset:576
    buffer_load_ushort v147, v30, s[32:35], s3 offen offset:832
    buffer_load_ushort v148, v31, s[32:35], s3 offen offset:64
    buffer_load_ushort v149, v31, s[32:35], s3 offen offset:320
    buffer_load_ushort v150, v31, s[32:35], s3 offen offset:576
    buffer_load_ushort v151, v31, s[32:35], s3 offen offset:832
    buffer_load_ushort v152, v30, s[32:35], s3 offen offset:96
    buffer_load_ushort v153, v30, s[32:35], s3 offen offset:352
    buffer_load_ushort v154, v30, s[32:35], s3 offen offset:608
    buffer_load_ushort v155, v30, s[32:35], s3 offen offset:864
    buffer_load_ushort v156, v31, s[32:35], s3 offen offset:96
    buffer_load_ushort v157, v31, s[32:35], s3 offen offset:352
    buffer_load_ushort v158, v31, s[32:35], s3 offen offset:608
    buffer_load_ushort v159, v31, s[32:35], s3 offen offset:864
    buffer_load_ushort v160, v30, s[32:35], s3 offen offset:128
    buffer_load_ushort v161, v30, s[32:35], s3 offen offset:384
    buffer_load_ushort v162, v30, s[32:35], s3 offen offset:640
    buffer_load_ushort v163, v30, s[32:35], s3 offen offset:896
    buffer_load_ushort v164, v31, s[32:35], s3 offen offset:128
    buffer_load_ushort v165, v31, s[32:35], s3 offen offset:384
    buffer_load_ushort v166, v31, s[32:35], s3 offen offset:640
    buffer_load_ushort v167, v31, s[32:35], s3 offen offset:896
    buffer_load_ushort v168, v30, s[32:35], s3 offen offset:160
    buffer_load_ushort v169, v30, s[32:35], s3 offen offset:416
    buffer_load_ushort v170, v30, s[32:35], s3 offen offset:672
    buffer_load_ushort v171, v30, s[32:35], s3 offen offset:928
    buffer_load_ushort v172, v31, s[32:35], s3 offen offset:160
    buffer_load_ushort v173, v31, s[32:35], s3 offen offset:416
    buffer_load_ushort v174, v31, s[32:35], s3 offen offset:672
    buffer_load_ushort v175, v31, s[32:35], s3 offen offset:928
    buffer_load_ushort v176, v30, s[32:35], s3 offen offset:192
    buffer_load_ushort v177, v30, s[32:35], s3 offen offset:448
    buffer_load_ushort v178, v30, s[32:35], s3 offen offset:704
    buffer_load_ushort v179, v30, s[32:35], s3 offen offset:960
    buffer_load_ushort v180, v31, s[32:35], s3 offen offset:192
    buffer_load_ushort v181, v31, s[32:35], s3 offen offset:448
    buffer_load_ushort v182, v31, s[32:35], s3 offen offset:704
    buffer_load_ushort v183, v31, s[32:35], s3 offen offset:960
    buffer_load_ushort v184, v30, s[32:35], s3 offen offset:224
    buffer_load_ushort v185, v30, s[32:35], s3 offen offset:480
    buffer_load_ushort v186, v30, s[32:35], s3 offen offset:736
    buffer_load_ushort v187, v30, s[32:35], s3 offen offset:992
    buffer_load_ushort v188, v31, s[32:35], s3 offen offset:224
    buffer_load_ushort v189, v31, s[32:35], s3 offen offset:480
    buffer_load_ushort v190, v31, s[32:35], s3 offen offset:736
    buffer_load_ushort v191, v31, s[32:35], s3 offen offset:992
    s_waitcnt vmcnt(0)
    v_mfma_f32_16x16x32_bf16 v[192:195], a[128:131], v[64:67], v[36:39]
    v_mfma_f32_16x16x32_bf16 v[192:195], a[132:135], v[68:71], v[192:195]
    v_mfma_f32_16x16x32_bf16 v[192:195], a[136:139], v[72:75], v[192:195]
    v_mfma_f32_16x16x32_bf16 v[192:195], a[140:143], v[76:79], v[192:195]
    v_mfma_f32_16x16x32_bf16 v[196:199], a[128:131], v[80:83], v[40:43]
    v_mfma_f32_16x16x32_bf16 v[196:199], a[132:135], v[84:87], v[196:199]
    v_mfma_f32_16x16x32_bf16 v[196:199], a[136:139], v[88:91], v[196:199]
    v_mfma_f32_16x16x32_bf16 v[196:199], a[140:143], v[92:95], v[196:199]
    v_mfma_f32_16x16x32_bf16 v[200:203], a[128:131], v[96:99], v[44:47]
    v_mfma_f32_16x16x32_bf16 v[200:203], a[132:135], v[100:103], v[200:203]
    v_mfma_f32_16x16x32_bf16 v[200:203], a[136:139], v[104:107], v[200:203]
    v_mfma_f32_16x16x32_bf16 v[200:203], a[140:143], v[108:111], v[200:203]
    v_mfma_f32_16x16x32_bf16 v[204:207], a[128:131], v[112:115], v[48:51]
    v_mfma_f32_16x16x32_bf16 v[204:207], a[132:135], v[116:119], v[204:207]
    v_mfma_f32_16x16x32_bf16 v[204:207], a[136:139], v[120:123], v[204:207]
    v_mfma_f32_16x16x32_bf16 v[204:207], a[140:143], v[124:127], v[204:207]
    v_mfma_f32_16x16x32_bf16 v[208:211], a[144:147], v[64:67], v[36:39]
    v_mfma_f32_16x16x32_bf16 v[208:211], a[148:151], v[68:71], v[208:211]
    v_mfma_f32_16x16x32_bf16 v[208:211], a[152:155], v[72:75], v[208:211]
    v_mfma_f32_16x16x32_bf16 v[208:211], a[156:159], v[76:79], v[208:211]
    v_mfma_f32_16x16x32_bf16 v[212:215], a[144:147], v[80:83], v[40:43]
    v_mfma_f32_16x16x32_bf16 v[212:215], a[148:151], v[84:87], v[212:215]
    v_mfma_f32_16x16x32_bf16 v[212:215], a[152:155], v[88:91], v[212:215]
    v_mfma_f32_16x16x32_bf16 v[212:215], a[156:159], v[92:95], v[212:215]
    v_mfma_f32_16x16x32_bf16 v[216:219], a[144:147], v[96:99], v[44:47]
    v_mfma_f32_16x16x32_bf16 v[216:219], a[148:151], v[100:103], v[216:219]
    v_mfma_f32_16x16x32_bf16 v[216:219], a[152:155], v[104:107], v[216:219]
    v_mfma_f32_16x16x32_bf16 v[216:219], a[156:159], v[108:111], v[216:219]
    v_mfma_f32_16x16x32_bf16 v[220:223], a[144:147], v[112:115], v[48:51]
    v_mfma_f32_16x16x32_bf16 v[220:223], a[148:151], v[116:119], v[220:223]
    v_mfma_f32_16x16x32_bf16 v[220:223], a[152:155], v[120:123], v[220:223]
    v_mfma_f32_16x16x32_bf16 v[220:223], a[156:159], v[124:127], v[220:223]
    s_nop 7
    v_lshl_or_b32 v128, v129, 16, v128
    v_lshl_or_b32 v129, v131, 16, v130
    v_lshl_or_b32 v130, v133, 16, v132
    v_lshl_or_b32 v131, v135, 16, v134
    v_lshl_or_b32 v132, v137, 16, v136
    v_lshl_or_b32 v133, v139, 16, v138
    v_lshl_or_b32 v134, v141, 16, v140
    v_lshl_or_b32 v135, v143, 16, v142
    v_lshl_or_b32 v136, v145, 16, v144
    v_lshl_or_b32 v137, v147, 16, v146
    v_lshl_or_b32 v138, v149, 16, v148
    v_lshl_or_b32 v139, v151, 16, v150
    v_lshl_or_b32 v140, v153, 16, v152
    v_lshl_or_b32 v141, v155, 16, v154
    v_lshl_or_b32 v142, v157, 16, v156
    v_lshl_or_b32 v143, v159, 16, v158
    v_lshl_or_b32 v144, v161, 16, v160
    v_lshl_or_b32 v145, v163, 16, v162
    v_lshl_or_b32 v146, v165, 16, v164
    v_lshl_or_b32 v147, v167, 16, v166
    v_lshl_or_b32 v148, v169, 16, v168
    v_lshl_or_b32 v149, v171, 16, v170
    v_lshl_or_b32 v150, v173, 16, v172
    v_lshl_or_b32 v151, v175, 16, v174
    v_lshl_or_b32 v152, v177, 16, v176
    v_lshl_or_b32 v153, v179, 16, v178
    v_lshl_or_b32 v154, v181, 16, v180
    v_lshl_or_b32 v155, v183, 16, v182
    v_lshl_or_b32 v156, v185, 16, v184
    v_lshl_or_b32 v157, v187, 16, v186
    v_lshl_or_b32 v158, v189, 16, v188
    v_lshl_or_b32 v159, v191, 16, v190
    v_exp_f32 v192, v192
    v_exp_f32 v193, v193
    v_exp_f32 v194, v194
    v_exp_f32 v195, v195
    v_exp_f32 v196, v196
    v_exp_f32 v197, v197
    v_exp_f32 v198, v198
    v_exp_f32 v199, v199
    v_exp_f32 v200, v200
    v_exp_f32 v201, v201
    v_exp_f32 v202, v202
    v_exp_f32 v203, v203
    v_exp_f32 v204, v204
    v_exp_f32 v205, v205
    v_exp_f32 v206, v206
    v_exp_f32 v207, v207
    v_exp_f32 v208, v208
    v_exp_f32 v209, v209
    v_exp_f32 v210, v210
    v_exp_f32 v211, v211
    v_exp_f32 v212, v212
    v_exp_f32 v213, v213
    v_exp_f32 v214, v214
    v_exp_f32 v215, v215
    v_exp_f32 v216, v216
    v_exp_f32 v217, v217
    v_exp_f32 v218, v218
    v_exp_f32 v219, v219
    v_exp_f32 v220, v220
    v_exp_f32 v221, v221
    v_exp_f32 v222, v222
    v_exp_f32 v223, v223
    s_nop 0
    v_cvt_pk_bf16_f32 v12, v192, v193
    v_cvt_pk_bf16_f32 v13, v194, v195
    v_cvt_pk_bf16_f32 v14, v208, v209
    v_cvt_pk_bf16_f32 v15, v210, v211
    v_cvt_pk_bf16_f32 v16, v196, v197
    v_cvt_pk_bf16_f32 v17, v198, v199
    v_cvt_pk_bf16_f32 v18, v212, v213
    v_cvt_pk_bf16_f32 v19, v214, v215
    v_cvt_pk_bf16_f32 v20, v200, v201
    v_cvt_pk_bf16_f32 v21, v202, v203
    v_cvt_pk_bf16_f32 v22, v216, v217
    v_cvt_pk_bf16_f32 v23, v218, v219
    v_cvt_pk_bf16_f32 v24, v204, v205
    v_cvt_pk_bf16_f32 v25, v206, v207
    v_cvt_pk_bf16_f32 v26, v220, v221
    v_cvt_pk_bf16_f32 v27, v222, v223
    s_nop 1
    v_mfma_f32_16x16x32_bf16 a[0:3], v[128:131], v[12:15], a[0:3]
    v_mfma_f32_16x16x32_bf16 a[4:7], v[128:131], v[16:19], a[4:7]
    v_mfma_f32_16x16x32_bf16 a[8:11], v[128:131], v[20:23], a[8:11]
    v_mfma_f32_16x16x32_bf16 a[12:15], v[128:131], v[24:27], a[12:15]
    v_mfma_f32_16x16x32_bf16 a[16:19], v[132:135], v[12:15], a[16:19]
    v_mfma_f32_16x16x32_bf16 a[20:23], v[132:135], v[16:19], a[20:23]
    v_mfma_f32_16x16x32_bf16 a[24:27], v[132:135], v[20:23], a[24:27]
    v_mfma_f32_16x16x32_bf16 a[28:31], v[132:135], v[24:27], a[28:31]
    v_mfma_f32_16x16x32_bf16 a[32:35], v[136:139], v[12:15], a[32:35]
    v_mfma_f32_16x16x32_bf16 a[36:39], v[136:139], v[16:19], a[36:39]
    v_mfma_f32_16x16x32_bf16 a[40:43], v[136:139], v[20:23], a[40:43]
    v_mfma_f32_16x16x32_bf16 a[44:47], v[136:139], v[24:27], a[44:47]
    v_mfma_f32_16x16x32_bf16 a[48:51], v[140:143], v[12:15], a[48:51]
    v_mfma_f32_16x16x32_bf16 a[52:55], v[140:143], v[16:19], a[52:55]
    v_mfma_f32_16x16x32_bf16 a[56:59], v[140:143], v[20:23], a[56:59]
    v_mfma_f32_16x16x32_bf16 a[60:63], v[140:143], v[24:27], a[60:63]
    v_mfma_f32_16x16x32_bf16 a[64:67], v[144:147], v[12:15], a[64:67]
    v_mfma_f32_16x16x32_bf16 a[68:71], v[144:147], v[16:19], a[68:71]
    v_mfma_f32_16x16x32_bf16 a[72:75], v[144:147], v[20:23], a[72:75]
    v_mfma_f32_16x16x32_bf16 a[76:79], v[144:147], v[24:27], a[76:79]
    v_mfma_f32_16x16x32_bf16 a[80:83], v[148:151], v[12:15], a[80:83]
    v_mfma_f32_16x16x32_bf16 a[84:87], v[148:151], v[16:19], a[84:87]
    v_mfma_f32_16x16x32_bf16 a[88:91], v[148:151], v[20:23], a[88:91]
    v_mfma_f32_16x16x32_bf16 a[92:95], v[148:151], v[24:27], a[92:95]
    v_mfma_f32_16x16x32_bf16 a[96:99], v[152:155], v[12:15], a[96:99]
    v_mfma_f32_16x16x32_bf16 a[100:103], v[152:155], v[16:19], a[100:103]
    v_mfma_f32_16x16x32_bf16 a[104:107], v[152:155], v[20:23], a[104:107]
    v_mfma_f32_16x16x32_bf16 a[108:111], v[152:155], v[24:27], a[108:111]
    v_mfma_f32_16x16x32_bf16 a[112:115], v[156:159], v[12:15], a[112:115]
    v_mfma_f32_16x16x32_bf16 a[116:119], v[156:159], v[16:19], a[116:119]
    v_mfma_f32_16x16x32_bf16 a[120:123], v[156:159], v[20:23], a[120:123]
    v_mfma_f32_16x16x32_bf16 a[124:127], v[156:159], v[24:27], a[124:127]
    v_mfma_f32_16x16x32_bf16 v[240:243], v[32:35], v[12:15], v[240:243]
    v_mfma_f32_16x16x32_bf16 v[244:247], v[32:35], v[16:19], v[244:247]
    v_mfma_f32_16x16x32_bf16 v[248:251], v[32:35], v[20:23], v[248:251]
    v_mfma_f32_16x16x32_bf16 v[252:255], v[32:35], v[24:27], v[252:255]
    s_add_u32 s3, s3, 8192
    s_cmp_lt_u32 s3, 524288
    s_cbranch_scc1 L_k2_fb2
    s_nop 15
    s_branch L_k2_attn_done
.section .rodata,"a"
.p2align 6
.amdhsa_kernel recurrent_scan__mha_block_cached__geglu_ffn__prompt_kernel
  .amdhsa_next_free_vgpr 512
  .amdhsa_next_free_sgpr 102
  .amdhsa_accum_offset 256
  .amdhsa_group_segment_fixed_size 0
  .amdhsa_kernarg_size 96
  .amdhsa_user_sgpr_count 2
  .amdhsa_user_sgpr_kernarg_segment_ptr 1
  .amdhsa_system_sgpr_workgroup_id_x 1
  .amdhsa_float_denorm_mode_32 3
  .amdhsa_float_denorm_mode_16_64 3
.end_amdhsa_kernel
```
